```python
import torch

def _softmax(x, axis=-1):
    return torch.softmax(x, dim=axis)
def _gelu(x):
    return torch.nn.functional.gelu(x, approximate="tanh")
def _silu(x):
    return torch.nn.functional.silu(x)
def _sigmoid(x):
    return torch.sigmoid(x)
def _layernorm(x, axis=-1, eps=1e-5):
    m = x.mean(dim=axis, keepdim=True)
    v = x.var(dim=axis, keepdim=True, unbiased=False)
    return (x - m) / torch.sqrt(v + eps)
def _scatter_add(tgt, idx, src, axis=0):
    return tgt.clone().index_add_(axis, idx, src)
def _segment_sum(src, seg, n):
    out = torch.zeros((n,) + src.shape[1:], dtype=src.dtype)
    return out.index_add_(0, seg, src)
def _pad(x, pw):
    flat = tuple(v for pair in reversed(pw) for v in pair)
    return torch.nn.functional.pad(x, flat)

kernel_name = 'parallel_sum__ssm_conv_s5__glu_gated_swiglu__prompt'

def setup_inputs():

    _w = (lambda a: (lambda t: t.to(torch.bfloat16) if t.is_floating_point() else t)(torch.as_tensor(a)))
    def _A_setup():
        B, S, D = 1, 2048, 576
        P = D
        Lambda_re = -0.5 * (lambda _x: torch.exp(torch.as_tensor(_x)))((lambda *s: torch.randn(*s, dtype=torch.bfloat16) * 0.2)(P))
        Lambda_im = (lambda *s: torch.randn(*s, dtype=torch.bfloat16) * 0.8)(P) * 1.0
        B_re = (lambda *s: torch.randn(*s, dtype=torch.bfloat16) * 0.2)(P, D) * (D ** -0.5)
        B_im = (lambda *s: torch.randn(*s, dtype=torch.bfloat16) * 0.2)(P, D) * (D ** -0.5)
        C_re = (lambda *s: torch.randn(*s, dtype=torch.bfloat16) * 0.2)(D, P) * (P ** -0.5)
        C_im = (lambda *s: torch.randn(*s, dtype=torch.bfloat16) * 0.2)(D, P) * (P ** -0.5)
        log_dt = (lambda *s: torch.randn(*s, dtype=torch.bfloat16) * 0.2)(P) * 0.3 - 2.0
        Dskip = (lambda *s: torch.randn(*s, dtype=torch.bfloat16) * 0.05)(D)
        return {
            "x": _w((lambda *s: torch.randn(*s, dtype=torch.bfloat16) * 0.05)(B, S, D)),
            "Lambda_re": _w(Lambda_re),
            "Lambda_im": _w(Lambda_im),
            "B_re": _w(B_re),
            "B_im": _w(B_im),
            "C_re": _w(C_re),
            "C_im": _w(C_im),
            "log_dt": _w(log_dt),
            "Dskip": _w(Dskip),
        }
    _A_in = _A_setup()

    def _B_setup():
        B, S, D, F = 1, 2048, 576, 4608
        return {
            "x": _w((lambda *s: torch.randn(*s, dtype=torch.bfloat16) * 0.05)(B, S, D)),
            "w1": _w((lambda *s: torch.randn(*s, dtype=torch.bfloat16) * 0.4)(D, F) * (2.0 / D) ** 0.5),
            "w3": _w((lambda *s: torch.randn(*s, dtype=torch.bfloat16) * 0.4)(D, F) * (2.0 / D) ** 0.5),
            "w2": _w((lambda *s: torch.randn(*s, dtype=torch.bfloat16) * 0.4)(F, D) * (2.0 / F) ** 0.5),
        }
    _B_in = _B_setup()

    return {
        "A_x": _A_in["x"],
        "A_Lambda_re": _A_in["Lambda_re"],
        "A_Lambda_im": _A_in["Lambda_im"],
        "A_B_re": _A_in["B_re"],
        "A_B_im": _A_in["B_im"],
        "A_C_re": _A_in["C_re"],
        "A_C_im": _A_in["C_im"],
        "A_log_dt": _A_in["log_dt"],
        "A_Dskip": _A_in["Dskip"],
        "B_x": _B_in["x"],
        "B_w1": _B_in["w1"],
        "B_w3": _B_in["w3"],
        "B_w2": _B_in["w2"],
    }

def reference(A_x, A_Lambda_re, A_Lambda_im, A_B_re, A_B_im, A_C_re, A_C_im, A_log_dt, A_Dskip, B_x, B_w1, B_w3, B_w2):
    def _A_ref(x, Lambda_re, Lambda_im, B_re, B_im, C_re, C_im, log_dt, Dskip):
        Bsz, L, H = x.shape
        Lam = Lambda_re + 1j * Lambda_im
        Bmat = B_re + 1j * B_im
        Cmat = C_re + 1j * C_im
        dt = torch.exp(log_dt)
        Lam_bar = torch.exp(dt * Lam)
        B_bar = ((Lam_bar - 1.0) / Lam)[:, None] * Bmat
        Bu = torch.einsum("bld,pd->blp", x + 0j, B_bar)
        h = torch.zeros_like(Bu[:, 0, :])
        hs = []
        for t in range(L):
            h = Lam_bar[None, :] * h + Bu[:, t, :]
            hs.append(h)
        hseq = torch.stack(hs, 1)
        y = 2.0 * torch.einsum("blp,dp->bld", hseq, Cmat).real + x * Dskip[None, None, :]
        return y

    def _B_ref(x, w1, w3, w2):
        gate = torch.einsum("bsd,df->bsf", x, w1)
        up = torch.einsum("bsd,df->bsf", x, w3)
        h = _silu(gate) * up
        out = torch.einsum("bsf,fd->bsd", h, w2)
        return out

    x = A_x
    xn = _layernorm(x, axis=-1)
    return x + _A_ref(xn, A_Lambda_re, A_Lambda_im, A_B_re, A_B_im, A_C_re, A_C_im, A_log_dt, A_Dskip) + _B_ref(xn, B_w1, B_w3, B_w2)
```

```asm
; @launch grid=(256,1,1) block=(256,1,1) lds=163840
.amdgcn_target "amdgcn-amd-amdhsa--gfx950"
.text

.macro MA d, a, b
v_mfma_f32_16x16x32_bf16 v[\d:\d+3], v[\a:\a+3], a[\b:\b+3], v[\d:\d+3]
.endm
.macro TR d, v, o
ds_read_b64_tr_b16 v[\d:\d+1], v\v offset:\o
.endm
.globl parallel_sum__ssm_conv_s5__glu_gated_swiglu__prompt_kernel
.p2align 8
.type parallel_sum__ssm_conv_s5__glu_gated_swiglu__prompt_kernel,@function
parallel_sum__ssm_conv_s5__glu_gated_swiglu__prompt_kernel:
L_code_begin:
s_cmp_ge_u32 s2, 256
s_cbranch_scc1 L_k1_end
s_load_dwordx4 s[56:59], s[0:1], 80
s_load_dwordx2 s[60:61], s[0:1], 96
s_load_dwordx2 s[62:63], s[0:1], 120
s_load_dwordx4 s[64:67], s[0:1], 24
s_load_dwordx4 s[72:75], s[0:1], 40
s_load_dwordx4 s[84:87], s[0:1], 8
s_load_dwordx2 s[88:89], s[0:1], 56
s_load_dwordx2 s[68:69], s[0:1], 0
s_load_dwordx2 s[70:71], s[0:1], 112
v_lshrrev_b32 v88, 6, v0
v_and_b32 v89, 63, v0
v_readfirstlane_b32 s40, v88
v_lshlrev_b32 v1, 4, v89
s_lshr_b32 s41, s2, 4
s_and_b32 s42, s2, 15
s_lshl_b32 s43, s40, 10
s_and_b32 s80, s40, 2
s_mul_i32 s46, s41, 147456
s_add_u32 s46, s46, s43
s_lshl_b32 s82, s41, 4
s_add_u32 s82, s82, s42
s_mul_i32 s49, s82, 147456
s_add_u32 s49, s49, 0x300000
v_lshrrev_b32 v88, 3, v89
s_lshl_b32 s82, s40, 3
v_add_u32 v88, s82, v88
v_mul_u32_u24 v2, 9216, v88
v_mul_u32_u24 v3, 1152, v88
v_bfe_u32 v88, v89, 4, 1
s_and_b32 s82, s40, 1
s_lshl_b32 s82, s82, 1
v_or_b32 v88, s82, v88
v_lshlrev_b32 v88, 1, v88
v_and_b32 v90, 7, v89
v_xor_b32 v88, v88, v90
v_lshl_add_u32 v2, v88, 4, v2
v_lshrrev_b32 v88, 4, v89
v_lshlrev_b32 v88, 1, v88
v_xor_b32 v88, v88, v90
v_lshl_add_u32 v3, v88, 4, v3
s_lshl_b32 s82, s41, 7
s_lshr_b32 s83, s42, 3
s_lshl_b32 s83, s83, 6
s_add_u32 s82, s82, s83
s_and_b32 s83, s42, 1
s_lshl_b32 s83, s83, 5
s_add_u32 s82, s82, s83
s_bfe_u32 s83, s42, 0x20001
s_lshl_b32 s83, s83, 2
s_add_u32 s82, s82, s83
v_lshrrev_b32 v97, 7, v0
v_bfe_u32 v98, v0, 5, 2
v_lshl_add_u32 v97, v97, 4, v98
v_add_u32 v97, s82, v97
v_and_b32 v98, 31, v0
v_mul_u32_u24 v99, 1152, v97
v_lshl_add_u32 v99, v98, 2, v99
s_waitcnt lgkmcnt(0)
s_mov_b32 s92, s68
s_mov_b32 s93, s69
s_mov_b32 s94, 0x240000
s_mov_b32 s95, 0x20000
buffer_load_dword v106, v99, s[92:95], 0 offen offset:0
buffer_load_dword v107, v99, s[92:95], 0 offen offset:128
buffer_load_dword v108, v99, s[92:95], 0 offen offset:256
buffer_load_dword v109, v99, s[92:95], 0 offen offset:384
buffer_load_dword v110, v99, s[92:95], 0 offen offset:512
buffer_load_dword v111, v99, s[92:95], 0 offen offset:640
buffer_load_dword v112, v99, s[92:95], 0 offen offset:768
buffer_load_dword v113, v99, s[92:95], 0 offen offset:896
buffer_load_dword v114, v99, s[92:95], 0 offen offset:1024
s_mov_b32 s20, s62
s_mov_b32 s21, s63
s_mov_b32 s22, 0x3f00000
s_mov_b32 s23, 0x20000
s_mov_b32 s8, s56
s_mov_b32 s9, s57
s_mov_b32 s10, 0x510000
s_mov_b32 s11, 0x20000
s_mov_b32 s12, s58
s_mov_b32 s13, s59
s_mov_b32 s14, 0x510000
s_mov_b32 s15, 0x20000
s_mov_b32 s16, s60
s_mov_b32 s17, s61
s_mov_b32 s18, 0x510000
s_mov_b32 s19, 0x20000
s_mov_b32 s24, s64
s_mov_b32 s25, s65
s_mov_b32 s26, 0xa2000
s_mov_b32 s27, 0x20000
s_mov_b32 s28, s66
s_mov_b32 s29, s67
s_mov_b32 s30, 0xa2000
s_mov_b32 s31, 0x20000
s_add_u32 s32, s62, 0x260000
s_addc_u32 s33, s63, 0
s_mov_b32 s34, 0x12000
s_mov_b32 s35, 0x20000
s_mov_b32 s36, s70
s_mov_b32 s37, s71
s_mov_b32 s38, 0x100
s_mov_b32 s39, 0x20000
s_lshl_b32 s82, s41, 4
s_add_u32 s82, s82, s42
s_lshl_b32 s54, s82, 6
s_add_u32 s54, s54, 0x254000
s_lshl_b32 s82, s41, 4
s_add_u32 s96, s70, s82
s_addc_u32 s97, s71, 0
s_load_dword s99, s[96:97], 0x0
s_lshl_b32 s82, s41, 7
s_add_u32 s82, s82, 0x250000
s_mov_b32 s100, s82
s_add_u32 s90, s62, s82
s_addc_u32 s91, s63, 0
v_lshlrev_b32 v102, 2, v0
v_cmp_gt_u32 vcc, 16, v0
s_getreg_b32 s82, hwreg(HW_REG_XCC_ID)
s_and_b32 s82, s82, 15
s_add_u32 s82, s82, 1
v_cndmask_b32 v102, -4, v102, vcc
v_mov_b32 v103, 0
v_writelane_b32 v103, s82, 14
buffer_store_dword v103, v102, s[20:23], s54 offen sc1
s_getpc_b64 s[64:65]
L_pc1:
s_sub_u32 s64, s64, L_pc1-L_code_begin
s_subb_u32 s65, s65, 0
s_mov_b32 s66, L_code_end-L_code_begin
s_mov_b32 s67, 0x20000
s_lshr_b32 s82, s2, 3
s_lshl_b32 s82, s82, 12
s_add_u32 s83, s82, 131072
v_lshlrev_b32 v160, 4, v0
buffer_load_dwordx4 v[164:167], v160, s[64:67], s82 offen
buffer_load_dwordx4 v[164:167], v160, s[64:67], s83 offen
s_cmp_lt_u32 s42, 9
s_cbranch_scc1 L_front_pb
s_mul_i32 s82, s42, 640
s_sub_u32 s82, s82, 1152
s_mul_i32 s83, s41, 331776
s_add_u32 s82, s82, s83
v_lshrrev_b32 v160, 3, v0
v_mul_u32_u24 v160, 9216, v160
v_and_b32 v161, 7, v0
v_lshl_add_u32 v160, v161, 4, v160
s_add_u32 s83, s82, 36864
buffer_load_dwordx4 v[164:167], v160, s[8:11], s82 offen
buffer_load_dwordx4 v[164:167], v160, s[12:15], s82 offen
buffer_load_dwordx4 v[164:167], v160, s[8:11], s83 offen
buffer_load_dwordx4 v[164:167], v160, s[12:15], s83 offen
s_branch L_front_pd
L_front_pb:
s_mul_i32 s82, s42, 73728
s_mul_i32 s83, s41, 4608
s_add_u32 s82, s82, s83
v_lshlrev_b32 v160, 4, v0
s_add_u32 s83, s82, 512
buffer_load_dwordx4 v[164:167], v160, s[24:27], s82 offen
buffer_load_dwordx4 v[164:167], v160, s[28:31], s82 offen
buffer_load_dwordx4 v[164:167], v160, s[24:27], s83 offen
buffer_load_dwordx4 v[164:167], v160, s[28:31], s83 offen
L_front_pd:
v_lshrrev_b32 v100, 2, v98
v_lshlrev_b32 v100, 7, v100
v_lshrrev_b32 v102, 5, v0
v_lshl_add_u32 v100, v102, 4, v100
v_and_b32 v102, 3, v0
v_lshl_add_u32 v100, v102, 2, v100
v_add_u32 v100, 139264, v100
v_bfe_u32 v101, v0, 5, 1
v_lshlrev_b32 v101, 13, v101
v_bfe_u32 v102, v0, 3, 2
v_lshl_add_u32 v101, v102, 8, v101
v_and_b32 v102, 7, v0
v_lshl_add_u32 v101, v102, 4, v101
s_waitcnt vmcnt(15)
v_lshlrev_b32 v116, 16, v106
v_and_b32 v117, 0xffff0000, v106
s_waitcnt vmcnt(14)
v_lshlrev_b32 v118, 16, v107
v_and_b32 v119, 0xffff0000, v107
s_waitcnt vmcnt(13)
v_lshlrev_b32 v120, 16, v108
v_and_b32 v121, 0xffff0000, v108
s_waitcnt vmcnt(12)
v_lshlrev_b32 v122, 16, v109
v_and_b32 v123, 0xffff0000, v109
s_waitcnt vmcnt(11)
v_lshlrev_b32 v124, 16, v110
v_and_b32 v125, 0xffff0000, v110
s_waitcnt vmcnt(10)
v_lshlrev_b32 v126, 16, v111
v_and_b32 v127, 0xffff0000, v111
s_waitcnt vmcnt(9)
v_lshlrev_b32 v128, 16, v112
v_and_b32 v129, 0xffff0000, v112
s_waitcnt vmcnt(8)
v_lshlrev_b32 v130, 16, v113
v_and_b32 v131, 0xffff0000, v113
s_waitcnt vmcnt(7)
v_lshlrev_b32 v132, 16, v114
v_and_b32 v133, 0xffff0000, v114
v_pk_add_f32 v[106:107], v[116:117], v[118:119]
v_pk_add_f32 v[108:109], v[120:121], v[122:123]
v_pk_add_f32 v[110:111], v[124:125], v[126:127]
v_pk_add_f32 v[112:113], v[128:129], v[130:131]
v_pk_add_f32 v[106:107], v[106:107], v[108:109]
v_pk_add_f32 v[110:111], v[110:111], v[112:113]
v_pk_add_f32 v[106:107], v[106:107], v[132:133]
v_pk_add_f32 v[106:107], v[106:107], v[110:111]
v_add_f32 v102, v106, v107
s_nop 1
v_add_f32_dpp v102, v102, v102 row_ror:8 row_mask:0xf bank_mask:0xf
s_nop 1
v_add_f32_dpp v102, v102, v102 row_ror:4 row_mask:0xf bank_mask:0xf
s_nop 1
v_add_f32_dpp v102, v102, v102 row_ror:2 row_mask:0xf bank_mask:0xf
s_nop 1
v_add_f32_dpp v102, v102, v102 row_ror:1 row_mask:0xf bank_mask:0xf
v_mov_b32 v136, v102
s_nop 1
v_permlane16_swap_b32 v102, v136
v_add_f32 v102, v102, v136
v_mul_f32 v102, 0x3ae38e39, v102
v_cvt_pk_bf16_f32 v104, v102, v102
v_lshlrev_b32 v104, 16, v104
v_pk_add_f32 v[144:145], v[116:117], v[102:103] op_sel_hi:[1,0] neg_lo:[0,1] neg_hi:[0,1]
v_pk_add_f32 v[146:147], v[118:119], v[102:103] op_sel_hi:[1,0] neg_lo:[0,1] neg_hi:[0,1]
v_pk_add_f32 v[148:149], v[120:121], v[102:103] op_sel_hi:[1,0] neg_lo:[0,1] neg_hi:[0,1]
v_pk_add_f32 v[150:151], v[122:123], v[102:103] op_sel_hi:[1,0] neg_lo:[0,1] neg_hi:[0,1]
v_pk_add_f32 v[152:153], v[124:125], v[102:103] op_sel_hi:[1,0] neg_lo:[0,1] neg_hi:[0,1]
v_pk_add_f32 v[154:155], v[126:127], v[102:103] op_sel_hi:[1,0] neg_lo:[0,1] neg_hi:[0,1]
v_pk_add_f32 v[156:157], v[128:129], v[102:103] op_sel_hi:[1,0] neg_lo:[0,1] neg_hi:[0,1]
v_pk_add_f32 v[158:159], v[130:131], v[102:103] op_sel_hi:[1,0] neg_lo:[0,1] neg_hi:[0,1]
v_pk_add_f32 v[160:161], v[132:133], v[102:103] op_sel_hi:[1,0] neg_lo:[0,1] neg_hi:[0,1]
v_pk_mul_f32 v[106:107], v[144:145], v[144:145]
v_pk_mul_f32 v[108:109], v[146:147], v[146:147]
v_pk_mul_f32 v[110:111], v[148:149], v[148:149]
v_pk_fma_f32 v[106:107], v[150:151], v[150:151], v[106:107]
v_pk_fma_f32 v[108:109], v[152:153], v[152:153], v[108:109]
v_pk_fma_f32 v[110:111], v[154:155], v[154:155], v[110:111]
v_pk_fma_f32 v[106:107], v[156:157], v[156:157], v[106:107]
v_pk_fma_f32 v[108:109], v[158:159], v[158:159], v[108:109]
v_pk_fma_f32 v[110:111], v[160:161], v[160:161], v[110:111]
v_pk_add_f32 v[106:107], v[106:107], v[108:109]
v_pk_add_f32 v[106:107], v[106:107], v[110:111]
v_add_f32 v103, v106, v107
v_pk_add_f32 v[116:117], v[116:117], v[104:105] op_sel_hi:[1,0] neg_lo:[0,1] neg_hi:[0,1]
v_pk_add_f32 v[118:119], v[118:119], v[104:105] op_sel_hi:[1,0] neg_lo:[0,1] neg_hi:[0,1]
v_pk_add_f32 v[120:121], v[120:121], v[104:105] op_sel_hi:[1,0] neg_lo:[0,1] neg_hi:[0,1]
v_pk_add_f32 v[122:123], v[122:123], v[104:105] op_sel_hi:[1,0] neg_lo:[0,1] neg_hi:[0,1]
v_pk_add_f32 v[124:125], v[124:125], v[104:105] op_sel_hi:[1,0] neg_lo:[0,1] neg_hi:[0,1]
v_pk_add_f32 v[126:127], v[126:127], v[104:105] op_sel_hi:[1,0] neg_lo:[0,1] neg_hi:[0,1]
v_pk_add_f32 v[128:129], v[128:129], v[104:105] op_sel_hi:[1,0] neg_lo:[0,1] neg_hi:[0,1]
v_pk_add_f32 v[130:131], v[130:131], v[104:105] op_sel_hi:[1,0] neg_lo:[0,1] neg_hi:[0,1]
v_pk_add_f32 v[132:133], v[132:133], v[104:105] op_sel_hi:[1,0] neg_lo:[0,1] neg_hi:[0,1]
v_add_f32_dpp v103, v103, v103 row_ror:8 row_mask:0xf bank_mask:0xf
s_nop 1
v_add_f32_dpp v103, v103, v103 row_ror:4 row_mask:0xf bank_mask:0xf
s_nop 1
v_add_f32_dpp v103, v103, v103 row_ror:2 row_mask:0xf bank_mask:0xf
s_nop 1
v_add_f32_dpp v103, v103, v103 row_ror:1 row_mask:0xf bank_mask:0xf
v_mov_b32 v136, v103
s_nop 1
v_permlane16_swap_b32 v103, v136
v_add_f32 v103, v103, v136
v_cvt_pk_bf16_f32 v116, v116, v117
v_cvt_pk_bf16_f32 v118, v118, v119
v_cvt_pk_bf16_f32 v120, v120, v121
v_cvt_pk_bf16_f32 v122, v122, v123
v_cvt_pk_bf16_f32 v124, v124, v125
v_cvt_pk_bf16_f32 v126, v126, v127
v_cvt_pk_bf16_f32 v128, v128, v129
v_cvt_pk_bf16_f32 v130, v130, v131
v_cvt_pk_bf16_f32 v132, v132, v133
v_and_b32 v117, 0xffff0000, v116
v_lshlrev_b32 v116, 16, v116
v_and_b32 v119, 0xffff0000, v118
v_lshlrev_b32 v118, 16, v118
v_and_b32 v121, 0xffff0000, v120
v_lshlrev_b32 v120, 16, v120
v_and_b32 v123, 0xffff0000, v122
v_lshlrev_b32 v122, 16, v122
v_and_b32 v125, 0xffff0000, v124
v_lshlrev_b32 v124, 16, v124
v_and_b32 v127, 0xffff0000, v126
v_lshlrev_b32 v126, 16, v126
v_and_b32 v129, 0xffff0000, v128
v_lshlrev_b32 v128, 16, v128
v_and_b32 v131, 0xffff0000, v130
v_lshlrev_b32 v130, 16, v130
v_and_b32 v133, 0xffff0000, v132
v_lshlrev_b32 v132, 16, v132
v_mul_f32 v103, 0x3ae38e39, v103
v_cvt_pk_bf16_f32 v103, v103, v103
v_lshlrev_b32 v103, 16, v103
v_add_f32 v103, 0x3727c5ac, v103
v_cvt_pk_bf16_f32 v103, v103, v103
v_lshlrev_b32 v103, 16, v103
v_sqrt_f32 v103, v103
s_nop 0
v_cvt_pk_bf16_f32 v103, v103, v103
v_lshlrev_b32 v103, 16, v103
v_rcp_f32 v105, v103
s_nop 0
v_fma_f32 v106, -v103, v105, 2.0
v_mul_f32 v105, v105, v106
v_mul_f32 v134, 0x3fb8aa3b, v105
v_pk_mul_f32 v[116:117], v[116:117], v[134:135] op_sel_hi:[1,0]
v_pk_mul_f32 v[118:119], v[118:119], v[134:135] op_sel_hi:[1,0]
v_pk_mul_f32 v[120:121], v[120:121], v[134:135] op_sel_hi:[1,0]
v_pk_mul_f32 v[122:123], v[122:123], v[134:135] op_sel_hi:[1,0]
v_pk_mul_f32 v[124:125], v[124:125], v[134:135] op_sel_hi:[1,0]
v_pk_mul_f32 v[126:127], v[126:127], v[134:135] op_sel_hi:[1,0]
v_pk_mul_f32 v[128:129], v[128:129], v[134:135] op_sel_hi:[1,0]
v_pk_mul_f32 v[130:131], v[130:131], v[134:135] op_sel_hi:[1,0]
v_pk_mul_f32 v[132:133], v[132:133], v[134:135] op_sel_hi:[1,0]
v_cvt_pk_bf16_f32 v116, v116, v117
ds_write_b32 v100, v116 offset:0
v_cvt_pk_bf16_f32 v118, v118, v119
ds_write_b32 v100, v118 offset:1024
v_cvt_pk_bf16_f32 v120, v120, v121
ds_write_b32 v100, v120 offset:2048
v_cvt_pk_bf16_f32 v122, v122, v123
ds_write_b32 v100, v122 offset:3072
v_cvt_pk_bf16_f32 v124, v124, v125
ds_write_b32 v100, v124 offset:4096
v_cvt_pk_bf16_f32 v126, v126, v127
ds_write_b32 v100, v126 offset:5120
v_cvt_pk_bf16_f32 v128, v128, v129
ds_write_b32 v100, v128 offset:6144
v_cvt_pk_bf16_f32 v130, v130, v131
ds_write_b32 v100, v130 offset:7168
v_cvt_pk_bf16_f32 v132, v132, v133
ds_write_b32 v100, v132 offset:8192
v_lshlrev_b32 v102, 3, v97
v_cmp_eq_u32 vcc, 0, v98
s_mov_b32 s82, 0x240000
s_lshl_b32 s83, s41, 2
v_cndmask_b32 v102, -8, v102, vcc
buffer_store_dwordx2 v[104:105], v102, s[20:23], s82 offen sc1
v_lshlrev_b32 v100, 4, v0
v_add_u32 v100, 139264, v100
s_mul_i32 s82, s41, 147456
s_lshr_b32 s83, s42, 3
s_lshl_b32 s83, s83, 12
s_add_u32 s82, s82, s83
s_bfe_u32 s83, s42, 0x20001
s_lshl_b32 s83, s83, 10
s_add_u32 s82, s82, s83
s_and_b32 s83, s42, 1
s_lshl_b32 s83, s83, 7
s_add_u32 s82, s82, s83
s_lshl_b32 s83, s40, 14
s_add_u32 s82, s82, s83
s_waitcnt lgkmcnt(0)
s_barrier
ds_read_b128 v[144:147], v100 offset:0
ds_read_b128 v[148:151], v100 offset:4096
ds_read_b128 v[152:155], v100 offset:8192
s_waitcnt lgkmcnt(2)
buffer_store_dwordx4 v[144:147], v101, s[20:23], s82 offen sc1
s_add_u32 s82, s82, 65536
s_waitcnt lgkmcnt(1)
buffer_store_dwordx4 v[148:151], v101, s[20:23], s82 offen sc1
s_cmp_eq_u32 s40, 0
s_mov_b32 s83, 0x40000000
s_cselect_b32 s83, 65536, s83
s_add_u32 s82, s82, s83
s_waitcnt lgkmcnt(0)
buffer_store_dwordx4 v[152:155], v101, s[20:23], s82 offen sc1
s_cmp_lt_u32 s42, 9
s_cbranch_scc1 L_k1_S
s_cmp_lt_u32 s42, 14
s_cbranch_scc1 L_k1_A
s_branch L_k1_B
L_k1_end:
s_endpgm
L_k1_S:
s_lshl_b32 s44, s42, 9
s_mul_i32 s45, s42, 294912
s_mul_i32 s47, s42, 73728
s_lshl_b32 s48, s42, 7
v_bfe_u32 v88, v0, 3, 3
s_and_b32 s82, s40, 1
s_lshl_b32 s82, s82, 4
s_lshr_b32 s83, s40, 1
s_add_u32 s82, s82, s83
v_lshl_add_u32 v88, v88, 1, s82
v_mul_u32_u24 v4, 1152, v88
s_and_b32 s82, s40, 1
s_lshl_b32 s82, s82, 2
v_bfe_u32 v88, v0, 4, 2
v_or_b32 v88, s82, v88
v_and_b32 v89, 7, v0
v_xor_b32 v88, v88, v89
v_lshl_add_u32 v4, v88, 4, v4
v_and_b32 v88, 15, v0
v_lshlrev_b32 v88, 2, v88
s_lshl_b32 s82, s80, 5
s_add_u32 s82, s82, s48
v_add_u32 v88, s82, v88
s_mov_b32 s92, s84
s_mov_b32 s93, s85
s_mov_b32 s94, 0x480
s_mov_b32 s95, 0x20000
buffer_load_dword v44, v88, s[92:95], 0 offen
s_nop 4
s_mov_b32 s92, s86
s_mov_b32 s93, s87
s_mov_b32 s94, 0x480
s_mov_b32 s95, 0x20000
buffer_load_dword v45, v88, s[92:95], 0 offen
s_nop 4
s_mov_b32 s92, s88
s_mov_b32 s93, s89
s_mov_b32 s94, 0x480
s_mov_b32 s95, 0x20000
buffer_load_dword v46, v88, s[92:95], 0 offen
s_nop 4
v_bfe_u32 v88, v0, 4, 2
v_bfe_u32 v89, v0, 2, 2
v_lshlrev_b32 v5, 10, v88
v_lshl_add_u32 v5, v89, 7, v5
v_and_b32 v88, 1, v88
v_lshlrev_b32 v88, 1, v88
v_lshrrev_b32 v89, 1, v89
v_or_b32 v88, v88, v89
v_xor_b32 v88, s80, v88
v_lshl_add_u32 v5, v88, 5, v5
v_and_b32 v88, 3, v0
v_lshl_add_u32 v5, v88, 3, v5
v_xor_b32 v6, 32, v5
v_add_u32 v7, 0x10000, v5
v_add_u32 v8, 0x10000, v6
s_lshl_b32 s82, s80, 12
s_and_b32 s83, s40, 1
s_lshl_b32 s83, s83, 12
s_add_u32 s83, s83, 73728
v_add_u32 v12, s83, v1
v_add_u32 v13, 0x10000, v12
v_add_u32 v11, s82, v12
s_lshl_b32 s82, s40, 12
v_add_u32 v14, s82, v1
s_getpc_b64 s[92:93]
L_pc2:
s_sub_u32 s92, s92, L_pc2-L_k1_S
s_subb_u32 s93, s93, 0
s_mov_b32 s94, L_code_end-L_k1_S
s_mov_b32 s95, 0x20000
v_and_b32 v88, 15, v0
v_lshlrev_b32 v9, 7, v88
s_lshl_b32 s82, s80, 11
v_add_u32 v9, s82, v9
v_bfe_u32 v88, v0, 1, 3
v_bfe_u32 v89, v0, 4, 2
v_xor_b32 v88, v88, v89
v_lshl_add_u32 v9, v88, 4, v9
v_xor_b32 v10, 64, v9
s_and_b32 s82, s40, 1
s_lshl_b32 s82, s82, 2
v_bfe_u32 v95, v0, 4, 2
v_cvt_f32_u32 v88, v95
v_mul_f32 v88, 0x43000000, v88
v_add_u32 v95, s82, v95
v_cvt_f32_u32 v89, v95
v_mul_f32 v89, 0x41800000, v89
v_cmp_eq_u32 s[56:57], 1, v95
v_cmp_eq_u32 s[58:59], 2, v95
v_cmp_eq_u32 s[60:61], 3, v95
v_cmp_eq_u32 s[62:63], 4, v95
v_cmp_eq_u32 s[64:65], 5, v95
v_cmp_eq_u32 s[66:67], 6, v95
v_cmp_eq_u32 s[68:69], 7, v95
s_lshl_b32 s78, s40, 13
s_add_u32 s78, s78, 73728
v_add_u32 v90, s78, v1
s_and_b32 s79, s40, 1
s_lshl_b32 s79, s79, 13
s_add_u32 s79, s79, 73728
v_and_b32 v94, 15, v0
v_lshlrev_b32 v93, 4, v94
s_lshl_b32 s82, s80, 7
s_add_u32 s83, s82, 155648
v_add_u32 v92, s83, v93
v_lshl_add_u32 v91, v95, 9, v92
s_lshl_b32 s83, s42, 9
s_add_u32 s82, s82, s83
s_mul_i32 s83, s41, 4608
s_add_u32 s77, s82, s83
v_add_u32 v93, s77, v93
v_cmp_eq_u32 vcc, 0, v95
s_lshl_b32 s76, s42, 6
s_add_u32 s76, s76, 0x25403c
s_lshl_b32 s82, s41, 10
s_add_u32 s82, s82, s76
v_cndmask_b32 v93, -16, v93, vcc
v_mov_b32 v94, s82
v_cmp_eq_u32 vcc, 0, v0
v_mov_b32 v95, 1
s_lshl_b64 s[70:71], 1, s41
v_cndmask_b32 v94, -4, v94, vcc
s_sub_u32 s70, s70, 1
s_waitcnt vmcnt(0) lgkmcnt(0)
s_barrier
s_cmp_lg_u32 s40, 0
s_cbranch_scc1 L_S_hs_oth
s_mov_b32 s99, 1
s_atomic_add s99, s[96:97], 0x0 glc
L_S_hs_oth:
s_mul_i32 s82, s41, 331776
s_add_u32 s82, s82, s44
s_add_u32 s82, s82, 0
v_lshrrev_b32 v160, 3, v0
v_mul_u32_u24 v160, 9216, v160
v_and_b32 v161, 7, v0
v_lshl_add_u32 v160, v161, 4, v160
s_add_u32 s83, s82, 36864
buffer_load_dwordx4 v[164:167], v160, s[8:11], s82 offen offset:0
buffer_load_dwordx4 v[164:167], v160, s[12:15], s82 offen offset:0
buffer_load_dwordx4 v[164:167], v160, s[8:11], s83 offen offset:0
buffer_load_dwordx4 v[164:167], v160, s[12:15], s83 offen offset:0
buffer_load_dwordx4 v[164:167], v160, s[8:11], s82 offen offset:128
buffer_load_dwordx4 v[164:167], v160, s[12:15], s82 offen offset:128
buffer_load_dwordx4 v[164:167], v160, s[8:11], s83 offen offset:128
buffer_load_dwordx4 v[164:167], v160, s[12:15], s83 offen offset:128
s_add_u32 m0, s43, 0x0
s_add_u32 s50, s47, 0x0
buffer_load_dwordx4 v4, s[24:27], s50 offen lds
s_add_u32 m0, s43, 0x1000
s_add_u32 s51, s47, 0x9000
buffer_load_dwordx4 v4, s[24:27], s51 offen lds
s_add_u32 m0, s43, 0x2000
s_add_u32 s50, s47, 0x0
buffer_load_dwordx4 v4, s[28:31], s50 offen lds
s_add_u32 m0, s43, 0x3000
s_add_u32 s51, s47, 0x9000
buffer_load_dwordx4 v4, s[28:31], s51 offen lds
s_add_u32 m0, s43, 0x4000
s_add_u32 s50, s47, 0x80
buffer_load_dwordx4 v4, s[24:27], s50 offen lds
s_add_u32 m0, s43, 0x5000
s_add_u32 s51, s47, 0x9080
buffer_load_dwordx4 v4, s[24:27], s51 offen lds
s_add_u32 m0, s43, 0x6000
s_add_u32 s50, s47, 0x80
buffer_load_dwordx4 v4, s[28:31], s50 offen lds
s_add_u32 m0, s43, 0x7000
s_add_u32 s51, s47, 0x9080
buffer_load_dwordx4 v4, s[28:31], s51 offen lds
s_add_u32 m0, s43, 0x8000
s_add_u32 s50, s47, 0x100
buffer_load_dwordx4 v4, s[24:27], s50 offen lds
s_add_u32 m0, s43, 0x9000
s_add_u32 s51, s47, 0x9100
buffer_load_dwordx4 v4, s[24:27], s51 offen lds
s_add_u32 m0, s43, 0xa000
s_add_u32 s50, s47, 0x100
buffer_load_dwordx4 v4, s[28:31], s50 offen lds
s_add_u32 m0, s43, 0xb000
s_add_u32 s51, s47, 0x9100
buffer_load_dwordx4 v4, s[28:31], s51 offen lds
s_add_u32 m0, s43, 0xc000
s_add_u32 s50, s44, 0x0
buffer_load_dwordx4 v2, s[8:11], s50 offen lds
s_add_u32 m0, s43, 0xd000
s_add_u32 s51, s44, 0x0
buffer_load_dwordx4 v2, s[12:15], s51 offen lds
s_add_u32 m0, s43, 0xe000
s_add_u32 s50, s44, 0x48000
buffer_load_dwordx4 v2, s[8:11], s50 offen lds
s_add_u32 m0, s43, 0xf000
s_add_u32 s51, s44, 0x48000
buffer_load_dwordx4 v2, s[12:15], s51 offen lds
s_add_u32 m0, s43, 0x10000
s_add_u32 s50, s44, 0x90000
buffer_load_dwordx4 v2, s[8:11], s50 offen lds
s_add_u32 m0, s43, 0x11000
s_add_u32 s51, s44, 0x90000
buffer_load_dwordx4 v2, s[12:15], s51 offen lds
s_cmp_lg_u32 s40, 0
s_cbranch_scc1 L_S_hs_done
s_mov_b32 s83, 0x40000
s_waitcnt lgkmcnt(0)
s_or_b32 s98, s99, 15
s_add_u32 s99, s99, 1
L_S_hs_spin:
s_cmp_gt_u32 s99, s98
s_cbranch_scc1 L_S_hs_done
s_sub_u32 s83, s83, 1
s_cbranch_scc1 L_S_hs_done
s_sleep 8
s_add_u32 s99, s99, 4
s_cmp_gt_u32 s99, s98
s_cbranch_scc1 L_S_hs_near
s_sleep 0
L_S_hs_near:
s_mov_b32 s99, 0
s_atomic_add s99, s[96:97], 0x0 glc
s_waitcnt lgkmcnt(0)
s_branch L_S_hs_spin
L_S_hs_done:
s_barrier
s_add_u32 m0, s43, 0x12000
s_add_u32 s50, s46, 0x0
buffer_load_dwordx4 v1, s[20:23], s50 offen sc1 lds
s_add_u32 m0, s43, 0x13000
s_add_u32 s51, s46, 0x1000
buffer_load_dwordx4 v1, s[20:23], s51 offen sc1 lds
s_add_u32 m0, s43, 0x14000
s_add_u32 s50, s46, 0x2000
buffer_load_dwordx4 v1, s[20:23], s50 offen sc1 lds
s_add_u32 m0, s43, 0x15000
s_add_u32 s51, s46, 0x3000
buffer_load_dwordx4 v1, s[20:23], s51 offen sc1 lds
s_add_u32 m0, s43, 0x16000
s_add_u32 s50, s46, 0x4000
buffer_load_dwordx4 v1, s[20:23], s50 offen sc1 lds
s_add_u32 m0, s43, 0x17000
s_add_u32 s51, s46, 0x5000
buffer_load_dwordx4 v1, s[20:23], s51 offen sc1 lds
s_add_u32 m0, s43, 0x18000
s_add_u32 s50, s46, 0x6000
buffer_load_dwordx4 v1, s[20:23], s50 offen sc1 lds
s_add_u32 m0, s43, 0x19000
s_add_u32 s51, s46, 0x7000
buffer_load_dwordx4 v1, s[20:23], s51 offen sc1 lds
s_add_u32 m0, s43, 0x1a000
s_add_u32 s50, s46, 0x8000
buffer_load_dwordx4 v1, s[20:23], s50 offen sc1 lds
s_add_u32 m0, s43, 0x1b000
s_add_u32 s51, s46, 0x9000
buffer_load_dwordx4 v1, s[20:23], s51 offen sc1 lds
s_add_u32 m0, s43, 0x1c000
s_add_u32 s50, s46, 0xa000
buffer_load_dwordx4 v1, s[20:23], s50 offen sc1 lds
s_add_u32 m0, s43, 0x1d000
s_add_u32 s51, s46, 0xb000
buffer_load_dwordx4 v1, s[20:23], s51 offen sc1 lds
s_waitcnt vmcnt(4)
s_barrier
ds_read_b128 v[64:67], v9 offset:0
ds_read_b128 a[0:3], v12 offset:0
ds_read_b128 a[4:7], v12 offset:1024
ds_read_b128 a[8:11], v12 offset:2048
ds_read_b128 a[12:15], v12 offset:3072
ds_read_b128 v[68:71], v10 offset:0
ds_read_b128 a[16:19], v12 offset:8192
ds_read_b128 a[20:23], v12 offset:9216
ds_read_b128 a[24:27], v12 offset:10240
ds_read_b128 a[28:31], v12 offset:11264
ds_read_b128 v[72:75], v9 offset:8192
ds_read_b128 a[32:35], v12 offset:16384
ds_read_b128 a[36:39], v12 offset:17408
ds_read_b128 a[40:43], v12 offset:18432
ds_read_b128 a[44:47], v12 offset:19456
ds_read_b128 a[48:51], v12 offset:24576
ds_read_b128 a[52:55], v12 offset:25600
ds_read_b128 a[56:59], v12 offset:26624
ds_read_b128 a[60:63], v12 offset:27648
s_waitcnt lgkmcnt(15)
v_mfma_f32_16x16x32_bf16 v[96:99], a[0:3], v[64:67], 0
ds_read_b128 v[76:79], v9 offset:2048
v_lshlrev_b32 v48, 16, v44
v_mfma_f32_16x16x32_bf16 v[100:103], a[4:7], v[64:67], 0
ds_read_b128 v[80:83], v10 offset:2048
v_lshlrev_b32 v49, 16, v45
v_mfma_f32_16x16x32_bf16 v[104:107], a[8:11], v[64:67], 0
ds_read_b128 v[84:87], v9 offset:10240
v_lshlrev_b32 v50, 16, v46
s_waitcnt lgkmcnt(15)
v_mfma_f32_16x16x32_bf16 v[108:111], a[12:15], v[64:67], 0
v_mul_f32 v50, 0x3fb8aa3b, v50
v_mfma_f32_16x16x32_bf16 v[96:99], a[16:19], v[68:71], v[96:99]
v_exp_f32 v50, v50
s_waitcnt lgkmcnt(14)
v_mfma_f32_16x16x32_bf16 v[100:103], a[20:23], v[68:71], v[100:103]
v_cvt_pk_bf16_f32 v50, v50, v50
v_lshlrev_b32 v50, 16, v50
s_waitcnt lgkmcnt(13)
v_mfma_f32_16x16x32_bf16 v[104:107], a[24:27], v[68:71], v[104:107]
v_mul_f32 v51, v50, v48
v_mul_f32 v52, v50, v49
s_waitcnt lgkmcnt(12)
v_mfma_f32_16x16x32_bf16 v[108:111], a[28:31], v[68:71], v[108:111]
v_mul_f32 v51, 0x3fb8aa3b, v51
v_mul_f32 v52, 0x3e22f983, v52
s_waitcnt lgkmcnt(11)
v_mfma_f32_16x16x32_bf16 v[128:131], a[0:3], v[72:75], 0
v_mul_f32 v53, 1.0, v51
v_mul_f32 v54, 1.0, v52
v_mfma_f32_16x16x32_bf16 v[132:135], a[4:7], v[72:75], 0
v_exp_f32 v53, v53
v_mfma_f32_16x16x32_bf16 v[136:139], a[8:11], v[72:75], 0
v_fract_f32 v54, v54
v_mfma_f32_16x16x32_bf16 v[140:143], a[12:15], v[72:75], 0
s_waitcnt lgkmcnt(2)
v_mfma_f32_16x16x32_bf16 v[112:115], a[0:3], v[76:79], 0
ds_read_b128 v[64:67], v10 offset:8192
s_waitcnt lgkmcnt(2)
v_mfma_f32_16x16x32_bf16 v[112:115], a[16:19], v[80:83], v[112:115]
ds_read_b128 v[68:71], v9 offset:16384
s_waitcnt lgkmcnt(2)
v_mfma_f32_16x16x32_bf16 v[144:147], a[0:3], v[84:87], 0
ds_read_b128 v[72:75], v10 offset:16384
v_mfma_f32_16x16x32_bf16 v[116:119], a[4:7], v[76:79], 0
v_cos_f32 v16, v54
v_mfma_f32_16x16x32_bf16 v[116:119], a[20:23], v[80:83], v[116:119]
v_sin_f32 v17, v54
v_mfma_f32_16x16x32_bf16 v[148:151], a[4:7], v[84:87], 0
v_mul_f32 v16, v16, v53
v_mul_f32 v17, v17, v53
v_mfma_f32_16x16x32_bf16 v[120:123], a[8:11], v[76:79], 0
v_mul_f32 v53, v48, v48
v_fmac_f32 v53, v49, v49
v_mfma_f32_16x16x32_bf16 v[120:123], a[24:27], v[80:83], v[120:123]
v_rcp_f32 v53, v53
v_mfma_f32_16x16x32_bf16 v[152:155], a[8:11], v[84:87], 0
v_add_f32 v54, -1.0, v16
v_mul_f32 v53, 0x4038aa3b, v53
v_mfma_f32_16x16x32_bf16 v[124:127], a[12:15], v[76:79], 0
v_mul_f32 v20, v54, v48
v_fmac_f32 v20, v17, v49
v_mfma_f32_16x16x32_bf16 v[124:127], a[28:31], v[80:83], v[124:127]
v_mul_f32 v21, v17, v48
v_fma_f32 v21, -v54, v49, v21
v_mfma_f32_16x16x32_bf16 v[156:159], a[12:15], v[84:87], 0
v_mul_f32 v20, v20, v53
s_waitcnt lgkmcnt(2)
v_mfma_f32_16x16x32_bf16 v[128:131], a[16:19], v[64:67], v[128:131]
ds_read_b128 v[76:79], v10 offset:10240
v_mul_f32 v21, v21, v53
v_mfma_f32_16x16x32_bf16 v[132:135], a[20:23], v[64:67], v[132:135]
ds_read_b128 v[80:83], v9 offset:18432
v_mul_f32 v53, 0x41800000, v51
v_mfma_f32_16x16x32_bf16 v[136:139], a[24:27], v[64:67], v[136:139]
ds_read_b128 v[84:87], v10 offset:18432
v_mul_f32 v54, 0x41800000, v52
v_mfma_f32_16x16x32_bf16 v[140:143], a[28:31], v[64:67], v[140:143]
v_exp_f32 v53, v53
s_waitcnt lgkmcnt(4)
v_mfma_f32_16x16x32_bf16 v[96:99], a[32:35], v[68:71], v[96:99]
v_fract_f32 v54, v54
v_mfma_f32_16x16x32_bf16 v[100:103], a[36:39], v[68:71], v[100:103]
v_cos_f32 v28, v54
v_mfma_f32_16x16x32_bf16 v[104:107], a[40:43], v[68:71], v[104:107]
v_sin_f32 v29, v54
v_mfma_f32_16x16x32_bf16 v[108:111], a[44:47], v[68:71], v[108:111]
v_mul_f32 v28, v28, v53
v_mul_f32 v29, v29, v53
s_waitcnt lgkmcnt(3)
v_mfma_f32_16x16x32_bf16 v[96:99], a[48:51], v[72:75], v[96:99]
v_mul_f32 v53, 0x44000000, v51
v_mul_f32 v54, 0x44000000, v52
v_mfma_f32_16x16x32_bf16 v[100:103], a[52:55], v[72:75], v[100:103]
v_exp_f32 v53, v53
v_mfma_f32_16x16x32_bf16 v[104:107], a[56:59], v[72:75], v[104:107]
v_fract_f32 v54, v54
v_and_b32 v56, 0xffff0000, v44
v_mfma_f32_16x16x32_bf16 v[108:111], a[60:63], v[72:75], v[108:111]
v_and_b32 v57, 0xffff0000, v45
s_waitcnt lgkmcnt(2)
v_mfma_f32_16x16x32_bf16 v[144:147], a[16:19], v[76:79], v[144:147]
s_waitcnt vmcnt(0)
s_waitcnt lgkmcnt(0)
s_barrier
s_add_u32 m0, s43, 0x1e000
s_add_u32 s50, s46, 0xc000
v_mfma_f32_16x16x32_bf16 v[112:115], a[32:35], v[80:83], v[112:115]
ds_read_b128 v[64:67], v9 offset:24576
ds_read_b128 a[64:67], v12 offset:32768
v_mfma_f32_16x16x32_bf16 v[112:115], a[48:51], v[84:87], v[112:115]
ds_read_b128 a[68:71], v12 offset:33792
ds_read_b128 a[72:75], v12 offset:34816
v_mfma_f32_16x16x32_bf16 v[148:151], a[20:23], v[76:79], v[148:151]
ds_read_b128 a[76:79], v12 offset:35840
ds_read_b128 v[68:71], v10 offset:24576
v_mfma_f32_16x16x32_bf16 v[116:119], a[36:39], v[80:83], v[116:119]
ds_read_b128 a[80:83], v12 offset:40960
ds_read_b128 a[84:87], v12 offset:41984
v_mfma_f32_16x16x32_bf16 v[116:119], a[52:55], v[84:87], v[116:119]
ds_read_b128 a[88:91], v12 offset:43008
ds_read_b128 a[92:95], v12 offset:44032
v_mfma_f32_16x16x32_bf16 v[152:155], a[24:27], v[76:79], v[152:155]
ds_read_b128 v[72:75], v9 offset:32768
v_and_b32 v58, 0xffff0000, v46
v_mfma_f32_16x16x32_bf16 v[120:123], a[40:43], v[80:83], v[120:123]
buffer_load_dwordx4 v1, s[20:23], s50 offen sc1 lds
v_mfma_f32_16x16x32_bf16 v[120:123], a[56:59], v[84:87], v[120:123]
s_add_u32 m0, s43, 0x1f000
s_add_u32 s51, s46, 0xd000
v_cos_f32 v32, v54
v_mfma_f32_16x16x32_bf16 v[156:159], a[28:31], v[76:79], v[156:159]
buffer_load_dwordx4 v1, s[20:23], s51 offen sc1 lds
v_mfma_f32_16x16x32_bf16 v[124:127], a[44:47], v[80:83], v[124:127]
s_add_u32 m0, s43, 0x0
s_add_u32 s50, s47, 0x180
v_sin_f32 v33, v54
v_mfma_f32_16x16x32_bf16 v[124:127], a[60:63], v[84:87], v[124:127]
buffer_load_dwordx4 v4, s[24:27], s50 offen lds
s_waitcnt lgkmcnt(0)
v_mfma_f32_16x16x32_bf16 v[128:131], a[32:35], v[64:67], v[128:131]
s_add_u32 m0, s43, 0x1000
s_add_u32 s51, s47, 0x9180
ds_read_b128 v[76:79], v9 offset:26624
v_mfma_f32_16x16x32_bf16 v[132:135], a[36:39], v[64:67], v[132:135]
ds_read_b128 v[80:83], v10 offset:26624
v_mul_f32 v32, v32, v53
v_mfma_f32_16x16x32_bf16 v[136:139], a[40:43], v[64:67], v[136:139]
ds_read_b128 v[84:87], v9 offset:34816
v_mul_f32 v33, v33, v53
v_mfma_f32_16x16x32_bf16 v[140:143], a[44:47], v[64:67], v[140:143]
buffer_load_dwordx4 v4, s[24:27], s51 offen lds
v_mfma_f32_16x16x32_bf16 v[128:131], a[48:51], v[68:71], v[128:131]
s_add_u32 m0, s43, 0x20000
s_add_u32 s50, s46, 0xe000
v_mul_f32 v53, v88, v51
v_mfma_f32_16x16x32_bf16 v[132:135], a[52:55], v[68:71], v[132:135]
buffer_load_dwordx4 v1, s[20:23], s50 offen sc1 lds
v_mfma_f32_16x16x32_bf16 v[136:139], a[56:59], v[68:71], v[136:139]
s_add_u32 m0, s43, 0x21000
s_add_u32 s51, s46, 0xf000
v_exp_f32 v53, v53
v_mfma_f32_16x16x32_bf16 v[140:143], a[60:63], v[68:71], v[140:143]
buffer_load_dwordx4 v1, s[20:23], s51 offen sc1 lds
v_mfma_f32_16x16x32_bf16 v[96:99], a[64:67], v[72:75], v[96:99]
s_add_u32 m0, s43, 0x2000
s_add_u32 s50, s47, 0x180
v_mul_f32 v54, v88, v52
v_mfma_f32_16x16x32_bf16 v[100:103], a[68:71], v[72:75], v[100:103]
buffer_load_dwordx4 v4, s[28:31], s50 offen lds
v_mfma_f32_16x16x32_bf16 v[104:107], a[72:75], v[72:75], v[104:107]
s_add_u32 m0, s43, 0x3000
s_add_u32 s51, s47, 0x9180
v_fract_f32 v54, v54
v_mfma_f32_16x16x32_bf16 v[108:111], a[76:79], v[72:75], v[108:111]
buffer_load_dwordx4 v4, s[28:31], s51 offen lds
s_waitcnt lgkmcnt(0)
v_mfma_f32_16x16x32_bf16 v[144:147], a[32:35], v[76:79], v[144:147]
s_add_u32 m0, s43, 0x22000
s_add_u32 s50, s46, 0x10000
ds_read_b128 v[64:67], v10 offset:32768
v_mfma_f32_16x16x32_bf16 v[144:147], a[48:51], v[80:83], v[144:147]
ds_read_b128 v[68:71], v9 offset:40960
v_mul_f32 v58, 0x3fb8aa3b, v58
v_mfma_f32_16x16x32_bf16 v[112:115], a[64:67], v[84:87], v[112:115]
ds_read_b128 v[72:75], v10 offset:40960
v_mfma_f32_16x16x32_bf16 v[148:151], a[36:39], v[76:79], v[148:151]
buffer_load_dwordx4 v1, s[20:23], s50 offen sc1 lds
v_mfma_f32_16x16x32_bf16 v[148:151], a[52:55], v[80:83], v[148:151]
s_add_u32 m0, s43, 0x23000
s_add_u32 s51, s46, 0x11000
v_cos_f32 v36, v54
v_mfma_f32_16x16x32_bf16 v[116:119], a[68:71], v[84:87], v[116:119]
buffer_load_dwordx4 v1, s[20:23], s51 offen sc1 lds
v_mfma_f32_16x16x32_bf16 v[152:155], a[40:43], v[76:79], v[152:155]
s_add_u32 m0, s43, 0x24000
s_add_u32 s50, s46, 0x12000
v_sin_f32 v37, v54
v_mfma_f32_16x16x32_bf16 v[152:155], a[56:59], v[80:83], v[152:155]
buffer_load_dwordx4 v1, s[20:23], s50 offen sc1 lds
v_mfma_f32_16x16x32_bf16 v[120:123], a[72:75], v[84:87], v[120:123]
s_add_u32 m0, s43, 0x25000
s_add_u32 s51, s46, 0x13000
v_exp_f32 v58, v58
v_mfma_f32_16x16x32_bf16 v[156:159], a[44:47], v[76:79], v[156:159]
buffer_load_dwordx4 v1, s[20:23], s51 offen sc1 lds
v_mfma_f32_16x16x32_bf16 v[156:159], a[60:63], v[80:83], v[156:159]
s_add_u32 m0, s43, 0x4000
s_add_u32 s50, s47, 0x200
v_mul_f32 v36, v36, v53
v_mfma_f32_16x16x32_bf16 v[124:127], a[76:79], v[84:87], v[124:127]
buffer_load_dwordx4 v4, s[24:27], s50 offen lds
s_waitcnt lgkmcnt(2)
v_mfma_f32_16x16x32_bf16 v[96:99], a[80:83], v[64:67], v[96:99]
s_add_u32 m0, s43, 0x5000
s_add_u32 s51, s47, 0x9200
ds_read_b128 v[76:79], v10 offset:34816
v_mfma_f32_16x16x32_bf16 v[100:103], a[84:87], v[64:67], v[100:103]
ds_read_b128 v[80:83], v9 offset:43008
v_mul_f32 v37, v37, v53
v_mfma_f32_16x16x32_bf16 v[104:107], a[88:91], v[64:67], v[104:107]
ds_read_b128 v[84:87], v10 offset:43008
v_mul_f32 v53, v89, v51
v_mfma_f32_16x16x32_bf16 v[108:111], a[92:95], v[64:67], v[108:111]
buffer_load_dwordx4 v4, s[24:27], s51 offen lds
s_waitcnt lgkmcnt(4)
v_mfma_f32_16x16x32_bf16 v[128:131], a[64:67], v[68:71], v[128:131]
v_exp_f32 v53, v53
v_mfma_f32_16x16x32_bf16 v[132:135], a[68:71], v[68:71], v[132:135]
v_mul_f32 v54, v89, v52
v_fract_f32 v54, v54
v_mfma_f32_16x16x32_bf16 v[136:139], a[72:75], v[68:71], v[136:139]
v_cos_f32 v40, v54
v_mfma_f32_16x16x32_bf16 v[140:143], a[76:79], v[68:71], v[140:143]
v_sin_f32 v41, v54
s_waitcnt lgkmcnt(3)
v_mfma_f32_16x16x32_bf16 v[128:131], a[80:83], v[72:75], v[128:131]
v_mul_f32 v40, v40, v53
v_mul_f32 v41, v41, v53
v_mfma_f32_16x16x32_bf16 v[132:135], a[84:87], v[72:75], v[132:135]
v_cvt_pk_bf16_f32 v58, v58, v58
v_lshlrev_b32 v58, 16, v58
v_mfma_f32_16x16x32_bf16 v[136:139], a[88:91], v[72:75], v[136:139]
v_mul_f32 v59, v58, v56
v_mul_f32 v60, v58, v57
v_mfma_f32_16x16x32_bf16 v[140:143], a[92:95], v[72:75], v[140:143]
v_mul_f32 v59, 0x3fb8aa3b, v59
s_waitcnt lgkmcnt(2)
v_mfma_f32_16x16x32_bf16 v[112:115], a[80:83], v[76:79], v[112:115]
s_waitcnt lgkmcnt(0)
s_barrier
s_add_u32 m0, s43, 0x6000
s_add_u32 s50, s44, 0xd8000
v_mfma_f32_16x16x32_bf16 v[144:147], a[64:67], v[80:83], v[144:147]
TR 64,5,49152
v_mul_f32 v60, 0x3e22f983, v60
v_mfma_f32_16x16x32_bf16 v[144:147], a[80:83], v[84:87], v[144:147]
TR 66,5,49664
v_mul_f32 v61, 1.0, v59
v_mfma_f32_16x16x32_bf16 v[116:119], a[84:87], v[76:79], v[116:119]
TR 68,5,57344
v_mul_f32 v62, 1.0, v60
v_mfma_f32_16x16x32_bf16 v[148:151], a[68:71], v[80:83], v[148:151]
TR 70,5,57856
v_fract_f32 v62, v62
v_mfma_f32_16x16x32_bf16 v[148:151], a[84:87], v[84:87], v[148:151]
TR 72,7,0
v_mfma_f32_16x16x32_bf16 v[120:123], a[88:91], v[76:79], v[120:123]
TR 74,7,512
v_mfma_f32_16x16x32_bf16 v[152:155], a[72:75], v[80:83], v[152:155]
buffer_load_dwordx4 v2, s[8:11], s50 offen lds
v_mfma_f32_16x16x32_bf16 v[152:155], a[88:91], v[84:87], v[152:155]
s_add_u32 m0, s43, 0x7000
s_add_u32 s51, s44, 0xd8000
v_exp_f32 v61, v61
v_mfma_f32_16x16x32_bf16 v[124:127], a[92:95], v[76:79], v[124:127]
buffer_load_dwordx4 v2, s[12:15], s51 offen lds
v_mfma_f32_16x16x32_bf16 v[156:159], a[76:79], v[80:83], v[156:159]
s_add_u32 m0, s43, 0x8000
s_add_u32 s50, s44, 0x120000
v_cos_f32 v18, v62
v_mfma_f32_16x16x32_bf16 v[156:159], a[92:95], v[84:87], v[156:159]
buffer_load_dwordx4 v2, s[8:11], s50 offen lds
s_waitcnt lgkmcnt(0)
v_mfma_f32_16x16x32_bf16 v[160:163], v[64:67], a[0:3], 0
s_add_u32 m0, s43, 0x9000
s_add_u32 s51, s44, 0x120000
TR 76,6,49152
MA 160,68,16
TR 78,6,49664
v_mul_f32 v18, v18, v61
MA 160,72,32
TR 80,6,57344
v_mfma_f32_16x16x32_bf16 v[164:167], v[64:67], a[4:7], 0
TR 82,6,57856
MA 164,68,20
TR 84,8,0
MA 164,72,36
TR 86,8,512
v_mfma_f32_16x16x32_bf16 v[168:171], v[64:67], a[8:11], 0
buffer_load_dwordx4 v2, s[12:15], s51 offen lds
MA 168,68,24
s_add_u32 m0, s43, 0xa000
s_add_u32 s50, s44, 0x168000
v_sin_f32 v19, v62
MA 168,72,40
buffer_load_dwordx4 v2, s[8:11], s50 offen lds
v_mfma_f32_16x16x32_bf16 v[172:175], v[64:67], a[12:15], 0
s_add_u32 m0, s43, 0xb000
s_add_u32 s51, s44, 0x168000
v_mul_f32 v19, v19, v61
MA 172,68,28
buffer_load_dwordx4 v2, s[12:15], s51 offen lds
MA 172,72,44
v_mul_f32 v61, v56, v56
s_waitcnt lgkmcnt(0)
v_mfma_f32_16x16x32_bf16 v[176:179], v[76:79], a[0:3], 0
TR 64,5,53248
v_fmac_f32 v61, v57, v57
MA 176,80,16
TR 66,5,53760
v_add_f32 v62, -1.0, v18
MA 176,84,32
TR 68,5,61440
v_mul_f32 v22, v62, v56
v_mfma_f32_16x16x32_bf16 v[180:183], v[76:79], a[4:7], 0
TR 70,5,61952
v_fmac_f32 v22, v19, v57
MA 180,80,20
TR 72,7,4096
v_mul_f32 v23, v19, v56
MA 180,84,36
TR 74,7,4608
v_fma_f32 v23, -v62, v57, v23
v_mfma_f32_16x16x32_bf16 v[184:187], v[76:79], a[8:11], 0
v_rcp_f32 v61, v61
MA 184,80,24
v_mul_f32 v61, 0x4038aa3b, v61
v_mul_f32 v22, v22, v61
MA 184,84,40
v_mul_f32 v23, v23, v61
v_mul_f32 v61, 0x41800000, v59
v_mfma_f32_16x16x32_bf16 v[188:191], v[76:79], a[12:15], 0
v_exp_f32 v61, v61
MA 188,80,28
v_mul_f32 v62, 0x41800000, v60
v_fract_f32 v62, v62
MA 188,84,44
s_waitcnt lgkmcnt(0)
v_mfma_f32_16x16x32_bf16 v[192:195], v[64:67], a[0:3], 0
TR 76,6,53248
MA 192,68,16
TR 78,6,53760
MA 192,72,32
TR 80,6,61440
v_mfma_f32_16x16x32_bf16 v[196:199], v[64:67], a[4:7], 0
TR 82,6,61952
MA 196,68,20
TR 84,8,4096
MA 196,72,36
TR 86,8,4608
v_mfma_f32_16x16x32_bf16 v[200:203], v[64:67], a[8:11], 0
v_cos_f32 v30, v62
MA 200,68,24
v_sin_f32 v31, v62
MA 200,72,40
v_mul_f32 v30, v30, v61
v_mul_f32 v31, v31, v61
v_mfma_f32_16x16x32_bf16 v[204:207], v[64:67], a[12:15], 0
v_mul_f32 v61, 0x44000000, v59
v_mul_f32 v62, 0x44000000, v60
MA 204,68,28
v_exp_f32 v61, v61
MA 204,72,44
v_fract_f32 v62, v62
s_waitcnt lgkmcnt(0)
v_mfma_f32_16x16x32_bf16 v[208:211], v[76:79], a[0:3], 0
s_waitcnt vmcnt(6)
s_barrier
s_add_u32 m0, s43, 0x12000
s_add_u32 s50, s46, 0x14000
MA 208,80,16
ds_read_b128 v[64:67], v9 offset:0
ds_read_b128 a[96:99], v12 offset:49152
MA 208,84,32
ds_read_b128 a[100:103], v12 offset:50176
ds_read_b128 a[104:107], v12 offset:51200
v_mfma_f32_16x16x32_bf16 v[212:215], v[76:79], a[4:7], 0
ds_read_b128 a[108:111], v12 offset:52224
ds_read_b128 v[68:71], v10 offset:0
MA 212,80,20
ds_read_b128 a[112:115], v12 offset:57344
ds_read_b128 a[116:119], v12 offset:58368
MA 212,84,36
ds_read_b128 a[120:123], v12 offset:59392
ds_read_b128 a[124:127], v12 offset:60416
v_mfma_f32_16x16x32_bf16 v[216:219], v[76:79], a[8:11], 0
ds_read_b128 v[72:75], v9 offset:8192
ds_read_b128 a[128:131], v13 offset:0
MA 216,80,24
ds_read_b128 a[132:135], v13 offset:1024
ds_read_b128 a[136:139], v13 offset:2048
MA 216,84,40
ds_read_b128 a[140:143], v13 offset:3072
ds_read_b128 a[144:147], v13 offset:8192
v_mfma_f32_16x16x32_bf16 v[220:223], v[76:79], a[12:15], 0
ds_read_b128 a[148:151], v13 offset:9216
ds_read_b128 a[152:155], v13 offset:10240
MA 220,80,28
ds_read_b128 a[156:159], v13 offset:11264
MA 220,84,44
buffer_load_dwordx4 v1, s[20:23], s50 offen sc1 lds
s_waitcnt lgkmcnt(15)
v_mfma_f32_16x16x32_bf16 v[96:99], a[96:99], v[64:67], v[96:99]
s_add_u32 m0, s43, 0x13000
s_add_u32 s51, s46, 0x15000
ds_read_b128 v[76:79], v9 offset:2048
v_mfma_f32_16x16x32_bf16 v[100:103], a[100:103], v[64:67], v[100:103]
ds_read_b128 v[80:83], v10 offset:2048
v_mfma_f32_16x16x32_bf16 v[104:107], a[104:107], v[64:67], v[104:107]
ds_read_b128 v[84:87], v9 offset:10240
s_waitcnt lgkmcnt(15)
v_mfma_f32_16x16x32_bf16 v[108:111], a[108:111], v[64:67], v[108:111]
buffer_load_dwordx4 v1, s[20:23], s51 offen sc1 lds
v_mfma_f32_16x16x32_bf16 v[96:99], a[112:115], v[68:71], v[96:99]
s_add_u32 m0, s43, 0xc000
s_add_u32 s50, s47, 0x200
v_cos_f32 v34, v62
s_waitcnt lgkmcnt(14)
v_mfma_f32_16x16x32_bf16 v[100:103], a[116:119], v[68:71], v[100:103]
buffer_load_dwordx4 v4, s[28:31], s50 offen lds
s_waitcnt lgkmcnt(13)
v_mfma_f32_16x16x32_bf16 v[104:107], a[120:123], v[68:71], v[104:107]
s_add_u32 m0, s43, 0xd000
s_add_u32 s51, s47, 0x9200
v_sin_f32 v35, v62
s_waitcnt lgkmcnt(12)
v_mfma_f32_16x16x32_bf16 v[108:111], a[124:127], v[68:71], v[108:111]
buffer_load_dwordx4 v4, s[28:31], s51 offen lds
s_waitcnt lgkmcnt(11)
v_mfma_f32_16x16x32_bf16 v[128:131], a[96:99], v[72:75], v[128:131]
s_add_u32 m0, s43, 0x14000
s_add_u32 s50, s46, 0x16000
v_mul_f32 v34, v34, v61
v_mfma_f32_16x16x32_bf16 v[132:135], a[100:103], v[72:75], v[132:135]
buffer_load_dwordx4 v1, s[20:23], s50 offen sc1 lds
v_mfma_f32_16x16x32_bf16 v[136:139], a[104:107], v[72:75], v[136:139]
s_add_u32 m0, s43, 0x15000
s_add_u32 s51, s46, 0x17000
v_mul_f32 v35, v35, v61
v_mfma_f32_16x16x32_bf16 v[140:143], a[108:111], v[72:75], v[140:143]
buffer_load_dwordx4 v1, s[20:23], s51 offen sc1 lds
s_waitcnt lgkmcnt(2)
v_mfma_f32_16x16x32_bf16 v[112:115], a[96:99], v[76:79], v[112:115]
s_add_u32 m0, s43, 0xe000
s_add_u32 s50, s47, 0x280
ds_read_b128 v[64:67], v10 offset:8192
s_waitcnt lgkmcnt(2)
v_mfma_f32_16x16x32_bf16 v[112:115], a[112:115], v[80:83], v[112:115]
ds_read_b128 v[68:71], v9 offset:16384
v_mul_f32 v61, v88, v59
s_waitcnt lgkmcnt(2)
v_mfma_f32_16x16x32_bf16 v[144:147], a[96:99], v[84:87], v[144:147]
ds_read_b128 v[72:75], v10 offset:16384
v_mul_f32 v62, v88, v60
v_mfma_f32_16x16x32_bf16 v[116:119], a[100:103], v[76:79], v[116:119]
buffer_load_dwordx4 v4, s[24:27], s50 offen lds
v_mfma_f32_16x16x32_bf16 v[116:119], a[116:119], v[80:83], v[116:119]
s_add_u32 m0, s43, 0xf000
s_add_u32 s51, s47, 0x9280
v_exp_f32 v61, v61
v_mfma_f32_16x16x32_bf16 v[148:151], a[100:103], v[84:87], v[148:151]
buffer_load_dwordx4 v4, s[24:27], s51 offen lds
v_mfma_f32_16x16x32_bf16 v[120:123], a[104:107], v[76:79], v[120:123]
s_add_u32 m0, s43, 0x10000
s_add_u32 s50, s47, 0x280
v_fract_f32 v62, v62
v_mfma_f32_16x16x32_bf16 v[120:123], a[120:123], v[80:83], v[120:123]
buffer_load_dwordx4 v4, s[28:31], s50 offen lds
v_mfma_f32_16x16x32_bf16 v[152:155], a[104:107], v[84:87], v[152:155]
s_add_u32 m0, s43, 0x11000
s_add_u32 s51, s47, 0x9280
v_cos_f32 v38, v62
v_mfma_f32_16x16x32_bf16 v[124:127], a[108:111], v[76:79], v[124:127]
buffer_load_dwordx4 v4, s[28:31], s51 offen lds
v_mfma_f32_16x16x32_bf16 v[124:127], a[124:127], v[80:83], v[124:127]
v_sin_f32 v39, v62
v_mfma_f32_16x16x32_bf16 v[156:159], a[108:111], v[84:87], v[156:159]
v_mul_f32 v38, v38, v61
s_waitcnt lgkmcnt(2)
v_mfma_f32_16x16x32_bf16 v[128:131], a[112:115], v[64:67], v[128:131]
ds_read_b128 v[76:79], v10 offset:10240
v_mul_f32 v39, v39, v61
v_mfma_f32_16x16x32_bf16 v[132:135], a[116:119], v[64:67], v[132:135]
ds_read_b128 v[80:83], v9 offset:18432
v_mul_f32 v61, v89, v59
v_mfma_f32_16x16x32_bf16 v[136:139], a[120:123], v[64:67], v[136:139]
ds_read_b128 v[84:87], v10 offset:18432
v_mul_f32 v62, v89, v60
v_mfma_f32_16x16x32_bf16 v[140:143], a[124:127], v[64:67], v[140:143]
v_exp_f32 v61, v61
s_waitcnt lgkmcnt(4)
v_mfma_f32_16x16x32_bf16 v[96:99], a[128:131], v[68:71], v[96:99]
v_fract_f32 v62, v62
v_mfma_f32_16x16x32_bf16 v[100:103], a[132:135], v[68:71], v[100:103]
v_cos_f32 v42, v62
v_mfma_f32_16x16x32_bf16 v[104:107], a[136:139], v[68:71], v[104:107]
v_sin_f32 v43, v62
v_mfma_f32_16x16x32_bf16 v[108:111], a[140:143], v[68:71], v[108:111]
v_mul_f32 v42, v42, v61
v_mul_f32 v43, v43, v61
s_waitcnt lgkmcnt(3)
v_mfma_f32_16x16x32_bf16 v[96:99], a[144:147], v[72:75], v[96:99]
v_mfma_f32_16x16x32_bf16 v[100:103], a[148:151], v[72:75], v[100:103]
v_mfma_f32_16x16x32_bf16 v[104:107], a[152:155], v[72:75], v[104:107]
v_mfma_f32_16x16x32_bf16 v[108:111], a[156:159], v[72:75], v[108:111]
s_waitcnt lgkmcnt(2)
v_mfma_f32_16x16x32_bf16 v[144:147], a[112:115], v[76:79], v[144:147]
s_waitcnt vmcnt(10)
s_waitcnt lgkmcnt(0)
s_barrier
s_add_u32 m0, s43, 0x0
s_add_u32 s50, s44, 0x1b0000
v_mfma_f32_16x16x32_bf16 v[112:115], a[128:131], v[80:83], v[112:115]
TR 64,5,24576
v_mfma_f32_16x16x32_bf16 v[112:115], a[144:147], v[84:87], v[112:115]
TR 66,5,25088
v_mfma_f32_16x16x32_bf16 v[148:151], a[116:119], v[76:79], v[148:151]
TR 68,5,32768
v_mfma_f32_16x16x32_bf16 v[116:119], a[132:135], v[80:83], v[116:119]
TR 70,5,33280
v_mfma_f32_16x16x32_bf16 v[116:119], a[148:151], v[84:87], v[116:119]
TR 72,5,40960
v_mfma_f32_16x16x32_bf16 v[152:155], a[120:123], v[76:79], v[152:155]
TR 74,5,41472
v_mfma_f32_16x16x32_bf16 v[120:123], a[136:139], v[80:83], v[120:123]
buffer_load_dwordx4 v2, s[8:11], s50 offen lds
v_mfma_f32_16x16x32_bf16 v[120:123], a[152:155], v[84:87], v[120:123]
s_add_u32 m0, s43, 0x1000
s_add_u32 s51, s44, 0x1b0000
v_mfma_f32_16x16x32_bf16 v[156:159], a[124:127], v[76:79], v[156:159]
buffer_load_dwordx4 v2, s[12:15], s51 offen lds
v_mfma_f32_16x16x32_bf16 v[124:127], a[140:143], v[80:83], v[124:127]
s_add_u32 m0, s43, 0x2000
s_add_u32 s50, s44, 0x1f8000
v_mfma_f32_16x16x32_bf16 v[124:127], a[156:159], v[84:87], v[124:127]
buffer_load_dwordx4 v2, s[8:11], s50 offen lds
s_waitcnt lgkmcnt(0)
MA 160,64,48
s_add_u32 m0, s43, 0x3000
s_add_u32 s51, s44, 0x1f8000
TR 76,6,24576
MA 160,68,64
TR 78,6,25088
MA 160,72,80
TR 80,6,32768
MA 164,64,52
TR 82,6,33280
MA 164,68,68
TR 84,6,40960
MA 164,72,84
TR 86,6,41472
MA 168,64,56
buffer_load_dwordx4 v2, s[12:15], s51 offen lds
MA 168,68,72
s_add_u32 m0, s43, 0x4000
s_add_u32 s50, s44, 0x240000
MA 168,72,88
buffer_load_dwordx4 v2, s[8:11], s50 offen lds
MA 172,64,60
s_add_u32 m0, s43, 0x5000
s_add_u32 s51, s44, 0x240000
MA 172,68,76
buffer_load_dwordx4 v2, s[12:15], s51 offen lds
MA 172,72,92
s_waitcnt lgkmcnt(0)
MA 176,76,48
TR 64,5,28672
MA 176,80,64
TR 66,5,29184
MA 176,84,80
TR 68,5,36864
MA 180,76,52
TR 70,5,37376
MA 180,80,68
TR 72,5,45056
MA 180,84,84
TR 74,5,45568
MA 184,76,56
MA 184,80,72
MA 184,84,88
MA 188,76,60
MA 188,80,76
MA 188,84,92
s_waitcnt lgkmcnt(0)
MA 192,64,48
TR 76,6,28672
MA 192,68,64
TR 78,6,29184
MA 192,72,80
TR 80,6,36864
MA 196,64,52
TR 82,6,37376
MA 196,68,68
TR 84,6,45056
MA 196,72,84
TR 86,6,45568
MA 200,64,56
MA 200,68,72
MA 200,72,88
MA 204,64,60
MA 204,68,76
MA 204,72,92
s_waitcnt lgkmcnt(0)
MA 208,76,48
s_waitcnt vmcnt(6)
s_barrier
s_add_u32 m0, s43, 0x16000
s_add_u32 s50, s46, 0x18000
MA 208,80,64
ds_read_b128 v[64:67], v9 offset:49152
ds_read_b128 a[160:163], v12 offset:0
MA 208,84,80
ds_read_b128 a[164:167], v12 offset:1024
ds_read_b128 a[168:171], v12 offset:2048
MA 212,76,52
ds_read_b128 a[172:175], v12 offset:3072
ds_read_b128 v[68:71], v10 offset:49152
MA 212,80,68
ds_read_b128 a[176:179], v12 offset:8192
ds_read_b128 a[180:183], v12 offset:9216
MA 212,84,84
ds_read_b128 a[184:187], v12 offset:10240
ds_read_b128 a[188:191], v12 offset:11264
MA 216,76,56
ds_read_b128 v[72:75], v9 offset:57344
MA 216,80,72
buffer_load_dwordx4 v1, s[20:23], s50 offen sc1 lds
MA 216,84,88
s_add_u32 m0, s43, 0x17000
s_add_u32 s51, s46, 0x19000
MA 220,76,60
buffer_load_dwordx4 v1, s[20:23], s51 offen sc1 lds
MA 220,80,76
s_add_u32 m0, s43, 0x6000
s_add_u32 s50, s47, 0x300
MA 220,84,92
buffer_load_dwordx4 v4, s[24:27], s50 offen lds
s_waitcnt lgkmcnt(0)
v_mfma_f32_16x16x32_bf16 v[128:131], a[128:131], v[64:67], v[128:131]
s_add_u32 m0, s43, 0x7000
s_add_u32 s51, s47, 0x9300
ds_read_b128 v[76:79], v9 offset:51200
v_mfma_f32_16x16x32_bf16 v[132:135], a[132:135], v[64:67], v[132:135]
ds_read_b128 v[80:83], v10 offset:51200
v_mfma_f32_16x16x32_bf16 v[136:139], a[136:139], v[64:67], v[136:139]
ds_read_b128 v[84:87], v9 offset:59392
v_mfma_f32_16x16x32_bf16 v[140:143], a[140:143], v[64:67], v[140:143]
buffer_load_dwordx4 v4, s[24:27], s51 offen lds
v_mfma_f32_16x16x32_bf16 v[128:131], a[144:147], v[68:71], v[128:131]
s_add_u32 m0, s43, 0x18000
s_add_u32 s50, s46, 0x1a000
v_mfma_f32_16x16x32_bf16 v[132:135], a[148:151], v[68:71], v[132:135]
buffer_load_dwordx4 v1, s[20:23], s50 offen sc1 lds
v_mfma_f32_16x16x32_bf16 v[136:139], a[152:155], v[68:71], v[136:139]
s_add_u32 m0, s43, 0x19000
s_add_u32 s51, s46, 0x1b000
v_mfma_f32_16x16x32_bf16 v[140:143], a[156:159], v[68:71], v[140:143]
buffer_load_dwordx4 v1, s[20:23], s51 offen sc1 lds
v_mfma_f32_16x16x32_bf16 v[96:99], a[160:163], v[72:75], v[96:99]
s_add_u32 m0, s43, 0x8000
s_add_u32 s50, s47, 0x300
v_mfma_f32_16x16x32_bf16 v[100:103], a[164:167], v[72:75], v[100:103]
buffer_load_dwordx4 v4, s[28:31], s50 offen lds
v_mfma_f32_16x16x32_bf16 v[104:107], a[168:171], v[72:75], v[104:107]
s_add_u32 m0, s43, 0x9000
s_add_u32 s51, s47, 0x9300
v_mfma_f32_16x16x32_bf16 v[108:111], a[172:175], v[72:75], v[108:111]
buffer_load_dwordx4 v4, s[28:31], s51 offen lds
s_waitcnt lgkmcnt(0)
v_mfma_f32_16x16x32_bf16 v[144:147], a[128:131], v[76:79], v[144:147]
s_add_u32 m0, s43, 0x1a000
s_add_u32 s50, s46, 0x1c000
ds_read_b128 v[64:67], v10 offset:57344
v_mfma_f32_16x16x32_bf16 v[144:147], a[144:147], v[80:83], v[144:147]
v_add_u32 v47, 0x10000, v9
ds_read_b128 v[68:71], v47 offset:0
v_mfma_f32_16x16x32_bf16 v[112:115], a[160:163], v[84:87], v[112:115]
v_add_u32 v47, 0x10000, v10
ds_read_b128 v[72:75], v47 offset:0
v_mfma_f32_16x16x32_bf16 v[148:151], a[132:135], v[76:79], v[148:151]
buffer_load_dwordx4 v1, s[20:23], s50 offen sc1 lds
v_mfma_f32_16x16x32_bf16 v[148:151], a[148:151], v[80:83], v[148:151]
s_add_u32 m0, s43, 0x1b000
s_add_u32 s51, s46, 0x1d000
v_mfma_f32_16x16x32_bf16 v[116:119], a[164:167], v[84:87], v[116:119]
buffer_load_dwordx4 v1, s[20:23], s51 offen sc1 lds
v_mfma_f32_16x16x32_bf16 v[152:155], a[136:139], v[76:79], v[152:155]
s_add_u32 m0, s43, 0x1c000
s_add_u32 s50, s46, 0x1e000
v_mfma_f32_16x16x32_bf16 v[152:155], a[152:155], v[80:83], v[152:155]
buffer_load_dwordx4 v1, s[20:23], s50 offen sc1 lds
v_mfma_f32_16x16x32_bf16 v[120:123], a[168:171], v[84:87], v[120:123]
s_add_u32 m0, s43, 0x1d000
s_add_u32 s51, s46, 0x1f000
v_mfma_f32_16x16x32_bf16 v[156:159], a[140:143], v[76:79], v[156:159]
buffer_load_dwordx4 v1, s[20:23], s51 offen sc1 lds
v_mfma_f32_16x16x32_bf16 v[156:159], a[156:159], v[80:83], v[156:159]
s_add_u32 m0, s43, 0xa000
s_add_u32 s50, s47, 0x380
v_mfma_f32_16x16x32_bf16 v[124:127], a[172:175], v[84:87], v[124:127]
buffer_load_dwordx4 v4, s[24:27], s50 offen lds
s_waitcnt lgkmcnt(2)
v_mfma_f32_16x16x32_bf16 v[96:99], a[176:179], v[64:67], v[96:99]
s_add_u32 m0, s43, 0xb000
s_add_u32 s51, s47, 0x9380
ds_read_b128 v[76:79], v10 offset:59392
v_mfma_f32_16x16x32_bf16 v[100:103], a[180:183], v[64:67], v[100:103]
v_add_u32 v47, 0x10000, v9
ds_read_b128 v[80:83], v47 offset:2048
v_mfma_f32_16x16x32_bf16 v[104:107], a[184:187], v[64:67], v[104:107]
v_add_u32 v47, 0x10000, v10
ds_read_b128 v[84:87], v47 offset:2048
v_mfma_f32_16x16x32_bf16 v[108:111], a[188:191], v[64:67], v[108:111]
buffer_load_dwordx4 v4, s[24:27], s51 offen lds
s_waitcnt lgkmcnt(4)
v_mfma_f32_16x16x32_bf16 v[128:131], a[160:163], v[68:71], v[128:131]
v_mfma_f32_16x16x32_bf16 v[132:135], a[164:167], v[68:71], v[132:135]
v_mfma_f32_16x16x32_bf16 v[136:139], a[168:171], v[68:71], v[136:139]
v_mfma_f32_16x16x32_bf16 v[140:143], a[172:175], v[68:71], v[140:143]
s_waitcnt lgkmcnt(3)
v_mfma_f32_16x16x32_bf16 v[128:131], a[176:179], v[72:75], v[128:131]
v_mfma_f32_16x16x32_bf16 v[132:135], a[180:183], v[72:75], v[132:135]
v_mfma_f32_16x16x32_bf16 v[136:139], a[184:187], v[72:75], v[136:139]
v_mfma_f32_16x16x32_bf16 v[140:143], a[188:191], v[72:75], v[140:143]
s_waitcnt lgkmcnt(2)
v_mfma_f32_16x16x32_bf16 v[112:115], a[176:179], v[76:79], v[112:115]
s_waitcnt vmcnt(14)
s_waitcnt lgkmcnt(0)
s_barrier
s_add_u32 m0, s43, 0x1e000
s_add_u32 s50, s46, 0x20000
v_mfma_f32_16x16x32_bf16 v[144:147], a[160:163], v[80:83], v[144:147]
TR 64,5,0
v_mfma_f32_16x16x32_bf16 v[144:147], a[176:179], v[84:87], v[144:147]
TR 66,5,512
v_mfma_f32_16x16x32_bf16 v[116:119], a[180:183], v[76:79], v[116:119]
TR 68,5,8192
v_mfma_f32_16x16x32_bf16 v[148:151], a[164:167], v[80:83], v[148:151]
TR 70,5,8704
v_mfma_f32_16x16x32_bf16 v[148:151], a[180:183], v[84:87], v[148:151]
TR 72,5,16384
v_mfma_f32_16x16x32_bf16 v[120:123], a[184:187], v[76:79], v[120:123]
TR 74,5,16896
v_mfma_f32_16x16x32_bf16 v[152:155], a[168:171], v[80:83], v[152:155]
buffer_load_dwordx4 v1, s[20:23], s50 offen sc1 lds
v_mfma_f32_16x16x32_bf16 v[152:155], a[184:187], v[84:87], v[152:155]
s_add_u32 m0, s43, 0x1f000
s_add_u32 s51, s46, 0x21000
v_mfma_f32_16x16x32_bf16 v[124:127], a[188:191], v[76:79], v[124:127]
buffer_load_dwordx4 v1, s[20:23], s51 offen sc1 lds
v_mfma_f32_16x16x32_bf16 v[156:159], a[172:175], v[80:83], v[156:159]
s_add_u32 m0, s43, 0xc000
s_add_u32 s50, s47, 0x380
v_mfma_f32_16x16x32_bf16 v[156:159], a[188:191], v[84:87], v[156:159]
buffer_load_dwordx4 v4, s[28:31], s50 offen lds
s_waitcnt lgkmcnt(0)
MA 160,64,96
s_add_u32 m0, s43, 0xd000
s_add_u32 s51, s47, 0x9380
TR 76,6,0
MA 160,68,112
TR 78,6,512
MA 160,72,128
TR 80,6,8192
MA 164,64,100
TR 82,6,8704
MA 164,68,116
TR 84,6,16384
MA 164,72,132
TR 86,6,16896
MA 168,64,104
buffer_load_dwordx4 v4, s[28:31], s51 offen lds
MA 168,68,120
s_add_u32 m0, s43, 0x20000
s_add_u32 s50, s46, 0x22000
MA 168,72,136
buffer_load_dwordx4 v1, s[20:23], s50 offen sc1 lds
MA 172,64,108
s_add_u32 m0, s43, 0x21000
s_add_u32 s51, s46, 0x23000
MA 172,68,124
buffer_load_dwordx4 v1, s[20:23], s51 offen sc1 lds
MA 172,72,140
s_add_u32 m0, s43, 0xe000
s_add_u32 s50, s47, 0x400
s_waitcnt lgkmcnt(0)
MA 176,76,96
TR 64,5,4096
MA 176,80,112
TR 66,5,4608
MA 176,84,128
TR 68,5,12288
MA 180,76,100
TR 70,5,12800
MA 180,80,116
TR 72,5,20480
MA 180,84,132
TR 74,5,20992
MA 184,76,104
buffer_load_dwordx4 v4, s[24:27], s50 offen lds
MA 184,80,120
s_add_u32 m0, s43, 0xf000
s_add_u32 s51, s47, 0x9400
MA 184,84,136
buffer_load_dwordx4 v4, s[24:27], s51 offen lds
MA 188,76,108
s_add_u32 m0, s43, 0x10000
s_add_u32 s50, s47, 0x400
MA 188,80,124
buffer_load_dwordx4 v4, s[28:31], s50 offen lds
MA 188,84,140
s_add_u32 m0, s43, 0x11000
s_add_u32 s51, s47, 0x9400
s_waitcnt lgkmcnt(0)
MA 192,64,96
TR 76,6,4096
MA 192,68,112
TR 78,6,4608
MA 192,72,128
TR 80,6,12288
MA 196,64,100
TR 82,6,12800
MA 196,68,116
TR 84,6,20480
MA 196,72,132
TR 86,6,20992
MA 200,64,104
buffer_load_dwordx4 v4, s[28:31], s51 offen lds
MA 200,68,120
MA 200,72,136
MA 204,64,108
MA 204,68,124
MA 204,72,140
s_waitcnt lgkmcnt(0)
MA 208,76,96
s_waitcnt vmcnt(10)
s_barrier
s_add_u32 m0, s43, 0x0
s_add_u32 s50, s44, 0x288000
MA 208,80,112
ds_read_b128 v[64:67], v9 offset:24576
ds_read_b128 a[192:195], v12 offset:16384
MA 208,84,128
ds_read_b128 a[196:199], v12 offset:17408
ds_read_b128 a[200:203], v12 offset:18432
MA 212,76,100
ds_read_b128 a[204:207], v12 offset:19456
ds_read_b128 v[68:71], v10 offset:24576
MA 212,80,116
ds_read_b128 a[208:211], v12 offset:24576
ds_read_b128 a[212:215], v12 offset:25600
MA 212,84,132
ds_read_b128 a[216:219], v12 offset:26624
ds_read_b128 a[220:223], v12 offset:27648
MA 216,76,104
ds_read_b128 v[72:75], v9 offset:32768
ds_read_b128 a[224:227], v12 offset:32768
MA 216,80,120
ds_read_b128 a[228:231], v12 offset:33792
ds_read_b128 a[232:235], v12 offset:34816
MA 216,84,136
ds_read_b128 a[236:239], v12 offset:35840
ds_read_b128 a[240:243], v12 offset:40960
MA 220,76,108
ds_read_b128 a[244:247], v12 offset:41984
ds_read_b128 a[248:251], v12 offset:43008
MA 220,80,124
ds_read_b128 a[252:255], v12 offset:44032
MA 220,84,140
buffer_load_dwordx4 v2, s[8:11], s50 offen lds
s_waitcnt lgkmcnt(15)
v_mfma_f32_16x16x32_bf16 v[96:99], a[192:195], v[64:67], v[96:99]
s_add_u32 m0, s43, 0x1000
s_add_u32 s51, s44, 0x288000
ds_read_b128 v[76:79], v9 offset:26624
v_mfma_f32_16x16x32_bf16 v[100:103], a[196:199], v[64:67], v[100:103]
ds_read_b128 v[80:83], v10 offset:26624
v_mfma_f32_16x16x32_bf16 v[104:107], a[200:203], v[64:67], v[104:107]
ds_read_b128 v[84:87], v9 offset:34816
s_waitcnt lgkmcnt(15)
v_mfma_f32_16x16x32_bf16 v[108:111], a[204:207], v[64:67], v[108:111]
buffer_load_dwordx4 v2, s[12:15], s51 offen lds
v_mfma_f32_16x16x32_bf16 v[96:99], a[208:211], v[68:71], v[96:99]
s_add_u32 m0, s43, 0x2000
s_add_u32 s50, s44, 0x2d0000
s_waitcnt lgkmcnt(14)
v_mfma_f32_16x16x32_bf16 v[100:103], a[212:215], v[68:71], v[100:103]
buffer_load_dwordx4 v2, s[8:11], s50 offen lds
s_waitcnt lgkmcnt(13)
v_mfma_f32_16x16x32_bf16 v[104:107], a[216:219], v[68:71], v[104:107]
s_add_u32 m0, s43, 0x3000
s_add_u32 s51, s44, 0x2d0000
s_waitcnt lgkmcnt(12)
v_mfma_f32_16x16x32_bf16 v[108:111], a[220:223], v[68:71], v[108:111]
buffer_load_dwordx4 v2, s[12:15], s51 offen lds
s_waitcnt lgkmcnt(11)
v_mfma_f32_16x16x32_bf16 v[128:131], a[192:195], v[72:75], v[128:131]
s_add_u32 m0, s43, 0x4000
s_add_u32 s50, s44, 0x318000
v_mfma_f32_16x16x32_bf16 v[132:135], a[196:199], v[72:75], v[132:135]
buffer_load_dwordx4 v2, s[8:11], s50 offen lds
v_mfma_f32_16x16x32_bf16 v[136:139], a[200:203], v[72:75], v[136:139]
s_add_u32 m0, s43, 0x5000
s_add_u32 s51, s44, 0x318000
v_mfma_f32_16x16x32_bf16 v[140:143], a[204:207], v[72:75], v[140:143]
buffer_load_dwordx4 v2, s[12:15], s51 offen lds
s_waitcnt lgkmcnt(2)
v_mfma_f32_16x16x32_bf16 v[112:115], a[192:195], v[76:79], v[112:115]
ds_read_b128 v[64:67], v10 offset:32768
s_waitcnt lgkmcnt(2)
v_mfma_f32_16x16x32_bf16 v[112:115], a[208:211], v[80:83], v[112:115]
ds_read_b128 v[68:71], v9 offset:40960
s_waitcnt lgkmcnt(2)
v_mfma_f32_16x16x32_bf16 v[144:147], a[192:195], v[84:87], v[144:147]
ds_read_b128 v[72:75], v10 offset:40960
v_mfma_f32_16x16x32_bf16 v[116:119], a[196:199], v[76:79], v[116:119]
v_mfma_f32_16x16x32_bf16 v[116:119], a[212:215], v[80:83], v[116:119]
v_mfma_f32_16x16x32_bf16 v[148:151], a[196:199], v[84:87], v[148:151]
v_mfma_f32_16x16x32_bf16 v[120:123], a[200:203], v[76:79], v[120:123]
v_mfma_f32_16x16x32_bf16 v[120:123], a[216:219], v[80:83], v[120:123]
v_mfma_f32_16x16x32_bf16 v[152:155], a[200:203], v[84:87], v[152:155]
v_mfma_f32_16x16x32_bf16 v[124:127], a[204:207], v[76:79], v[124:127]
v_mfma_f32_16x16x32_bf16 v[124:127], a[220:223], v[80:83], v[124:127]
v_mfma_f32_16x16x32_bf16 v[156:159], a[204:207], v[84:87], v[156:159]
s_waitcnt lgkmcnt(2)
v_mfma_f32_16x16x32_bf16 v[128:131], a[208:211], v[64:67], v[128:131]
ds_read_b128 v[76:79], v10 offset:34816
v_mfma_f32_16x16x32_bf16 v[132:135], a[212:215], v[64:67], v[132:135]
ds_read_b128 v[80:83], v9 offset:43008
v_mfma_f32_16x16x32_bf16 v[136:139], a[216:219], v[64:67], v[136:139]
ds_read_b128 v[84:87], v10 offset:43008
v_mfma_f32_16x16x32_bf16 v[140:143], a[220:223], v[64:67], v[140:143]
s_waitcnt lgkmcnt(4)
v_mfma_f32_16x16x32_bf16 v[96:99], a[224:227], v[68:71], v[96:99]
v_mfma_f32_16x16x32_bf16 v[100:103], a[228:231], v[68:71], v[100:103]
v_mfma_f32_16x16x32_bf16 v[104:107], a[232:235], v[68:71], v[104:107]
v_mfma_f32_16x16x32_bf16 v[108:111], a[236:239], v[68:71], v[108:111]
s_waitcnt lgkmcnt(3)
v_mfma_f32_16x16x32_bf16 v[96:99], a[240:243], v[72:75], v[96:99]
v_mfma_f32_16x16x32_bf16 v[100:103], a[244:247], v[72:75], v[100:103]
v_mfma_f32_16x16x32_bf16 v[104:107], a[248:251], v[72:75], v[104:107]
v_mfma_f32_16x16x32_bf16 v[108:111], a[252:255], v[72:75], v[108:111]
s_waitcnt lgkmcnt(2)
v_mfma_f32_16x16x32_bf16 v[144:147], a[208:211], v[76:79], v[144:147]
s_waitcnt vmcnt(6)
s_waitcnt lgkmcnt(0)
s_barrier
s_add_u32 m0, s43, 0x6000
s_add_u32 s50, s44, 0x360000
v_mfma_f32_16x16x32_bf16 v[112:115], a[224:227], v[80:83], v[112:115]
ds_read_b128 v[64:67], v9 offset:49152
ds_read_b128 v[224:227], v12 offset:49152
v_mfma_f32_16x16x32_bf16 v[112:115], a[240:243], v[84:87], v[112:115]
ds_read_b128 v[228:231], v12 offset:50176
ds_read_b128 v[232:235], v12 offset:51200
v_mfma_f32_16x16x32_bf16 v[148:151], a[212:215], v[76:79], v[148:151]
ds_read_b128 v[236:239], v12 offset:52224
ds_read_b128 v[68:71], v10 offset:49152
v_mfma_f32_16x16x32_bf16 v[116:119], a[228:231], v[80:83], v[116:119]
ds_read_b128 v[240:243], v12 offset:57344
ds_read_b128 v[244:247], v12 offset:58368
v_mfma_f32_16x16x32_bf16 v[116:119], a[244:247], v[84:87], v[116:119]
ds_read_b128 v[248:251], v12 offset:59392
ds_read_b128 v[252:255], v12 offset:60416
v_mfma_f32_16x16x32_bf16 v[152:155], a[216:219], v[76:79], v[152:155]
ds_read_b128 v[72:75], v9 offset:57344
v_mfma_f32_16x16x32_bf16 v[120:123], a[232:235], v[80:83], v[120:123]
buffer_load_dwordx4 v2, s[8:11], s50 offen lds
v_mfma_f32_16x16x32_bf16 v[120:123], a[248:251], v[84:87], v[120:123]
s_add_u32 m0, s43, 0x7000
s_add_u32 s51, s44, 0x360000
v_mfma_f32_16x16x32_bf16 v[156:159], a[220:223], v[76:79], v[156:159]
buffer_load_dwordx4 v2, s[12:15], s51 offen lds
v_mfma_f32_16x16x32_bf16 v[124:127], a[236:239], v[80:83], v[124:127]
s_add_u32 m0, s43, 0x8000
s_add_u32 s50, s44, 0x3a8000
v_mfma_f32_16x16x32_bf16 v[124:127], a[252:255], v[84:87], v[124:127]
buffer_load_dwordx4 v2, s[8:11], s50 offen lds
s_waitcnt lgkmcnt(0)
v_mfma_f32_16x16x32_bf16 v[128:131], a[224:227], v[64:67], v[128:131]
s_add_u32 m0, s43, 0x9000
s_add_u32 s51, s44, 0x3a8000
ds_read_b128 v[76:79], v9 offset:51200
v_mfma_f32_16x16x32_bf16 v[132:135], a[228:231], v[64:67], v[132:135]
ds_read_b128 v[80:83], v10 offset:51200
v_mfma_f32_16x16x32_bf16 v[136:139], a[232:235], v[64:67], v[136:139]
ds_read_b128 v[84:87], v9 offset:59392
v_mfma_f32_16x16x32_bf16 v[140:143], a[236:239], v[64:67], v[140:143]
buffer_load_dwordx4 v2, s[12:15], s51 offen lds
v_mfma_f32_16x16x32_bf16 v[128:131], a[240:243], v[68:71], v[128:131]
s_add_u32 m0, s43, 0xa000
s_add_u32 s50, s44, 0x3f0000
v_mfma_f32_16x16x32_bf16 v[132:135], a[244:247], v[68:71], v[132:135]
buffer_load_dwordx4 v2, s[8:11], s50 offen lds
v_mfma_f32_16x16x32_bf16 v[136:139], a[248:251], v[68:71], v[136:139]
s_add_u32 m0, s43, 0xb000
s_add_u32 s51, s44, 0x3f0000
v_mfma_f32_16x16x32_bf16 v[140:143], a[252:255], v[68:71], v[140:143]
buffer_load_dwordx4 v2, s[12:15], s51 offen lds
v_mfma_f32_16x16x32_bf16 v[96:99], v[224:227], v[72:75], v[96:99]
v_mfma_f32_16x16x32_bf16 v[100:103], v[228:231], v[72:75], v[100:103]
v_mfma_f32_16x16x32_bf16 v[104:107], v[232:235], v[72:75], v[104:107]
v_mfma_f32_16x16x32_bf16 v[108:111], v[236:239], v[72:75], v[108:111]
s_waitcnt lgkmcnt(0)
v_mfma_f32_16x16x32_bf16 v[144:147], a[224:227], v[76:79], v[144:147]
ds_read_b128 v[64:67], v10 offset:57344
v_mfma_f32_16x16x32_bf16 v[144:147], a[240:243], v[80:83], v[144:147]
v_add_u32 v47, 0x10000, v9
ds_read_b128 v[68:71], v47 offset:0
v_mfma_f32_16x16x32_bf16 v[112:115], v[224:227], v[84:87], v[112:115]
v_add_u32 v47, 0x10000, v10
ds_read_b128 v[72:75], v47 offset:0
v_mfma_f32_16x16x32_bf16 v[148:151], a[228:231], v[76:79], v[148:151]
v_mfma_f32_16x16x32_bf16 v[148:151], a[244:247], v[80:83], v[148:151]
v_mfma_f32_16x16x32_bf16 v[116:119], v[228:231], v[84:87], v[116:119]
v_mfma_f32_16x16x32_bf16 v[152:155], a[232:235], v[76:79], v[152:155]
v_mfma_f32_16x16x32_bf16 v[152:155], a[248:251], v[80:83], v[152:155]
v_mfma_f32_16x16x32_bf16 v[120:123], v[232:235], v[84:87], v[120:123]
v_mfma_f32_16x16x32_bf16 v[156:159], a[236:239], v[76:79], v[156:159]
v_mfma_f32_16x16x32_bf16 v[156:159], a[252:255], v[80:83], v[156:159]
v_mfma_f32_16x16x32_bf16 v[124:127], v[236:239], v[84:87], v[124:127]
s_waitcnt lgkmcnt(2)
v_mfma_f32_16x16x32_bf16 v[96:99], v[240:243], v[64:67], v[96:99]
ds_read_b128 v[76:79], v10 offset:59392
v_mfma_f32_16x16x32_bf16 v[100:103], v[244:247], v[64:67], v[100:103]
v_add_u32 v47, 0x10000, v9
ds_read_b128 v[80:83], v47 offset:2048
v_mfma_f32_16x16x32_bf16 v[104:107], v[248:251], v[64:67], v[104:107]
v_add_u32 v47, 0x10000, v10
ds_read_b128 v[84:87], v47 offset:2048
v_mfma_f32_16x16x32_bf16 v[108:111], v[252:255], v[64:67], v[108:111]
s_waitcnt lgkmcnt(4)
v_mfma_f32_16x16x32_bf16 v[128:131], v[224:227], v[68:71], v[128:131]
v_mfma_f32_16x16x32_bf16 v[132:135], v[228:231], v[68:71], v[132:135]
v_mfma_f32_16x16x32_bf16 v[136:139], v[232:235], v[68:71], v[136:139]
v_mfma_f32_16x16x32_bf16 v[140:143], v[236:239], v[68:71], v[140:143]
s_waitcnt lgkmcnt(3)
v_mfma_f32_16x16x32_bf16 v[128:131], v[240:243], v[72:75], v[128:131]
v_mfma_f32_16x16x32_bf16 v[132:135], v[244:247], v[72:75], v[132:135]
v_mfma_f32_16x16x32_bf16 v[136:139], v[248:251], v[72:75], v[136:139]
v_mfma_f32_16x16x32_bf16 v[140:143], v[252:255], v[72:75], v[140:143]
s_waitcnt lgkmcnt(2)
v_mfma_f32_16x16x32_bf16 v[112:115], v[240:243], v[76:79], v[112:115]
s_waitcnt vmcnt(6)
s_waitcnt lgkmcnt(0)
s_barrier
s_add_u32 m0, s43, 0xc000
s_add_u32 s50, s44, 0x438000
v_mfma_f32_16x16x32_bf16 v[144:147], v[224:227], v[80:83], v[144:147]
TR 64,5,0
v_mfma_f32_16x16x32_bf16 v[144:147], v[240:243], v[84:87], v[144:147]
TR 66,5,512
v_mfma_f32_16x16x32_bf16 v[116:119], v[244:247], v[76:79], v[116:119]
TR 68,5,8192
v_mfma_f32_16x16x32_bf16 v[148:151], v[228:231], v[80:83], v[148:151]
TR 70,5,8704
v_mfma_f32_16x16x32_bf16 v[148:151], v[244:247], v[84:87], v[148:151]
TR 72,5,16384
v_mfma_f32_16x16x32_bf16 v[120:123], v[248:251], v[76:79], v[120:123]
TR 74,5,16896
v_mfma_f32_16x16x32_bf16 v[152:155], v[232:235], v[80:83], v[152:155]
buffer_load_dwordx4 v2, s[8:11], s50 offen lds
v_mfma_f32_16x16x32_bf16 v[152:155], v[248:251], v[84:87], v[152:155]
s_add_u32 m0, s43, 0xd000
s_add_u32 s51, s44, 0x438000
v_mfma_f32_16x16x32_bf16 v[124:127], v[252:255], v[76:79], v[124:127]
buffer_load_dwordx4 v2, s[12:15], s51 offen lds
v_mfma_f32_16x16x32_bf16 v[156:159], v[236:239], v[80:83], v[156:159]
s_add_u32 m0, s43, 0xe000
s_add_u32 s50, s44, 0x480000
v_mfma_f32_16x16x32_bf16 v[156:159], v[252:255], v[84:87], v[156:159]
buffer_load_dwordx4 v2, s[8:11], s50 offen lds
s_mov_b32 s24, s72
s_mov_b32 s25, s73
s_mov_b32 s26, 0xa2000
s_mov_b32 s27, 0x20000
s_mov_b32 s28, s74
s_mov_b32 s29, s75
s_mov_b32 s30, 0xa2000
s_mov_b32 s31, 0x20000
v_bfe_u32 v60, v0, 3, 3
s_lshl_b32 s82, s40, 3
v_add_u32 v60, s82, v60
v_mul_u32_u24 v4, 1152, v60
s_and_b32 s82, s40, 1
s_lshl_b32 s82, s82, 2
v_bfe_u32 v60, v0, 4, 2
v_or_b32 v60, s82, v60
v_and_b32 v61, 7, v0
v_xor_b32 v60, v60, v61
v_lshl_add_u32 v4, v60, 4, v4
s_waitcnt lgkmcnt(0)
MA 160,64,144
s_add_u32 m0, s43, 0xf000
TR 76,6,0
MA 160,68,160
s_add_u32 s51, s44, 0x480000
TR 78,6,512
MA 160,72,176
TR 80,6,8192
MA 164,64,148
TR 82,6,8704
MA 164,68,164
TR 84,6,16384
MA 164,72,180
TR 86,6,16896
MA 168,64,152
buffer_load_dwordx4 v2, s[12:15], s51 offen lds
MA 168,68,168
s_add_u32 m0, s43, 0x10000
ds_write_b128 v90, v[96:99] offset:32768
s_nop 1
v_fma_f32 v97, v16, v96, v97
MA 168,72,184
s_add_u32 s50, s44, 0x4c8000
ds_write_b128 v90, v[128:131] offset:36864
s_nop 1
v_fma_f32 v129, v16, v128, v129
MA 172,64,156
ds_write_b128 v90, v[112:115] offset:0
v_fma_f32 v97, -v17, v128, v97
MA 172,68,172
ds_write_b128 v90, v[144:147] offset:4096
v_fma_f32 v129, v17, v96, v129
MA 172,72,188
buffer_load_dwordx4 v2, s[8:11], s50 offen lds
s_waitcnt lgkmcnt(4)
MA 176,76,144
s_add_u32 m0, s43, 0x11000
TR 64,5,4096
v_fma_f32 v113, v18, v112, v113
v_fma_f32 v145, v18, v144, v145
MA 176,80,160
s_add_u32 s51, s44, 0x4c8000
TR 66,5,4608
v_fma_f32 v113, -v19, v144, v113
v_fma_f32 v145, v19, v112, v145
MA 176,84,176
TR 68,5,12288
v_fma_f32 v98, v16, v97, v98
v_fma_f32 v130, v16, v129, v130
MA 180,76,148
TR 70,5,12800
v_fma_f32 v98, -v17, v129, v98
v_fma_f32 v130, v17, v97, v130
MA 180,80,164
TR 72,5,20480
v_fma_f32 v114, v18, v113, v114
v_fma_f32 v146, v18, v145, v146
MA 180,84,180
TR 74,5,20992
v_fma_f32 v114, -v19, v145, v114
v_fma_f32 v146, v19, v113, v146
MA 184,76,152
buffer_load_dwordx4 v2, s[12:15], s51 offen lds
MA 184,80,168
ds_write_b128 v90, v[100:103] offset:33792
v_fma_f32 v99, v16, v98, v99
MA 184,84,184
ds_write_b128 v90, v[132:135] offset:37888
v_fma_f32 v131, v16, v130, v131
MA 188,76,156
ds_write_b128 v90, v[116:119] offset:1024
v_fma_f32 v99, -v17, v130, v99
MA 188,80,172
ds_write_b128 v90, v[148:151] offset:5120
v_fma_f32 v131, v17, v98, v131
MA 188,84,188
v_fma_f32 v115, v18, v114, v115
v_fma_f32 v147, v18, v146, v147
s_waitcnt lgkmcnt(4)
MA 192,64,144
TR 76,6,4096
v_and_b32 v88, 63, v0
v_cmp_gt_u32 vcc, 9, v88
s_mul_i32 s82, s41, 36
s_mul_i32 s83, s40, 9
s_add_u32 s82, s82, s83
v_add_u32 v88, s82, v88
v_mul_u32_u24 v88, 9216, v88
v_cndmask_b32 v88, -4, v88, vcc
MA 192,68,160
TR 78,6,4608
s_add_u32 s83, s44, 256
v_fma_f32 v115, -v19, v146, v115
v_fma_f32 v147, v19, v114, v147
MA 192,72,176
TR 80,6,12288
v_fma_f32 v100, v16, v99, v100
v_fma_f32 v132, v16, v131, v132
MA 196,64,148
TR 82,6,12800
v_fma_f32 v100, -v17, v131, v100
v_fma_f32 v132, v17, v99, v132
MA 196,68,164
TR 84,6,20480
v_fma_f32 v116, v18, v115, v116
v_fma_f32 v148, v18, v147, v148
MA 196,72,180
TR 86,6,20992
v_fma_f32 v116, -v19, v147, v116
v_fma_f32 v148, v19, v115, v148
MA 200,64,152
buffer_load_dword v89, v88, s[8:11], s83 offen
v_fma_f32 v101, v16, v100, v101
v_fma_f32 v133, v16, v132, v133
MA 200,68,168
buffer_load_dword v89, v88, s[12:15], s83 offen
s_add_u32 s83, s44, 384
v_fma_f32 v101, -v17, v132, v101
v_fma_f32 v133, v17, v100, v133
MA 200,72,184
ds_write_b128 v90, v[104:107] offset:34816
v_fma_f32 v117, v18, v116, v117
MA 204,64,156
v_fma_f32 v149, v18, v148, v149
v_fma_f32 v117, -v19, v148, v117
v_fma_f32 v149, v19, v116, v149
MA 204,68,172
v_fma_f32 v102, v16, v101, v102
v_fma_f32 v134, v16, v133, v134
v_fma_f32 v102, -v17, v133, v102
MA 204,72,188
v_fma_f32 v134, v17, v101, v134
v_fma_f32 v118, v18, v117, v118
s_waitcnt lgkmcnt(1)
MA 208,76,144
s_waitcnt vmcnt(8)
s_waitcnt lgkmcnt(0)
s_barrier
s_add_u32 m0, s43, 0x0
ds_write_b128 v90, v[136:139] offset:38912
v_fma_f32 v150, v18, v149, v150
MA 208,80,160
s_add_u32 s50, s44, 0x80
TR 64,5,24576
v_fma_f32 v118, -v19, v149, v118
v_fma_f32 v150, v19, v117, v150
MA 208,84,176
TR 66,5,25088
v_fma_f32 v103, v16, v102, v103
v_fma_f32 v135, v16, v134, v135
MA 212,76,148
TR 68,5,32768
v_fma_f32 v103, -v17, v134, v103
v_fma_f32 v135, v17, v102, v135
MA 212,80,164
TR 70,5,33280
v_fma_f32 v119, v18, v118, v119
v_fma_f32 v151, v18, v150, v151
MA 212,84,180
TR 72,5,40960
v_fma_f32 v119, -v19, v150, v119
v_fma_f32 v151, v19, v118, v151
MA 216,76,152
TR 74,5,41472
v_fma_f32 v104, v16, v103, v104
v_fma_f32 v136, v16, v135, v136
MA 216,80,168
buffer_load_dwordx4 v2, s[8:11], s50 offen lds
MA 216,84,184
s_add_u32 m0, s43, 0x1000
ds_write_b128 v90, v[120:123] offset:2048
v_fma_f32 v104, -v17, v135, v104
MA 220,76,156
s_add_u32 s51, s44, 0x80
ds_write_b128 v90, v[152:155] offset:6144
v_fma_f32 v136, v17, v103, v136
MA 220,80,172
v_fma_f32 v120, v18, v119, v120
v_fma_f32 v152, v18, v151, v152
v_fma_f32 v120, -v19, v151, v120
MA 220,84,188
v_fma_f32 v152, v19, v119, v152
v_fma_f32 v105, v16, v104, v105
s_waitcnt lgkmcnt(2)
MA 160,64,192
TR 76,6,24576
v_fma_f32 v137, v16, v136, v137
v_fma_f32 v105, -v17, v136, v105
MA 160,68,208
TR 78,6,25088
v_fma_f32 v137, v17, v104, v137
v_fma_f32 v121, v18, v120, v121
MA 160,72,224
TR 80,6,32768
v_fma_f32 v153, v18, v152, v153
v_fma_f32 v121, -v19, v152, v121
MA 164,64,196
TR 82,6,33280
v_fma_f32 v153, v19, v120, v153
v_fma_f32 v106, v16, v105, v106
MA 164,68,212
TR 84,6,40960
v_fma_f32 v138, v16, v137, v138
v_fma_f32 v106, -v17, v137, v106
MA 164,72,228
TR 86,6,41472
v_fma_f32 v138, v17, v105, v138
v_fma_f32 v122, v18, v121, v122
MA 168,64,200
buffer_load_dwordx4 v2, s[12:15], s51 offen lds
MA 168,68,216
s_add_u32 m0, s43, 0x2000
ds_write_b128 v90, v[108:111] offset:35840
v_fma_f32 v154, v18, v153, v154
MA 168,72,232
s_add_u32 s50, s44, 0x48080
ds_write_b128 v90, v[140:143] offset:39936
v_fma_f32 v122, -v19, v153, v122
MA 172,64,204
ds_write_b128 v90, v[124:127] offset:3072
v_fma_f32 v154, v19, v121, v154
MA 172,68,220
ds_write_b128 v90, v[156:159] offset:7168
v_fma_f32 v107, v16, v106, v107
MA 172,72,236
buffer_load_dwordx4 v2, s[8:11], s50 offen lds
s_waitcnt lgkmcnt(4)
MA 176,76,192
s_add_u32 m0, s43, 0x3000
TR 64,5,28672
v_fma_f32 v139, v16, v138, v139
v_fma_f32 v107, -v17, v138, v107
MA 176,80,208
s_add_u32 s51, s44, 0x48080
TR 66,5,29184
v_fma_f32 v139, v17, v106, v139
v_fma_f32 v123, v18, v122, v123
MA 176,84,224
TR 68,5,36864
v_fma_f32 v155, v18, v154, v155
v_fma_f32 v123, -v19, v154, v123
MA 180,76,196
TR 70,5,37376
v_fma_f32 v155, v19, v122, v155
v_fma_f32 v108, v16, v107, v108
MA 180,80,212
TR 72,5,45056
v_fma_f32 v140, v16, v139, v140
v_fma_f32 v108, -v17, v139, v108
MA 180,84,228
TR 74,5,45568
v_fma_f32 v140, v17, v107, v140
v_fma_f32 v124, v18, v123, v124
MA 184,76,200
buffer_load_dwordx4 v2, s[12:15], s51 offen lds
MA 184,80,216
s_add_u32 m0, s43, 0x4000
v_fma_f32 v156, v18, v155, v156
v_fma_f32 v124, -v19, v155, v124
v_fma_f32 v156, v19, v123, v156
MA 184,84,232
s_add_u32 s50, s44, 0x90080
v_fma_f32 v109, v16, v108, v109
v_fma_f32 v141, v16, v140, v141
v_fma_f32 v109, -v17, v140, v109
MA 188,76,204
v_fma_f32 v141, v17, v108, v141
v_fma_f32 v125, v18, v124, v125
v_fma_f32 v157, v18, v156, v157
MA 188,80,220
v_fma_f32 v125, -v19, v156, v125
v_fma_f32 v157, v19, v124, v157
v_fma_f32 v110, v16, v109, v110
MA 188,84,236
buffer_load_dwordx4 v2, s[8:11], s50 offen lds
s_waitcnt lgkmcnt(0)
MA 192,64,192
s_add_u32 m0, s43, 0x5000
TR 76,6,28672
v_fma_f32 v142, v16, v141, v142
v_fma_f32 v110, -v17, v141, v110
MA 192,68,208
s_add_u32 s51, s44, 0x90080
TR 78,6,29184
v_fma_f32 v142, v17, v109, v142
v_fma_f32 v126, v18, v125, v126
MA 192,72,224
TR 80,6,36864
v_fma_f32 v158, v18, v157, v158
v_fma_f32 v126, -v19, v157, v126
MA 196,64,196
TR 82,6,37376
v_fma_f32 v158, v19, v125, v158
v_fma_f32 v44, v16, v110, v111
MA 196,68,212
TR 84,6,45056
v_fma_f32 v45, v16, v142, v143
v_fma_f32 v44, -v17, v142, v44
MA 196,72,228
TR 86,6,45568
v_fma_f32 v45, v17, v110, v45
v_fma_f32 v46, v18, v126, v127
MA 200,64,200
buffer_load_dwordx4 v2, s[12:15], s51 offen lds
MA 200,68,216
buffer_load_dword v89, v88, s[8:11], s83 offen
v_fma_f32 v47, v18, v158, v159
v_fma_f32 v46, -v19, v158, v46
MA 200,72,232
buffer_load_dword v89, v88, s[12:15], s83 offen
v_lshrrev_b32 v88, 2, v0
v_and_b32 v89, 0xcf, v0
v_cmp_eq_u32 vcc, v89, v0
v_and_or_b32 v88, v88, 48, v89
v_and_b32 v88, 63, v88
v_lshl_add_u32 v88, s41, 8, v88
v_lshlrev_b32 v88, 7, v88
v_cndmask_b32 v88, -4, v88, vcc
MA 204,64,204
s_add_u32 s83, s45, 0
v_fma_f32 v47, v19, v126, v47
v_mov_b32 v24, 0
v_mov_b32 v25, 0
MA 204,68,220
v_mov_b32 v26, 0
v_mov_b32 v27, 0
MA 204,72,236
s_waitcnt lgkmcnt(0)
MA 208,76,192
s_waitcnt vmcnt(10)
s_barrier
s_add_u32 m0, s43, 0x6000
ds_write_b128 v91, v[44:47]
MA 208,80,208
s_add_u32 s50, s44, 0xd8080
TR 64,5,49152
MA 208,84,224
TR 66,5,49664
MA 212,76,196
TR 68,5,57344
MA 212,80,212
TR 70,5,57856
MA 212,84,228
TR 72,7,0
MA 216,76,200
TR 74,7,512
MA 216,80,216
buffer_load_dwordx4 v2, s[8:11], s50 offen lds
MA 216,84,232
s_add_u32 m0, s43, 0x7000
MA 220,76,204
s_add_u32 s51, s44, 0xd8080
MA 220,80,220
MA 220,84,236
s_waitcnt lgkmcnt(0)
MA 160,64,240
TR 76,6,49152
v_mfma_f32_16x16x32_bf16 v[160:163], v[68:71], v[224:227], v[160:163]
TR 78,6,49664
v_mfma_f32_16x16x32_bf16 v[160:163], v[72:75], v[240:243], v[160:163]
TR 80,6,57344
MA 164,64,244
TR 82,6,57856
v_mfma_f32_16x16x32_bf16 v[164:167], v[68:71], v[228:231], v[164:167]
TR 84,8,0
v_mfma_f32_16x16x32_bf16 v[164:167], v[72:75], v[244:247], v[164:167]
TR 86,8,512
MA 168,64,248
buffer_load_dwordx4 v2, s[12:15], s51 offen lds
v_mfma_f32_16x16x32_bf16 v[168:171], v[68:71], v[232:235], v[168:171]
s_add_u32 m0, s43, 0x8000
v_mfma_f32_16x16x32_bf16 v[168:171], v[72:75], v[248:251], v[168:171]
s_add_u32 s50, s44, 0x120080
MA 172,64,252
v_mfma_f32_16x16x32_bf16 v[172:175], v[68:71], v[236:239], v[172:175]
v_mfma_f32_16x16x32_bf16 v[172:175], v[72:75], v[252:255], v[172:175]
buffer_load_dwordx4 v2, s[8:11], s50 offen lds
s_waitcnt lgkmcnt(0)
MA 176,76,240
s_add_u32 m0, s43, 0x9000
TR 64,5,53248
v_mfma_f32_16x16x32_bf16 v[176:179], v[80:83], v[224:227], v[176:179]
s_add_u32 s51, s44, 0x120080
TR 66,5,53760
v_mfma_f32_16x16x32_bf16 v[176:179], v[84:87], v[240:243], v[176:179]
TR 68,5,61440
MA 180,76,244
TR 70,5,61952
v_mfma_f32_16x16x32_bf16 v[180:183], v[80:83], v[228:231], v[180:183]
TR 72,7,4096
v_mfma_f32_16x16x32_bf16 v[180:183], v[84:87], v[244:247], v[180:183]
TR 74,7,4608
MA 184,76,248
buffer_load_dwordx4 v2, s[12:15], s51 offen lds
v_mfma_f32_16x16x32_bf16 v[184:187], v[80:83], v[232:235], v[184:187]
s_add_u32 m0, s43, 0xa000
v_mfma_f32_16x16x32_bf16 v[184:187], v[84:87], v[248:251], v[184:187]
s_add_u32 s50, s44, 0x168080
MA 188,76,252
v_mfma_f32_16x16x32_bf16 v[188:191], v[80:83], v[236:239], v[188:191]
v_mfma_f32_16x16x32_bf16 v[188:191], v[84:87], v[252:255], v[188:191]
buffer_load_dwordx4 v2, s[8:11], s50 offen lds
s_waitcnt lgkmcnt(0)
MA 192,64,240
s_add_u32 m0, s43, 0xb000
TR 76,6,53248
v_mfma_f32_16x16x32_bf16 v[192:195], v[68:71], v[224:227], v[192:195]
s_add_u32 s51, s44, 0x168080
TR 78,6,53760
v_mfma_f32_16x16x32_bf16 v[192:195], v[72:75], v[240:243], v[192:195]
TR 80,6,61440
MA 196,64,244
TR 82,6,61952
v_mfma_f32_16x16x32_bf16 v[196:199], v[68:71], v[228:231], v[196:199]
TR 84,8,4096
v_mfma_f32_16x16x32_bf16 v[196:199], v[72:75], v[244:247], v[196:199]
TR 86,8,4608
MA 200,64,248
buffer_load_dwordx4 v2, s[12:15], s51 offen lds
v_mfma_f32_16x16x32_bf16 v[200:203], v[68:71], v[232:235], v[200:203]
buffer_load_dword v89, v88, s[16:19], s83 offen
s_add_u32 s83, s45, 8192
v_mfma_f32_16x16x32_bf16 v[200:203], v[72:75], v[248:251], v[200:203]
MA 204,64,252
v_mfma_f32_16x16x32_bf16 v[204:207], v[68:71], v[236:239], v[204:207]
v_mfma_f32_16x16x32_bf16 v[204:207], v[72:75], v[252:255], v[204:207]
s_waitcnt lgkmcnt(0)
MA 208,76,240
s_waitcnt vmcnt(9)
s_barrier
s_add_u32 m0, s43, 0xc000
ds_read_b128 v[44:47], v92 offset:0
v_mfma_f32_16x16x32_bf16 v[208:211], v[80:83], v[224:227], v[208:211]
s_add_u32 s50, s44, 0x1b0080
TR 64,5,0
v_mfma_f32_16x16x32_bf16 v[208:211], v[84:87], v[240:243], v[208:211]
TR 66,5,512
MA 212,76,244
TR 68,5,8192
v_mfma_f32_16x16x32_bf16 v[212:215], v[80:83], v[228:231], v[212:215]
TR 70,5,8704
v_mfma_f32_16x16x32_bf16 v[212:215], v[84:87], v[244:247], v[212:215]
TR 72,5,16384
MA 216,76,248
TR 74,5,16896
v_mfma_f32_16x16x32_bf16 v[216:219], v[80:83], v[232:235], v[216:219]
buffer_load_dwordx4 v2, s[8:11], s50 offen lds
v_mfma_f32_16x16x32_bf16 v[216:219], v[84:87], v[248:251], v[216:219]
s_add_u32 m0, s43, 0xd000
ds_read_b128 v[48:51], v92 offset:512
MA 220,76,252
s_add_u32 s51, s44, 0x1b0080
ds_read_b128 v[52:55], v92 offset:1024
v_mfma_f32_16x16x32_bf16 v[220:223], v[80:83], v[236:239], v[220:223]
ds_read_b128 v[56:59], v92 offset:1536
v_mfma_f32_16x16x32_bf16 v[220:223], v[84:87], v[252:255], v[220:223]
ds_read_b128 v[60:63], v92 offset:2048
s_waitcnt lgkmcnt(4)
v_mfma_f32_16x16x32_bf16 v[96:99], v[64:67], a[0:3], 0
TR 76,6,0
MA 96,68,16
TR 78,6,512
MA 96,72,32
TR 80,6,8192
v_mfma_f32_16x16x32_bf16 v[100:103], v[64:67], a[4:7], 0
TR 82,6,8704
MA 100,68,20
TR 84,6,16384
s_waitcnt lgkmcnt(8)
v_cndmask_b32 v24, v24, v44, s[56:57]
v_cndmask_b32 v25, v25, v45, s[56:57]
MA 100,72,36
TR 86,6,16896
v_fma_f32 v48, v28, v44, v48
v_fma_f32 v49, v28, v45, v49
v_mfma_f32_16x16x32_bf16 v[104:107], v[64:67], a[8:11], 0
buffer_load_dwordx4 v2, s[12:15], s51 offen lds
MA 104,68,24
s_add_u32 m0, s43, 0xe000
v_fma_f32 v48, -v29, v45, v48
v_fma_f32 v49, v29, v44, v49
v_cndmask_b32 v26, v26, v46, s[56:57]
MA 104,72,40
s_add_u32 s50, s44, 0x1f8080
v_cndmask_b32 v27, v27, v47, s[56:57]
v_fma_f32 v50, v30, v46, v50
v_fma_f32 v51, v30, v47, v51
v_mfma_f32_16x16x32_bf16 v[108:111], v[64:67], a[12:15], 0
v_fma_f32 v50, -v31, v47, v50
v_fma_f32 v51, v31, v46, v51
s_waitcnt lgkmcnt(8)
v_cndmask_b32 v24, v24, v48, s[58:59]
MA 108,68,28
ds_read_b128 v[44:47], v92 offset:2560
v_cndmask_b32 v25, v25, v49, s[58:59]
v_fma_f32 v52, v28, v48, v52
MA 108,72,44
buffer_load_dwordx4 v2, s[8:11], s50 offen lds
s_waitcnt lgkmcnt(1)
v_mfma_f32_16x16x32_bf16 v[112:115], v[76:79], a[0:3], 0
s_add_u32 m0, s43, 0xf000
TR 64,5,4096
v_fma_f32 v53, v28, v49, v53
v_fma_f32 v52, -v29, v49, v52
MA 112,80,16
s_add_u32 s51, s44, 0x1f8080
TR 66,5,4608
v_fma_f32 v53, v29, v48, v53
v_cndmask_b32 v26, v26, v50, s[58:59]
MA 112,84,32
TR 68,5,12288
v_cndmask_b32 v27, v27, v51, s[58:59]
v_fma_f32 v54, v30, v50, v54
v_mfma_f32_16x16x32_bf16 v[116:119], v[76:79], a[4:7], 0
TR 70,5,12800
v_fma_f32 v55, v30, v51, v55
v_fma_f32 v54, -v31, v51, v54
MA 116,80,20
TR 72,5,20480
v_fma_f32 v55, v31, v50, v55
v_cndmask_b32 v24, v24, v52, s[60:61]
MA 116,84,36
TR 74,5,20992
v_cndmask_b32 v25, v25, v53, s[60:61]
v_fma_f32 v56, v28, v52, v56
v_mfma_f32_16x16x32_bf16 v[120:123], v[76:79], a[8:11], 0
buffer_load_dwordx4 v2, s[12:15], s51 offen lds
MA 120,80,24
s_add_u32 m0, s43, 0x10000
ds_read_b128 v[48:51], v92 offset:3072
v_fma_f32 v57, v28, v53, v57
v_fma_f32 v56, -v29, v53, v56
MA 120,84,40
s_add_u32 s50, s44, 0x240080
v_fma_f32 v57, v29, v52, v57
v_cndmask_b32 v26, v26, v54, s[60:61]
v_cndmask_b32 v27, v27, v55, s[60:61]
v_mfma_f32_16x16x32_bf16 v[124:127], v[76:79], a[12:15], 0
v_fma_f32 v58, v30, v54, v58
v_fma_f32 v59, v30, v55, v59
v_fma_f32 v58, -v31, v55, v58
MA 124,80,28
v_fma_f32 v59, v31, v54, v59
v_cndmask_b32 v24, v24, v56, s[62:63]
v_cndmask_b32 v25, v25, v57, s[62:63]
MA 124,84,44
buffer_load_dwordx4 v2, s[8:11], s50 offen lds
s_waitcnt lgkmcnt(1)
v_mfma_f32_16x16x32_bf16 v[128:131], v[64:67], a[0:3], 0
s_add_u32 m0, s43, 0x11000
TR 76,6,4096
v_fma_f32 v60, v28, v56, v60
v_fma_f32 v61, v28, v57, v61
MA 128,68,16
s_add_u32 s51, s44, 0x240080
TR 78,6,4608
v_fma_f32 v60, -v29, v57, v60
v_fma_f32 v61, v29, v56, v61
MA 128,72,32
TR 80,6,12288
v_cndmask_b32 v26, v26, v58, s[62:63]
v_cndmask_b32 v27, v27, v59, s[62:63]
v_mfma_f32_16x16x32_bf16 v[132:135], v[64:67], a[4:7], 0
TR 82,6,12800
v_fma_f32 v62, v30, v58, v62
v_fma_f32 v63, v30, v59, v63
MA 132,68,20
TR 84,6,20480
v_fma_f32 v62, -v31, v59, v62
v_fma_f32 v63, v31, v58, v63
MA 132,72,36
TR 86,6,20992
v_cndmask_b32 v24, v24, v60, s[64:65]
v_cndmask_b32 v25, v25, v61, s[64:65]
v_mfma_f32_16x16x32_bf16 v[136:139], v[64:67], a[8:11], 0
buffer_load_dwordx4 v2, s[12:15], s51 offen lds
MA 136,68,24
buffer_load_dword v89, v88, s[16:19], s83 offen
s_add_u32 s83, s45, 16384
v_fma_f32 v44, v28, v60, v44
v_fma_f32 v45, v28, v61, v45
MA 136,72,40
ds_read_b128 v[52:55], v92 offset:3584
v_fma_f32 v44, -v29, v61, v44
v_fma_f32 v45, v29, v60, v45
v_mfma_f32_16x16x32_bf16 v[140:143], v[64:67], a[12:15], 0
v_cndmask_b32 v26, v26, v62, s[64:65]
v_cndmask_b32 v27, v27, v63, s[64:65]
v_fma_f32 v46, v30, v62, v46
MA 140,68,28
v_fma_f32 v47, v30, v63, v47
v_fma_f32 v46, -v31, v63, v46
v_fma_f32 v47, v31, v62, v47
MA 140,72,44
s_waitcnt lgkmcnt(7)
v_cndmask_b32 v24, v24, v44, s[66:67]
v_cndmask_b32 v25, v25, v45, s[66:67]
s_waitcnt lgkmcnt(1)
v_mfma_f32_16x16x32_bf16 v[144:147], v[76:79], a[0:3], 0
s_waitcnt vmcnt(8)
s_waitcnt lgkmcnt(0)
s_barrier
s_add_u32 m0, s43, 0x0
v_fma_f32 v48, v28, v44, v48
v_fma_f32 v49, v28, v45, v49
MA 144,80,16
s_add_u32 s50, s44, 0x288080
TR 64,5,24576
v_fma_f32 v48, -v29, v45, v48
v_fma_f32 v49, v29, v44, v49
MA 144,84,32
TR 66,5,25088
v_cndmask_b32 v26, v26, v46, s[66:67]
v_cndmask_b32 v27, v27, v47, s[66:67]
v_mfma_f32_16x16x32_bf16 v[148:151], v[76:79], a[4:7], 0
TR 68,5,32768
v_fma_f32 v50, v30, v46, v50
v_fma_f32 v51, v30, v47, v51
MA 148,80,20
TR 70,5,33280
v_fma_f32 v50, -v31, v47, v50
v_fma_f32 v51, v31, v46, v51
MA 148,84,36
TR 72,5,40960
v_cndmask_b32 v24, v24, v48, s[68:69]
v_cndmask_b32 v25, v25, v49, s[68:69]
v_mfma_f32_16x16x32_bf16 v[152:155], v[76:79], a[8:11], 0
TR 74,5,41472
v_fma_f32 v52, v28, v48, v52
v_fma_f32 v53, v28, v49, v53
MA 152,80,24
buffer_load_dwordx4 v2, s[8:11], s50 offen lds
MA 152,84,40
s_add_u32 m0, s43, 0x1000
v_fma_f32 v52, -v29, v49, v52
v_fma_f32 v53, v29, v48, v53
v_cndmask_b32 v26, v26, v50, s[68:69]
v_mfma_f32_16x16x32_bf16 v[156:159], v[76:79], a[12:15], 0
s_add_u32 s51, s44, 0x288080
v_cndmask_b32 v27, v27, v51, s[68:69]
v_fma_f32 v54, v30, v50, v54
v_fma_f32 v55, v30, v51, v55
MA 156,80,28
v_fma_f32 v54, -v31, v51, v54
v_fma_f32 v55, v31, v50, v55
v_mul_f32 v192, v160, v192
MA 156,84,44
buffer_store_dwordx4 v[52:55], v93, s[32:35], 0 offen sc1
v_and_b32 v91, 63, v0
s_waitcnt lgkmcnt(0)
MA 96,64,48
TR 76,6,24576
v_exp_f32 v160, -v160
MA 96,68,64
TR 78,6,25088
v_lshlrev_b32 v91, 10, v91
v_mul_f32 v193, v161, v193
MA 96,72,80
TR 80,6,32768
v_exp_f32 v161, -v161
MA 100,64,52
TR 82,6,33280
v_mul_f32 v194, v162, v194
v_mul_f32 v195, v163, v195
MA 100,68,68
TR 84,6,40960
v_exp_f32 v162, -v162
MA 100,72,84
TR 86,6,41472
v_exp_f32 v163, -v163
MA 104,64,56
buffer_load_dwordx4 v2, s[12:15], s51 offen lds
MA 104,68,72
s_add_u32 m0, s43, 0x2000
v_mul_f32 v208, v176, v208
v_exp_f32 v176, -v176
MA 104,72,88
s_add_u32 s50, s44, 0x2d0080
v_mul_f32 v209, v177, v209
v_exp_f32 v177, -v177
MA 108,64,60
v_mul_f32 v210, v178, v210
v_exp_f32 v178, -v178
MA 108,68,76
v_mul_f32 v211, v179, v211
v_exp_f32 v179, -v179
MA 108,72,92
buffer_load_dwordx4 v2, s[8:11], s50 offen lds
s_waitcnt lgkmcnt(0)
MA 112,76,48
s_add_u32 m0, s43, 0x3000
TR 64,5,28672
v_add_f32 v160, 1.0, v160
v_add_f32 v161, 1.0, v161
MA 112,80,64
s_add_u32 s51, s44, 0x2d0080
TR 66,5,29184
v_rcp_f32 v160, v160
MA 112,84,80
TR 68,5,36864
v_rcp_f32 v161, v161
MA 116,76,52
TR 70,5,37376
v_add_f32 v162, 1.0, v162
v_add_f32 v163, 1.0, v163
MA 116,80,68
TR 72,5,45056
v_rcp_f32 v162, v162
MA 116,84,84
TR 74,5,45568
v_rcp_f32 v163, v163
MA 120,76,56
buffer_load_dwordx4 v2, s[12:15], s51 offen lds
MA 120,80,72
s_add_u32 m0, s43, 0x4000
v_add_f32 v176, 1.0, v176
v_rcp_f32 v176, v176
MA 120,84,88
s_add_u32 s50, s44, 0x318080
v_add_f32 v177, 1.0, v177
v_rcp_f32 v177, v177
MA 124,76,60
v_add_f32 v178, 1.0, v178
v_rcp_f32 v178, v178
MA 124,80,76
v_add_f32 v179, 1.0, v179
v_rcp_f32 v179, v179
MA 124,84,92
buffer_load_dwordx4 v2, s[8:11], s50 offen lds
s_waitcnt lgkmcnt(0)
MA 128,64,48
s_add_u32 m0, s43, 0x5000
TR 76,6,28672
v_mul_f32 v192, v192, v160
v_mul_f32 v193, v193, v161
MA 128,68,64
s_add_u32 s51, s44, 0x318080
TR 78,6,29184
v_mul_f32 v194, v194, v162
v_mul_f32 v195, v195, v163
MA 128,72,80
TR 80,6,36864
v_mul_f32 v208, v208, v176
v_mul_f32 v209, v209, v177
MA 132,64,52
TR 82,6,37376
v_mul_f32 v210, v210, v178
v_mul_f32 v211, v211, v179
MA 132,68,68
TR 84,6,45056
v_cvt_pk_bf16_f32 v160, v192, v193
v_cvt_pk_bf16_f32 v161, v194, v195
MA 132,72,84
TR 86,6,45568
v_cvt_pk_bf16_f32 v162, v208, v209
v_cvt_pk_bf16_f32 v163, v210, v211
MA 136,64,56
buffer_load_dwordx4 v2, s[12:15], s51 offen lds
MA 136,68,72
buffer_load_dword v89, v88, s[16:19], s83 offen
s_add_u32 s83, s45, 24576
v_add_u32 v15, 0x10000, v11
v_mul_f32 v196, v164, v196
MA 136,72,88
ds_write_b128 v15, v[160:163] offset:0
v_mul_f32 v197, v165, v197
MA 140,64,60
v_exp_f32 v164, -v164
v_mul_f32 v198, v166, v198
MA 140,68,76
v_exp_f32 v165, -v165
v_mul_f32 v199, v167, v199
MA 140,72,92
v_exp_f32 v166, -v166
s_waitcnt lgkmcnt(1)
MA 144,76,48
s_waitcnt vmcnt(9)
s_waitcnt lgkmcnt(0)
s_barrier
s_add_u32 m0, s43, 0x6000
v_exp_f32 v167, -v167
v_mul_f32 v212, v180, v212
MA 144,80,64
s_add_u32 s50, s44, 0x360080
TR 64,5,49152
v_exp_f32 v180, -v180
MA 144,84,80
TR 66,5,49664
v_mul_f32 v213, v181, v213
v_mul_f32 v214, v182, v214
MA 148,76,52
TR 68,5,57344
v_exp_f32 v181, -v181
MA 148,80,68
TR 70,5,57856
v_exp_f32 v182, -v182
MA 148,84,84
TR 72,7,0
v_mul_f32 v215, v183, v215
v_add_f32 v164, 1.0, v164
MA 152,76,56
TR 74,7,512
v_exp_f32 v183, -v183
MA 152,80,72
buffer_load_dwordx4 v2, s[8:11], s50 offen lds
MA 152,84,88
s_add_u32 m0, s43, 0x7000
v_rcp_f32 v164, v164
v_add_f32 v165, 1.0, v165
MA 156,76,60
s_add_u32 s51, s44, 0x360080
v_rcp_f32 v165, v165
v_add_f32 v166, 1.0, v166
MA 156,80,76
v_rcp_f32 v166, v166
v_add_f32 v167, 1.0, v167
MA 156,84,92
v_rcp_f32 v167, v167
s_waitcnt lgkmcnt(0)
MA 96,64,96
TR 76,6,49152
v_add_f32 v180, 1.0, v180
v_add_f32 v181, 1.0, v181
MA 96,68,112
TR 78,6,49664
v_rcp_f32 v180, v180
MA 96,72,128
TR 80,6,57344
v_rcp_f32 v181, v181
MA 100,64,100
TR 82,6,57856
v_add_f32 v182, 1.0, v182
v_add_f32 v183, 1.0, v183
MA 100,68,116
TR 84,8,0
v_rcp_f32 v182, v182
MA 100,72,132
TR 86,8,512
v_rcp_f32 v183, v183
MA 104,64,104
buffer_load_dwordx4 v2, s[12:15], s51 offen lds
MA 104,68,120
s_add_u32 m0, s43, 0x8000
v_mul_f32 v196, v196, v164
v_mul_f32 v197, v197, v165
v_mul_f32 v198, v198, v166
MA 104,72,136
s_add_u32 s50, s44, 0x3a8080
v_mul_f32 v199, v199, v167
v_mul_f32 v212, v212, v180
v_mul_f32 v213, v213, v181
MA 108,64,108
v_mul_f32 v214, v214, v182
v_mul_f32 v215, v215, v183
v_cvt_pk_bf16_f32 v164, v196, v197
MA 108,68,124
v_cvt_pk_bf16_f32 v165, v198, v199
v_cvt_pk_bf16_f32 v166, v212, v213
v_cvt_pk_bf16_f32 v167, v214, v215
MA 108,72,140
buffer_load_dwordx4 v2, s[8:11], s50 offen lds
s_waitcnt lgkmcnt(0)
MA 112,76,96
s_add_u32 m0, s43, 0x9000
TR 64,5,53248
v_mul_f32 v200, v168, v200
v_mul_f32 v201, v169, v201
MA 112,80,112
s_add_u32 s51, s44, 0x3a8080
TR 66,5,53760
v_exp_f32 v168, -v168
MA 112,84,128
TR 68,5,61440
v_exp_f32 v169, -v169
MA 116,76,100
TR 70,5,61952
v_mul_f32 v202, v170, v202
v_mul_f32 v203, v171, v203
MA 116,80,116
TR 72,7,4096
v_exp_f32 v170, -v170
MA 116,84,132
TR 74,7,4608
v_exp_f32 v171, -v171
MA 120,76,104
buffer_load_dwordx4 v2, s[12:15], s51 offen lds
MA 120,80,120
s_add_u32 m0, s43, 0xa000
ds_write_b128 v15, v[164:167] offset:1024
v_mul_f32 v216, v184, v216
MA 120,84,136
s_add_u32 s50, s44, 0x3f0080
v_exp_f32 v184, -v184
v_mul_f32 v217, v185, v217
MA 124,76,108
v_exp_f32 v185, -v185
v_mul_f32 v218, v186, v218
MA 124,80,124
v_exp_f32 v186, -v186
v_mul_f32 v219, v187, v219
MA 124,84,140
buffer_load_dwordx4 v2, s[8:11], s50 offen lds
s_waitcnt lgkmcnt(1)
MA 128,64,96
s_add_u32 m0, s43, 0xb000
TR 76,6,53248
v_exp_f32 v187, -v187
MA 128,68,112
s_add_u32 s51, s44, 0x3f0080
TR 78,6,53760
v_add_f32 v168, 1.0, v168
v_add_f32 v169, 1.0, v169
MA 128,72,128
TR 80,6,61440
v_rcp_f32 v168, v168
MA 132,64,100
TR 82,6,61952
v_rcp_f32 v169, v169
MA 132,68,116
TR 84,8,4096
v_add_f32 v170, 1.0, v170
v_add_f32 v171, 1.0, v171
MA 132,72,132
TR 86,8,4608
v_rcp_f32 v170, v170
MA 136,64,104
buffer_load_dwordx4 v2, s[12:15], s51 offen lds
MA 136,68,120
buffer_load_dword v89, v88, s[16:19], s83 offen
v_rcp_f32 v171, v171
s_mov_b32 s83, L_S_p2-L_k1_S
MA 136,72,136
v_lshlrev_b32 v88, 7, v0
v_add_f32 v184, 1.0, v184
v_add_f32 v185, 1.0, v185
MA 140,64,108
v_rcp_f32 v184, v184
v_add_f32 v186, 1.0, v186
MA 140,68,124
v_rcp_f32 v185, v185
v_add_f32 v187, 1.0, v187
MA 140,72,140
v_rcp_f32 v186, v186
s_waitcnt lgkmcnt(0)
MA 144,76,96
s_waitcnt vmcnt(8)
s_barrier
s_add_u32 m0, s43, 0xc000
v_rcp_f32 v187, v187
v_mul_f32 v200, v200, v168
MA 144,80,112
s_add_u32 s50, s44, 0x438080
TR 64,5,0
v_mul_f32 v201, v201, v169
v_mul_f32 v202, v202, v170
MA 144,84,128
TR 66,5,512
v_mul_f32 v203, v203, v171
v_mul_f32 v216, v216, v184
MA 148,76,100
TR 68,5,8192
v_mul_f32 v217, v217, v185
v_mul_f32 v218, v218, v186
MA 148,80,116
TR 70,5,8704
v_mul_f32 v219, v219, v187
v_cvt_pk_bf16_f32 v168, v200, v201
MA 148,84,132
TR 72,5,16384
v_cvt_pk_bf16_f32 v169, v202, v203
v_cvt_pk_bf16_f32 v170, v216, v217
MA 152,76,104
TR 74,5,16896
v_cvt_pk_bf16_f32 v171, v218, v219
v_mul_f32 v204, v172, v204
MA 152,80,120
buffer_load_dwordx4 v2, s[8:11], s50 offen lds
MA 152,84,136
s_add_u32 m0, s43, 0xd000
ds_write_b128 v15, v[168:171] offset:2048
v_mul_f32 v205, v173, v205
MA 156,76,108
s_add_u32 s51, s44, 0x438080
v_exp_f32 v172, -v172
v_mul_f32 v206, v174, v206
MA 156,80,124
v_exp_f32 v173, -v173
v_mul_f32 v207, v175, v207
MA 156,84,140
v_exp_f32 v174, -v174
s_waitcnt lgkmcnt(1)
MA 96,64,144
TR 76,6,0
v_exp_f32 v175, -v175
MA 96,68,160
TR 78,6,512
v_mul_f32 v220, v188, v220
v_mul_f32 v221, v189, v221
MA 96,72,176
TR 80,6,8192
v_exp_f32 v188, -v188
MA 100,64,148
TR 82,6,8704
v_exp_f32 v189, -v189
s_nop 0
MA 100,68,164
TR 84,6,16384
v_mul_f32 v222, v190, v222
v_mul_f32 v223, v191, v223
MA 100,72,180
TR 86,6,16896
v_exp_f32 v190, -v190
MA 104,64,152
buffer_load_dwordx4 v2, s[12:15], s51 offen lds
MA 104,68,168
s_add_u32 m0, s43, 0xe000
v_exp_f32 v191, -v191
v_add_f32 v172, 1.0, v172
MA 104,72,184
s_add_u32 s50, s44, 0x480080
v_rcp_f32 v172, v172
v_add_f32 v173, 1.0, v173
MA 108,64,156
v_rcp_f32 v173, v173
v_add_f32 v174, 1.0, v174
MA 108,68,172
v_rcp_f32 v174, v174
v_add_f32 v175, 1.0, v175
MA 108,72,188
buffer_load_dwordx4 v2, s[8:11], s50 offen lds
s_waitcnt lgkmcnt(0)
MA 112,76,144
s_add_u32 m0, s43, 0xf000
TR 64,5,4096
v_rcp_f32 v175, v175
MA 112,80,160
s_add_u32 s51, s44, 0x480080
TR 66,5,4608
v_add_f32 v188, 1.0, v188
v_add_f32 v189, 1.0, v189
MA 112,84,176
TR 68,5,12288
v_rcp_f32 v188, v188
MA 116,76,148
TR 70,5,12800
v_rcp_f32 v189, v189
MA 116,80,164
TR 72,5,20480
v_add_f32 v190, 1.0, v190
v_add_f32 v191, 1.0, v191
MA 116,84,180
TR 74,5,20992
v_rcp_f32 v190, v190
MA 120,76,152
buffer_load_dwordx4 v2, s[12:15], s51 offen lds
MA 120,80,168
s_add_u32 m0, s43, 0x10000
v_rcp_f32 v191, v191
v_mul_f32 v204, v204, v172
MA 120,84,184
s_add_u32 s50, s44, 0x4c8080
v_mul_f32 v205, v205, v173
v_mul_f32 v206, v206, v174
v_mul_f32 v207, v207, v175
MA 124,76,156
v_mul_f32 v220, v220, v188
v_mul_f32 v221, v221, v189
v_mul_f32 v222, v222, v190
MA 124,80,172
v_mul_f32 v223, v223, v191
v_cvt_pk_bf16_f32 v172, v204, v205
v_cvt_pk_bf16_f32 v173, v206, v207
MA 124,84,188
buffer_load_dwordx4 v2, s[8:11], s50 offen lds
s_waitcnt lgkmcnt(0)
MA 128,64,144
s_add_u32 m0, s43, 0x11000
TR 76,6,4096
v_cvt_pk_bf16_f32 v174, v220, v221
v_cvt_pk_bf16_f32 v175, v222, v223
MA 128,68,160
s_add_u32 s51, s44, 0x4c8080
TR 78,6,4608
MA 128,72,176
TR 80,6,12288
MA 132,64,148
TR 82,6,12800
MA 132,68,164
TR 84,6,20480
MA 132,72,180
TR 86,6,20992
MA 136,64,152
buffer_load_dwordx4 v2, s[12:15], s51 offen lds
MA 136,68,168
buffer_load_dword v89, v88, s[92:95], s83 offen
s_mul_i32 s82, s41, 36
v_add_u32 v88, s82, v0
v_cmp_gt_u32 vcc, 36, v0
v_mul_u32_u24 v88, 1152, v88
s_nop 0
v_cndmask_b32 v88, -4, v88, vcc
MA 136,72,184
ds_write_b128 v15, v[172:175] offset:3072
MA 140,64,156
MA 140,68,172
MA 140,72,188
s_waitcnt lgkmcnt(1)
MA 144,76,144
s_waitcnt vmcnt(8)
s_waitcnt lgkmcnt(0)
s_barrier
s_add_u32 m0, s43, 0x0
buffer_store_dword v95, v94, s[20:23], 0 offen sc1
MA 144,80,160
s_add_u32 s50, s44, 0x100
TR 64,5,24576
v_cmp_gt_u32 vcc, 16384, v91
v_add_u32 v91, s76, v91
s_nop 0
v_cndmask_b32 v91, -4, v91, vcc
MA 144,84,176
TR 66,5,25088
v_and_b32 v92, 15, v0
v_lshl_add_u32 v92, v92, 4, s77
MA 148,76,148
TR 68,5,32768
v_subrev_u32 v92, 4608, v92
v_bfe_u32 v60, v0, 4, 2
MA 148,80,164
TR 70,5,33280
v_mul_u32_u24 v60, 4608, v60
v_sub_u32 v60, v92, v60
MA 148,84,180
TR 72,5,40960
v_subrev_u32 v61, 0x4800, v60
v_subrev_u32 v62, 0x9000, v60
MA 152,76,152
TR 74,5,41472
v_subrev_u32 v63, 0xd800, v60
v_and_b32 v46, 63, v0
MA 152,80,168
buffer_load_dwordx4 v2, s[8:11], s50 offen lds
MA 152,84,184
s_add_u32 m0, s43, 0x1000
v_lshlrev_b32 v46, 4, v46
MA 156,76,156
s_add_u32 s51, s44, 0x100
MA 156,80,172
MA 156,84,188
s_waitcnt lgkmcnt(0)
MA 96,64,192
TR 76,6,24576
MA 96,68,208
TR 78,6,25088
MA 96,72,224
TR 80,6,32768
MA 100,64,196
TR 82,6,33280
MA 100,68,212
TR 84,6,40960
MA 100,72,228
TR 86,6,41472
MA 104,64,200
buffer_load_dwordx4 v2, s[12:15], s51 offen lds
MA 104,68,216
s_add_u32 m0, s43, 0x2000
MA 104,72,232
s_add_u32 s50, s44, 0x48100
MA 108,64,204
MA 108,68,220
MA 108,72,236
buffer_load_dwordx4 v2, s[8:11], s50 offen lds
s_waitcnt lgkmcnt(0)
MA 112,76,192
s_add_u32 m0, s43, 0x3000
TR 64,5,28672
MA 112,80,208
s_add_u32 s51, s44, 0x48100
TR 66,5,29184
MA 112,84,224
TR 68,5,36864
MA 116,76,196
TR 70,5,37376
MA 116,80,212
TR 72,5,45056
MA 116,84,228
TR 74,5,45568
MA 120,76,200
buffer_load_dwordx4 v2, s[12:15], s51 offen lds
MA 120,80,216
s_add_u32 m0, s43, 0x4000
MA 120,84,232
s_add_u32 s50, s44, 0x90100
MA 124,76,204
MA 124,80,220
MA 124,84,236
buffer_load_dwordx4 v2, s[8:11], s50 offen lds
s_waitcnt lgkmcnt(0)
MA 128,64,192
s_add_u32 m0, s43, 0x5000
TR 76,6,28672
MA 128,68,208
s_add_u32 s51, s44, 0x90100
TR 78,6,29184
MA 128,72,224
TR 80,6,36864
MA 132,64,196
TR 82,6,37376
MA 132,68,212
TR 84,6,45056
MA 132,72,228
TR 86,6,45568
MA 136,64,200
buffer_load_dwordx4 v2, s[12:15], s51 offen lds
MA 136,68,216
buffer_load_dword v89, v88, s[24:27], s48 offen
MA 136,72,232
buffer_load_dword v89, v88, s[28:31], s48 offen
MA 140,64,204
MA 140,68,220
MA 140,72,236
s_waitcnt lgkmcnt(0)
MA 144,76,192
s_waitcnt vmcnt(10)
s_barrier
s_add_u32 m0, s43, 0x6000
MA 144,80,208
s_add_u32 s50, s44, 0xd8100
TR 64,5,49152
MA 144,84,224
TR 66,5,49664
MA 148,76,196
TR 68,5,57344
MA 148,80,212
TR 70,5,57856
MA 148,84,228
TR 72,7,0
MA 152,76,200
TR 74,7,512
MA 152,80,216
buffer_load_dwordx4 v2, s[8:11], s50 offen lds
MA 152,84,232
s_add_u32 m0, s43, 0x7000
buffer_load_dword v45, v46, s[36:39], 0 offen sc1
MA 156,76,204
s_add_u32 s51, s44, 0xd8100
MA 156,80,220
MA 156,84,236
s_waitcnt lgkmcnt(0)
MA 96,64,240
TR 76,6,49152
v_mfma_f32_16x16x32_bf16 v[96:99], v[68:71], v[224:227], v[96:99]
TR 78,6,49664
v_mfma_f32_16x16x32_bf16 v[96:99], v[72:75], v[240:243], v[96:99]
TR 80,6,57344
MA 100,64,244
TR 82,6,57856
v_mfma_f32_16x16x32_bf16 v[100:103], v[68:71], v[228:231], v[100:103]
TR 84,8,0
v_mfma_f32_16x16x32_bf16 v[100:103], v[72:75], v[244:247], v[100:103]
TR 86,8,512
MA 104,64,248
buffer_load_dwordx4 v2, s[12:15], s51 offen lds
v_mfma_f32_16x16x32_bf16 v[104:107], v[68:71], v[232:235], v[104:107]
s_add_u32 m0, s43, 0x8000
buffer_load_dword v44, v91, s[20:23], 0 offen sc1
v_mfma_f32_16x16x32_bf16 v[104:107], v[72:75], v[248:251], v[104:107]
s_add_u32 s50, s44, 0x120100
MA 108,64,252
v_mfma_f32_16x16x32_bf16 v[108:111], v[68:71], v[236:239], v[108:111]
v_mfma_f32_16x16x32_bf16 v[108:111], v[72:75], v[252:255], v[108:111]
buffer_load_dwordx4 v2, s[8:11], s50 offen lds
s_waitcnt lgkmcnt(0)
MA 112,76,240
s_add_u32 m0, s43, 0x9000
TR 64,5,53248
v_mfma_f32_16x16x32_bf16 v[112:115], v[80:83], v[224:227], v[112:115]
s_add_u32 s51, s44, 0x120100
TR 66,5,53760
v_mfma_f32_16x16x32_bf16 v[112:115], v[84:87], v[240:243], v[112:115]
TR 68,5,61440
MA 116,76,244
TR 70,5,61952
v_mfma_f32_16x16x32_bf16 v[116:119], v[80:83], v[228:231], v[116:119]
TR 72,7,4096
v_mfma_f32_16x16x32_bf16 v[116:119], v[84:87], v[244:247], v[116:119]
TR 74,7,4608
MA 120,76,248
buffer_load_dwordx4 v2, s[12:15], s51 offen lds
v_mfma_f32_16x16x32_bf16 v[120:123], v[80:83], v[232:235], v[120:123]
s_add_u32 m0, s43, 0xa000
v_mfma_f32_16x16x32_bf16 v[120:123], v[84:87], v[248:251], v[120:123]
s_add_u32 s50, s44, 0x168100
MA 124,76,252
v_mfma_f32_16x16x32_bf16 v[124:127], v[80:83], v[236:239], v[124:127]
v_mfma_f32_16x16x32_bf16 v[124:127], v[84:87], v[252:255], v[124:127]
buffer_load_dwordx4 v2, s[8:11], s50 offen lds
s_waitcnt lgkmcnt(0)
MA 128,64,240
s_add_u32 m0, s43, 0xb000
TR 76,6,53248
v_mfma_f32_16x16x32_bf16 v[128:131], v[68:71], v[224:227], v[128:131]
s_add_u32 s51, s44, 0x168100
TR 78,6,53760
v_mfma_f32_16x16x32_bf16 v[128:131], v[72:75], v[240:243], v[128:131]
TR 80,6,61440
MA 132,64,244
TR 82,6,61952
v_mfma_f32_16x16x32_bf16 v[132:135], v[68:71], v[228:231], v[132:135]
TR 84,8,4096
v_mfma_f32_16x16x32_bf16 v[132:135], v[72:75], v[244:247], v[132:135]
TR 86,8,4608
MA 136,64,248
buffer_load_dwordx4 v2, s[12:15], s51 offen lds
v_mfma_f32_16x16x32_bf16 v[136:139], v[68:71], v[232:235], v[136:139]
v_mfma_f32_16x16x32_bf16 v[136:139], v[72:75], v[248:251], v[136:139]
MA 140,64,252
v_mfma_f32_16x16x32_bf16 v[140:143], v[68:71], v[236:239], v[140:143]
v_mfma_f32_16x16x32_bf16 v[140:143], v[72:75], v[252:255], v[140:143]
s_waitcnt lgkmcnt(0)
MA 144,76,240
s_waitcnt vmcnt(10)
s_barrier
s_add_u32 m0, s43, 0xc000
v_mfma_f32_16x16x32_bf16 v[144:147], v[80:83], v[224:227], v[144:147]
s_add_u32 s50, s44, 0x1b0100
TR 64,5,0
v_mfma_f32_16x16x32_bf16 v[144:147], v[84:87], v[240:243], v[144:147]
TR 66,5,512
MA 148,76,244
TR 68,5,8192
v_mfma_f32_16x16x32_bf16 v[148:151], v[80:83], v[228:231], v[148:151]
TR 70,5,8704
v_mfma_f32_16x16x32_bf16 v[148:151], v[84:87], v[244:247], v[148:151]
TR 72,5,16384
MA 152,76,248
TR 74,5,16896
v_mfma_f32_16x16x32_bf16 v[152:155], v[80:83], v[232:235], v[152:155]
buffer_load_dwordx4 v2, s[8:11], s50 offen lds
v_mfma_f32_16x16x32_bf16 v[152:155], v[84:87], v[248:251], v[152:155]
s_add_u32 m0, s43, 0xd000
MA 156,76,252
s_add_u32 s51, s44, 0x1b0100
v_mfma_f32_16x16x32_bf16 v[156:159], v[80:83], v[236:239], v[156:159]
v_mfma_f32_16x16x32_bf16 v[156:159], v[84:87], v[252:255], v[156:159]
s_waitcnt lgkmcnt(0)
v_mfma_f32_16x16x32_bf16 v[160:163], v[64:67], a[0:3], 0
TR 76,6,0
MA 160,68,16
TR 78,6,512
MA 160,72,32
TR 80,6,8192
v_mfma_f32_16x16x32_bf16 v[164:167], v[64:67], a[4:7], 0
TR 82,6,8704
MA 164,68,20
TR 84,6,16384
v_mul_f32 v128, v96, v128
v_mul_f32 v129, v97, v129
MA 164,72,36
TR 86,6,16896
v_exp_f32 v96, -v96
v_mfma_f32_16x16x32_bf16 v[168:171], v[64:67], a[8:11], 0
buffer_load_dwordx4 v2, s[12:15], s51 offen lds
MA 168,68,24
s_add_u32 m0, s43, 0xe000
v_exp_f32 v97, -v97
v_mul_f32 v130, v98, v130
MA 168,72,40
s_add_u32 s50, s44, 0x1f8100
v_exp_f32 v98, -v98
v_mul_f32 v131, v99, v131
v_mfma_f32_16x16x32_bf16 v[172:175], v[64:67], a[12:15], 0
v_exp_f32 v99, -v99
s_waitcnt vmcnt(6)
v_readlane_b32 s83, v45, s41
s_nop 0
s_add_u32 s83, s83, 15
s_andn2_b32 s83, s83, 15
v_cmp_le_u32 vcc, s83, v45
s_nop 1
v_cndmask_b32 v44, 0, v44, vcc
v_cmp_eq_u32 vcc, 1, v44
s_nop 1
s_and_b64 vcc, vcc, s[70:71]
s_cmp_eq_u64 vcc, s[70:71]
s_cbranch_scc1 L_S_poll_ok
s_mov_b32 s99, 0x40000
L_S_poll:
s_sub_u32 s99, s99, 1
s_cbranch_scc1 L_S_poll_ok
s_sleep 1
buffer_load_dword v45, v46, s[36:39], 0 offen sc1
buffer_load_dword v44, v91, s[20:23], 0 offen sc1
s_waitcnt vmcnt(0)
v_readlane_b32 s83, v45, s41
s_nop 0
s_add_u32 s83, s83, 15
s_andn2_b32 s83, s83, 15
v_cmp_le_u32 vcc, s83, v45
s_nop 1
v_cndmask_b32 v44, 0, v44, vcc
v_cmp_eq_u32 vcc, 1, v44
s_nop 1
s_and_b64 vcc, vcc, s[70:71]
s_cmp_eq_u64 vcc, s[70:71]
s_cbranch_scc0 L_S_poll
L_S_poll_ok:
MA 172,68,28
buffer_load_dwordx4 v[44:47], v60, s[32:35], 0 offen sc1
v_mul_f32 v144, v112, v144
v_mul_f32 v145, v113, v145
MA 172,72,44
buffer_load_dwordx4 v2, s[8:11], s50 offen lds
s_waitcnt lgkmcnt(0)
v_mfma_f32_16x16x32_bf16 v[176:179], v[76:79], a[0:3], 0
s_add_u32 m0, s43, 0xf000
TR 64,5,4096
v_exp_f32 v112, -v112
MA 176,80,16
s_add_u32 s51, s44, 0x1f8100
TR 66,5,4608
v_exp_f32 v113, -v113
MA 176,84,32
TR 68,5,12288
v_mul_f32 v146, v114, v146
v_mul_f32 v147, v115, v147
v_mfma_f32_16x16x32_bf16 v[180:183], v[76:79], a[4:7], 0
TR 70,5,12800
v_exp_f32 v114, -v114
MA 180,80,20
TR 72,5,20480
v_exp_f32 v115, -v115
MA 180,84,36
TR 74,5,20992
v_add_f32 v96, 1.0, v96
v_add_f32 v97, 1.0, v97
v_mfma_f32_16x16x32_bf16 v[184:187], v[76:79], a[8:11], 0
buffer_load_dwordx4 v2, s[12:15], s51 offen lds
MA 184,80,24
s_add_u32 m0, s43, 0x10000
buffer_load_dwordx4 v[48:51], v61, s[32:35], 0 offen sc1
v_rcp_f32 v96, v96
MA 184,84,40
s_add_u32 s50, s44, 0x240100
buffer_load_dwordx4 v[52:55], v62, s[32:35], 0 offen sc1
v_rcp_f32 v97, v97
v_mfma_f32_16x16x32_bf16 v[188:191], v[76:79], a[12:15], 0
buffer_load_dwordx4 v[56:59], v63, s[32:35], 0 offen sc1
v_add_f32 v98, 1.0, v98
v_add_f32 v99, 1.0, v99
MA 188,80,28
v_rcp_f32 v98, v98
v_add_f32 v112, 1.0, v112
MA 188,84,44
buffer_load_dwordx4 v2, s[8:11], s50 offen lds
s_waitcnt lgkmcnt(0)
v_mfma_f32_16x16x32_bf16 v[192:195], v[64:67], a[0:3], 0
s_add_u32 m0, s43, 0x11000
TR 76,6,4096
v_rcp_f32 v99, v99
MA 192,68,16
s_add_u32 s51, s44, 0x240100
TR 78,6,4608
v_rcp_f32 v112, v112
MA 192,72,32
TR 80,6,12288
v_add_f32 v113, 1.0, v113
v_add_f32 v114, 1.0, v114
v_mfma_f32_16x16x32_bf16 v[196:199], v[64:67], a[4:7], 0
TR 82,6,12800
v_rcp_f32 v113, v113
MA 196,68,20
TR 84,6,20480
v_rcp_f32 v114, v114
MA 196,72,36
TR 86,6,20992
v_add_f32 v115, 1.0, v115
v_mul_f32 v128, v128, v96
v_mfma_f32_16x16x32_bf16 v[200:203], v[64:67], a[8:11], 0
buffer_load_dwordx4 v2, s[12:15], s51 offen lds
MA 200,68,24
v_rcp_f32 v115, v115
v_mul_f32 v129, v129, v97
MA 200,72,40
v_mul_f32 v130, v130, v98
v_mul_f32 v131, v131, v99
v_mul_f32 v144, v144, v112
v_mfma_f32_16x16x32_bf16 v[204:207], v[64:67], a[12:15], 0
v_mul_f32 v145, v145, v113
v_mul_f32 v146, v146, v114
v_mul_f32 v147, v147, v115
MA 204,68,28
v_cvt_pk_bf16_f32 v96, v128, v129
v_cvt_pk_bf16_f32 v97, v130, v131
v_cvt_pk_bf16_f32 v98, v144, v145
MA 204,72,44
v_cvt_pk_bf16_f32 v99, v146, v147
v_mul_f32 v132, v100, v132
s_waitcnt lgkmcnt(0)
v_mfma_f32_16x16x32_bf16 v[208:211], v[76:79], a[0:3], 0
s_waitcnt vmcnt(10)
s_barrier
s_add_u32 m0, s43, 0x0
v_exp_f32 v100, -v100
v_mul_f32 v133, v101, v133
MA 208,80,16
s_add_u32 s50, s44, 0x288100
TR 64,5,24576
v_exp_f32 v101, -v101
MA 208,84,32
TR 66,5,25088
v_mul_f32 v134, v102, v134
v_mul_f32 v135, v103, v135
v_mfma_f32_16x16x32_bf16 v[212:215], v[76:79], a[4:7], 0
TR 68,5,32768
v_exp_f32 v102, -v102
MA 212,80,20
TR 70,5,33280
v_exp_f32 v103, -v103
MA 212,84,36
TR 72,5,40960
v_mul_f32 v148, v116, v148
v_mul_f32 v149, v117, v149
v_mfma_f32_16x16x32_bf16 v[216:219], v[76:79], a[8:11], 0
TR 74,5,41472
v_exp_f32 v116, -v116
MA 216,80,24
buffer_load_dwordx4 v2, s[8:11], s50 offen lds
MA 216,84,40
s_add_u32 m0, s43, 0x1000
v_exp_f32 v117, -v117
v_mul_f32 v150, v118, v150
v_mfma_f32_16x16x32_bf16 v[220:223], v[76:79], a[12:15], 0
s_add_u32 s51, s44, 0x288100
v_exp_f32 v118, -v118
v_mul_f32 v151, v119, v151
MA 220,80,28
v_exp_f32 v119, -v119
v_add_f32 v100, 1.0, v100
MA 220,84,44
v_rcp_f32 v100, v100
s_waitcnt lgkmcnt(0)
MA 160,64,48
TR 76,6,24576
v_add_f32 v101, 1.0, v101
v_add_f32 v102, 1.0, v102
MA 160,68,64
TR 78,6,25088
v_rcp_f32 v101, v101
MA 160,72,80
TR 80,6,32768
v_rcp_f32 v102, v102
MA 164,64,52
TR 82,6,33280
v_add_f32 v103, 1.0, v103
v_add_f32 v116, 1.0, v116
MA 164,68,68
TR 84,6,40960
v_rcp_f32 v103, v103
MA 164,72,84
TR 86,6,41472
v_rcp_f32 v116, v116
MA 168,64,56
buffer_load_dwordx4 v2, s[12:15], s51 offen lds
MA 168,68,72
s_add_u32 m0, s43, 0x2000
v_add_f32 v117, 1.0, v117
v_rcp_f32 v117, v117
MA 168,72,88
s_add_u32 s50, s44, 0x2d0100
v_add_f32 v118, 1.0, v118
v_rcp_f32 v118, v118
MA 172,64,60
v_add_f32 v119, 1.0, v119
v_rcp_f32 v119, v119
MA 172,68,76
v_mul_f32 v132, v132, v100
v_mul_f32 v133, v133, v101
v_mul_f32 v134, v134, v102
MA 172,72,92
buffer_load_dwordx4 v2, s[8:11], s50 offen lds
s_waitcnt lgkmcnt(0)
MA 176,76,48
s_add_u32 m0, s43, 0x3000
TR 64,5,28672
v_mul_f32 v135, v135, v103
v_mul_f32 v148, v148, v116
MA 176,80,64
s_add_u32 s51, s44, 0x2d0100
TR 66,5,29184
v_mul_f32 v149, v149, v117
v_mul_f32 v150, v150, v118
MA 176,84,80
TR 68,5,36864
v_mul_f32 v151, v151, v119
v_cvt_pk_bf16_f32 v100, v132, v133
MA 180,76,52
TR 70,5,37376
v_cvt_pk_bf16_f32 v101, v134, v135
v_cvt_pk_bf16_f32 v102, v148, v149
MA 180,80,68
TR 72,5,45056
v_cvt_pk_bf16_f32 v103, v150, v151
v_mul_f32 v136, v104, v136
MA 180,84,84
TR 74,5,45568
v_exp_f32 v104, -v104
MA 184,76,56
buffer_load_dwordx4 v2, s[12:15], s51 offen lds
MA 184,80,72
s_add_u32 m0, s43, 0x4000
v_mul_f32 v137, v105, v137
v_exp_f32 v105, -v105
MA 184,84,88
s_add_u32 s50, s44, 0x318100
v_mul_f32 v138, v106, v138
v_exp_f32 v106, -v106
MA 188,76,60
v_mul_f32 v139, v107, v139
v_exp_f32 v107, -v107
MA 188,80,76
v_mul_f32 v152, v120, v152
v_exp_f32 v120, -v120
MA 188,84,92
buffer_load_dwordx4 v2, s[8:11], s50 offen lds
s_waitcnt lgkmcnt(0)
MA 192,64,48
s_add_u32 m0, s43, 0x5000
TR 76,6,28672
s_waitcnt vmcnt(7)
v_fma_f32 v52, v32, v56, v52
MA 192,68,64
s_add_u32 s51, s44, 0x318100
TR 78,6,29184
v_fma_f32 v53, v32, v57, v53
v_fma_f32 v52, -v33, v57, v52
MA 192,72,80
TR 80,6,36864
v_fma_f32 v53, v33, v56, v53
v_fma_f32 v54, v34, v58, v54
MA 196,64,52
TR 82,6,37376
v_fma_f32 v55, v34, v59, v55
v_fma_f32 v54, -v35, v59, v54
MA 196,68,68
TR 84,6,45056
v_fma_f32 v55, v35, v58, v55
v_fma_f32 v48, v32, v52, v48
MA 196,72,84
TR 86,6,45568
v_fma_f32 v49, v32, v53, v49
v_fma_f32 v48, -v33, v53, v48
MA 200,64,56
buffer_load_dwordx4 v2, s[12:15], s51 offen lds
MA 200,68,72
v_fma_f32 v49, v33, v52, v49
v_fma_f32 v50, v34, v54, v50
v_fma_f32 v51, v34, v55, v51
MA 200,72,88
v_fma_f32 v50, -v35, v55, v50
v_fma_f32 v51, v35, v54, v51
v_fma_f32 v44, v32, v48, v44
MA 204,64,60
v_fma_f32 v45, v32, v49, v45
v_fma_f32 v44, -v33, v49, v44
v_fma_f32 v45, v33, v48, v45
MA 204,68,76
v_fma_f32 v46, v34, v50, v46
v_fma_f32 v47, v34, v51, v47
v_fma_f32 v46, -v35, v51, v46
MA 204,72,92
v_fma_f32 v47, v35, v50, v47
v_mul_f32 v48, v36, v44
s_waitcnt lgkmcnt(0)
MA 208,76,48
s_waitcnt vmcnt(6)
s_barrier
s_add_u32 m0, s43, 0x6000
v_mul_f32 v49, v36, v45
v_fma_f32 v48, -v37, v45, v48
MA 208,80,64
s_add_u32 s50, s44, 0x360100
TR 64,5,49152
v_fma_f32 v49, v37, v44, v49
v_mul_f32 v50, v38, v46
MA 208,84,80
TR 66,5,49664
v_mul_f32 v51, v38, v47
v_fma_f32 v50, -v39, v47, v50
MA 212,76,52
TR 68,5,57344
v_fma_f32 v51, v39, v46, v51
v_mov_b32 v52, v48
MA 212,80,68
TR 70,5,57856
v_mov_b32 v53, v49
v_mov_b32 v54, v50
MA 212,84,84
TR 72,7,0
v_mov_b32 v55, v51
v_permlane16_swap_b32 v48, v52
MA 216,76,56
TR 74,7,512
v_permlane16_swap_b32 v49, v53
v_permlane16_swap_b32 v50, v54
MA 216,80,72
buffer_load_dwordx4 v2, s[8:11], s50 offen lds
MA 216,84,88
s_add_u32 m0, s43, 0x7000
v_permlane16_swap_b32 v51, v55
v_add_f32 v48, v48, v52
v_add_f32 v49, v49, v53
MA 220,76,60
s_add_u32 s51, s44, 0x360100
v_add_f32 v50, v50, v54
v_add_f32 v51, v51, v55
v_mov_b32 v52, v48
MA 220,80,76
v_mov_b32 v53, v49
v_mov_b32 v54, v50
v_mov_b32 v55, v51
MA 220,84,92
ds_read_b128 v[28:31], v90 offset:0
v_permlane32_swap_b32 v48, v52
s_waitcnt lgkmcnt(1)
MA 160,64,96
TR 76,6,49152
v_permlane32_swap_b32 v49, v53
v_permlane32_swap_b32 v50, v54
MA 160,68,112
TR 78,6,49664
v_permlane32_swap_b32 v51, v55
v_add_f32 v48, v48, v52
MA 160,72,128
TR 80,6,57344
v_add_f32 v49, v49, v53
v_add_f32 v50, v50, v54
MA 164,64,100
TR 82,6,57856
v_add_f32 v51, v51, v55
v_fma_f32 v24, v40, v48, v24
MA 164,68,116
TR 84,8,0
v_fma_f32 v25, v40, v49, v25
v_fma_f32 v24, -v41, v49, v24
MA 164,72,132
TR 86,8,512
v_fma_f32 v25, v41, v48, v25
v_fma_f32 v26, v42, v50, v26
MA 168,64,104
buffer_load_dwordx4 v2, s[12:15], s51 offen lds
MA 168,68,120
s_add_u32 m0, s43, 0x8000
ds_read_b128 v[32:35], v90 offset:1024
v_fma_f32 v27, v42, v51, v27
v_fma_f32 v26, -v43, v51, v26
MA 168,72,136
s_add_u32 s50, s44, 0x3a8100
ds_read_b128 v[36:39], v90 offset:2048
v_fma_f32 v27, v43, v50, v27
v_and_b32 v92, 15, v0
MA 172,64,108
ds_read_b128 v[40:43], v90 offset:3072
v_bfe_u32 v91, v0, 4, 2
v_lshlrev_b32 v91, 2, v91
MA 172,68,124
ds_read_b128 v[44:47], v90 offset:4096
v_xor_b32 v91, v91, v92
v_lshlrev_b32 v91, 3, v91
MA 172,72,140
buffer_load_dwordx4 v2, s[8:11], s50 offen lds
s_waitcnt lgkmcnt(4)
MA 176,76,96
s_add_u32 m0, s43, 0x9000
TR 64,5,53248
v_lshl_add_u32 v91, v92, 8, v91
v_add_u32 v91, s78, v91
MA 176,80,112
s_add_u32 s51, s44, 0x3a8100
TR 66,5,53760
v_mul_f32 v153, v121, v153
v_mul_f32 v154, v122, v154
MA 176,84,128
TR 68,5,61440
v_exp_f32 v121, -v121
MA 180,76,100
TR 70,5,61952
v_exp_f32 v122, -v122
MA 180,80,116
TR 72,7,4096
v_mul_f32 v155, v123, v155
v_add_f32 v104, 1.0, v104
MA 180,84,132
TR 74,7,4608
v_exp_f32 v123, -v123
MA 184,76,104
buffer_load_dwordx4 v2, s[12:15], s51 offen lds
MA 184,80,120
s_add_u32 m0, s43, 0xa000
ds_read_b128 v[48:51], v90 offset:5120
v_rcp_f32 v104, v104
MA 184,84,136
s_add_u32 s50, s44, 0x3f0100
ds_read_b128 v[52:55], v90 offset:6144
v_add_f32 v105, 1.0, v105
v_add_f32 v106, 1.0, v106
MA 188,76,108
ds_read_b128 v[56:59], v90 offset:7168
v_rcp_f32 v105, v105
MA 188,80,124
v_rcp_f32 v106, v106
v_add_f32 v107, 1.0, v107
MA 188,84,140
buffer_load_dwordx4 v2, s[8:11], s50 offen lds
s_waitcnt lgkmcnt(3)
MA 192,64,96
s_add_u32 m0, s43, 0xb000
TR 76,6,53248
v_rcp_f32 v107, v107
MA 192,68,112
s_add_u32 s51, s44, 0x3f0100
TR 78,6,53760
v_add_f32 v120, 1.0, v120
v_add_f32 v121, 1.0, v121
MA 192,72,128
TR 80,6,61440
v_rcp_f32 v120, v120
MA 196,64,100
TR 82,6,61952
v_rcp_f32 v121, v121
MA 196,68,116
TR 84,8,4096
v_add_f32 v122, 1.0, v122
v_add_f32 v123, 1.0, v123
MA 196,72,132
TR 86,8,4608
v_rcp_f32 v122, v122
MA 200,64,104
buffer_load_dwordx4 v2, s[12:15], s51 offen lds
MA 200,68,120
v_rcp_f32 v123, v123
s_waitcnt lgkmcnt(6)
v_fma_f32 v28, v18, v26, v28
MA 200,72,136
v_fma_f32 v44, v18, v27, v44
v_fma_f32 v28, -v19, v27, v28
v_fma_f32 v44, v19, v26, v44
MA 204,64,108
v_mul_f32 v60, v22, v28
v_mul_f32 v62, v22, v44
v_fma_f32 v60, -v23, v44, v60
MA 204,68,124
v_fma_f32 v62, -v23, v28, -v62
v_fma_f32 v29, v18, v28, v29
v_fma_f32 v45, v18, v44, v45
MA 204,72,140
v_fma_f32 v29, -v19, v44, v29
v_fma_f32 v45, v19, v28, v45
s_waitcnt lgkmcnt(0)
MA 208,76,96
s_waitcnt vmcnt(6)
s_barrier
s_add_u32 m0, s43, 0xc000
v_mul_f32 v61, v22, v29
v_mul_f32 v63, v22, v45
MA 208,80,112
s_add_u32 s50, s44, 0x438100
TR 64,5,0
v_fma_f32 v61, -v23, v45, v61
v_fma_f32 v63, -v23, v29, -v63
MA 208,84,128
TR 66,5,512
v_cvt_pk_bf16_f32 v88, v60, v61
v_cvt_pk_bf16_f32 v92, v62, v63
MA 212,76,100
TR 68,5,8192
v_fma_f32 v30, v18, v29, v30
v_fma_f32 v46, v18, v45, v46
MA 212,80,116
TR 70,5,8704
v_fma_f32 v30, -v19, v45, v30
v_fma_f32 v46, v19, v29, v46
MA 212,84,132
TR 72,5,16384
v_mul_f32 v60, v22, v30
v_mul_f32 v62, v22, v46
MA 216,76,104
TR 74,5,16896
v_fma_f32 v60, -v23, v46, v60
v_fma_f32 v62, -v23, v30, -v62
MA 216,80,120
buffer_load_dwordx4 v2, s[8:11], s50 offen lds
MA 216,84,136
s_add_u32 m0, s43, 0xd000
v_fma_f32 v31, v18, v30, v31
v_fma_f32 v47, v18, v46, v47
v_fma_f32 v31, -v19, v46, v31
MA 220,76,108
s_add_u32 s51, s44, 0x438100
v_fma_f32 v47, v19, v30, v47
v_mul_f32 v61, v22, v31
v_mul_f32 v63, v22, v47
MA 220,80,124
v_fma_f32 v61, -v23, v47, v61
v_fma_f32 v63, -v23, v31, -v63
v_cvt_pk_bf16_f32 v89, v60, v61
MA 220,84,140
v_cvt_pk_bf16_f32 v93, v62, v63
v_xor_b32 v94, 0, v91
s_waitcnt lgkmcnt(0)
MA 160,64,144
TR 76,6,0
v_fma_f32 v32, v18, v31, v32
v_fma_f32 v48, v18, v47, v48
MA 160,68,160
TR 78,6,512
v_fma_f32 v32, -v19, v47, v32
v_fma_f32 v48, v19, v31, v48
MA 160,72,176
TR 80,6,8192
v_mul_f32 v60, v22, v32
v_mul_f32 v62, v22, v48
MA 164,64,148
TR 82,6,8704
v_fma_f32 v60, -v23, v48, v60
v_fma_f32 v62, -v23, v32, -v62
MA 164,68,164
TR 84,6,16384
v_fma_f32 v33, v18, v32, v33
v_fma_f32 v49, v18, v48, v49
MA 164,72,180
TR 86,6,16896
v_fma_f32 v33, -v19, v48, v33
v_fma_f32 v49, v19, v32, v49
MA 168,64,152
buffer_load_dwordx4 v2, s[12:15], s51 offen lds
MA 168,68,168
s_add_u32 m0, s43, 0xe000
ds_write_b64 v94, v[88:89] offset:128
v_mul_f32 v61, v22, v33
MA 168,72,184
s_add_u32 s50, s44, 0x480100
ds_write_b64 v94, v[92:93] offset:4224
v_mul_f32 v63, v22, v49
MA 172,64,156
v_fma_f32 v61, -v23, v49, v61
v_fma_f32 v63, -v23, v33, -v63
v_cvt_pk_bf16_f32 v88, v60, v61
MA 172,68,172
v_cvt_pk_bf16_f32 v92, v62, v63
v_fma_f32 v34, v18, v33, v34
v_fma_f32 v50, v18, v49, v50
MA 172,72,188
buffer_load_dwordx4 v2, s[8:11], s50 offen lds
s_waitcnt lgkmcnt(2)
MA 176,76,144
s_add_u32 m0, s43, 0xf000
TR 64,5,4096
v_fma_f32 v34, -v19, v49, v34
v_fma_f32 v50, v19, v33, v50
MA 176,80,160
s_add_u32 s51, s44, 0x480100
TR 66,5,4608
v_mul_f32 v60, v22, v34
v_mul_f32 v62, v22, v50
MA 176,84,176
TR 68,5,12288
v_fma_f32 v60, -v23, v50, v60
v_fma_f32 v62, -v23, v34, -v62
MA 180,76,148
TR 70,5,12800
v_fma_f32 v35, v18, v34, v35
v_fma_f32 v51, v18, v50, v51
MA 180,80,164
TR 72,5,20480
v_fma_f32 v35, -v19, v50, v35
v_fma_f32 v51, v19, v34, v51
MA 180,84,180
TR 74,5,20992
v_mul_f32 v61, v22, v35
v_mul_f32 v63, v22, v51
MA 184,76,152
buffer_load_dwordx4 v2, s[12:15], s51 offen lds
MA 184,80,168
s_add_u32 m0, s43, 0x10000
v_fma_f32 v61, -v23, v51, v61
v_fma_f32 v63, -v23, v35, -v63
v_cvt_pk_bf16_f32 v89, v60, v61
MA 184,84,184
s_add_u32 s50, s44, 0x4c8100
v_cvt_pk_bf16_f32 v93, v62, v63
v_xor_b32 v94, 8, v91
v_fma_f32 v36, v18, v35, v36
MA 188,76,156
ds_write_b64 v94, v[88:89] offset:128
v_fma_f32 v52, v18, v51, v52
MA 188,80,172
ds_write_b64 v94, v[92:93] offset:4224
v_fma_f32 v36, -v19, v51, v36
MA 188,84,188
buffer_load_dwordx4 v2, s[8:11], s50 offen lds
s_waitcnt lgkmcnt(2)
MA 192,64,144
s_add_u32 m0, s43, 0x11000
TR 76,6,4096
v_fma_f32 v52, v19, v35, v52
v_mul_f32 v60, v22, v36
MA 192,68,160
s_add_u32 s51, s44, 0x4c8100
TR 78,6,4608
v_mul_f32 v62, v22, v52
v_fma_f32 v60, -v23, v52, v60
MA 192,72,176
TR 80,6,12288
v_fma_f32 v62, -v23, v36, -v62
v_fma_f32 v37, v18, v36, v37
MA 196,64,148
TR 82,6,12800
v_fma_f32 v53, v18, v52, v53
v_fma_f32 v37, -v19, v52, v37
MA 196,68,164
TR 84,6,20480
v_fma_f32 v53, v19, v36, v53
v_mul_f32 v61, v22, v37
MA 196,72,180
TR 86,6,20992
v_mul_f32 v63, v22, v53
v_fma_f32 v61, -v23, v53, v61
MA 200,64,152
buffer_load_dwordx4 v2, s[12:15], s51 offen lds
MA 200,68,168
v_fma_f32 v63, -v23, v37, -v63
v_cvt_pk_bf16_f32 v88, v60, v61
v_cvt_pk_bf16_f32 v92, v62, v63
MA 200,72,184
v_fma_f32 v38, v18, v37, v38
v_fma_f32 v54, v18, v53, v54
v_fma_f32 v38, -v19, v53, v38
MA 204,64,156
v_fma_f32 v54, v19, v37, v54
v_mul_f32 v60, v22, v38
v_mul_f32 v62, v22, v54
MA 204,68,172
v_fma_f32 v60, -v23, v54, v60
v_fma_f32 v62, -v23, v38, -v62
v_fma_f32 v39, v18, v38, v39
MA 204,72,188
v_fma_f32 v55, v18, v54, v55
v_fma_f32 v39, -v19, v54, v39
s_waitcnt lgkmcnt(0)
MA 208,76,144
s_waitcnt vmcnt(6)
s_barrier
s_add_u32 m0, s43, 0x0
v_fma_f32 v55, v19, v38, v55
v_mul_f32 v61, v22, v39
MA 208,80,160
s_add_u32 s50, s44, 0x180
TR 64,5,24576
v_mul_f32 v63, v22, v55
v_fma_f32 v61, -v23, v55, v61
MA 208,84,176
TR 66,5,25088
v_fma_f32 v63, -v23, v39, -v63
v_cvt_pk_bf16_f32 v89, v60, v61
MA 212,76,148
TR 68,5,32768
v_cvt_pk_bf16_f32 v93, v62, v63
v_xor_b32 v94, 16, v91
MA 212,80,164
TR 70,5,33280
v_fma_f32 v40, v18, v39, v40
v_fma_f32 v56, v18, v55, v56
MA 212,84,180
TR 72,5,40960
v_fma_f32 v40, -v19, v55, v40
v_fma_f32 v56, v19, v39, v56
MA 216,76,152
TR 74,5,41472
v_mul_f32 v60, v22, v40
v_mul_f32 v62, v22, v56
MA 216,80,168
buffer_load_dwordx4 v2, s[8:11], s50 offen lds
MA 216,84,184
s_add_u32 m0, s43, 0x1000
ds_write_b64 v94, v[88:89] offset:128
v_fma_f32 v60, -v23, v56, v60
MA 220,76,156
s_add_u32 s51, s44, 0x180
ds_write_b64 v94, v[92:93] offset:4224
v_fma_f32 v62, -v23, v40, -v62
MA 220,80,172
v_fma_f32 v41, v18, v40, v41
v_fma_f32 v57, v18, v56, v57
v_fma_f32 v41, -v19, v56, v41
MA 220,84,188
v_fma_f32 v57, v19, v40, v57
v_mul_f32 v61, v22, v41
s_waitcnt lgkmcnt(2)
MA 160,64,192
TR 76,6,24576
v_mul_f32 v63, v22, v57
v_fma_f32 v61, -v23, v57, v61
MA 160,68,208
TR 78,6,25088
v_fma_f32 v63, -v23, v41, -v63
v_cvt_pk_bf16_f32 v88, v60, v61
MA 160,72,224
TR 80,6,32768
v_cvt_pk_bf16_f32 v92, v62, v63
v_fma_f32 v42, v18, v41, v42
MA 164,64,196
TR 82,6,33280
v_fma_f32 v58, v18, v57, v58
v_fma_f32 v42, -v19, v57, v42
MA 164,68,212
TR 84,6,40960
v_fma_f32 v58, v19, v41, v58
v_mul_f32 v60, v22, v42
MA 164,72,228
TR 86,6,41472
v_mul_f32 v62, v22, v58
v_fma_f32 v60, -v23, v58, v60
MA 168,64,200
buffer_load_dwordx4 v2, s[12:15], s51 offen lds
MA 168,68,216
s_add_u32 m0, s43, 0x2000
v_fma_f32 v62, -v23, v42, -v62
v_fma_f32 v43, v18, v42, v43
v_fma_f32 v59, v18, v58, v59
MA 168,72,232
s_add_u32 s50, s44, 0x48180
v_fma_f32 v43, -v19, v58, v43
v_fma_f32 v59, v19, v42, v59
v_mul_f32 v61, v22, v43
MA 172,64,204
v_mul_f32 v63, v22, v59
v_fma_f32 v61, -v23, v59, v61
v_fma_f32 v63, -v23, v43, -v63
MA 172,68,220
v_cvt_pk_bf16_f32 v89, v60, v61
v_cvt_pk_bf16_f32 v93, v62, v63
v_xor_b32 v94, 24, v91
MA 172,72,236
buffer_load_dwordx4 v2, s[8:11], s50 offen lds
s_waitcnt lgkmcnt(0)
MA 176,76,192
s_add_u32 m0, s43, 0x3000
TR 64,5,28672
v_mul_f32 v136, v136, v104
v_mul_f32 v137, v137, v105
MA 176,80,208
s_add_u32 s51, s44, 0x48180
TR 66,5,29184
v_mul_f32 v138, v138, v106
v_mul_f32 v139, v139, v107
MA 176,84,224
TR 68,5,36864
v_mul_f32 v152, v152, v120
v_mul_f32 v153, v153, v121
MA 180,76,196
TR 70,5,37376
v_mul_f32 v154, v154, v122
v_mul_f32 v155, v155, v123
MA 180,80,212
TR 72,5,45056
v_cvt_pk_bf16_f32 v104, v136, v137
v_cvt_pk_bf16_f32 v105, v138, v139
MA 180,84,228
TR 74,5,45568
v_cvt_pk_bf16_f32 v106, v152, v153
v_cvt_pk_bf16_f32 v107, v154, v155
MA 184,76,200
buffer_load_dwordx4 v2, s[12:15], s51 offen lds
MA 184,80,216
s_add_u32 m0, s43, 0x4000
ds_write_b64 v94, v[88:89] offset:128
v_mul_f32 v140, v108, v140
MA 184,84,232
s_add_u32 s50, s44, 0x90180
ds_write_b64 v94, v[92:93] offset:4224
v_mul_f32 v141, v109, v141
MA 188,76,204
ds_read_b128 v[28:31], v90 offset:32768
v_exp_f32 v108, -v108
MA 188,80,220
ds_read_b128 v[32:35], v90 offset:33792
v_exp_f32 v109, -v109
MA 188,84,236
buffer_load_dwordx4 v2, s[8:11], s50 offen lds
s_waitcnt lgkmcnt(4)
MA 192,64,192
s_add_u32 m0, s43, 0x5000
TR 76,6,28672
v_mul_f32 v142, v110, v142
v_mul_f32 v143, v111, v143
MA 192,68,208
s_add_u32 s51, s44, 0x90180
TR 78,6,29184
v_exp_f32 v110, -v110
MA 192,72,224
TR 80,6,36864
v_exp_f32 v111, -v111
MA 196,64,196
TR 82,6,37376
v_mul_f32 v156, v124, v156
v_mul_f32 v157, v125, v157
MA 196,68,212
TR 84,6,45056
v_exp_f32 v124, -v124
MA 196,72,228
TR 86,6,45568
v_exp_f32 v125, -v125
MA 200,64,200
buffer_load_dwordx4 v2, s[12:15], s51 offen lds
MA 200,68,216
ds_read_b128 v[36:39], v90 offset:34816
v_mul_f32 v158, v126, v158
v_mul_f32 v159, v127, v159
MA 200,72,232
ds_read_b128 v[40:43], v90 offset:35840
v_exp_f32 v126, -v126
MA 204,64,204
v_exp_f32 v127, -v127
v_add_f32 v108, 1.0, v108
MA 204,68,220
v_rcp_f32 v108, v108
v_add_f32 v109, 1.0, v109
MA 204,72,236
v_add_f32 v110, 1.0, v110
s_waitcnt lgkmcnt(2)
MA 208,76,192
s_waitcnt vmcnt(6)
s_waitcnt lgkmcnt(0)
s_barrier
s_add_u32 m0, s43, 0x6000
ds_read_b128 v[44:47], v90 offset:36864
MA 208,80,208
s_add_u32 s50, s44, 0xd8180
TR 64,5,49152
v_add_f32 v111, 1.0, v111
MA 208,84,224
TR 66,5,49664
v_add_f32 v124, 1.0, v124
MA 212,76,196
TR 68,5,57344
v_add_f32 v125, 1.0, v125
MA 212,80,212
TR 70,5,57856
v_add_f32 v126, 1.0, v126
MA 212,84,228
TR 72,7,0
v_add_f32 v127, 1.0, v127
MA 216,76,200
TR 74,7,512
v_mul_f32 v140, v140, v108
MA 216,80,216
buffer_load_dwordx4 v2, s[8:11], s50 offen lds
MA 216,84,232
s_add_u32 m0, s43, 0x7000
ds_read_b128 v[48:51], v90 offset:37888
MA 220,76,204
s_add_u32 s51, s44, 0xd8180
ds_read_b128 v[52:55], v90 offset:38912
MA 220,80,220
ds_read_b128 v[56:59], v90 offset:39936
MA 220,84,236
s_waitcnt lgkmcnt(3)
MA 160,64,240
TR 76,6,49152
v_rcp_f32 v109, v109
v_mfma_f32_16x16x32_bf16 v[160:163], v[68:71], v[224:227], v[160:163]
TR 78,6,49664
v_rcp_f32 v110, v110
v_mfma_f32_16x16x32_bf16 v[160:163], v[72:75], v[240:243], v[160:163]
TR 80,6,57344
v_rcp_f32 v111, v111
MA 164,64,244
TR 82,6,57856
v_rcp_f32 v124, v124
v_mfma_f32_16x16x32_bf16 v[164:167], v[68:71], v[228:231], v[164:167]
TR 84,8,0
v_rcp_f32 v125, v125
v_mfma_f32_16x16x32_bf16 v[164:167], v[72:75], v[244:247], v[164:167]
TR 86,8,512
v_rcp_f32 v126, v126
MA 168,64,248
buffer_load_dwordx4 v2, s[12:15], s51 offen lds
v_mfma_f32_16x16x32_bf16 v[168:171], v[68:71], v[232:235], v[168:171]
s_add_u32 m0, s43, 0x8000
v_rcp_f32 v127, v127
s_waitcnt lgkmcnt(6)
v_fma_f32 v28, v16, v24, v28
v_mfma_f32_16x16x32_bf16 v[168:171], v[72:75], v[248:251], v[168:171]
s_add_u32 s50, s44, 0x120180
v_fma_f32 v44, v16, v25, v44
v_fma_f32 v28, -v17, v25, v28
v_fma_f32 v44, v17, v24, v44
MA 172,64,252
v_mul_f32 v60, v20, v28
v_mul_f32 v62, v20, v44
v_fma_f32 v60, -v21, v44, v60
v_mfma_f32_16x16x32_bf16 v[172:175], v[68:71], v[236:239], v[172:175]
v_fma_f32 v62, -v21, v28, -v62
v_fma_f32 v29, v16, v28, v29
v_fma_f32 v45, v16, v44, v45
v_mfma_f32_16x16x32_bf16 v[172:175], v[72:75], v[252:255], v[172:175]
buffer_load_dwordx4 v2, s[8:11], s50 offen lds
s_waitcnt lgkmcnt(0)
MA 176,76,240
s_add_u32 m0, s43, 0x9000
TR 64,5,53248
v_fma_f32 v29, -v17, v44, v29
v_fma_f32 v45, v17, v28, v45
v_mfma_f32_16x16x32_bf16 v[176:179], v[80:83], v[224:227], v[176:179]
s_add_u32 s51, s44, 0x120180
TR 66,5,53760
v_mul_f32 v61, v20, v29
v_mul_f32 v63, v20, v45
v_mfma_f32_16x16x32_bf16 v[176:179], v[84:87], v[240:243], v[176:179]
TR 68,5,61440
v_fma_f32 v61, -v21, v45, v61
v_fma_f32 v63, -v21, v29, -v63
MA 180,76,244
TR 70,5,61952
v_cvt_pk_bf16_f32 v88, v60, v61
v_cvt_pk_bf16_f32 v92, v62, v63
v_mfma_f32_16x16x32_bf16 v[180:183], v[80:83], v[228:231], v[180:183]
TR 72,7,4096
v_fma_f32 v30, v16, v29, v30
v_fma_f32 v46, v16, v45, v46
v_mfma_f32_16x16x32_bf16 v[180:183], v[84:87], v[244:247], v[180:183]
TR 74,7,4608
v_fma_f32 v30, -v17, v45, v30
v_fma_f32 v46, v17, v29, v46
MA 184,76,248
buffer_load_dwordx4 v2, s[12:15], s51 offen lds
v_mfma_f32_16x16x32_bf16 v[184:187], v[80:83], v[232:235], v[184:187]
s_add_u32 m0, s43, 0xa000
v_mul_f32 v60, v20, v30
v_mul_f32 v62, v20, v46
v_fma_f32 v60, -v21, v46, v60
v_mfma_f32_16x16x32_bf16 v[184:187], v[84:87], v[248:251], v[184:187]
s_add_u32 s50, s44, 0x168180
v_fma_f32 v62, -v21, v30, -v62
v_fma_f32 v31, v16, v30, v31
v_fma_f32 v47, v16, v46, v47
MA 188,76,252
v_fma_f32 v31, -v17, v46, v31
v_fma_f32 v47, v17, v30, v47
v_mul_f32 v61, v20, v31
v_mfma_f32_16x16x32_bf16 v[188:191], v[80:83], v[236:239], v[188:191]
v_mul_f32 v63, v20, v47
v_fma_f32 v61, -v21, v47, v61
v_mfma_f32_16x16x32_bf16 v[188:191], v[84:87], v[252:255], v[188:191]
buffer_load_dwordx4 v2, s[8:11], s50 offen lds
s_waitcnt lgkmcnt(0)
MA 192,64,240
s_add_u32 m0, s43, 0xb000
TR 76,6,53248
v_fma_f32 v63, -v21, v31, -v63
v_mfma_f32_16x16x32_bf16 v[192:195], v[68:71], v[224:227], v[192:195]
s_add_u32 s51, s44, 0x168180
TR 78,6,53760
v_cvt_pk_bf16_f32 v89, v60, v61
v_mfma_f32_16x16x32_bf16 v[192:195], v[72:75], v[240:243], v[192:195]
TR 80,6,61440
v_cvt_pk_bf16_f32 v93, v62, v63
MA 196,64,244
TR 82,6,61952
v_xor_b32 v94, 0, v91
v_mfma_f32_16x16x32_bf16 v[196:199], v[68:71], v[228:231], v[196:199]
TR 84,8,4096
v_fma_f32 v32, v16, v31, v32
v_mfma_f32_16x16x32_bf16 v[196:199], v[72:75], v[244:247], v[196:199]
TR 86,8,4608
v_fma_f32 v48, v16, v47, v48
MA 200,64,248
buffer_load_dwordx4 v2, s[12:15], s51 offen lds
v_mfma_f32_16x16x32_bf16 v[200:203], v[68:71], v[232:235], v[200:203]
ds_write_b64 v94, v[88:89] offset:0
v_mfma_f32_16x16x32_bf16 v[200:203], v[72:75], v[248:251], v[200:203]
ds_write_b64 v94, v[92:93] offset:4096
MA 204,64,252
v_fma_f32 v32, -v17, v47, v32
v_fma_f32 v48, v17, v31, v48
v_mfma_f32_16x16x32_bf16 v[204:207], v[68:71], v[236:239], v[204:207]
v_mul_f32 v60, v20, v32
v_mul_f32 v62, v20, v48
v_mfma_f32_16x16x32_bf16 v[204:207], v[72:75], v[252:255], v[204:207]
v_fma_f32 v60, -v21, v48, v60
s_waitcnt lgkmcnt(2)
MA 208,76,240
s_waitcnt vmcnt(6)
s_waitcnt lgkmcnt(0)
s_barrier
s_add_u32 m0, s43, 0xc000
ds_write_b128 v11, v[96:99] offset:32768
v_mfma_f32_16x16x32_bf16 v[208:211], v[80:83], v[224:227], v[208:211]
s_add_u32 s50, s44, 0x1b0180
TR 64,5,0
v_fma_f32 v62, -v21, v32, -v62
v_mfma_f32_16x16x32_bf16 v[208:211], v[84:87], v[240:243], v[208:211]
TR 66,5,512
v_fma_f32 v33, v16, v32, v33
MA 212,76,244
TR 68,5,8192
v_fma_f32 v49, v16, v48, v49
v_mfma_f32_16x16x32_bf16 v[212:215], v[80:83], v[228:231], v[212:215]
TR 70,5,8704
v_fma_f32 v33, -v17, v48, v33
v_mfma_f32_16x16x32_bf16 v[212:215], v[84:87], v[244:247], v[212:215]
TR 72,5,16384
v_fma_f32 v49, v17, v32, v49
MA 216,76,248
TR 74,5,16896
v_mul_f32 v61, v20, v33
v_mfma_f32_16x16x32_bf16 v[216:219], v[80:83], v[232:235], v[216:219]
buffer_load_dwordx4 v2, s[8:11], s50 offen lds
v_mfma_f32_16x16x32_bf16 v[216:219], v[84:87], v[248:251], v[216:219]
s_add_u32 m0, s43, 0xd000
ds_write_b128 v11, v[100:103] offset:33792
MA 220,76,252
s_add_u32 s51, s44, 0x1b0180
ds_write_b128 v11, v[104:107] offset:34816
v_mfma_f32_16x16x32_bf16 v[220:223], v[80:83], v[236:239], v[220:223]
v_mul_f32 v63, v20, v49
v_fma_f32 v61, -v21, v49, v61
v_mfma_f32_16x16x32_bf16 v[220:223], v[84:87], v[252:255], v[220:223]
v_fma_f32 v63, -v21, v33, -v63
v_mul_f32 v141, v141, v109
v_mul_f32 v142, v142, v110
v_mul_f32 v143, v143, v111
v_mul_f32 v156, v156, v124
v_mul_f32 v157, v157, v125
v_mul_f32 v158, v158, v126
v_mul_f32 v159, v159, v127
v_cvt_pk_bf16_f32 v108, v140, v141
v_cvt_pk_bf16_f32 v109, v142, v143
v_cvt_pk_bf16_f32 v110, v156, v157
v_cvt_pk_bf16_f32 v111, v158, v159
ds_write_b128 v11, v[108:111] offset:35840
s_waitcnt lgkmcnt(3)
v_mfma_f32_16x16x32_bf16 v[96:99], v[64:67], a[0:3], 0
TR 76,6,0
v_cvt_pk_bf16_f32 v88, v60, v61
v_cvt_pk_bf16_f32 v92, v62, v63
MA 96,68,16
TR 78,6,512
v_fma_f32 v34, v16, v33, v34
v_fma_f32 v50, v16, v49, v50
MA 96,72,32
TR 80,6,8192
v_fma_f32 v34, -v17, v49, v34
v_fma_f32 v50, v17, v33, v50
v_mfma_f32_16x16x32_bf16 v[100:103], v[64:67], a[4:7], 0
TR 82,6,8704
v_mul_f32 v60, v20, v34
v_mul_f32 v62, v20, v50
MA 100,68,20
TR 84,6,16384
v_fma_f32 v60, -v21, v50, v60
v_fma_f32 v62, -v21, v34, -v62
MA 100,72,36
TR 86,6,16896
v_fma_f32 v35, v16, v34, v35
v_fma_f32 v51, v16, v50, v51
v_mfma_f32_16x16x32_bf16 v[104:107], v[64:67], a[8:11], 0
buffer_load_dwordx4 v2, s[12:15], s51 offen lds
MA 104,68,24
s_add_u32 m0, s43, 0xe000
v_fma_f32 v35, -v17, v50, v35
v_fma_f32 v51, v17, v34, v51
v_mul_f32 v61, v20, v35
MA 104,72,40
s_add_u32 s50, s44, 0x1f8180
v_mul_f32 v63, v20, v51
v_fma_f32 v61, -v21, v51, v61
v_fma_f32 v63, -v21, v35, -v63
v_mfma_f32_16x16x32_bf16 v[108:111], v[64:67], a[12:15], 0
v_cvt_pk_bf16_f32 v89, v60, v61
v_cvt_pk_bf16_f32 v93, v62, v63
v_xor_b32 v94, 8, v91
MA 108,68,28
ds_write_b64 v94, v[88:89] offset:0
MA 108,72,44
buffer_load_dwordx4 v2, s[8:11], s50 offen lds
s_waitcnt lgkmcnt(1)
v_mfma_f32_16x16x32_bf16 v[112:115], v[76:79], a[0:3], 0
s_add_u32 m0, s43, 0xf000
TR 64,5,4096
v_fma_f32 v36, v16, v35, v36
MA 112,80,16
s_add_u32 s51, s44, 0x1f8180
TR 66,5,4608
v_fma_f32 v52, v16, v51, v52
MA 112,84,32
TR 68,5,12288
v_fma_f32 v36, -v17, v51, v36
v_mfma_f32_16x16x32_bf16 v[116:119], v[76:79], a[4:7], 0
TR 70,5,12800
v_fma_f32 v52, v17, v35, v52
MA 116,80,20
TR 72,5,20480
v_mul_f32 v60, v20, v36
MA 116,84,36
TR 74,5,20992
v_mul_f32 v62, v20, v52
v_mfma_f32_16x16x32_bf16 v[120:123], v[76:79], a[8:11], 0
buffer_load_dwordx4 v2, s[12:15], s51 offen lds
MA 120,80,24
s_add_u32 m0, s43, 0x10000
ds_write_b64 v94, v[92:93] offset:4096
MA 120,84,40
s_add_u32 s50, s44, 0x240180
v_fma_f32 v60, -v21, v52, v60
v_fma_f32 v62, -v21, v36, -v62
v_mfma_f32_16x16x32_bf16 v[124:127], v[76:79], a[12:15], 0
v_fma_f32 v37, v16, v36, v37
v_fma_f32 v53, v16, v52, v53
MA 124,80,28
v_fma_f32 v37, -v17, v52, v37
v_fma_f32 v53, v17, v36, v53
MA 124,84,44
buffer_load_dwordx4 v2, s[8:11], s50 offen lds
s_waitcnt lgkmcnt(1)
v_mfma_f32_16x16x32_bf16 v[128:131], v[64:67], a[0:3], 0
s_add_u32 m0, s43, 0x11000
TR 76,6,4096
v_mul_f32 v61, v20, v37
MA 128,68,16
s_add_u32 s51, s44, 0x240180
TR 78,6,4608
v_mul_f32 v63, v20, v53
MA 128,72,32
TR 80,6,12288
v_fma_f32 v61, -v21, v53, v61
v_mfma_f32_16x16x32_bf16 v[132:135], v[64:67], a[4:7], 0
TR 82,6,12800
v_fma_f32 v63, -v21, v37, -v63
MA 132,68,20
TR 84,6,20480
v_cvt_pk_bf16_f32 v88, v60, v61
MA 132,72,36
TR 86,6,20992
v_cvt_pk_bf16_f32 v92, v62, v63
v_mfma_f32_16x16x32_bf16 v[136:139], v[64:67], a[8:11], 0
buffer_load_dwordx4 v2, s[12:15], s51 offen lds
MA 136,68,24
v_fma_f32 v38, v16, v37, v38
v_fma_f32 v54, v16, v53, v54
MA 136,72,40
v_fma_f32 v38, -v17, v53, v38
v_fma_f32 v54, v17, v37, v54
v_mfma_f32_16x16x32_bf16 v[140:143], v[64:67], a[12:15], 0
v_mul_f32 v60, v20, v38
v_mul_f32 v62, v20, v54
MA 140,68,28
v_fma_f32 v60, -v21, v54, v60
v_fma_f32 v62, -v21, v38, -v62
MA 140,72,44
v_fma_f32 v39, v16, v38, v39
s_waitcnt lgkmcnt(0)
v_mfma_f32_16x16x32_bf16 v[144:147], v[76:79], a[0:3], 0
s_waitcnt vmcnt(6)
s_barrier
s_add_u32 m0, s43, 0x0
v_fma_f32 v55, v16, v54, v55
MA 144,80,16
s_add_u32 s50, s44, 0x288180
TR 64,5,24576
v_fma_f32 v39, -v17, v54, v39
MA 144,84,32
TR 66,5,25088
v_fma_f32 v55, v17, v38, v55
v_mfma_f32_16x16x32_bf16 v[148:151], v[76:79], a[4:7], 0
TR 68,5,32768
v_mul_f32 v61, v20, v39
MA 148,80,20
TR 70,5,33280
v_mul_f32 v63, v20, v55
MA 148,84,36
TR 72,5,40960
v_fma_f32 v61, -v21, v55, v61
v_mfma_f32_16x16x32_bf16 v[152:155], v[76:79], a[8:11], 0
TR 74,5,41472
v_fma_f32 v63, -v21, v39, -v63
MA 152,80,24
buffer_load_dwordx4 v2, s[8:11], s50 offen lds
MA 152,84,40
s_add_u32 m0, s43, 0x1000
v_cvt_pk_bf16_f32 v89, v60, v61
v_cvt_pk_bf16_f32 v93, v62, v63
v_mfma_f32_16x16x32_bf16 v[156:159], v[76:79], a[12:15], 0
s_add_u32 s51, s44, 0x288180
v_xor_b32 v94, 16, v91
v_fma_f32 v40, v16, v39, v40
MA 156,80,28
ds_write_b64 v94, v[88:89] offset:0
MA 156,84,44
ds_write_b64 v94, v[92:93] offset:4096
s_waitcnt lgkmcnt(2)
MA 96,64,48
TR 76,6,24576
v_fma_f32 v56, v16, v55, v56
v_fma_f32 v40, -v17, v55, v40
MA 96,68,64
TR 78,6,25088
v_fma_f32 v56, v17, v39, v56
v_mul_f32 v60, v20, v40
MA 96,72,80
TR 80,6,32768
v_mul_f32 v62, v20, v56
v_fma_f32 v60, -v21, v56, v60
MA 100,64,52
TR 82,6,33280
v_fma_f32 v62, -v21, v40, -v62
v_fma_f32 v41, v16, v40, v41
MA 100,68,68
TR 84,6,40960
v_fma_f32 v57, v16, v56, v57
v_fma_f32 v41, -v17, v56, v41
MA 100,72,84
TR 86,6,41472
v_fma_f32 v57, v17, v40, v57
v_mul_f32 v61, v20, v41
MA 104,64,56
buffer_load_dwordx4 v2, s[12:15], s51 offen lds
MA 104,68,72
s_add_u32 m0, s43, 0x2000
ds_read_b128 a[0:3], v13 offset:0
v_mul_f32 v63, v20, v57
v_fma_f32 v61, -v21, v57, v61
MA 104,72,88
s_add_u32 s50, s44, 0x2d0180
ds_read_b128 a[4:7], v13 offset:1024
v_fma_f32 v63, -v21, v41, -v63
v_cvt_pk_bf16_f32 v88, v60, v61
MA 108,64,60
ds_read_b128 a[8:11], v13 offset:2048
v_cvt_pk_bf16_f32 v92, v62, v63
MA 108,68,76
ds_read_b128 a[12:15], v13 offset:3072
v_fma_f32 v42, v16, v41, v42
MA 108,72,92
buffer_load_dwordx4 v2, s[8:11], s50 offen lds
s_waitcnt lgkmcnt(4)
MA 112,76,48
s_add_u32 m0, s43, 0x3000
TR 64,5,28672
v_fma_f32 v58, v16, v57, v58
MA 112,80,64
s_add_u32 s51, s44, 0x2d0180
TR 66,5,29184
v_fma_f32 v42, -v17, v57, v42
MA 112,84,80
TR 68,5,36864
v_fma_f32 v58, v17, v41, v58
MA 116,76,52
TR 70,5,37376
v_mul_f32 v60, v20, v42
MA 116,80,68
TR 72,5,45056
v_mul_f32 v62, v20, v58
MA 116,84,84
TR 74,5,45568
v_fma_f32 v60, -v21, v58, v60
MA 120,76,56
buffer_load_dwordx4 v2, s[12:15], s51 offen lds
MA 120,80,72
s_add_u32 m0, s43, 0x4000
ds_read_b128 a[16:19], v13 offset:8192
v_fma_f32 v62, -v21, v42, -v62
MA 120,84,88
s_add_u32 s50, s44, 0x318180
ds_read_b128 a[20:23], v13 offset:9216
v_fma_f32 v43, v16, v42, v43
MA 124,76,60
ds_read_b128 a[24:27], v13 offset:10240
v_fma_f32 v59, v16, v58, v59
MA 124,80,76
ds_read_b128 a[28:31], v13 offset:11264
v_fma_f32 v43, -v17, v58, v43
MA 124,84,92
buffer_load_dwordx4 v2, s[8:11], s50 offen lds
s_waitcnt lgkmcnt(4)
MA 128,64,48
s_add_u32 m0, s43, 0x5000
TR 76,6,28672
v_fma_f32 v59, v17, v42, v59
MA 128,68,64
s_add_u32 s51, s44, 0x318180
TR 78,6,29184
v_mul_f32 v61, v20, v43
MA 128,72,80
TR 80,6,36864
v_mul_f32 v63, v20, v59
MA 132,64,52
TR 82,6,37376
v_fma_f32 v61, -v21, v59, v61
MA 132,68,68
TR 84,6,45056
v_fma_f32 v63, -v21, v43, -v63
MA 132,72,84
TR 86,6,45568
v_cvt_pk_bf16_f32 v89, v60, v61
MA 136,64,56
buffer_load_dwordx4 v2, s[12:15], s51 offen lds
MA 136,68,72
ds_read_b128 a[32:35], v12 offset:32768
v_cvt_pk_bf16_f32 v93, v62, v63
MA 136,72,88
ds_read_b128 a[36:39], v12 offset:33792
v_xor_b32 v94, 24, v91
MA 140,64,60
v_bfe_u32 v60, v0, 4, 2
v_bfe_u32 v61, v0, 2, 2
MA 140,68,76
v_and_b32 v62, 3, v0
v_xor_b32 v62, v62, v60
MA 140,72,92
v_lshlrev_b32 v62, 2, v62
s_waitcnt lgkmcnt(2)
MA 144,76,48
s_waitcnt vmcnt(6)
s_waitcnt lgkmcnt(0)
s_barrier
s_add_u32 m0, s43, 0x6000
ds_write_b64 v94, v[88:89] offset:0
MA 144,80,64
s_add_u32 s50, s44, 0x360180
TR 64,5,49152
v_lshrrev_b32 v63, 1, v61
MA 144,84,80
TR 66,5,49664
v_or_b32 v62, v62, v63
MA 148,76,52
TR 68,5,57344
v_lshlrev_b32 v62, 3, v62
MA 148,80,68
TR 70,5,57856
v_lshl_add_u32 v62, v60, 10, v62
MA 148,84,84
TR 72,7,0
v_lshl_add_u32 v62, v61, 7, v62
MA 152,76,56
TR 74,7,512
v_add_u32 v56, s79, v62
MA 152,80,72
buffer_load_dwordx4 v2, s[8:11], s50 offen lds
MA 152,84,88
s_add_u32 m0, s43, 0x7000
ds_write_b64 v94, v[92:93] offset:4096
MA 156,76,60
s_add_u32 s51, s44, 0x360180
ds_read_b128 a[40:43], v12 offset:34816
v_xor_b32 v57, 8, v56
MA 156,80,76
ds_read_b128 a[44:47], v12 offset:35840
v_xor_b32 v58, 16, v56
MA 156,84,92
v_xor_b32 v59, 24, v56
s_waitcnt lgkmcnt(3)
MA 96,64,96
TR 76,6,49152
v_mul_f32 v192, v160, v192
v_mul_f32 v193, v161, v193
MA 96,68,112
TR 78,6,49664
v_exp_f32 v160, -v160
MA 96,72,128
TR 80,6,57344
v_exp_f32 v161, -v161
MA 100,64,100
TR 82,6,57856
v_mul_f32 v194, v162, v194
v_mul_f32 v195, v163, v195
MA 100,68,116
TR 84,8,0
v_exp_f32 v162, -v162
MA 100,72,132
TR 86,8,512
v_exp_f32 v163, -v163
MA 104,64,104
buffer_load_dwordx4 v2, s[12:15], s51 offen lds
MA 104,68,120
s_add_u32 m0, s43, 0x8000
ds_read_b128 a[48:51], v12 offset:40960
v_mul_f32 v208, v176, v208
v_mul_f32 v209, v177, v209
MA 104,72,136
s_add_u32 s50, s44, 0x3a8180
ds_read_b128 a[52:55], v12 offset:41984
v_exp_f32 v176, -v176
MA 108,64,108
ds_read_b128 a[56:59], v12 offset:43008
v_exp_f32 v177, -v177
MA 108,68,124
ds_read_b128 a[60:63], v12 offset:44032
v_mul_f32 v210, v178, v210
v_mul_f32 v211, v179, v211
MA 108,72,140
buffer_load_dwordx4 v2, s[8:11], s50 offen lds
s_waitcnt lgkmcnt(4)
MA 112,76,96
s_add_u32 m0, s43, 0x9000
TR 64,5,53248
v_add_f32 v160, 1.0, v160
MA 112,80,112
s_add_u32 s51, s44, 0x3a8180
TR 66,5,53760
v_add_f32 v161, 1.0, v161
MA 112,84,128
TR 68,5,61440
v_add_f32 v162, 1.0, v162
MA 116,76,100
TR 70,5,61952
v_add_f32 v163, 1.0, v163
MA 116,80,116
TR 72,7,4096
v_add_f32 v176, 1.0, v176
MA 116,84,132
TR 74,7,4608
v_add_f32 v177, 1.0, v177
MA 120,76,104
buffer_load_dwordx4 v2, s[12:15], s51 offen lds
MA 120,80,120
s_add_u32 m0, s43, 0xa000
v_exp_f32 v178, -v178
MA 120,84,136
s_add_u32 s50, s44, 0x3f0180
v_exp_f32 v179, -v179
MA 124,76,108
v_rcp_f32 v160, v160
MA 124,80,124
v_rcp_f32 v161, v161
MA 124,84,140
buffer_load_dwordx4 v2, s[8:11], s50 offen lds
s_waitcnt lgkmcnt(0)
MA 128,64,96
s_add_u32 m0, s43, 0xb000
TR 76,6,53248
v_add_f32 v178, 1.0, v178
MA 128,68,112
s_add_u32 s51, s44, 0x3f0180
TR 78,6,53760
v_add_f32 v179, 1.0, v179
MA 128,72,128
TR 80,6,61440
v_mul_f32 v192, v192, v160
MA 132,64,100
TR 82,6,61952
v_mul_f32 v193, v193, v161
MA 132,68,116
TR 84,8,4096
v_cvt_pk_bf16_f32 v160, v192, v193
MA 132,72,132
TR 86,8,4608
v_mul_f32 v196, v164, v196
MA 136,64,104
buffer_load_dwordx4 v2, s[12:15], s51 offen lds
MA 136,68,120
v_rcp_f32 v162, v162
MA 136,72,136
v_rcp_f32 v163, v163
MA 140,64,108
v_rcp_f32 v176, v176
MA 140,68,124
v_rcp_f32 v177, v177
MA 140,72,140
v_mul_f32 v194, v194, v162
s_waitcnt lgkmcnt(0)
MA 144,76,96
s_waitcnt vmcnt(6)
s_barrier
s_add_u32 m0, s43, 0xc000
ds_read_b64_tr_b16 a[64:65], v56 offset:0
MA 144,80,112
s_add_u32 s50, s44, 0x438180
TR 64,5,0
v_mul_f32 v195, v195, v163
MA 144,84,128
TR 66,5,512
v_mul_f32 v208, v208, v176
MA 148,76,100
TR 68,5,8192
v_mul_f32 v209, v209, v177
MA 148,80,116
TR 70,5,8704
v_cvt_pk_bf16_f32 v161, v194, v195
MA 148,84,132
TR 72,5,16384
v_cvt_pk_bf16_f32 v162, v208, v209
MA 152,76,104
TR 74,5,16896
v_mul_f32 v197, v165, v197
MA 152,80,120
buffer_load_dwordx4 v2, s[8:11], s50 offen lds
MA 152,84,136
s_add_u32 m0, s43, 0xd000
ds_read_b64_tr_b16 a[66:67], v58 offset:512
v_mul_f32 v198, v166, v198
MA 156,76,108
s_add_u32 s51, s44, 0x438180
ds_read_b64_tr_b16 a[68:69], v57 offset:0
v_mul_f32 v199, v167, v199
MA 156,80,124
ds_read_b64_tr_b16 a[70:71], v59 offset:512
v_mul_f32 v212, v180, v212
MA 156,84,140
ds_read_b64_tr_b16 a[72:73], v58 offset:0
s_waitcnt lgkmcnt(4)
MA 96,64,144
TR 76,6,0
v_rcp_f32 v178, v178
MA 96,68,160
TR 78,6,512
v_rcp_f32 v179, v179
MA 96,72,176
TR 80,6,8192
v_exp_f32 v164, -v164
MA 100,64,148
TR 82,6,8704
v_exp_f32 v165, -v165
MA 100,68,164
TR 84,6,16384
v_exp_f32 v166, -v166
MA 100,72,180
TR 86,6,16896
v_exp_f32 v167, -v167
MA 104,64,152
buffer_load_dwordx4 v2, s[12:15], s51 offen lds
MA 104,68,168
s_add_u32 m0, s43, 0xe000
ds_read_b64_tr_b16 a[74:75], v56 offset:512
v_exp_f32 v180, -v180
MA 104,72,184
s_add_u32 s50, s44, 0x480180
ds_read_b64_tr_b16 a[76:77], v59 offset:0
v_mul_f32 v210, v210, v178
v_mul_f32 v211, v211, v179
MA 108,64,156
ds_read_b64_tr_b16 a[78:79], v57 offset:512
v_cvt_pk_bf16_f32 v163, v210, v211
v_mul_f32 v213, v181, v213
MA 108,68,172
ds_write_b128 v11, v[160:163] offset:49152
v_mul_f32 v214, v182, v214
MA 108,72,188
buffer_load_dwordx4 v2, s[8:11], s50 offen lds
s_waitcnt lgkmcnt(4)
MA 112,76,144
s_add_u32 m0, s43, 0xf000
TR 64,5,4096
v_mul_f32 v215, v183, v215
MA 112,80,160
s_add_u32 s51, s44, 0x480180
TR 66,5,4608
v_add_f32 v164, 1.0, v164
MA 112,84,176
TR 68,5,12288
v_add_f32 v165, 1.0, v165
MA 116,76,148
TR 70,5,12800
v_add_f32 v166, 1.0, v166
MA 116,80,164
TR 72,5,20480
v_add_f32 v167, 1.0, v167
MA 116,84,180
TR 74,5,20992
v_add_f32 v180, 1.0, v180
MA 120,76,152
buffer_load_dwordx4 v2, s[12:15], s51 offen lds
MA 120,80,168
s_add_u32 m0, s43, 0x10000
ds_read_b64_tr_b16 a[80:81], v56 offset:16384
MA 120,84,184
s_add_u32 s50, s44, 0x4c8180
ds_read_b64_tr_b16 a[82:83], v58 offset:16896
MA 124,76,156
ds_read_b64_tr_b16 a[84:85], v57 offset:16384
MA 124,80,172
ds_read_b64_tr_b16 a[86:87], v59 offset:16896
MA 124,84,188
buffer_load_dwordx4 v2, s[8:11], s50 offen lds
s_waitcnt lgkmcnt(4)
MA 128,64,144
s_add_u32 m0, s43, 0x11000
TR 76,6,4096
MA 128,68,160
s_add_u32 s51, s44, 0x4c8180
TR 78,6,4608
MA 128,72,176
TR 80,6,12288
MA 132,64,148
TR 82,6,12800
MA 132,68,164
TR 84,6,20480
MA 132,72,180
TR 86,6,20992
MA 136,64,152
buffer_load_dwordx4 v2, s[12:15], s51 offen lds
MA 136,68,168
ds_read_b64_tr_b16 a[88:89], v58 offset:16384
MA 136,72,184
ds_read_b64_tr_b16 a[90:91], v56 offset:16896
MA 140,64,156
v_exp_f32 v181, -v181
MA 140,68,172
v_exp_f32 v182, -v182
MA 140,72,188
v_add_f32 v181, 1.0, v181
s_waitcnt lgkmcnt(2)
MA 144,76,144
s_waitcnt vmcnt(6)
s_waitcnt lgkmcnt(0)
s_barrier
s_add_u32 m0, s43, 0x0
ds_read_b64_tr_b16 a[92:93], v59 offset:16384
MA 144,80,160
s_add_u32 s50, s45, 0x0
TR 64,5,24576
v_add_f32 v182, 1.0, v182
MA 144,84,176
TR 66,5,25088
v_mul_f32 v200, v168, v200
MA 148,76,148
TR 68,5,32768
MA 148,80,164
TR 70,5,33280
MA 148,84,180
TR 72,5,40960
MA 152,76,152
TR 74,5,41472
MA 152,80,168
buffer_load_dwordx4 v3, s[16:19], s50 offen lds
MA 152,84,184
s_add_u32 m0, s43, 0x1000
ds_read_b64_tr_b16 a[94:95], v57 offset:16896
MA 156,76,156
s_add_u32 s51, s45, 0x9000
ds_read_b64_tr_b16 a[96:97], v56 offset:4096
MA 156,80,172
ds_read_b64_tr_b16 a[98:99], v58 offset:4608
MA 156,84,188
ds_read_b64_tr_b16 a[100:101], v57 offset:4096
s_waitcnt lgkmcnt(4)
MA 96,64,192
TR 76,6,24576
v_exp_f32 v183, -v183
MA 96,68,208
TR 78,6,25088
v_rcp_f32 v164, v164
MA 96,72,224
TR 80,6,32768
v_rcp_f32 v165, v165
MA 100,64,196
TR 82,6,33280
v_rcp_f32 v166, v166
MA 100,68,212
TR 84,6,40960
v_rcp_f32 v167, v167
MA 100,72,228
TR 86,6,41472
v_rcp_f32 v180, v180
MA 104,64,200
buffer_load_dwordx4 v3, s[16:19], s51 offen lds
MA 104,68,216
s_add_u32 m0, s43, 0x2000
ds_read_b64_tr_b16 a[102:103], v59 offset:4608
v_rcp_f32 v181, v181
MA 104,72,232
s_add_u32 s50, s45, 0x12000
ds_read_b64_tr_b16 a[104:105], v58 offset:4096
v_rcp_f32 v182, v182
MA 108,64,204
ds_read_b64_tr_b16 a[106:107], v56 offset:4608
v_exp_f32 v168, -v168
MA 108,68,220
ds_read_b64_tr_b16 a[108:109], v59 offset:4096
v_add_f32 v183, 1.0, v183
v_mul_f32 v196, v196, v164
MA 108,72,236
buffer_load_dwordx4 v3, s[16:19], s50 offen lds
s_waitcnt lgkmcnt(4)
MA 112,76,192
s_add_u32 m0, s43, 0x3000
TR 64,5,28672
v_rcp_f32 v183, v183
MA 112,80,208
s_add_u32 s51, s45, 0x1b000
TR 66,5,29184
v_mul_f32 v197, v197, v165
v_mul_f32 v198, v198, v166
MA 112,84,224
TR 68,5,36864
v_mul_f32 v199, v199, v167
v_mul_f32 v212, v212, v180
MA 116,76,196
TR 70,5,37376
v_mul_f32 v213, v213, v181
v_mul_f32 v214, v214, v182
MA 116,80,212
TR 72,5,45056
v_mul_f32 v215, v215, v183
v_cvt_pk_bf16_f32 v164, v196, v197
MA 116,84,228
TR 74,5,45568
v_cvt_pk_bf16_f32 v165, v198, v199
v_cvt_pk_bf16_f32 v166, v212, v213
MA 120,76,200
buffer_load_dwordx4 v3, s[16:19], s51 offen lds
MA 120,80,216
s_add_u32 m0, s43, 0x4000
ds_read_b64_tr_b16 a[110:111], v57 offset:4608
v_cvt_pk_bf16_f32 v167, v214, v215
v_mul_f32 v201, v169, v201
MA 120,84,232
s_add_u32 s50, s48, 0x0
ds_write_b128 v11, v[164:167] offset:50176
v_mul_f32 v202, v170, v202
MA 124,76,204
ds_read_b64_tr_b16 a[112:113], v56 offset:20480
v_exp_f32 v169, -v169
MA 124,80,220
ds_read_b64_tr_b16 a[114:115], v58 offset:20992
v_exp_f32 v170, -v170
MA 124,84,236
buffer_load_dwordx4 v4, s[24:27], s50 offen lds
s_waitcnt lgkmcnt(4)
MA 128,64,192
s_add_u32 m0, s43, 0x5000
TR 76,6,28672
v_mul_f32 v203, v171, v203
v_mul_f32 v216, v184, v216
MA 128,68,208
s_add_u32 s51, s48, 0x9000
TR 78,6,29184
v_mul_f32 v217, v185, v217
MA 128,72,224
TR 80,6,36864
v_mul_f32 v218, v186, v218
MA 132,64,196
TR 82,6,37376
v_mul_f32 v219, v187, v219
MA 132,68,212
TR 84,6,45056
v_add_f32 v168, 1.0, v168
MA 132,72,228
TR 86,6,45568
v_add_f32 v169, 1.0, v169
MA 136,64,200
buffer_load_dwordx4 v4, s[24:27], s51 offen lds
MA 136,68,216
ds_read_b64_tr_b16 a[116:117], v57 offset:20480
v_add_f32 v170, 1.0, v170
MA 136,72,232
ds_read_b64_tr_b16 a[118:119], v59 offset:20992
MA 140,64,204
v_exp_f32 v171, -v171
MA 140,68,220
v_exp_f32 v184, -v184
MA 140,72,236
v_add_f32 v171, 1.0, v171
s_waitcnt lgkmcnt(2)
MA 144,76,192
s_waitcnt vmcnt(6)
s_waitcnt lgkmcnt(0)
s_barrier
s_add_u32 m0, s43, 0x6000
ds_read_b64_tr_b16 a[120:121], v58 offset:20480
MA 144,80,208
s_add_u32 s50, s48, 0x0
TR 64,5,49152
v_add_f32 v184, 1.0, v184
MA 144,84,224
TR 66,5,49664
MA 148,76,196
TR 68,5,57344
MA 148,80,212
TR 70,5,57856
MA 148,84,228
TR 72,7,0
MA 152,76,200
TR 74,7,512
MA 152,80,216
buffer_load_dwordx4 v4, s[28:31], s50 offen lds
MA 152,84,232
s_add_u32 m0, s43, 0x7000
ds_read_b64_tr_b16 a[122:123], v56 offset:20992
MA 156,76,204
s_add_u32 s51, s48, 0x9000
ds_read_b64_tr_b16 a[124:125], v59 offset:20480
MA 156,80,220
ds_read_b64_tr_b16 a[126:127], v57 offset:20992
MA 156,84,236
s_waitcnt lgkmcnt(3)
MA 96,64,240
TR 76,6,49152
v_exp_f32 v185, -v185
v_mfma_f32_16x16x32_bf16 v[96:99], v[68:71], v[224:227], v[96:99]
TR 78,6,49664
v_exp_f32 v186, -v186
v_mfma_f32_16x16x32_bf16 v[96:99], v[72:75], v[240:243], v[96:99]
TR 80,6,57344
v_exp_f32 v187, -v187
MA 100,64,244
TR 82,6,57856
v_rcp_f32 v168, v168
v_mfma_f32_16x16x32_bf16 v[100:103], v[68:71], v[228:231], v[100:103]
TR 84,8,0
v_rcp_f32 v169, v169
v_mfma_f32_16x16x32_bf16 v[100:103], v[72:75], v[244:247], v[100:103]
TR 86,8,512
v_rcp_f32 v170, v170
MA 104,64,248
buffer_load_dwordx4 v4, s[28:31], s51 offen lds
v_mfma_f32_16x16x32_bf16 v[104:107], v[68:71], v[232:235], v[104:107]
s_add_u32 m0, s43, 0x8000
v_rcp_f32 v171, v171
v_add_f32 v185, 1.0, v185
v_mfma_f32_16x16x32_bf16 v[104:107], v[72:75], v[248:251], v[104:107]
s_add_u32 s50, s45, 0x24000
v_rcp_f32 v184, v184
v_add_f32 v186, 1.0, v186
MA 108,64,252
v_rcp_f32 v185, v185
v_add_f32 v187, 1.0, v187
v_mfma_f32_16x16x32_bf16 v[108:111], v[68:71], v[236:239], v[108:111]
v_rcp_f32 v186, v186
v_mul_f32 v200, v200, v168
v_mfma_f32_16x16x32_bf16 v[108:111], v[72:75], v[252:255], v[108:111]
buffer_load_dwordx4 v3, s[16:19], s50 offen lds
s_waitcnt lgkmcnt(0)
MA 112,76,240
s_add_u32 m0, s43, 0x9000
TR 64,5,53248
v_rcp_f32 v187, v187
v_mfma_f32_16x16x32_bf16 v[112:115], v[80:83], v[224:227], v[112:115]
s_add_u32 s51, s45, 0x2d000
TR 66,5,53760
v_mul_f32 v201, v201, v169
v_mul_f32 v202, v202, v170
v_mfma_f32_16x16x32_bf16 v[112:115], v[84:87], v[240:243], v[112:115]
TR 68,5,61440
v_mul_f32 v203, v203, v171
v_mul_f32 v216, v216, v184
MA 116,76,244
TR 70,5,61952
v_mul_f32 v217, v217, v185
v_mul_f32 v218, v218, v186
v_mfma_f32_16x16x32_bf16 v[116:119], v[80:83], v[228:231], v[116:119]
TR 72,7,4096
v_mul_f32 v219, v219, v187
v_cvt_pk_bf16_f32 v168, v200, v201
v_mfma_f32_16x16x32_bf16 v[116:119], v[84:87], v[244:247], v[116:119]
TR 74,7,4608
v_cvt_pk_bf16_f32 v169, v202, v203
v_cvt_pk_bf16_f32 v170, v216, v217
MA 120,76,248
buffer_load_dwordx4 v3, s[16:19], s51 offen lds
v_mfma_f32_16x16x32_bf16 v[120:123], v[80:83], v[232:235], v[120:123]
s_add_u32 m0, s43, 0xa000
v_cvt_pk_bf16_f32 v171, v218, v219
v_mul_f32 v204, v172, v204
v_mul_f32 v205, v173, v205
v_mfma_f32_16x16x32_bf16 v[120:123], v[84:87], v[248:251], v[120:123]
s_add_u32 s50, s45, 0x80
ds_write_b128 v11, v[168:171] offset:51200
v_mul_f32 v206, v174, v206
MA 124,76,252
v_exp_f32 v172, -v172
v_mul_f32 v207, v175, v207
v_mfma_f32_16x16x32_bf16 v[124:127], v[80:83], v[236:239], v[124:127]
v_exp_f32 v173, -v173
v_mfma_f32_16x16x32_bf16 v[124:127], v[84:87], v[252:255], v[124:127]
buffer_load_dwordx4 v3, s[16:19], s50 offen lds
s_waitcnt lgkmcnt(1)
MA 128,64,240
s_add_u32 m0, s43, 0xb000
TR 76,6,53248
v_mul_f32 v220, v188, v220
v_mfma_f32_16x16x32_bf16 v[128:131], v[68:71], v[224:227], v[128:131]
s_add_u32 s51, s45, 0x9080
TR 78,6,53760
v_mul_f32 v221, v189, v221
v_mfma_f32_16x16x32_bf16 v[128:131], v[72:75], v[240:243], v[128:131]
TR 80,6,61440
v_mul_f32 v222, v190, v222
MA 132,64,244
TR 82,6,61952
v_mul_f32 v223, v191, v223
v_mfma_f32_16x16x32_bf16 v[132:135], v[68:71], v[228:231], v[132:135]
TR 84,8,4096
v_add_f32 v172, 1.0, v172
v_mfma_f32_16x16x32_bf16 v[132:135], v[72:75], v[244:247], v[132:135]
TR 86,8,4608
v_add_f32 v173, 1.0, v173
MA 136,64,248
buffer_load_dwordx4 v3, s[16:19], s51 offen lds
v_mfma_f32_16x16x32_bf16 v[136:139], v[68:71], v[232:235], v[136:139]
v_exp_f32 v174, -v174
v_mfma_f32_16x16x32_bf16 v[136:139], v[72:75], v[248:251], v[136:139]
v_exp_f32 v175, -v175
MA 140,64,252
v_exp_f32 v188, -v188
v_mfma_f32_16x16x32_bf16 v[140:143], v[68:71], v[236:239], v[140:143]
v_exp_f32 v189, -v189
v_mfma_f32_16x16x32_bf16 v[140:143], v[72:75], v[252:255], v[140:143]
v_add_f32 v174, 1.0, v174
s_waitcnt lgkmcnt(0)
MA 144,76,240
s_waitcnt vmcnt(6)
s_barrier
L_S_p2:
v_bfe_u32 v88, v0, 4, 2
v_bfe_u32 v89, v0, 2, 2
v_lshlrev_b32 v5, 9, v88
v_lshl_add_u32 v5, v89, 7, v5
v_and_b32 v88, 1, v88
v_lshlrev_b32 v88, 1, v88
v_lshrrev_b32 v89, 1, v89
v_or_b32 v88, v88, v89
v_xor_b32 v88, s80, v88
v_lshl_add_u32 v5, v88, 5, v5
v_and_b32 v88, 3, v0
v_lshl_add_u32 v5, v88, 3, v5
v_xor_b32 v6, 32, v5
v_add_u32 v7, 0x10000, v5
v_add_u32 v8, 0x10000, v6
s_add_u32 m0, s43, 0xc000
v_exp_f32 v190, -v190
v_mfma_f32_16x16x32_bf16 v[144:147], v[80:83], v[224:227], v[144:147]
s_add_u32 s50, s45, 0x12080
TR 64,5,0
v_add_f32 v175, 1.0, v175
v_mfma_f32_16x16x32_bf16 v[144:147], v[84:87], v[240:243], v[144:147]
TR 66,5,2048
v_add_f32 v188, 1.0, v188
MA 148,76,244
TR 68,5,4096
v_add_f32 v189, 1.0, v189
v_mfma_f32_16x16x32_bf16 v[148:151], v[80:83], v[228:231], v[148:151]
TR 70,5,6144
v_add_f32 v190, 1.0, v190
v_mfma_f32_16x16x32_bf16 v[148:151], v[84:87], v[244:247], v[148:151]
TR 72,5,8192
MA 152,76,248
TR 74,5,10240
v_mfma_f32_16x16x32_bf16 v[152:155], v[80:83], v[232:235], v[152:155]
buffer_load_dwordx4 v3, s[16:19], s50 offen lds
v_mfma_f32_16x16x32_bf16 v[152:155], v[84:87], v[248:251], v[152:155]
s_add_u32 m0, s43, 0xd000
v_exp_f32 v191, -v191
MA 156,76,252
s_add_u32 s51, s45, 0x1b080
v_rcp_f32 v172, v172
v_mfma_f32_16x16x32_bf16 v[156:159], v[80:83], v[236:239], v[156:159]
v_rcp_f32 v173, v173
v_mfma_f32_16x16x32_bf16 v[156:159], v[84:87], v[252:255], v[156:159]
v_add_f32 v191, 1.0, v191
v_rcp_f32 v174, v174
v_rcp_f32 v175, v175
v_rcp_f32 v188, v188
v_rcp_f32 v189, v189
v_rcp_f32 v190, v190
v_rcp_f32 v191, v191
v_mul_f32 v204, v204, v172
v_mul_f32 v205, v205, v173
v_mul_f32 v206, v206, v174
v_mul_f32 v207, v207, v175
v_mul_f32 v220, v220, v188
v_mul_f32 v221, v221, v189
v_mul_f32 v222, v222, v190
v_mul_f32 v223, v223, v191
v_cvt_pk_bf16_f32 v172, v204, v205
v_cvt_pk_bf16_f32 v173, v206, v207
v_cvt_pk_bf16_f32 v174, v220, v221
v_cvt_pk_bf16_f32 v175, v222, v223
ds_write_b128 v11, v[172:175] offset:52224
s_waitcnt lgkmcnt(1)
v_mfma_f32_16x16x32_bf16 v[160:163], v[64:67], a[0:3], 0
TR 76,6,0
MA 160,68,16
TR 78,6,2048
MA 160,72,32
TR 80,6,4096
v_mfma_f32_16x16x32_bf16 v[164:167], v[64:67], a[4:7], 0
TR 82,6,6144
MA 164,68,20
TR 84,6,8192
v_mul_f32 v128, v96, v128
v_mul_f32 v129, v97, v129
MA 164,72,36
TR 86,6,10240
v_exp_f32 v96, -v96
v_mfma_f32_16x16x32_bf16 v[168:171], v[64:67], a[8:11], 0
buffer_load_dwordx4 v3, s[16:19], s51 offen lds
MA 168,68,24
s_add_u32 m0, s43, 0xe000
v_exp_f32 v97, -v97
v_mul_f32 v130, v98, v130
MA 168,72,40
s_add_u32 s50, s48, 0x12000
v_exp_f32 v98, -v98
v_mul_f32 v131, v99, v131
v_mfma_f32_16x16x32_bf16 v[172:175], v[64:67], a[12:15], 0
v_exp_f32 v99, -v99
v_mul_f32 v144, v112, v144
MA 172,68,28
v_exp_f32 v112, -v112
v_mul_f32 v145, v113, v145
MA 172,72,44
buffer_load_dwordx4 v4, s[24:27], s50 offen lds
s_waitcnt lgkmcnt(0)
v_mfma_f32_16x16x32_bf16 v[176:179], v[76:79], a[0:3], 0
s_add_u32 m0, s43, 0xf000
TR 64,5,12288
v_exp_f32 v113, -v113
MA 176,80,16
s_add_u32 s51, s48, 0x1b000
TR 66,5,14336
v_mul_f32 v146, v114, v146
v_mul_f32 v147, v115, v147
MA 176,84,32
ds_read_b128 v[68:71], v9 offset:16384
v_exp_f32 v114, -v114
v_mfma_f32_16x16x32_bf16 v[180:183], v[76:79], a[4:7], 0
ds_read_b128 v[72:75], v10 offset:16384
v_exp_f32 v115, -v115
MA 180,80,20
buffer_load_dwordx4 v4, s[24:27], s51 offen lds
MA 180,84,36
s_add_u32 m0, s43, 0x10000
v_add_f32 v96, 1.0, v96
v_rcp_f32 v96, v96
v_mfma_f32_16x16x32_bf16 v[184:187], v[76:79], a[8:11], 0
s_add_u32 s50, s48, 0x12000
v_add_f32 v97, 1.0, v97
v_rcp_f32 v97, v97
MA 184,80,24
v_add_f32 v98, 1.0, v98
v_rcp_f32 v98, v98
MA 184,84,40
v_add_f32 v99, 1.0, v99
v_rcp_f32 v99, v99
v_mfma_f32_16x16x32_bf16 v[188:191], v[76:79], a[12:15], 0
buffer_load_dwordx4 v4, s[28:31], s50 offen lds
MA 188,80,28
s_add_u32 m0, s43, 0x11000
v_add_f32 v112, 1.0, v112
v_rcp_f32 v112, v112
MA 188,84,44
s_add_u32 s51, s48, 0x1b000
v_add_f32 v113, 1.0, v113
v_add_f32 v114, 1.0, v114
s_waitcnt lgkmcnt(0)
MA 160,64,48
TR 76,6,12288
v_rcp_f32 v113, v113
MA 160,68,64
TR 78,6,14336
v_rcp_f32 v114, v114
MA 160,72,80
ds_read_b128 v[80:83], v9 offset:18432
v_add_f32 v115, 1.0, v115
v_mul_f32 v128, v128, v96
MA 164,64,52
ds_read_b128 v[84:87], v10 offset:18432
v_rcp_f32 v115, v115
MA 164,68,68
buffer_load_dwordx4 v4, s[28:31], s51 offen lds
MA 164,72,84
v_mul_f32 v129, v129, v97
v_mul_f32 v130, v130, v98
v_mul_f32 v131, v131, v99
MA 168,64,56
v_mul_f32 v144, v144, v112
v_mul_f32 v145, v145, v113
v_mul_f32 v146, v146, v114
MA 168,68,72
v_mul_f32 v147, v147, v115
v_cvt_pk_bf16_f32 v96, v128, v129
v_cvt_pk_bf16_f32 v97, v130, v131
MA 168,72,88
v_cvt_pk_bf16_f32 v98, v144, v145
v_cvt_pk_bf16_f32 v99, v146, v147
v_add_u32 v15, 0x10000, v11
MA 172,64,60
v_mul_f32 v132, v100, v132
v_exp_f32 v100, -v100
MA 172,68,76
v_mul_f32 v133, v101, v133
v_exp_f32 v101, -v101
MA 172,72,92
v_mul_f32 v134, v102, v134
v_mul_f32 v135, v103, v135
s_waitcnt lgkmcnt(0)
MA 176,76,48
s_waitcnt vmcnt(6)
s_barrier
s_add_u32 m0, s43, 0x0
ds_read_b128 a[128:131], v12 offset:49152
v_exp_f32 v102, -v102
MA 176,80,64
s_add_u32 s50, s45, 0x24080
ds_read_b128 v[64:67], v9 offset:24576
v_exp_f32 v103, -v103
MA 176,84,80
ds_read_b128 v[68:71], v10 offset:24576
v_mul_f32 v148, v116, v148
v_mul_f32 v149, v117, v149
MA 180,76,52
TR 72,5,32768
v_exp_f32 v116, -v116
MA 180,80,68
TR 74,5,34816
v_exp_f32 v117, -v117
MA 180,84,84
buffer_load_dwordx4 v3, s[16:19], s50 offen lds
MA 184,76,56
s_add_u32 m0, s43, 0x1000
ds_read_b128 a[132:135], v12 offset:50176
v_mul_f32 v150, v118, v150
v_mul_f32 v151, v119, v151
MA 184,80,72
s_add_u32 s51, s45, 0x2d080
ds_read_b128 a[136:139], v12 offset:51200
v_exp_f32 v118, -v118
MA 184,84,88
ds_read_b128 a[140:143], v12 offset:52224
v_exp_f32 v119, -v119
MA 188,76,60
ds_read_b128 a[144:147], v12 offset:57344
v_add_f32 v100, 1.0, v100
v_add_f32 v101, 1.0, v101
MA 188,80,76
buffer_load_dwordx4 v3, s[16:19], s51 offen lds
MA 188,84,92
s_add_u32 m0, s43, 0x2000
ds_read_b128 a[148:151], v12 offset:58368
v_add_f32 v102, 1.0, v102
s_waitcnt lgkmcnt(5)
MA 160,64,96
s_add_u32 s50, s45, 0x36000
ds_read_b128 v[76:79], v9 offset:26624
v_rcp_f32 v100, v100
MA 160,68,112
ds_read_b128 v[80:83], v10 offset:26624
v_rcp_f32 v101, v101
MA 160,72,128
TR 84,6,32768
v_rcp_f32 v102, v102
MA 164,64,100
TR 86,6,34816
v_add_f32 v103, 1.0, v103
v_add_f32 v116, 1.0, v116
MA 164,68,116
buffer_load_dwordx4 v3, s[16:19], s50 offen lds
s_waitcnt lgkmcnt(8)
MA 164,72,132
s_add_u32 m0, s43, 0x3000
ds_read_b128 a[152:155], v12 offset:59392
v_rcp_f32 v103, v103
MA 168,64,104
s_add_u32 s51, s45, 0x3f000
ds_read_b128 a[156:159], v12 offset:60416
v_rcp_f32 v116, v116
MA 168,68,120
ds_write_b128 v15, v[96:99] offset:0
v_add_f32 v117, 1.0, v117
s_waitcnt lgkmcnt(10)
MA 168,72,136
v_rcp_f32 v117, v117
v_add_f32 v118, 1.0, v118
MA 172,64,108
buffer_load_dwordx4 v3, s[16:19], s51 offen lds
MA 172,68,124
s_add_u32 m0, s43, 0x4000
v_rcp_f32 v118, v118
v_add_f32 v119, 1.0, v119
s_waitcnt lgkmcnt(9)
MA 172,72,140
s_add_u32 s50, s45, 0x36080
v_rcp_f32 v119, v119
s_waitcnt lgkmcnt(3)
MA 176,76,96
TR 64,5,36864
v_mul_f32 v132, v132, v100
v_mul_f32 v133, v133, v101
MA 176,80,112
TR 66,5,38912
v_mul_f32 v134, v134, v102
v_mul_f32 v135, v135, v103
MA 176,84,128
TR 68,5,40960
v_mul_f32 v148, v148, v116
v_mul_f32 v149, v149, v117
MA 180,76,100
TR 70,5,43008
v_mul_f32 v150, v150, v118
v_mul_f32 v151, v151, v119
MA 180,80,116
TR 72,5,45056
v_cvt_pk_bf16_f32 v100, v132, v133
v_cvt_pk_bf16_f32 v101, v134, v135
MA 180,84,132
TR 74,5,47104
v_cvt_pk_bf16_f32 v102, v148, v149
v_cvt_pk_bf16_f32 v103, v150, v151
MA 184,76,104
buffer_load_dwordx4 v3, s[16:19], s50 offen lds
MA 184,80,120
s_add_u32 m0, s43, 0x5000
ds_write_b128 v15, v[100:103] offset:1024
v_mul_f32 v136, v104, v136
MA 184,84,136
s_add_u32 s51, s45, 0x3f080
v_exp_f32 v104, -v104
v_mul_f32 v137, v105, v137
MA 188,76,108
v_exp_f32 v105, -v105
v_mul_f32 v138, v106, v138
MA 188,80,124
v_exp_f32 v106, -v106
v_mul_f32 v139, v107, v139
MA 188,84,140
buffer_load_dwordx4 v3, s[16:19], s51 offen lds
s_waitcnt lgkmcnt(1)
MA 160,64,144
TR 76,6,36864
v_exp_f32 v107, -v107
v_mfma_f32_16x16x32_bf16 v[192:195], v[68:71], a[0:3], 0
TR 78,6,38912
v_mul_f32 v152, v120, v152
v_mul_f32 v153, v121, v153
MA 192,72,16
TR 80,6,40960
v_exp_f32 v120, -v120
MA 164,64,148
TR 82,6,43008
v_exp_f32 v121, -v121
v_mfma_f32_16x16x32_bf16 v[196:199], v[68:71], a[4:7], 0
TR 84,6,45056
v_mul_f32 v154, v122, v154
v_mul_f32 v155, v123, v155
MA 196,72,20
TR 86,6,47104
v_exp_f32 v122, -v122
MA 168,64,152
v_exp_f32 v123, -v123
v_add_f32 v104, 1.0, v104
v_mfma_f32_16x16x32_bf16 v[200:203], v[68:71], a[8:11], 0
v_rcp_f32 v104, v104
v_add_f32 v105, 1.0, v105
MA 200,72,24
v_rcp_f32 v105, v105
v_add_f32 v106, 1.0, v106
MA 172,64,156
v_rcp_f32 v106, v106
v_add_f32 v107, 1.0, v107
v_mfma_f32_16x16x32_bf16 v[204:207], v[68:71], a[12:15], 0
v_rcp_f32 v107, v107
v_add_f32 v120, 1.0, v120
MA 204,72,28
v_rcp_f32 v120, v120
s_waitcnt lgkmcnt(0)
MA 176,76,144
s_waitcnt vmcnt(6)
s_barrier
s_add_u32 m0, s43, 0x6000
v_add_f32 v121, 1.0, v121
v_rcp_f32 v121, v121
v_mfma_f32_16x16x32_bf16 v[208:211], v[80:83], a[0:3], 0
s_add_u32 s50, s45, 0x100
TR 64,5,49152
v_add_f32 v122, 1.0, v122
v_add_f32 v123, 1.0, v123
MA 208,84,16
TR 66,5,51200
v_rcp_f32 v122, v122
MA 180,76,148
TR 68,5,53248
v_rcp_f32 v123, v123
v_mfma_f32_16x16x32_bf16 v[212:215], v[80:83], a[4:7], 0
TR 70,5,55296
v_mul_f32 v136, v136, v104
v_mul_f32 v137, v137, v105
MA 212,84,20
ds_read_b128 v[72:75], v9 offset:57344
v_mul_f32 v138, v138, v106
v_mul_f32 v139, v139, v107
MA 184,76,152
buffer_load_dwordx4 v3, s[16:19], s50 offen lds
v_mfma_f32_16x16x32_bf16 v[216:219], v[80:83], a[8:11], 0
s_add_u32 m0, s43, 0x7000
v_mul_f32 v152, v152, v120
v_mul_f32 v153, v153, v121
v_mul_f32 v154, v154, v122
MA 216,84,24
s_add_u32 s51, s45, 0x9100
v_mul_f32 v155, v155, v123
v_cvt_pk_bf16_f32 v104, v136, v137
v_cvt_pk_bf16_f32 v105, v138, v139
MA 188,76,156
v_cvt_pk_bf16_f32 v106, v152, v153
v_cvt_pk_bf16_f32 v107, v154, v155
v_mul_f32 v140, v108, v140
v_mfma_f32_16x16x32_bf16 v[220:223], v[80:83], a[12:15], 0
ds_write_b128 v15, v[104:107] offset:2048
v_mul_f32 v141, v109, v141
MA 220,84,28
buffer_load_dwordx4 v3, s[16:19], s51 offen lds
s_waitcnt lgkmcnt(1)
MA 192,64,32
s_add_u32 m0, s43, 0x8000
TR 76,6,49152
v_exp_f32 v108, -v108
MA 192,68,48
s_add_u32 s50, s45, 0x12100
TR 78,6,51200
v_exp_f32 v109, -v109
MA 192,72,64
TR 80,6,53248
v_mul_f32 v142, v110, v142
v_mul_f32 v143, v111, v143
MA 196,64,36
TR 82,6,55296
v_exp_f32 v110, -v110
MA 196,68,52
ds_read_b128 v[84:87], v9 offset:59392
v_exp_f32 v111, -v111
MA 196,72,68
buffer_load_dwordx4 v3, s[16:19], s50 offen lds
MA 200,64,40
s_add_u32 m0, s43, 0x9000
v_mul_f32 v156, v124, v156
v_exp_f32 v124, -v124
MA 200,68,56
s_add_u32 s51, s45, 0x1b100
v_mul_f32 v157, v125, v157
v_exp_f32 v125, -v125
MA 200,72,72
v_mul_f32 v158, v126, v158
v_exp_f32 v126, -v126
MA 204,64,44
v_mul_f32 v159, v127, v159
v_exp_f32 v127, -v127
MA 204,68,60
buffer_load_dwordx4 v3, s[16:19], s51 offen lds
MA 204,72,76
s_add_u32 m0, s43, 0xa000
v_add_f32 v108, 1.0, v108
v_add_f32 v109, 1.0, v109
s_waitcnt lgkmcnt(0)
MA 208,76,32
s_add_u32 s50, s48, 0x24000
ds_read_b128 v[64:67], v10 offset:57344
v_rcp_f32 v108, v108
MA 208,80,48
v_add_u32 v60, 0x10000, v9
ds_read_b128 v[68:71], v60 offset:0
v_add_f32 v110, 1.0, v110
MA 208,84,64
v_add_u32 v60, 0x10000, v10
ds_read_b128 v[72:75], v60 offset:0
v_add_f32 v111, 1.0, v111
MA 212,76,36
buffer_load_dwordx4 v4, s[24:27], s50 offen lds
MA 212,80,52
s_add_u32 m0, s43, 0xb000
v_rcp_f32 v109, v109
v_add_f32 v124, 1.0, v124
MA 212,84,68
s_add_u32 s51, s48, 0x2d000
v_rcp_f32 v110, v110
v_add_f32 v125, 1.0, v125
MA 216,76,40
v_rcp_f32 v111, v111
v_add_f32 v126, 1.0, v126
MA 216,80,56
v_rcp_f32 v124, v124
v_add_f32 v127, 1.0, v127
MA 216,84,72
buffer_load_dwordx4 v4, s[24:27], s51 offen lds
MA 220,76,44
v_rcp_f32 v125, v125
v_mul_f32 v140, v140, v108
MA 220,80,60
v_rcp_f32 v126, v126
v_mul_f32 v141, v141, v109
MA 220,84,76
v_rcp_f32 v127, v127
s_waitcnt lgkmcnt(0)
MA 192,64,80
ds_read_b128 v[76:79], v10 offset:59392
v_mul_f32 v142, v142, v110
v_mul_f32 v143, v143, v111
MA 192,68,96
v_add_u32 v60, 0x10000, v9
ds_read_b128 v[80:83], v60 offset:2048
v_mul_f32 v156, v156, v124
MA 192,72,112
v_add_u32 v60, 0x10000, v10
ds_read_b128 v[84:87], v60 offset:2048
v_mul_f32 v157, v157, v125
MA 196,64,84
v_mul_f32 v158, v158, v126
v_mul_f32 v159, v159, v127
v_cvt_pk_bf16_f32 v108, v140, v141
MA 196,68,100
v_cvt_pk_bf16_f32 v109, v142, v143
v_cvt_pk_bf16_f32 v110, v156, v157
v_cvt_pk_bf16_f32 v111, v158, v159
MA 196,72,116
ds_write_b128 v15, v[108:111] offset:3072
MA 200,64,88
MA 200,68,104
MA 200,72,120
MA 204,64,92
MA 204,68,108
MA 204,72,124
s_waitcnt lgkmcnt(1)
MA 208,76,80
s_waitcnt vmcnt(6)
s_waitcnt lgkmcnt(0)
s_barrier
s_add_u32 m0, s43, 0xc000
ds_read_b128 a[160:163], v13 offset:0
MA 208,80,96
s_add_u32 s50, s48, 0x24000
TR 64,5,0
MA 208,84,112
TR 66,5,2048
MA 212,76,84
TR 68,5,4096
MA 212,80,100
TR 70,5,6144
MA 212,84,116
TR 72,5,8192
MA 216,76,88
TR 74,5,10240
MA 216,80,104
buffer_load_dwordx4 v4, s[28:31], s50 offen lds
MA 216,84,120
s_add_u32 m0, s43, 0xd000
ds_read_b128 a[164:167], v13 offset:1024
MA 220,76,92
s_add_u32 s51, s48, 0x2d000
ds_read_b128 a[168:171], v13 offset:2048
MA 220,80,108
ds_read_b128 a[172:175], v13 offset:3072
MA 220,84,124
ds_read_b128 a[176:179], v13 offset:8192
s_waitcnt lgkmcnt(4)
MA 192,64,128
TR 76,6,0
MA 192,68,144
TR 78,6,2048
MA 160,72,160
TR 80,6,4096
MA 196,64,132
TR 82,6,6144
MA 196,68,148
TR 84,6,8192
s_waitcnt lgkmcnt(8)
MA 164,72,164
TR 86,6,10240
MA 200,64,136
buffer_load_dwordx4 v4, s[28:31], s51 offen lds
MA 200,68,152
s_add_u32 m0, s43, 0xe000
ds_read_b128 a[180:183], v13 offset:9216
s_waitcnt lgkmcnt(9)
MA 168,72,168
s_add_u32 s50, s45, 0x24100
ds_read_b128 a[184:187], v13 offset:10240
MA 204,64,140
ds_read_b128 a[188:191], v13 offset:11264
MA 204,68,156
s_waitcnt lgkmcnt(10)
MA 172,72,172
buffer_load_dwordx4 v3, s[16:19], s50 offen lds
s_waitcnt lgkmcnt(3)
MA 208,76,128
s_add_u32 m0, s43, 0xf000
TR 64,5,12288
MA 208,80,144
s_add_u32 s51, s45, 0x2d100
TR 66,5,14336
MA 176,84,160
TR 68,5,16384
MA 212,76,132
TR 70,5,18432
MA 212,80,148
TR 72,5,20480
MA 180,84,164
TR 74,5,22528
MA 216,76,136
buffer_load_dwordx4 v3, s[16:19], s51 offen lds
MA 216,80,152
s_add_u32 m0, s43, 0x10000
MA 184,84,168
s_add_u32 s50, s45, 0x36100
MA 220,76,140
MA 220,80,156
MA 188,84,172
buffer_load_dwordx4 v3, s[16:19], s50 offen lds
s_waitcnt lgkmcnt(0)
MA 160,64,176
s_add_u32 m0, s43, 0x11000
TR 76,6,12288
MA 192,68,160
s_add_u32 s51, s45, 0x3f100
TR 78,6,14336
MA 192,72,176
TR 80,6,16384
MA 164,64,180
TR 82,6,18432
MA 196,68,164
TR 84,6,20480
MA 196,72,180
TR 86,6,22528
MA 168,64,184
buffer_load_dwordx4 v3, s[16:19], s51 offen lds
MA 200,68,168
MA 200,72,184
MA 172,64,188
MA 204,68,172
MA 204,72,188
s_waitcnt lgkmcnt(0)
MA 176,76,176
s_waitcnt vmcnt(6)
s_barrier
s_add_u32 m0, s43, 0x0
MA 208,80,160
s_add_u32 s50, s45, 0x180
TR 64,5,24576
MA 208,84,176
TR 66,5,26624
MA 180,76,180
TR 68,5,28672
MA 212,80,164
TR 70,5,30720
MA 212,84,180
TR 72,5,32768
MA 184,76,184
TR 74,5,34816
MA 216,80,168
buffer_load_dwordx4 v3, s[16:19], s50 offen lds
MA 216,84,184
s_add_u32 m0, s43, 0x1000
MA 188,76,188
s_add_u32 s51, s45, 0x9180
MA 220,80,172
MA 220,84,188
v_min_u32 v48, 1, v0
v_mov_b32 v49, 1
v_lshlrev_b32 v48, 31, v48
s_waitcnt lgkmcnt(0)
v_mfma_f32_16x16x32_bf16 v[224:227], v[64:67], a[0:3], 0
TR 76,6,24576
MA 224,68,16
TR 78,6,26624
MA 224,72,32
TR 80,6,28672
v_mfma_f32_16x16x32_bf16 v[228:231], v[64:67], a[4:7], 0
TR 82,6,30720
MA 228,68,20
TR 84,6,32768
s_add_u32 s96, s49, 0x0
v_cvt_pk_bf16_f32 v96, v160, v161
MA 228,72,36
TR 86,6,34816
v_cvt_pk_bf16_f32 v97, v162, v163
s_add_u32 s97, s49, 0x4000
v_mfma_f32_16x16x32_bf16 v[232:235], v[64:67], a[8:11], 0
buffer_load_dwordx4 v3, s[16:19], s51 offen lds
MA 232,68,24
s_add_u32 m0, s43, 0x2000
v_cvt_pk_bf16_f32 v98, v176, v177
v_cvt_pk_bf16_f32 v99, v178, v179
MA 232,72,40
s_add_u32 s50, s45, 0x12180
buffer_store_dwordx4 v[96:99], v14, s[20:23], s96 offen offset:0 sc1
v_mfma_f32_16x16x32_bf16 v[236:239], v[64:67], a[12:15], 0
v_cvt_pk_bf16_f32 v100, v164, v165
v_cvt_pk_bf16_f32 v101, v166, v167
MA 236,68,28
v_cvt_pk_bf16_f32 v102, v180, v181
v_cvt_pk_bf16_f32 v103, v182, v183
MA 236,72,44
buffer_load_dwordx4 v3, s[16:19], s50 offen lds
s_waitcnt lgkmcnt(0)
v_mfma_f32_16x16x32_bf16 v[240:243], v[76:79], a[0:3], 0
s_add_u32 m0, s43, 0x3000
TR 64,5,36864
v_cvt_pk_bf16_f32 v104, v168, v169
MA 240,80,16
s_add_u32 s51, s45, 0x1b180
TR 66,5,38912
v_cvt_pk_bf16_f32 v105, v170, v171
MA 240,84,32
ds_read_b128 v[68:71], v9 offset:40960
v_cvt_pk_bf16_f32 v106, v184, v185
v_mfma_f32_16x16x32_bf16 v[244:247], v[76:79], a[4:7], 0
ds_read_b128 v[72:75], v10 offset:40960
v_cvt_pk_bf16_f32 v107, v186, v187
MA 244,80,20
buffer_load_dwordx4 v3, s[16:19], s51 offen lds
MA 244,84,36
s_add_u32 m0, s43, 0x4000
v_cvt_pk_bf16_f32 v108, v172, v173
v_cvt_pk_bf16_f32 v109, v174, v175
v_mfma_f32_16x16x32_bf16 v[248:251], v[76:79], a[8:11], 0
s_add_u32 s50, s48, 0x36000
v_cvt_pk_bf16_f32 v110, v188, v189
v_cvt_pk_bf16_f32 v111, v190, v191
MA 248,80,24
buffer_store_dwordx4 v[100:103], v14, s[20:23], s96 offen offset:1024 sc1
MA 248,84,40
v_cvt_pk_bf16_f32 v112, v192, v193
v_cvt_pk_bf16_f32 v113, v194, v195
v_mfma_f32_16x16x32_bf16 v[252:255], v[76:79], a[12:15], 0
buffer_load_dwordx4 v4, s[24:27], s50 offen lds
MA 252,80,28
s_add_u32 m0, s43, 0x5000
v_cvt_pk_bf16_f32 v114, v208, v209
v_cvt_pk_bf16_f32 v115, v210, v211
MA 252,84,44
s_add_u32 s51, s48, 0x3f000
v_cvt_pk_bf16_f32 v116, v196, v197
s_waitcnt lgkmcnt(0)
MA 224,64,48
TR 76,6,36864
v_cvt_pk_bf16_f32 v117, v198, v199
MA 224,68,64
TR 78,6,38912
v_cvt_pk_bf16_f32 v118, v212, v213
MA 224,72,80
ds_read_b128 v[80:83], v9 offset:43008
v_cvt_pk_bf16_f32 v119, v214, v215
MA 228,64,52
ds_read_b128 v[84:87], v10 offset:43008
v_cvt_pk_bf16_f32 v120, v200, v201
MA 228,68,68
buffer_load_dwordx4 v4, s[24:27], s51 offen lds
MA 228,72,84
v_cvt_pk_bf16_f32 v121, v202, v203
v_cvt_pk_bf16_f32 v122, v216, v217
MA 232,64,56
buffer_store_dwordx4 v[104:107], v14, s[20:23], s96 offen offset:2048 sc1
MA 232,68,72
v_cvt_pk_bf16_f32 v123, v218, v219
v_cvt_pk_bf16_f32 v124, v204, v205
MA 232,72,88
v_cvt_pk_bf16_f32 v125, v206, v207
v_cvt_pk_bf16_f32 v126, v220, v221
MA 236,64,60
v_cvt_pk_bf16_f32 v127, v222, v223
MA 236,68,76
MA 236,72,92
s_waitcnt lgkmcnt(0)
MA 240,76,48
s_waitcnt vmcnt(9)
s_barrier
s_add_u32 m0, s43, 0x6000
MA 240,80,64
s_add_u32 s50, s48, 0x36000
ds_read_b128 v[64:67], v9 offset:49152
MA 240,84,80
ds_read_b128 v[68:71], v10 offset:49152
MA 244,76,52
TR 72,5,57344
MA 244,80,68
TR 74,5,59392
MA 244,84,84
buffer_load_dwordx4 v4, s[28:31], s50 offen lds
MA 248,76,56
s_add_u32 m0, s43, 0x7000
buffer_store_dwordx4 v[108:111], v14, s[20:23], s96 offen offset:3072 sc1
MA 248,80,72
s_add_u32 s51, s48, 0x3f000
MA 248,84,88
MA 252,76,60
MA 252,80,76
buffer_load_dwordx4 v4, s[28:31], s51 offen lds
MA 252,84,92
s_add_u32 m0, s43, 0x8000
s_waitcnt lgkmcnt(0)
MA 224,64,96
s_add_u32 s50, s45, 0x24180
ds_read_b128 v[76:79], v9 offset:51200
MA 224,68,112
ds_read_b128 v[80:83], v10 offset:51200
MA 224,72,128
TR 84,6,57344
MA 228,64,100
TR 86,6,59392
MA 228,68,116
buffer_load_dwordx4 v3, s[16:19], s50 offen lds
MA 228,72,132
s_add_u32 m0, s43, 0x9000
buffer_store_dwordx4 v[112:115], v14, s[20:23], s97 offen offset:0 sc1
MA 232,64,104
s_add_u32 s51, s45, 0x2d180
MA 232,68,120
MA 232,72,136
MA 236,64,108
buffer_load_dwordx4 v3, s[16:19], s51 offen lds
MA 236,68,124
s_add_u32 m0, s43, 0xa000
MA 236,72,140
s_add_u32 s50, s45, 0x36180
s_waitcnt lgkmcnt(0)
MA 240,76,96
TR 64,5,61440
MA 240,80,112
TR 66,5,63488
MA 240,84,128
TR 68,7,0
MA 244,76,100
TR 70,7,2048
MA 244,80,116
TR 72,7,4096
MA 244,84,132
TR 74,7,6144
MA 248,76,104
buffer_load_dwordx4 v3, s[16:19], s50 offen lds
MA 248,80,120
s_add_u32 m0, s43, 0xb000
buffer_store_dwordx4 v[116:119], v14, s[20:23], s97 offen offset:1024 sc1
MA 248,84,136
s_add_u32 s51, s45, 0x3f180
MA 252,76,108
MA 252,80,124
MA 252,84,140
buffer_load_dwordx4 v3, s[16:19], s51 offen lds
s_waitcnt lgkmcnt(0)
MA 224,64,144
TR 76,6,61440
MA 224,68,160
TR 78,6,63488
MA 224,72,176
TR 80,8,0
MA 228,64,148
TR 82,8,2048
MA 228,68,164
TR 84,8,4096
MA 228,72,180
TR 86,8,6144
MA 232,64,152
buffer_store_dwordx4 v[120:123], v14, s[20:23], s97 offen offset:2048 sc1
MA 232,68,168
MA 232,72,184
MA 236,64,156
MA 236,68,172
MA 236,72,188
s_waitcnt lgkmcnt(0)
MA 240,76,144
s_waitcnt vmcnt(11)
s_barrier
s_add_u32 m0, s43, 0xc000
MA 240,80,160
s_add_u32 s50, s45, 0x200
TR 64,5,0
MA 240,84,176
TR 66,5,2048
MA 244,76,148
TR 68,5,4096
MA 244,80,164
TR 70,5,6144
MA 244,84,180
TR 72,5,8192
MA 248,76,152
TR 74,5,10240
MA 248,80,168
buffer_load_dwordx4 v3, s[16:19], s50 offen lds
MA 248,84,184
s_add_u32 m0, s43, 0xd000
buffer_store_dwordx4 v[124:127], v14, s[20:23], s97 offen offset:3072 sc1
MA 252,76,156
s_add_u32 s51, s45, 0x9200
MA 252,80,172
MA 252,84,188
s_waitcnt lgkmcnt(0)
v_mfma_f32_16x16x32_bf16 v[160:163], v[64:67], a[0:3], 0
TR 76,6,0
MA 160,68,16
TR 78,6,2048
MA 160,72,32
TR 80,6,4096
v_mfma_f32_16x16x32_bf16 v[164:167], v[64:67], a[4:7], 0
TR 82,6,6144
MA 164,68,20
TR 84,6,8192
s_add_u32 s98, s49, 0x8000
v_cvt_pk_bf16_f32 v128, v224, v225
MA 164,72,36
TR 86,6,10240
v_cvt_pk_bf16_f32 v129, v226, v227
v_mfma_f32_16x16x32_bf16 v[168:171], v[64:67], a[8:11], 0
buffer_load_dwordx4 v3, s[16:19], s51 offen lds
MA 168,68,24
s_add_u32 m0, s43, 0xe000
s_waitcnt vmcnt(11)
s_nop 0
MA 168,72,40
s_add_u32 s50, s45, 0x12200
v_cvt_pk_bf16_f32 v130, v240, v241
v_cvt_pk_bf16_f32 v131, v242, v243
v_mfma_f32_16x16x32_bf16 v[172:175], v[64:67], a[12:15], 0
buffer_store_dwordx4 v[128:131], v14, s[20:23], s98 offen offset:0 sc1
MA 172,68,28
v_cvt_pk_bf16_f32 v132, v228, v229
v_cvt_pk_bf16_f32 v133, v230, v231
MA 172,72,44
buffer_load_dwordx4 v3, s[16:19], s50 offen lds
s_waitcnt lgkmcnt(0)
v_mfma_f32_16x16x32_bf16 v[176:179], v[76:79], a[0:3], 0
s_add_u32 m0, s43, 0xf000
TR 64,5,12288
v_cvt_pk_bf16_f32 v134, v244, v245
MA 176,80,16
s_add_u32 s51, s45, 0x1b200
TR 66,5,14336
v_cvt_pk_bf16_f32 v135, v246, v247
MA 176,84,32
ds_read_b128 v[68:71], v9 offset:16384
v_cvt_pk_bf16_f32 v136, v232, v233
v_mfma_f32_16x16x32_bf16 v[180:183], v[76:79], a[4:7], 0
ds_read_b128 v[72:75], v10 offset:16384
v_cvt_pk_bf16_f32 v137, v234, v235
MA 180,80,20
buffer_load_dwordx4 v3, s[16:19], s51 offen lds
MA 180,84,36
s_add_u32 m0, s43, 0x10000
v_cvt_pk_bf16_f32 v138, v248, v249
v_cvt_pk_bf16_f32 v139, v250, v251
v_mfma_f32_16x16x32_bf16 v[184:187], v[76:79], a[8:11], 0
s_add_u32 s50, s48, 0x48000
v_cvt_pk_bf16_f32 v140, v236, v237
v_cvt_pk_bf16_f32 v141, v238, v239
MA 184,80,24
v_cvt_pk_bf16_f32 v142, v252, v253
v_cvt_pk_bf16_f32 v143, v254, v255
MA 184,84,40
buffer_store_dwordx4 v[132:135], v14, s[20:23], s98 offen offset:1024 sc1
v_mfma_f32_16x16x32_bf16 v[188:191], v[76:79], a[12:15], 0
buffer_load_dwordx4 v4, s[24:27], s50 offen lds
MA 188,80,28
s_add_u32 m0, s43, 0x11000
MA 188,84,44
s_add_u32 s51, s48, 0x51000
s_waitcnt lgkmcnt(0)
MA 160,64,48
TR 76,6,12288
MA 160,68,64
TR 78,6,14336
MA 160,72,80
ds_read_b128 v[80:83], v9 offset:18432
MA 164,64,52
ds_read_b128 v[84:87], v10 offset:18432
MA 164,68,68
buffer_load_dwordx4 v4, s[24:27], s51 offen lds
MA 164,72,84
MA 168,64,56
MA 168,68,72
buffer_store_dwordx4 v[136:139], v14, s[20:23], s98 offen offset:2048 sc1
MA 168,72,88
MA 172,64,60
MA 172,68,76
MA 172,72,92
s_waitcnt lgkmcnt(0)
MA 176,76,48
s_waitcnt vmcnt(11)
s_barrier
s_add_u32 m0, s43, 0x0
buffer_store_dword v49, v48, s[20:23], s54 offen offset:0 sc1
MA 176,80,64
s_add_u32 s50, s48, 0x48000
ds_read_b128 v[64:67], v9 offset:24576
MA 176,84,80
ds_read_b128 v[68:71], v10 offset:24576
MA 180,76,52
TR 72,5,32768
MA 180,80,68
TR 74,5,34816
MA 180,84,84
buffer_load_dwordx4 v4, s[28:31], s50 offen lds
MA 184,76,56
s_add_u32 m0, s43, 0x1000
buffer_store_dwordx4 v[140:143], v14, s[20:23], s98 offen offset:3072 sc1
MA 184,80,72
s_add_u32 s51, s48, 0x51000
MA 184,84,88
MA 188,76,60
MA 188,80,76
buffer_load_dwordx4 v4, s[28:31], s51 offen lds
MA 188,84,92
s_add_u32 m0, s43, 0x2000
s_waitcnt lgkmcnt(0)
MA 160,64,96
s_add_u32 s50, s45, 0x24200
ds_read_b128 v[76:79], v9 offset:26624
MA 160,68,112
ds_read_b128 v[80:83], v10 offset:26624
MA 160,72,128
TR 84,6,32768
MA 164,64,100
TR 86,6,34816
MA 164,68,116
buffer_load_dwordx4 v3, s[16:19], s50 offen lds
MA 164,72,132
s_add_u32 m0, s43, 0x3000
MA 168,64,104
s_add_u32 s51, s45, 0x2d200
MA 168,68,120
MA 168,72,136
s_waitcnt vmcnt(13)
s_nop 0
MA 172,64,108
buffer_load_dwordx4 v3, s[16:19], s51 offen lds
MA 172,68,124
s_add_u32 m0, s43, 0x4000
MA 172,72,140
s_add_u32 s50, s45, 0x36200
s_waitcnt lgkmcnt(0)
MA 176,76,96
TR 64,5,36864
MA 176,80,112
TR 66,5,38912
MA 176,84,128
TR 68,5,40960
MA 180,76,100
TR 70,5,43008
MA 180,80,116
TR 72,5,45056
MA 180,84,132
TR 74,5,47104
MA 184,76,104
buffer_load_dwordx4 v3, s[16:19], s50 offen lds
MA 184,80,120
s_add_u32 m0, s43, 0x5000
MA 184,84,136
s_add_u32 s51, s45, 0x3f200
MA 188,76,108
MA 188,80,124
MA 188,84,140
buffer_load_dwordx4 v3, s[16:19], s51 offen lds
s_waitcnt lgkmcnt(0)
MA 160,64,144
TR 76,6,36864
MA 160,68,160
TR 78,6,38912
MA 160,72,176
TR 80,6,40960
MA 164,64,148
TR 82,6,43008
MA 164,68,164
TR 84,6,45056
MA 164,72,180
TR 86,6,47104
MA 168,64,152
MA 168,68,168
MA 168,72,184
MA 172,64,156
MA 172,68,172
MA 172,72,188
s_waitcnt lgkmcnt(0)
MA 176,76,144
s_waitcnt vmcnt(9)
s_barrier
s_add_u32 m0, s43, 0x6000
buffer_store_dword v49, v48, s[20:23], s54 offen offset:4 sc1
MA 176,80,160
s_add_u32 s50, s45, 0x280
TR 64,5,49152
MA 176,84,176
TR 66,5,51200
MA 180,76,148
TR 68,5,53248
MA 180,80,164
TR 70,5,55296
MA 180,84,180
TR 72,5,57344
MA 184,76,152
TR 74,5,59392
MA 184,80,168
buffer_load_dwordx4 v3, s[16:19], s50 offen lds
MA 184,84,184
s_add_u32 m0, s43, 0x7000
MA 188,76,156
s_add_u32 s51, s45, 0x9280
MA 188,80,172
MA 188,84,188
s_waitcnt lgkmcnt(0)
v_mfma_f32_16x16x32_bf16 v[192:195], v[64:67], a[0:3], 0
TR 76,6,49152
MA 192,68,16
TR 78,6,51200
MA 192,72,32
TR 80,6,53248
v_mfma_f32_16x16x32_bf16 v[196:199], v[64:67], a[4:7], 0
TR 82,6,55296
MA 196,68,20
TR 84,6,57344
s_add_u32 s99, s49, 0xc000
v_cvt_pk_bf16_f32 v144, v160, v161
MA 196,72,36
TR 86,6,59392
v_cvt_pk_bf16_f32 v145, v162, v163
v_mfma_f32_16x16x32_bf16 v[200:203], v[64:67], a[8:11], 0
buffer_load_dwordx4 v3, s[16:19], s51 offen lds
MA 200,68,24
s_add_u32 m0, s43, 0x8000
s_waitcnt vmcnt(8)
s_nop 0
MA 200,72,40
s_add_u32 s50, s45, 0x12280
v_cvt_pk_bf16_f32 v146, v176, v177
v_cvt_pk_bf16_f32 v147, v178, v179
v_mfma_f32_16x16x32_bf16 v[204:207], v[64:67], a[12:15], 0
buffer_store_dwordx4 v[144:147], v14, s[20:23], s99 offen offset:0 sc1
MA 204,68,28
v_cvt_pk_bf16_f32 v148, v164, v165
v_cvt_pk_bf16_f32 v149, v166, v167
MA 204,72,44
buffer_load_dwordx4 v3, s[16:19], s50 offen lds
s_waitcnt lgkmcnt(0)
v_mfma_f32_16x16x32_bf16 v[208:211], v[76:79], a[0:3], 0
s_add_u32 m0, s43, 0x9000
TR 64,5,61440
v_cvt_pk_bf16_f32 v150, v180, v181
MA 208,80,16
s_add_u32 s51, s45, 0x1b280
TR 66,5,63488
v_cvt_pk_bf16_f32 v151, v182, v183
MA 208,84,32
v_add_u32 v60, 0x10000, v9
ds_read_b128 v[68:71], v60 offset:0
v_mfma_f32_16x16x32_bf16 v[212:215], v[76:79], a[4:7], 0
v_add_u32 v60, 0x10000, v10
ds_read_b128 v[72:75], v60 offset:0
MA 212,80,20
buffer_load_dwordx4 v3, s[16:19], s51 offen lds
MA 212,84,36
s_add_u32 m0, s43, 0xa000
v_cvt_pk_bf16_f32 v152, v168, v169
v_cvt_pk_bf16_f32 v153, v170, v171
v_mfma_f32_16x16x32_bf16 v[216:219], v[76:79], a[8:11], 0
s_add_u32 s50, s48, 0x5a000
v_cvt_pk_bf16_f32 v154, v184, v185
v_cvt_pk_bf16_f32 v155, v186, v187
MA 216,80,24
v_cvt_pk_bf16_f32 v156, v172, v173
v_cvt_pk_bf16_f32 v157, v174, v175
MA 216,84,40
buffer_store_dwordx4 v[148:151], v14, s[20:23], s99 offen offset:1024 sc1
v_mfma_f32_16x16x32_bf16 v[220:223], v[76:79], a[12:15], 0
buffer_load_dwordx4 v4, s[24:27], s50 offen lds
MA 220,80,28
s_add_u32 m0, s43, 0xb000
v_cvt_pk_bf16_f32 v158, v188, v189
v_cvt_pk_bf16_f32 v159, v190, v191
MA 220,84,44
s_add_u32 s51, s48, 0x63000
s_waitcnt lgkmcnt(0)
MA 192,64,48
TR 76,6,61440
MA 192,68,64
TR 78,6,63488
MA 192,72,80
v_add_u32 v60, 0x10000, v9
ds_read_b128 v[80:83], v60 offset:2048
MA 196,64,52
v_add_u32 v60, 0x10000, v10
ds_read_b128 v[84:87], v60 offset:2048
MA 196,68,68
buffer_load_dwordx4 v4, s[24:27], s51 offen lds
MA 196,72,84
MA 200,64,56
MA 200,68,72
buffer_store_dwordx4 v[152:155], v14, s[20:23], s99 offen offset:2048 sc1
MA 200,72,88
MA 204,64,60
MA 204,68,76
MA 204,72,92
s_waitcnt lgkmcnt(0)
MA 208,76,48
s_waitcnt vmcnt(10)
s_barrier
s_add_u32 m0, s43, 0xc000
buffer_store_dword v49, v48, s[20:23], s54 offen offset:8 sc1
MA 208,80,64
s_add_u32 s50, s48, 0x5a000
ds_read_b128 v[64:67], v9 offset:0
MA 208,84,80
ds_read_b128 v[68:71], v10 offset:0
MA 212,76,52
TR 72,5,8192
MA 212,80,68
TR 74,5,10240
MA 212,84,84
buffer_load_dwordx4 v4, s[28:31], s50 offen lds
MA 216,76,56
s_add_u32 m0, s43, 0xd000
buffer_store_dwordx4 v[156:159], v14, s[20:23], s99 offen offset:3072 sc1
MA 216,80,72
s_add_u32 s51, s48, 0x63000
MA 216,84,88
MA 220,76,60
MA 220,80,76
buffer_load_dwordx4 v4, s[28:31], s51 offen lds
MA 220,84,92
s_add_u32 m0, s43, 0xe000
s_waitcnt lgkmcnt(0)
MA 192,64,96
s_add_u32 s50, s45, 0x24280
ds_read_b128 v[76:79], v9 offset:2048
MA 192,68,112
ds_read_b128 v[80:83], v10 offset:2048
MA 192,72,128
TR 84,6,8192
MA 196,64,100
TR 86,6,10240
MA 196,68,116
buffer_load_dwordx4 v3, s[16:19], s50 offen lds
MA 196,72,132
s_add_u32 m0, s43, 0xf000
MA 200,64,104
s_add_u32 s51, s45, 0x2d280
MA 200,68,120
MA 200,72,136
MA 204,64,108
buffer_load_dwordx4 v3, s[16:19], s51 offen lds
MA 204,68,124
s_add_u32 m0, s43, 0x10000
MA 204,72,140
s_add_u32 s50, s45, 0x36280
s_waitcnt lgkmcnt(0)
MA 208,76,96
TR 64,5,12288
MA 208,80,112
TR 66,5,14336
MA 208,84,128
TR 68,5,16384
MA 212,76,100
TR 70,5,18432
MA 212,80,116
TR 72,5,20480
MA 212,84,132
TR 74,5,22528
MA 216,76,104
buffer_load_dwordx4 v3, s[16:19], s50 offen lds
MA 216,80,120
s_add_u32 m0, s43, 0x11000
MA 216,84,136
s_add_u32 s51, s45, 0x3f280
MA 220,76,108
MA 220,80,124
MA 220,84,140
buffer_load_dwordx4 v3, s[16:19], s51 offen lds
s_waitcnt lgkmcnt(0)
MA 192,64,144
TR 76,6,12288
MA 192,68,160
TR 78,6,14336
MA 192,72,176
TR 80,6,16384
MA 196,64,148
TR 82,6,18432
MA 196,68,164
TR 84,6,20480
MA 196,72,180
TR 86,6,22528
MA 200,64,152
MA 200,68,168
MA 200,72,184
MA 204,64,156
MA 204,68,172
MA 204,72,188
s_waitcnt lgkmcnt(0)
MA 208,76,144
s_waitcnt vmcnt(9)
s_barrier
s_add_u32 m0, s43, 0x0
MA 208,80,160
s_add_u32 s50, s45, 0x300
TR 64,5,24576
MA 208,84,176
TR 66,5,26624
MA 212,76,148
TR 68,5,28672
MA 212,80,164
TR 70,5,30720
MA 212,84,180
TR 72,5,32768
MA 216,76,152
TR 74,5,34816
MA 216,80,168
buffer_load_dwordx4 v3, s[16:19], s50 offen lds
MA 216,84,184
s_add_u32 m0, s43, 0x1000
MA 220,76,156
s_add_u32 s51, s45, 0x9300
MA 220,80,172
MA 220,84,188
s_waitcnt lgkmcnt(0)
v_mfma_f32_16x16x32_bf16 v[224:227], v[64:67], a[0:3], 0
TR 76,6,24576
MA 224,68,16
TR 78,6,26624
MA 224,72,32
TR 80,6,28672
v_mfma_f32_16x16x32_bf16 v[228:231], v[64:67], a[4:7], 0
TR 82,6,30720
MA 228,68,20
TR 84,6,32768
s_add_u32 s96, s49, 0x10000
v_cvt_pk_bf16_f32 v96, v192, v193
MA 228,72,36
TR 86,6,34816
v_cvt_pk_bf16_f32 v97, v194, v195
v_mfma_f32_16x16x32_bf16 v[232:235], v[64:67], a[8:11], 0
buffer_load_dwordx4 v3, s[16:19], s51 offen lds
MA 232,68,24
s_add_u32 m0, s43, 0x2000
s_waitcnt vmcnt(7)
s_nop 0
MA 232,72,40
s_add_u32 s50, s45, 0x12300
v_cvt_pk_bf16_f32 v98, v208, v209
v_cvt_pk_bf16_f32 v99, v210, v211
v_mfma_f32_16x16x32_bf16 v[236:239], v[64:67], a[12:15], 0
buffer_store_dwordx4 v[96:99], v14, s[20:23], s96 offen offset:0 sc1
MA 236,68,28
v_cvt_pk_bf16_f32 v100, v196, v197
v_cvt_pk_bf16_f32 v101, v198, v199
MA 236,72,44
buffer_load_dwordx4 v3, s[16:19], s50 offen lds
s_waitcnt lgkmcnt(0)
v_mfma_f32_16x16x32_bf16 v[240:243], v[76:79], a[0:3], 0
s_add_u32 m0, s43, 0x3000
TR 64,5,36864
v_cvt_pk_bf16_f32 v102, v212, v213
MA 240,80,16
s_add_u32 s51, s45, 0x1b300
TR 66,5,38912
v_cvt_pk_bf16_f32 v103, v214, v215
MA 240,84,32
ds_read_b128 v[68:71], v9 offset:40960
v_cvt_pk_bf16_f32 v104, v200, v201
v_mfma_f32_16x16x32_bf16 v[244:247], v[76:79], a[4:7], 0
ds_read_b128 v[72:75], v10 offset:40960
v_cvt_pk_bf16_f32 v105, v202, v203
MA 244,80,20
buffer_load_dwordx4 v3, s[16:19], s51 offen lds
MA 244,84,36
s_add_u32 m0, s43, 0x4000
v_cvt_pk_bf16_f32 v106, v216, v217
v_cvt_pk_bf16_f32 v107, v218, v219
v_mfma_f32_16x16x32_bf16 v[248:251], v[76:79], a[8:11], 0
s_add_u32 s50, s48, 0x6c000
v_cvt_pk_bf16_f32 v108, v204, v205
v_cvt_pk_bf16_f32 v109, v206, v207
MA 248,80,24
v_cvt_pk_bf16_f32 v110, v220, v221
v_cvt_pk_bf16_f32 v111, v222, v223
MA 248,84,40
buffer_store_dwordx4 v[100:103], v14, s[20:23], s96 offen offset:1024 sc1
v_mfma_f32_16x16x32_bf16 v[252:255], v[76:79], a[12:15], 0
buffer_load_dwordx4 v4, s[24:27], s50 offen lds
MA 252,80,28
s_add_u32 m0, s43, 0x5000
MA 252,84,44
s_add_u32 s51, s48, 0x75000
s_waitcnt lgkmcnt(0)
MA 224,64,48
TR 76,6,36864
MA 224,68,64
TR 78,6,38912
MA 224,72,80
ds_read_b128 v[80:83], v9 offset:43008
MA 228,64,52
ds_read_b128 v[84:87], v10 offset:43008
MA 228,68,68
buffer_load_dwordx4 v4, s[24:27], s51 offen lds
MA 228,72,84
MA 232,64,56
MA 232,68,72
buffer_store_dwordx4 v[104:107], v14, s[20:23], s96 offen offset:2048 sc1
MA 232,72,88
MA 236,64,60
MA 236,68,76
MA 236,72,92
s_waitcnt lgkmcnt(0)
MA 240,76,48
s_waitcnt vmcnt(9)
s_barrier
s_add_u32 m0, s43, 0x6000
buffer_store_dword v49, v48, s[20:23], s54 offen offset:12 sc1
MA 240,80,64
s_add_u32 s50, s48, 0x6c000
ds_read_b128 v[64:67], v9 offset:49152
MA 240,84,80
ds_read_b128 v[68:71], v10 offset:49152
MA 244,76,52
TR 72,5,57344
MA 244,80,68
TR 74,5,59392
MA 244,84,84
buffer_load_dwordx4 v4, s[28:31], s50 offen lds
MA 248,76,56
s_add_u32 m0, s43, 0x7000
buffer_store_dwordx4 v[108:111], v14, s[20:23], s96 offen offset:3072 sc1
MA 248,80,72
s_add_u32 s51, s48, 0x75000
MA 248,84,88
MA 252,76,60
MA 252,80,76
buffer_load_dwordx4 v4, s[28:31], s51 offen lds
MA 252,84,92
s_add_u32 m0, s43, 0x8000
s_waitcnt lgkmcnt(0)
MA 224,64,96
s_add_u32 s50, s45, 0x24300
ds_read_b128 v[76:79], v9 offset:51200
MA 224,68,112
ds_read_b128 v[80:83], v10 offset:51200
MA 224,72,128
TR 84,6,57344
MA 228,64,100
TR 86,6,59392
MA 228,68,116
buffer_load_dwordx4 v3, s[16:19], s50 offen lds
MA 228,72,132
s_add_u32 m0, s43, 0x9000
MA 232,64,104
s_add_u32 s51, s45, 0x2d300
MA 232,68,120
MA 232,72,136
MA 236,64,108
buffer_load_dwordx4 v3, s[16:19], s51 offen lds
MA 236,68,124
s_add_u32 m0, s43, 0xa000
MA 236,72,140
s_add_u32 s50, s45, 0x36300
s_waitcnt lgkmcnt(0)
MA 240,76,96
TR 64,5,61440
MA 240,80,112
TR 66,5,63488
MA 240,84,128
TR 68,7,0
MA 244,76,100
TR 70,7,2048
MA 244,80,116
TR 72,7,4096
MA 244,84,132
TR 74,7,6144
MA 248,76,104
buffer_load_dwordx4 v3, s[16:19], s50 offen lds
MA 248,80,120
s_add_u32 m0, s43, 0xb000
MA 248,84,136
s_add_u32 s51, s45, 0x3f300
MA 252,76,108
MA 252,80,124
MA 252,84,140
buffer_load_dwordx4 v3, s[16:19], s51 offen lds
s_waitcnt lgkmcnt(0)
MA 224,64,144
TR 76,6,61440
MA 224,68,160
TR 78,6,63488
MA 224,72,176
TR 80,8,0
MA 228,64,148
TR 82,8,2048
MA 228,68,164
TR 84,8,4096
MA 228,72,180
TR 86,8,6144
MA 232,64,152
MA 232,68,168
MA 232,72,184
MA 236,64,156
MA 236,68,172
MA 236,72,188
s_waitcnt lgkmcnt(0)
MA 240,76,144
s_waitcnt vmcnt(9)
s_barrier
s_add_u32 m0, s43, 0xc000
MA 240,80,160
s_add_u32 s50, s45, 0x380
TR 64,5,0
MA 240,84,176
TR 66,5,2048
MA 244,76,148
TR 68,5,4096
MA 244,80,164
TR 70,5,6144
MA 244,84,180
TR 72,5,8192
MA 248,76,152
TR 74,5,10240
MA 248,80,168
buffer_load_dwordx4 v3, s[16:19], s50 offen lds
MA 248,84,184
s_add_u32 m0, s43, 0xd000
MA 252,76,156
s_add_u32 s51, s45, 0x9380
MA 252,80,172
MA 252,84,188
s_waitcnt lgkmcnt(0)
v_mfma_f32_16x16x32_bf16 v[160:163], v[64:67], a[0:3], 0
TR 76,6,0
MA 160,68,16
TR 78,6,2048
MA 160,72,32
TR 80,6,4096
v_mfma_f32_16x16x32_bf16 v[164:167], v[64:67], a[4:7], 0
TR 82,6,6144
MA 164,68,20
TR 84,6,8192
s_add_u32 s97, s49, 0x14000
v_cvt_pk_bf16_f32 v112, v224, v225
MA 164,72,36
TR 86,6,10240
v_cvt_pk_bf16_f32 v113, v226, v227
v_mfma_f32_16x16x32_bf16 v[168:171], v[64:67], a[8:11], 0
buffer_load_dwordx4 v3, s[16:19], s51 offen lds
MA 168,68,24
s_add_u32 m0, s43, 0xe000
s_waitcnt vmcnt(7)
s_nop 0
MA 168,72,40
s_add_u32 s50, s45, 0x12380
v_cvt_pk_bf16_f32 v114, v240, v241
v_cvt_pk_bf16_f32 v115, v242, v243
v_mfma_f32_16x16x32_bf16 v[172:175], v[64:67], a[12:15], 0
buffer_store_dwordx4 v[112:115], v14, s[20:23], s97 offen offset:0 sc1
MA 172,68,28
v_cvt_pk_bf16_f32 v116, v228, v229
v_cvt_pk_bf16_f32 v117, v230, v231
MA 172,72,44
buffer_load_dwordx4 v3, s[16:19], s50 offen lds
s_waitcnt lgkmcnt(0)
v_mfma_f32_16x16x32_bf16 v[176:179], v[76:79], a[0:3], 0
s_add_u32 m0, s43, 0xf000
TR 64,5,12288
v_cvt_pk_bf16_f32 v118, v244, v245
MA 176,80,16
s_add_u32 s51, s45, 0x1b380
TR 66,5,14336
v_cvt_pk_bf16_f32 v119, v246, v247
MA 176,84,32
ds_read_b128 v[68:71], v9 offset:16384
v_cvt_pk_bf16_f32 v120, v232, v233
v_mfma_f32_16x16x32_bf16 v[180:183], v[76:79], a[4:7], 0
ds_read_b128 v[72:75], v10 offset:16384
v_cvt_pk_bf16_f32 v121, v234, v235
MA 180,80,20
buffer_load_dwordx4 v3, s[16:19], s51 offen lds
MA 180,84,36
s_add_u32 m0, s43, 0x10000
v_cvt_pk_bf16_f32 v122, v248, v249
v_cvt_pk_bf16_f32 v123, v250, v251
v_mfma_f32_16x16x32_bf16 v[184:187], v[76:79], a[8:11], 0
s_add_u32 s50, s48, 0x7e000
v_cvt_pk_bf16_f32 v124, v236, v237
v_cvt_pk_bf16_f32 v125, v238, v239
MA 184,80,24
v_cvt_pk_bf16_f32 v126, v252, v253
v_cvt_pk_bf16_f32 v127, v254, v255
MA 184,84,40
buffer_store_dwordx4 v[116:119], v14, s[20:23], s97 offen offset:1024 sc1
v_mfma_f32_16x16x32_bf16 v[188:191], v[76:79], a[12:15], 0
buffer_load_dwordx4 v4, s[24:27], s50 offen lds
MA 188,80,28
s_add_u32 m0, s43, 0x11000
MA 188,84,44
s_add_u32 s51, s48, 0x87000
s_waitcnt lgkmcnt(0)
MA 160,64,48
TR 76,6,12288
MA 160,68,64
TR 78,6,14336
MA 160,72,80
ds_read_b128 v[80:83], v9 offset:18432
MA 164,64,52
ds_read_b128 v[84:87], v10 offset:18432
MA 164,68,68
buffer_load_dwordx4 v4, s[24:27], s51 offen lds
MA 164,72,84
MA 168,64,56
MA 168,68,72
buffer_store_dwordx4 v[120:123], v14, s[20:23], s97 offen offset:2048 sc1
MA 168,72,88
MA 172,64,60
MA 172,68,76
MA 172,72,92
s_waitcnt lgkmcnt(0)
MA 176,76,48
s_waitcnt vmcnt(9)
s_barrier
s_add_u32 m0, s43, 0x0
buffer_store_dword v49, v48, s[20:23], s54 offen offset:16 sc1
MA 176,80,64
s_add_u32 s50, s48, 0x7e000
ds_read_b128 v[64:67], v9 offset:24576
MA 176,84,80
ds_read_b128 v[68:71], v10 offset:24576
MA 180,76,52
TR 72,5,32768
MA 180,80,68
TR 74,5,34816
MA 180,84,84
buffer_load_dwordx4 v4, s[28:31], s50 offen lds
MA 184,76,56
s_add_u32 m0, s43, 0x1000
buffer_store_dwordx4 v[124:127], v14, s[20:23], s97 offen offset:3072 sc1
MA 184,80,72
s_add_u32 s51, s48, 0x87000
MA 184,84,88
MA 188,76,60
MA 188,80,76
buffer_load_dwordx4 v4, s[28:31], s51 offen lds
MA 188,84,92
s_add_u32 m0, s43, 0x2000
s_waitcnt lgkmcnt(0)
MA 160,64,96
s_add_u32 s50, s45, 0x24380
ds_read_b128 v[76:79], v9 offset:26624
MA 160,68,112
ds_read_b128 v[80:83], v10 offset:26624
MA 160,72,128
TR 84,6,32768
MA 164,64,100
TR 86,6,34816
MA 164,68,116
buffer_load_dwordx4 v3, s[16:19], s50 offen lds
MA 164,72,132
s_add_u32 m0, s43, 0x3000
MA 168,64,104
s_add_u32 s51, s45, 0x2d380
MA 168,68,120
MA 168,72,136
MA 172,64,108
buffer_load_dwordx4 v3, s[16:19], s51 offen lds
MA 172,68,124
s_add_u32 m0, s43, 0x4000
MA 172,72,140
s_add_u32 s50, s45, 0x36380
s_waitcnt lgkmcnt(0)
MA 176,76,96
TR 64,5,36864
MA 176,80,112
TR 66,5,38912
MA 176,84,128
TR 68,5,40960
MA 180,76,100
TR 70,5,43008
MA 180,80,116
TR 72,5,45056
MA 180,84,132
TR 74,5,47104
MA 184,76,104
buffer_load_dwordx4 v3, s[16:19], s50 offen lds
MA 184,80,120
s_add_u32 m0, s43, 0x5000
MA 184,84,136
s_add_u32 s51, s45, 0x3f380
MA 188,76,108
MA 188,80,124
MA 188,84,140
buffer_load_dwordx4 v3, s[16:19], s51 offen lds
s_waitcnt lgkmcnt(0)
MA 160,64,144
TR 76,6,36864
MA 160,68,160
TR 78,6,38912
MA 160,72,176
TR 80,6,40960
MA 164,64,148
TR 82,6,43008
MA 164,68,164
TR 84,6,45056
MA 164,72,180
TR 86,6,47104
MA 168,64,152
MA 168,68,168
MA 168,72,184
MA 172,64,156
MA 172,68,172
MA 172,72,188
s_waitcnt lgkmcnt(0)
MA 176,76,144
s_waitcnt vmcnt(9)
s_barrier
s_add_u32 m0, s43, 0x6000
MA 176,80,160
s_add_u32 s50, s45, 0x400
TR 64,5,49152
MA 176,84,176
TR 66,5,51200
MA 180,76,148
TR 68,5,53248
MA 180,80,164
TR 70,5,55296
MA 180,84,180
TR 72,5,57344
MA 184,76,152
TR 74,5,59392
MA 184,80,168
buffer_load_dwordx4 v3, s[16:19], s50 offen lds
MA 184,84,184
s_add_u32 m0, s43, 0x7000
MA 188,76,156
s_add_u32 s51, s45, 0x9400
MA 188,80,172
MA 188,84,188
s_waitcnt lgkmcnt(0)
v_mfma_f32_16x16x32_bf16 v[192:195], v[64:67], a[0:3], 0
TR 76,6,49152
MA 192,68,16
TR 78,6,51200
MA 192,72,32
TR 80,6,53248
v_mfma_f32_16x16x32_bf16 v[196:199], v[64:67], a[4:7], 0
TR 82,6,55296
MA 196,68,20
TR 84,6,57344
s_add_u32 s98, s49, 0x18000
v_cvt_pk_bf16_f32 v128, v160, v161
MA 196,72,36
TR 86,6,59392
v_cvt_pk_bf16_f32 v129, v162, v163
v_mfma_f32_16x16x32_bf16 v[200:203], v[64:67], a[8:11], 0
buffer_load_dwordx4 v3, s[16:19], s51 offen lds
MA 200,68,24
s_add_u32 m0, s43, 0x8000
s_waitcnt vmcnt(7)
s_nop 0
MA 200,72,40
s_add_u32 s50, s45, 0x12400
v_cvt_pk_bf16_f32 v130, v176, v177
v_cvt_pk_bf16_f32 v131, v178, v179
v_mfma_f32_16x16x32_bf16 v[204:207], v[64:67], a[12:15], 0
buffer_store_dwordx4 v[128:131], v14, s[20:23], s98 offen offset:0 sc1
MA 204,68,28
v_cvt_pk_bf16_f32 v132, v164, v165
v_cvt_pk_bf16_f32 v133, v166, v167
MA 204,72,44
buffer_load_dwordx4 v3, s[16:19], s50 offen lds
s_waitcnt lgkmcnt(0)
v_mfma_f32_16x16x32_bf16 v[208:211], v[76:79], a[0:3], 0
s_add_u32 m0, s43, 0x9000
TR 64,5,61440
v_cvt_pk_bf16_f32 v134, v180, v181
MA 208,80,16
s_add_u32 s51, s45, 0x1b400
TR 66,5,63488
v_cvt_pk_bf16_f32 v135, v182, v183
MA 208,84,32
v_add_u32 v60, 0x10000, v9
ds_read_b128 v[68:71], v60 offset:0
v_mfma_f32_16x16x32_bf16 v[212:215], v[76:79], a[4:7], 0
v_add_u32 v60, 0x10000, v10
ds_read_b128 v[72:75], v60 offset:0
MA 212,80,20
buffer_load_dwordx4 v3, s[16:19], s51 offen lds
MA 212,84,36
s_add_u32 m0, s43, 0xa000
v_cvt_pk_bf16_f32 v136, v168, v169
v_cvt_pk_bf16_f32 v137, v170, v171
v_mfma_f32_16x16x32_bf16 v[216:219], v[76:79], a[8:11], 0
s_add_u32 s50, s48, 0x90000
v_cvt_pk_bf16_f32 v138, v184, v185
v_cvt_pk_bf16_f32 v139, v186, v187
MA 216,80,24
v_cvt_pk_bf16_f32 v140, v172, v173
v_cvt_pk_bf16_f32 v141, v174, v175
MA 216,84,40
buffer_store_dwordx4 v[132:135], v14, s[20:23], s98 offen offset:1024 sc1
v_mfma_f32_16x16x32_bf16 v[220:223], v[76:79], a[12:15], 0
buffer_load_dwordx4 v4, s[24:27], s50 offen lds
MA 220,80,28
s_add_u32 m0, s43, 0xb000
v_cvt_pk_bf16_f32 v142, v188, v189
v_cvt_pk_bf16_f32 v143, v190, v191
MA 220,84,44
s_add_u32 s51, s48, 0x99000
s_waitcnt lgkmcnt(0)
MA 192,64,48
TR 76,6,61440
MA 192,68,64
TR 78,6,63488
MA 192,72,80
v_add_u32 v60, 0x10000, v9
ds_read_b128 v[80:83], v60 offset:2048
MA 196,64,52
v_add_u32 v60, 0x10000, v10
ds_read_b128 v[84:87], v60 offset:2048
MA 196,68,68
buffer_load_dwordx4 v4, s[24:27], s51 offen lds
MA 196,72,84
MA 200,64,56
MA 200,68,72
buffer_store_dwordx4 v[136:139], v14, s[20:23], s98 offen offset:2048 sc1
MA 200,72,88
MA 204,64,60
MA 204,68,76
MA 204,72,92
s_waitcnt lgkmcnt(0)
MA 208,76,48
s_waitcnt vmcnt(9)
s_barrier
s_add_u32 m0, s43, 0xc000
buffer_store_dword v49, v48, s[20:23], s54 offen offset:20 sc1
MA 208,80,64
s_add_u32 s50, s48, 0x90000
ds_read_b128 v[64:67], v9 offset:0
MA 208,84,80
ds_read_b128 v[68:71], v10 offset:0
MA 212,76,52
TR 72,5,8192
MA 212,80,68
TR 74,5,10240
MA 212,84,84
buffer_load_dwordx4 v4, s[28:31], s50 offen lds
MA 216,76,56
s_add_u32 m0, s43, 0xd000
buffer_store_dwordx4 v[140:143], v14, s[20:23], s98 offen offset:3072 sc1
MA 216,80,72
s_add_u32 s51, s48, 0x99000
MA 216,84,88
MA 220,76,60
MA 220,80,76
buffer_load_dwordx4 v4, s[28:31], s51 offen lds
MA 220,84,92
s_add_u32 m0, s43, 0xe000
s_waitcnt lgkmcnt(0)
MA 192,64,96
s_add_u32 s50, s45, 0x24400
ds_read_b128 v[76:79], v9 offset:2048
MA 192,68,112
ds_read_b128 v[80:83], v10 offset:2048
MA 192,72,128
TR 84,6,8192
MA 196,64,100
TR 86,6,10240
MA 196,68,116
buffer_load_dwordx4 v3, s[16:19], s50 offen lds
MA 196,72,132
s_add_u32 m0, s43, 0xf000
MA 200,64,104
s_add_u32 s51, s45, 0x2d400
MA 200,68,120
MA 200,72,136
MA 204,64,108
buffer_load_dwordx4 v3, s[16:19], s51 offen lds
MA 204,68,124
s_add_u32 m0, s43, 0x10000
MA 204,72,140
s_add_u32 s50, s45, 0x36400
s_waitcnt lgkmcnt(0)
MA 208,76,96
TR 64,5,12288
MA 208,80,112
TR 66,5,14336
MA 208,84,128
TR 68,5,16384
MA 212,76,100
TR 70,5,18432
MA 212,80,116
TR 72,5,20480
MA 212,84,132
TR 74,5,22528
MA 216,76,104
buffer_load_dwordx4 v3, s[16:19], s50 offen lds
MA 216,80,120
s_add_u32 m0, s43, 0x11000
MA 216,84,136
s_add_u32 s51, s45, 0x3f400
MA 220,76,108
MA 220,80,124
MA 220,84,140
buffer_load_dwordx4 v3, s[16:19], s51 offen lds
s_waitcnt lgkmcnt(0)
MA 192,64,144
TR 76,6,12288
MA 192,68,160
TR 78,6,14336
MA 192,72,176
TR 80,6,16384
MA 196,64,148
TR 82,6,18432
MA 196,68,164
TR 84,6,20480
MA 196,72,180
TR 86,6,22528
MA 200,64,152
MA 200,68,168
MA 200,72,184
MA 204,64,156
MA 204,68,172
MA 204,72,188
s_waitcnt lgkmcnt(0)
MA 208,76,144
s_waitcnt vmcnt(9)
s_barrier
MA 208,80,160
TR 64,5,24576
MA 208,84,176
TR 66,5,26624
MA 212,76,148
TR 68,5,28672
MA 212,80,164
TR 70,5,30720
MA 212,84,180
TR 72,5,32768
MA 216,76,152
TR 74,5,34816
MA 216,80,168
MA 216,84,184
MA 220,76,156
MA 220,80,172
MA 220,84,188
s_waitcnt lgkmcnt(0)
v_mfma_f32_16x16x32_bf16 v[224:227], v[64:67], a[0:3], 0
TR 76,6,24576
MA 224,68,16
TR 78,6,26624
MA 224,72,32
TR 80,6,28672
v_mfma_f32_16x16x32_bf16 v[228:231], v[64:67], a[4:7], 0
TR 82,6,30720
MA 228,68,20
TR 84,6,32768
s_add_u32 s99, s49, 0x1c000
v_cvt_pk_bf16_f32 v144, v192, v193
MA 228,72,36
TR 86,6,34816
v_cvt_pk_bf16_f32 v145, v194, v195
v_mfma_f32_16x16x32_bf16 v[232:235], v[64:67], a[8:11], 0
s_waitcnt vmcnt(5)
s_nop 0
v_cvt_pk_bf16_f32 v146, v208, v209
MA 232,68,24
v_cvt_pk_bf16_f32 v147, v210, v211
v_cvt_pk_bf16_f32 v148, v196, v197
MA 232,72,40
buffer_store_dwordx4 v[144:147], v14, s[20:23], s99 offen offset:0 sc1
v_mfma_f32_16x16x32_bf16 v[236:239], v[64:67], a[12:15], 0
v_cvt_pk_bf16_f32 v149, v198, v199
v_cvt_pk_bf16_f32 v150, v212, v213
MA 236,68,28
v_cvt_pk_bf16_f32 v151, v214, v215
v_cvt_pk_bf16_f32 v152, v200, v201
MA 236,72,44
v_cvt_pk_bf16_f32 v153, v202, v203
s_waitcnt lgkmcnt(0)
v_mfma_f32_16x16x32_bf16 v[240:243], v[76:79], a[0:3], 0
TR 64,5,36864
v_cvt_pk_bf16_f32 v154, v216, v217
MA 240,80,16
TR 66,5,38912
v_cvt_pk_bf16_f32 v155, v218, v219
MA 240,84,32
ds_read_b128 v[68:71], v9 offset:40960
v_cvt_pk_bf16_f32 v156, v204, v205
v_mfma_f32_16x16x32_bf16 v[244:247], v[76:79], a[4:7], 0
ds_read_b128 v[72:75], v10 offset:40960
v_cvt_pk_bf16_f32 v157, v206, v207
MA 244,80,20
v_cvt_pk_bf16_f32 v158, v220, v221
v_cvt_pk_bf16_f32 v159, v222, v223
MA 244,84,36
v_mfma_f32_16x16x32_bf16 v[248:251], v[76:79], a[8:11], 0
MA 248,80,24
buffer_store_dwordx4 v[148:151], v14, s[20:23], s99 offen offset:1024 sc1
MA 248,84,40
v_mfma_f32_16x16x32_bf16 v[252:255], v[76:79], a[12:15], 0
MA 252,80,28
MA 252,84,44
s_waitcnt lgkmcnt(0)
MA 224,64,48
TR 76,6,36864
MA 224,68,64
TR 78,6,38912
MA 224,72,80
ds_read_b128 v[80:83], v9 offset:43008
MA 228,64,52
ds_read_b128 v[84:87], v10 offset:43008
MA 228,68,68
MA 228,72,84
MA 232,64,56
buffer_store_dwordx4 v[152:155], v14, s[20:23], s99 offen offset:2048 sc1
MA 232,68,72
MA 232,72,88
MA 236,64,60
MA 236,68,76
MA 236,72,92
s_waitcnt lgkmcnt(0)
MA 240,76,48
s_waitcnt vmcnt(3)
s_barrier
buffer_store_dword v49, v48, s[20:23], s54 offen offset:24 sc1
MA 240,80,64
ds_read_b128 v[64:67], v9 offset:49152
MA 240,84,80
ds_read_b128 v[68:71], v10 offset:49152
MA 244,76,52
TR 72,5,57344
MA 244,80,68
TR 74,5,59392
MA 244,84,84
buffer_store_dwordx4 v[156:159], v14, s[20:23], s99 offen offset:3072 sc1
MA 248,76,56
MA 248,80,72
MA 248,84,88
MA 252,76,60
MA 252,80,76
MA 252,84,92
s_waitcnt lgkmcnt(0)
MA 224,64,96
ds_read_b128 v[76:79], v9 offset:51200
MA 224,68,112
ds_read_b128 v[80:83], v10 offset:51200
MA 224,72,128
TR 84,6,57344
MA 228,64,100
TR 86,6,59392
MA 228,68,116
MA 228,72,132
MA 232,64,104
MA 232,68,120
MA 232,72,136
MA 236,64,108
MA 236,68,124
MA 236,72,140
s_waitcnt lgkmcnt(0)
MA 240,76,96
TR 64,5,61440
MA 240,80,112
TR 66,5,63488
MA 240,84,128
TR 68,7,0
MA 244,76,100
TR 70,7,2048
MA 244,80,116
TR 72,7,4096
MA 244,84,132
TR 74,7,6144
MA 248,76,104
MA 248,80,120
MA 248,84,136
MA 252,76,108
MA 252,80,124
MA 252,84,140
s_waitcnt lgkmcnt(0)
MA 224,64,144
TR 76,6,61440
MA 224,68,160
TR 78,6,63488
MA 224,72,176
TR 80,8,0
MA 228,64,148
TR 82,8,2048
MA 228,68,164
TR 84,8,4096
MA 228,72,180
TR 86,8,6144
MA 232,64,152
MA 232,68,168
MA 232,72,184
MA 236,64,156
MA 236,68,172
MA 236,72,188
s_waitcnt lgkmcnt(0)
MA 240,76,144
MA 240,80,160
MA 240,84,176
MA 244,76,148
MA 244,80,164
MA 244,84,180
MA 248,76,152
MA 248,80,168
MA 248,84,184
MA 252,76,156
MA 252,80,172
MA 252,84,188
s_nop 7
s_add_u32 s96, s49, 0x20000
v_cvt_pk_bf16_f32 v96, v224, v225
v_cvt_pk_bf16_f32 v97, v226, v227
v_cvt_pk_bf16_f32 v98, v240, v241
v_cvt_pk_bf16_f32 v99, v242, v243
v_cvt_pk_bf16_f32 v100, v228, v229
v_cvt_pk_bf16_f32 v101, v230, v231
v_cvt_pk_bf16_f32 v102, v244, v245
v_cvt_pk_bf16_f32 v103, v246, v247
v_cvt_pk_bf16_f32 v104, v232, v233
v_cvt_pk_bf16_f32 v105, v234, v235
v_cvt_pk_bf16_f32 v106, v248, v249
v_cvt_pk_bf16_f32 v107, v250, v251
v_cvt_pk_bf16_f32 v108, v236, v237
v_cvt_pk_bf16_f32 v109, v238, v239
v_cvt_pk_bf16_f32 v110, v252, v253
v_cvt_pk_bf16_f32 v111, v254, v255
buffer_store_dwordx4 v[96:99], v14, s[20:23], s96 offen offset:0 sc1
buffer_store_dwordx4 v[100:103], v14, s[20:23], s96 offen offset:1024 sc1
buffer_store_dwordx4 v[104:107], v14, s[20:23], s96 offen offset:2048 sc1
buffer_store_dwordx4 v[108:111], v14, s[20:23], s96 offen offset:3072 sc1
s_mov_b32 s78, 0x180
s_mov_b32 s77, 0
s_branch L_tail
L_k1_S_end:
L_k1_A:
s_mul_i32 s44, s42, 320
s_sub_u32 s44, s44, 576
s_mul_i32 s45, s44, 1152
s_lshl_b32 s44, s44, 1
v_bfe_u32 v88, v0, 4, 2
v_bfe_u32 v89, v0, 2, 2
v_lshlrev_b32 v5, 10, v88
v_lshl_add_u32 v5, v89, 7, v5
v_and_b32 v88, 1, v88
v_lshlrev_b32 v88, 1, v88
v_lshrrev_b32 v89, 1, v89
v_or_b32 v88, v88, v89
v_xor_b32 v88, s80, v88
v_lshl_add_u32 v5, v88, 5, v5
v_and_b32 v88, 3, v0
v_lshl_add_u32 v5, v88, 3, v5
v_xor_b32 v6, 32, v5
v_add_u32 v7, 0x10000, v5
v_add_u32 v8, 0x10000, v6
s_lshl_b32 s82, s80, 12
s_and_b32 s83, s40, 1
s_lshl_b32 s83, s83, 12
s_add_u32 s83, s83, 73728
v_add_u32 v12, s83, v1
v_add_u32 v13, 0x10000, v12
v_add_u32 v11, s82, v12
s_lshl_b32 s82, s40, 12
v_add_u32 v14, s82, v1
s_getpc_b64 s[92:93]
L_pc3:
s_sub_u32 s92, s92, L_pc3-L_k1_A
s_subb_u32 s93, s93, 0
s_mov_b32 s94, L_code_end-L_k1_A
s_mov_b32 s95, 0x20000
s_waitcnt vmcnt(0) lgkmcnt(0)
s_barrier
s_cmp_lg_u32 s40, 0
s_cbranch_scc1 L_A_hs_oth
s_mov_b32 s99, 1
s_atomic_add s99, s[96:97], 0x0 glc
L_A_hs_oth:
s_mul_i32 s82, s41, 331776
s_add_u32 s82, s82, s44
s_add_u32 s82, s82, 128
v_lshrrev_b32 v160, 3, v0
v_mul_u32_u24 v160, 9216, v160
v_and_b32 v161, 7, v0
v_lshl_add_u32 v160, v161, 4, v160
s_add_u32 s83, s82, 36864
buffer_load_dwordx4 v[164:167], v160, s[8:11], s82 offen offset:0
buffer_load_dwordx4 v[164:167], v160, s[12:15], s82 offen offset:0
buffer_load_dwordx4 v[164:167], v160, s[8:11], s83 offen offset:0
buffer_load_dwordx4 v[164:167], v160, s[12:15], s83 offen offset:0
buffer_load_dwordx4 v[164:167], v160, s[8:11], s82 offen offset:128
buffer_load_dwordx4 v[164:167], v160, s[12:15], s82 offen offset:128
buffer_load_dwordx4 v[164:167], v160, s[8:11], s83 offen offset:128
buffer_load_dwordx4 v[164:167], v160, s[12:15], s83 offen offset:128
s_add_u32 m0, s43, 0x0
s_add_u32 s50, s44, 0x0
buffer_load_dwordx4 v2, s[8:11], s50 offen lds
s_add_u32 m0, s43, 0x1000
s_add_u32 s51, s44, 0x0
buffer_load_dwordx4 v2, s[12:15], s51 offen lds
s_add_u32 m0, s43, 0x2000
s_add_u32 s50, s44, 0x48000
buffer_load_dwordx4 v2, s[8:11], s50 offen lds
s_add_u32 m0, s43, 0x3000
s_add_u32 s51, s44, 0x48000
buffer_load_dwordx4 v2, s[12:15], s51 offen lds
s_add_u32 m0, s43, 0x4000
s_add_u32 s50, s44, 0x90000
buffer_load_dwordx4 v2, s[8:11], s50 offen lds
s_add_u32 m0, s43, 0x5000
s_add_u32 s51, s44, 0x90000
buffer_load_dwordx4 v2, s[12:15], s51 offen lds
s_add_u32 m0, s43, 0x6000
s_add_u32 s50, s44, 0xd8000
buffer_load_dwordx4 v2, s[8:11], s50 offen lds
s_add_u32 m0, s43, 0x7000
s_add_u32 s51, s44, 0xd8000
buffer_load_dwordx4 v2, s[12:15], s51 offen lds
s_add_u32 m0, s43, 0x8000
s_add_u32 s50, s44, 0x120000
buffer_load_dwordx4 v2, s[8:11], s50 offen lds
s_add_u32 m0, s43, 0x9000
s_add_u32 s51, s44, 0x120000
buffer_load_dwordx4 v2, s[12:15], s51 offen lds
s_add_u32 m0, s43, 0xa000
s_add_u32 s50, s44, 0x168000
buffer_load_dwordx4 v2, s[8:11], s50 offen lds
s_add_u32 m0, s43, 0xb000
s_add_u32 s51, s44, 0x168000
buffer_load_dwordx4 v2, s[12:15], s51 offen lds
s_add_u32 m0, s43, 0xc000
s_add_u32 s50, s44, 0x80
buffer_load_dwordx4 v2, s[8:11], s50 offen lds
s_add_u32 m0, s43, 0xd000
s_add_u32 s51, s44, 0x80
buffer_load_dwordx4 v2, s[12:15], s51 offen lds
s_add_u32 m0, s43, 0xe000
s_add_u32 s50, s44, 0x48080
buffer_load_dwordx4 v2, s[8:11], s50 offen lds
s_add_u32 m0, s43, 0xf000
s_add_u32 s51, s44, 0x48080
buffer_load_dwordx4 v2, s[12:15], s51 offen lds
s_add_u32 m0, s43, 0x10000
s_add_u32 s50, s44, 0x90080
buffer_load_dwordx4 v2, s[8:11], s50 offen lds
s_add_u32 m0, s43, 0x11000
s_add_u32 s51, s44, 0x90080
buffer_load_dwordx4 v2, s[12:15], s51 offen lds
s_cmp_lg_u32 s40, 0
s_cbranch_scc1 L_A_hs_done
s_mov_b32 s83, 0x40000
s_waitcnt lgkmcnt(0)
s_or_b32 s98, s99, 15
s_add_u32 s99, s99, 1
L_A_hs_spin:
s_cmp_gt_u32 s99, s98
s_cbranch_scc1 L_A_hs_done
s_sub_u32 s83, s83, 1
s_cbranch_scc1 L_A_hs_done
s_sleep 8
s_add_u32 s99, s99, 4
s_cmp_gt_u32 s99, s98
s_cbranch_scc1 L_A_hs_near
s_sleep 0
L_A_hs_near:
s_mov_b32 s99, 0
s_atomic_add s99, s[96:97], 0x0 glc
s_waitcnt lgkmcnt(0)
s_branch L_A_hs_spin
L_A_hs_done:
s_barrier
s_add_u32 m0, s43, 0x12000
s_add_u32 s50, s46, 0x0
buffer_load_dwordx4 v1, s[20:23], s50 offen sc1 lds
s_add_u32 m0, s43, 0x13000
s_add_u32 s51, s46, 0x1000
buffer_load_dwordx4 v1, s[20:23], s51 offen sc1 lds
s_add_u32 m0, s43, 0x14000
s_add_u32 s50, s46, 0x2000
buffer_load_dwordx4 v1, s[20:23], s50 offen sc1 lds
s_add_u32 m0, s43, 0x15000
s_add_u32 s51, s46, 0x3000
buffer_load_dwordx4 v1, s[20:23], s51 offen sc1 lds
s_add_u32 m0, s43, 0x16000
s_add_u32 s50, s46, 0x4000
buffer_load_dwordx4 v1, s[20:23], s50 offen sc1 lds
s_add_u32 m0, s43, 0x17000
s_add_u32 s51, s46, 0x5000
buffer_load_dwordx4 v1, s[20:23], s51 offen sc1 lds
s_add_u32 m0, s43, 0x18000
s_add_u32 s50, s46, 0x6000
buffer_load_dwordx4 v1, s[20:23], s50 offen sc1 lds
s_add_u32 m0, s43, 0x19000
s_add_u32 s51, s46, 0x7000
buffer_load_dwordx4 v1, s[20:23], s51 offen sc1 lds
s_add_u32 m0, s43, 0x1a000
s_add_u32 s50, s46, 0x8000
buffer_load_dwordx4 v1, s[20:23], s50 offen sc1 lds
s_add_u32 m0, s43, 0x1b000
s_add_u32 s51, s46, 0x9000
buffer_load_dwordx4 v1, s[20:23], s51 offen sc1 lds
s_add_u32 m0, s43, 0x1c000
s_add_u32 s50, s46, 0xa000
buffer_load_dwordx4 v1, s[20:23], s50 offen sc1 lds
s_add_u32 m0, s43, 0x1d000
s_add_u32 s51, s46, 0xb000
buffer_load_dwordx4 v1, s[20:23], s51 offen sc1 lds
s_waitcnt vmcnt(6)
s_barrier
TR 64,5,0
TR 66,5,512
ds_read_b128 a[0:3], v12 offset:0
ds_read_b128 a[4:7], v12 offset:1024
ds_read_b128 a[8:11], v12 offset:2048
ds_read_b128 a[12:15], v12 offset:3072
TR 68,5,8192
TR 70,5,8704
ds_read_b128 a[16:19], v12 offset:8192
ds_read_b128 a[20:23], v12 offset:9216
ds_read_b128 a[24:27], v12 offset:10240
ds_read_b128 a[28:31], v12 offset:11264
TR 72,5,16384
TR 74,5,16896
ds_read_b128 a[32:35], v12 offset:16384
ds_read_b128 a[36:39], v12 offset:17408
ds_read_b128 a[40:43], v12 offset:18432
ds_read_b128 a[44:47], v12 offset:19456
s_waitcnt lgkmcnt(15)
v_mfma_f32_16x16x32_bf16 v[96:99], v[64:67], a[0:3], 0
TR 76,6,0
s_waitcnt lgkmcnt(15)
v_mfma_f32_16x16x32_bf16 v[100:103], v[64:67], a[4:7], 0
TR 78,6,512
s_waitcnt lgkmcnt(15)
v_mfma_f32_16x16x32_bf16 v[104:107], v[64:67], a[8:11], 0
TR 80,6,8192
s_waitcnt lgkmcnt(15)
v_mfma_f32_16x16x32_bf16 v[108:111], v[64:67], a[12:15], 0
TR 82,6,8704
s_waitcnt lgkmcnt(13)
MA 96,68,16
TR 84,6,16384
s_waitcnt lgkmcnt(13)
MA 100,68,20
TR 86,6,16896
s_waitcnt lgkmcnt(13)
MA 104,68,24
s_waitcnt lgkmcnt(12)
MA 108,68,28
s_waitcnt lgkmcnt(9)
MA 96,72,32
s_waitcnt lgkmcnt(8)
MA 100,72,36
s_waitcnt lgkmcnt(7)
MA 104,72,40
s_waitcnt lgkmcnt(6)
MA 108,72,44
s_waitcnt lgkmcnt(4)
v_mfma_f32_16x16x32_bf16 v[112:115], v[76:79], a[0:3], 0
TR 64,5,4096
s_waitcnt lgkmcnt(3)
MA 112,80,16
TR 66,5,4608
s_waitcnt lgkmcnt(2)
MA 112,84,32
TR 68,5,12288
v_mfma_f32_16x16x32_bf16 v[116:119], v[76:79], a[4:7], 0
TR 70,5,12800
MA 116,80,20
TR 72,5,20480
MA 116,84,36
TR 74,5,20992
v_mfma_f32_16x16x32_bf16 v[120:123], v[76:79], a[8:11], 0
MA 120,80,24
MA 120,84,40
v_mfma_f32_16x16x32_bf16 v[124:127], v[76:79], a[12:15], 0
MA 124,80,28
MA 124,84,44
s_waitcnt lgkmcnt(4)
v_mfma_f32_16x16x32_bf16 v[128:131], v[64:67], a[0:3], 0
TR 76,6,4096
s_waitcnt lgkmcnt(3)
MA 128,68,16
TR 78,6,4608
s_waitcnt lgkmcnt(2)
MA 128,72,32
TR 80,6,12288
v_mfma_f32_16x16x32_bf16 v[132:135], v[64:67], a[4:7], 0
TR 82,6,12800
MA 132,68,20
TR 84,6,20480
MA 132,72,36
TR 86,6,20992
v_mfma_f32_16x16x32_bf16 v[136:139], v[64:67], a[8:11], 0
MA 136,68,24
MA 136,72,40
v_mfma_f32_16x16x32_bf16 v[140:143], v[64:67], a[12:15], 0
MA 140,68,28
MA 140,72,44
s_waitcnt lgkmcnt(4)
v_mfma_f32_16x16x32_bf16 v[144:147], v[76:79], a[0:3], 0
s_waitcnt vmcnt(0)
s_waitcnt lgkmcnt(0)
s_barrier
s_add_u32 m0, s43, 0x1e000
s_add_u32 s50, s46, 0xc000
MA 144,80,16
TR 64,5,24576
TR 66,5,25088
MA 144,84,32
ds_read_b128 a[48:51], v12 offset:24576
ds_read_b128 a[52:55], v12 offset:25600
v_mfma_f32_16x16x32_bf16 v[148:151], v[76:79], a[4:7], 0
ds_read_b128 a[56:59], v12 offset:26624
ds_read_b128 a[60:63], v12 offset:27648
MA 148,80,20
TR 68,5,32768
TR 70,5,33280
MA 148,84,36
ds_read_b128 a[64:67], v12 offset:32768
ds_read_b128 a[68:71], v12 offset:33792
v_mfma_f32_16x16x32_bf16 v[152:155], v[76:79], a[8:11], 0
ds_read_b128 a[72:75], v12 offset:34816
ds_read_b128 a[76:79], v12 offset:35840
MA 152,80,24
TR 72,5,40960
TR 74,5,41472
MA 152,84,40
ds_read_b128 a[80:83], v12 offset:40960
ds_read_b128 a[84:87], v12 offset:41984
v_mfma_f32_16x16x32_bf16 v[156:159], v[76:79], a[12:15], 0
ds_read_b128 a[88:91], v12 offset:43008
ds_read_b128 a[92:95], v12 offset:44032
MA 156,80,28
buffer_load_dwordx4 v1, s[20:23], s50 offen sc1 lds
MA 156,84,44
s_add_u32 m0, s43, 0x1f000
s_add_u32 s51, s46, 0xd000
s_waitcnt lgkmcnt(15)
MA 96,64,48
TR 76,6,24576
s_waitcnt lgkmcnt(15)
MA 100,64,52
TR 78,6,25088
s_waitcnt lgkmcnt(15)
MA 104,64,56
TR 80,6,32768
s_waitcnt lgkmcnt(15)
MA 108,64,60
TR 82,6,33280
s_waitcnt lgkmcnt(13)
MA 96,68,64
TR 84,6,40960
s_waitcnt lgkmcnt(13)
MA 100,68,68
TR 86,6,41472
s_waitcnt lgkmcnt(13)
MA 104,68,72
buffer_load_dwordx4 v1, s[20:23], s51 offen sc1 lds
s_waitcnt lgkmcnt(12)
MA 108,68,76
s_add_u32 m0, s43, 0x0
s_add_u32 s50, s44, 0x1b0000
s_waitcnt lgkmcnt(9)
MA 96,72,80
buffer_load_dwordx4 v2, s[8:11], s50 offen lds
s_waitcnt lgkmcnt(8)
MA 100,72,84
s_add_u32 m0, s43, 0x1000
s_add_u32 s51, s44, 0x1b0000
s_waitcnt lgkmcnt(7)
MA 104,72,88
buffer_load_dwordx4 v2, s[12:15], s51 offen lds
s_waitcnt lgkmcnt(6)
MA 108,72,92
s_add_u32 m0, s43, 0x20000
s_add_u32 s50, s46, 0xe000
s_waitcnt lgkmcnt(4)
MA 112,76,48
TR 64,5,28672
s_waitcnt lgkmcnt(3)
MA 112,80,64
TR 66,5,29184
s_waitcnt lgkmcnt(2)
MA 112,84,80
TR 68,5,36864
MA 116,76,52
TR 70,5,37376
MA 116,80,68
TR 72,5,45056
MA 116,84,84
TR 74,5,45568
MA 120,76,56
buffer_load_dwordx4 v1, s[20:23], s50 offen sc1 lds
MA 120,80,72
s_add_u32 m0, s43, 0x21000
s_add_u32 s51, s46, 0xf000
MA 120,84,88
buffer_load_dwordx4 v1, s[20:23], s51 offen sc1 lds
MA 124,76,60
s_add_u32 m0, s43, 0x2000
s_add_u32 s50, s44, 0x1f8000
MA 124,80,76
buffer_load_dwordx4 v2, s[8:11], s50 offen lds
MA 124,84,92
s_add_u32 m0, s43, 0x3000
s_add_u32 s51, s44, 0x1f8000
s_waitcnt lgkmcnt(4)
MA 128,64,48
TR 76,6,28672
s_waitcnt lgkmcnt(3)
MA 128,68,64
TR 78,6,29184
s_waitcnt lgkmcnt(2)
MA 128,72,80
TR 80,6,36864
MA 132,64,52
TR 82,6,37376
MA 132,68,68
TR 84,6,45056
MA 132,72,84
TR 86,6,45568
MA 136,64,56
buffer_load_dwordx4 v2, s[12:15], s51 offen lds
MA 136,68,72
s_add_u32 m0, s43, 0x22000
s_add_u32 s50, s46, 0x10000
MA 136,72,88
buffer_load_dwordx4 v1, s[20:23], s50 offen sc1 lds
MA 140,64,60
s_add_u32 m0, s43, 0x23000
s_add_u32 s51, s46, 0x11000
MA 140,68,76
buffer_load_dwordx4 v1, s[20:23], s51 offen sc1 lds
MA 140,72,92
s_add_u32 m0, s43, 0x4000
s_add_u32 s50, s44, 0x240000
s_waitcnt lgkmcnt(4)
MA 144,76,48
s_waitcnt lgkmcnt(0)
s_barrier
MA 144,80,64
TR 64,5,49152
MA 144,84,80
TR 66,5,49664
MA 148,76,52
TR 68,5,57344
MA 148,80,68
TR 70,5,57856
MA 148,84,84
TR 72,7,0
MA 152,76,56
TR 74,7,512
MA 152,80,72
buffer_load_dwordx4 v2, s[8:11], s50 offen lds
MA 152,84,88
s_add_u32 m0, s43, 0x5000
s_add_u32 s51, s44, 0x240000
MA 156,76,60
buffer_load_dwordx4 v2, s[12:15], s51 offen lds
MA 156,80,76
s_add_u32 m0, s43, 0x6000
s_add_u32 s50, s44, 0xd8080
MA 156,84,92
buffer_load_dwordx4 v2, s[8:11], s50 offen lds
s_waitcnt lgkmcnt(0)
v_mfma_f32_16x16x32_bf16 v[160:163], v[64:67], a[0:3], 0
s_add_u32 m0, s43, 0x7000
s_add_u32 s51, s44, 0xd8080
TR 76,6,49152
MA 160,68,16
TR 78,6,49664
MA 160,72,32
TR 80,6,57344
v_mfma_f32_16x16x32_bf16 v[164:167], v[64:67], a[4:7], 0
TR 82,6,57856
MA 164,68,20
TR 84,8,0
MA 164,72,36
TR 86,8,512
v_mfma_f32_16x16x32_bf16 v[168:171], v[64:67], a[8:11], 0
buffer_load_dwordx4 v2, s[12:15], s51 offen lds
MA 168,68,24
s_add_u32 m0, s43, 0x8000
s_add_u32 s50, s44, 0x120080
MA 168,72,40
buffer_load_dwordx4 v2, s[8:11], s50 offen lds
v_mfma_f32_16x16x32_bf16 v[172:175], v[64:67], a[12:15], 0
s_add_u32 m0, s43, 0x9000
s_add_u32 s51, s44, 0x120080
MA 172,68,28
buffer_load_dwordx4 v2, s[12:15], s51 offen lds
MA 172,72,44
s_add_u32 m0, s43, 0xa000
s_add_u32 s50, s44, 0x168080
s_waitcnt lgkmcnt(0)
v_mfma_f32_16x16x32_bf16 v[176:179], v[76:79], a[0:3], 0
TR 64,5,53248
MA 176,80,16
TR 66,5,53760
MA 176,84,32
TR 68,5,61440
v_mfma_f32_16x16x32_bf16 v[180:183], v[76:79], a[4:7], 0
TR 70,5,61952
MA 180,80,20
TR 72,7,4096
MA 180,84,36
TR 74,7,4608
v_mfma_f32_16x16x32_bf16 v[184:187], v[76:79], a[8:11], 0
buffer_load_dwordx4 v2, s[8:11], s50 offen lds
MA 184,80,24
s_add_u32 m0, s43, 0xb000
s_add_u32 s51, s44, 0x168080
MA 184,84,40
buffer_load_dwordx4 v2, s[12:15], s51 offen lds
v_mfma_f32_16x16x32_bf16 v[188:191], v[76:79], a[12:15], 0
MA 188,80,28
MA 188,84,44
s_waitcnt lgkmcnt(0)
v_mfma_f32_16x16x32_bf16 v[192:195], v[64:67], a[0:3], 0
TR 76,6,53248
MA 192,68,16
TR 78,6,53760
MA 192,72,32
TR 80,6,61440
v_mfma_f32_16x16x32_bf16 v[196:199], v[64:67], a[4:7], 0
TR 82,6,61952
MA 196,68,20
TR 84,8,4096
MA 196,72,36
TR 86,8,4608
v_mfma_f32_16x16x32_bf16 v[200:203], v[64:67], a[8:11], 0
MA 200,68,24
MA 200,72,40
v_mfma_f32_16x16x32_bf16 v[204:207], v[64:67], a[12:15], 0
MA 204,68,28
MA 204,72,44
s_waitcnt lgkmcnt(0)
v_mfma_f32_16x16x32_bf16 v[208:211], v[76:79], a[0:3], 0
s_waitcnt vmcnt(6)
s_barrier
s_add_u32 m0, s43, 0x24000
s_add_u32 s50, s46, 0x12000
MA 208,80,16
TR 64,5,0
TR 66,5,512
MA 208,84,32
ds_read_b128 a[96:99], v12 offset:49152
ds_read_b128 a[100:103], v12 offset:50176
v_mfma_f32_16x16x32_bf16 v[212:215], v[76:79], a[4:7], 0
ds_read_b128 a[104:107], v12 offset:51200
ds_read_b128 a[108:111], v12 offset:52224
MA 212,80,20
TR 68,5,8192
TR 70,5,8704
MA 212,84,36
ds_read_b128 a[112:115], v12 offset:57344
ds_read_b128 a[116:119], v12 offset:58368
v_mfma_f32_16x16x32_bf16 v[216:219], v[76:79], a[8:11], 0
ds_read_b128 a[120:123], v12 offset:59392
ds_read_b128 a[124:127], v12 offset:60416
MA 216,80,24
TR 72,5,16384
TR 74,5,16896
MA 216,84,40
ds_read_b128 a[128:131], v13 offset:0
ds_read_b128 a[132:135], v13 offset:1024
v_mfma_f32_16x16x32_bf16 v[220:223], v[76:79], a[12:15], 0
ds_read_b128 a[136:139], v13 offset:2048
ds_read_b128 a[140:143], v13 offset:3072
MA 220,80,28
buffer_load_dwordx4 v1, s[20:23], s50 offen sc1 lds
MA 220,84,44
s_add_u32 m0, s43, 0x25000
s_add_u32 s51, s46, 0x13000
s_waitcnt lgkmcnt(15)
MA 96,64,96
TR 76,6,0
s_waitcnt lgkmcnt(15)
MA 100,64,100
TR 78,6,512
s_waitcnt lgkmcnt(15)
MA 104,64,104
TR 80,6,8192
s_waitcnt lgkmcnt(15)
MA 108,64,108
TR 82,6,8704
s_waitcnt lgkmcnt(13)
MA 96,68,112
TR 84,6,16384
s_waitcnt lgkmcnt(13)
MA 100,68,116
TR 86,6,16896
s_waitcnt lgkmcnt(13)
MA 104,68,120
buffer_load_dwordx4 v1, s[20:23], s51 offen sc1 lds
s_waitcnt lgkmcnt(12)
MA 108,68,124
s_add_u32 m0, s43, 0xc000
s_add_u32 s50, s44, 0x288000
s_waitcnt lgkmcnt(9)
MA 96,72,128
buffer_load_dwordx4 v2, s[8:11], s50 offen lds
s_waitcnt lgkmcnt(8)
MA 100,72,132
s_add_u32 m0, s43, 0xd000
s_add_u32 s51, s44, 0x288000
s_waitcnt lgkmcnt(7)
MA 104,72,136
buffer_load_dwordx4 v2, s[12:15], s51 offen lds
s_waitcnt lgkmcnt(6)
MA 108,72,140
s_add_u32 m0, s43, 0x12000
s_add_u32 s50, s46, 0x14000
s_waitcnt lgkmcnt(4)
MA 112,76,96
TR 64,5,4096
s_waitcnt lgkmcnt(3)
MA 112,80,112
TR 66,5,4608
s_waitcnt lgkmcnt(2)
MA 112,84,128
TR 68,5,12288
MA 116,76,100
TR 70,5,12800
MA 116,80,116
TR 72,5,20480
MA 116,84,132
TR 74,5,20992
MA 120,76,104
buffer_load_dwordx4 v1, s[20:23], s50 offen sc1 lds
MA 120,80,120
s_add_u32 m0, s43, 0x13000
s_add_u32 s51, s46, 0x15000
MA 120,84,136
buffer_load_dwordx4 v1, s[20:23], s51 offen sc1 lds
MA 124,76,108
s_add_u32 m0, s43, 0xe000
s_add_u32 s50, s44, 0x2d0000
MA 124,80,124
buffer_load_dwordx4 v2, s[8:11], s50 offen lds
MA 124,84,140
s_add_u32 m0, s43, 0xf000
s_add_u32 s51, s44, 0x2d0000
s_waitcnt lgkmcnt(4)
MA 128,64,96
TR 76,6,4096
s_waitcnt lgkmcnt(3)
MA 128,68,112
TR 78,6,4608
s_waitcnt lgkmcnt(2)
MA 128,72,128
TR 80,6,12288
MA 132,64,100
TR 82,6,12800
MA 132,68,116
TR 84,6,20480
MA 132,72,132
TR 86,6,20992
MA 136,64,104
buffer_load_dwordx4 v2, s[12:15], s51 offen lds
MA 136,68,120
s_add_u32 m0, s43, 0x14000
s_add_u32 s50, s46, 0x16000
MA 136,72,136
buffer_load_dwordx4 v1, s[20:23], s50 offen sc1 lds
MA 140,64,108
s_add_u32 m0, s43, 0x15000
s_add_u32 s51, s46, 0x17000
MA 140,68,124
buffer_load_dwordx4 v1, s[20:23], s51 offen sc1 lds
MA 140,72,140
s_add_u32 m0, s43, 0x10000
s_add_u32 s50, s44, 0x318000
s_waitcnt lgkmcnt(4)
MA 144,76,96
s_waitcnt vmcnt(10)
s_waitcnt lgkmcnt(0)
s_barrier
MA 144,80,112
TR 64,5,24576
MA 144,84,128
TR 66,5,25088
MA 148,76,100
TR 68,5,32768
MA 148,80,116
TR 70,5,33280
MA 148,84,132
TR 72,5,40960
MA 152,76,104
TR 74,5,41472
MA 152,80,120
buffer_load_dwordx4 v2, s[8:11], s50 offen lds
MA 152,84,136
s_add_u32 m0, s43, 0x11000
s_add_u32 s51, s44, 0x318000
MA 156,76,108
buffer_load_dwordx4 v2, s[12:15], s51 offen lds
MA 156,80,124
s_add_u32 m0, s43, 0x0
s_add_u32 s50, s44, 0x1b0080
MA 156,84,140
buffer_load_dwordx4 v2, s[8:11], s50 offen lds
s_waitcnt lgkmcnt(0)
MA 160,64,48
s_add_u32 m0, s43, 0x1000
s_add_u32 s51, s44, 0x1b0080
TR 76,6,24576
MA 160,68,64
TR 78,6,25088
MA 160,72,80
TR 80,6,32768
MA 164,64,52
TR 82,6,33280
MA 164,68,68
TR 84,6,40960
MA 164,72,84
TR 86,6,41472
MA 168,64,56
buffer_load_dwordx4 v2, s[12:15], s51 offen lds
MA 168,68,72
s_add_u32 m0, s43, 0x2000
s_add_u32 s50, s44, 0x1f8080
MA 168,72,88
buffer_load_dwordx4 v2, s[8:11], s50 offen lds
MA 172,64,60
s_add_u32 m0, s43, 0x3000
s_add_u32 s51, s44, 0x1f8080
MA 172,68,76
buffer_load_dwordx4 v2, s[12:15], s51 offen lds
MA 172,72,92
s_add_u32 m0, s43, 0x4000
s_add_u32 s50, s44, 0x240080
s_waitcnt lgkmcnt(0)
MA 176,76,48
TR 64,5,28672
MA 176,80,64
TR 66,5,29184
MA 176,84,80
TR 68,5,36864
MA 180,76,52
TR 70,5,37376
MA 180,80,68
TR 72,5,45056
MA 180,84,84
TR 74,5,45568
MA 184,76,56
buffer_load_dwordx4 v2, s[8:11], s50 offen lds
MA 184,80,72
s_add_u32 m0, s43, 0x5000
s_add_u32 s51, s44, 0x240080
MA 184,84,88
buffer_load_dwordx4 v2, s[12:15], s51 offen lds
MA 188,76,60
MA 188,80,76
MA 188,84,92
s_waitcnt lgkmcnt(0)
MA 192,64,48
TR 76,6,28672
MA 192,68,64
TR 78,6,29184
MA 192,72,80
TR 80,6,36864
MA 196,64,52
TR 82,6,37376
MA 196,68,68
TR 84,6,45056
MA 196,72,84
TR 86,6,45568
MA 200,64,56
MA 200,68,72
MA 200,72,88
MA 204,64,60
MA 204,68,76
MA 204,72,92
s_waitcnt lgkmcnt(0)
MA 208,76,48
s_waitcnt vmcnt(6)
s_barrier
s_add_u32 m0, s43, 0x16000
s_add_u32 s50, s46, 0x18000
MA 208,80,64
TR 64,5,49152
TR 66,5,49664
MA 208,84,80
ds_read_b128 a[144:147], v13 offset:8192
ds_read_b128 a[148:151], v13 offset:9216
MA 212,76,52
ds_read_b128 a[152:155], v13 offset:10240
ds_read_b128 a[156:159], v13 offset:11264
MA 212,80,68
TR 68,5,57344
TR 70,5,57856
MA 212,84,84
ds_read_b128 a[160:163], v12 offset:0
ds_read_b128 a[164:167], v12 offset:1024
MA 216,76,56
ds_read_b128 a[168:171], v12 offset:2048
ds_read_b128 a[172:175], v12 offset:3072
MA 216,80,72
TR 72,7,0
TR 74,7,512
MA 216,84,88
ds_read_b128 a[176:179], v12 offset:8192
ds_read_b128 a[180:183], v12 offset:9216
MA 220,76,60
ds_read_b128 a[184:187], v12 offset:10240
ds_read_b128 a[188:191], v12 offset:11264
MA 220,80,76
buffer_load_dwordx4 v1, s[20:23], s50 offen sc1 lds
MA 220,84,92
s_add_u32 m0, s43, 0x17000
s_add_u32 s51, s46, 0x19000
s_waitcnt lgkmcnt(15)
MA 96,64,144
TR 76,6,49152
s_waitcnt lgkmcnt(15)
MA 100,64,148
TR 78,6,49664
s_waitcnt lgkmcnt(15)
MA 104,64,152
TR 80,6,57344
s_waitcnt lgkmcnt(15)
MA 108,64,156
TR 82,6,57856
s_waitcnt lgkmcnt(13)
MA 96,68,160
TR 84,8,0
s_waitcnt lgkmcnt(13)
MA 100,68,164
TR 86,8,512
s_waitcnt lgkmcnt(13)
MA 104,68,168
buffer_load_dwordx4 v1, s[20:23], s51 offen sc1 lds
s_waitcnt lgkmcnt(12)
MA 108,68,172
s_add_u32 m0, s43, 0x6000
s_add_u32 s50, s44, 0x360000
s_waitcnt lgkmcnt(9)
MA 96,72,176
buffer_load_dwordx4 v2, s[8:11], s50 offen lds
s_waitcnt lgkmcnt(8)
MA 100,72,180
s_add_u32 m0, s43, 0x7000
s_add_u32 s51, s44, 0x360000
s_waitcnt lgkmcnt(7)
MA 104,72,184
buffer_load_dwordx4 v2, s[12:15], s51 offen lds
s_waitcnt lgkmcnt(6)
MA 108,72,188
s_add_u32 m0, s43, 0x18000
s_add_u32 s50, s46, 0x1a000
s_waitcnt lgkmcnt(4)
MA 112,76,144
TR 64,5,53248
s_waitcnt lgkmcnt(3)
MA 112,80,160
TR 66,5,53760
s_waitcnt lgkmcnt(2)
MA 112,84,176
TR 68,5,61440
MA 116,76,148
TR 70,5,61952
MA 116,80,164
TR 72,7,4096
MA 116,84,180
TR 74,7,4608
MA 120,76,152
buffer_load_dwordx4 v1, s[20:23], s50 offen sc1 lds
MA 120,80,168
s_add_u32 m0, s43, 0x19000
s_add_u32 s51, s46, 0x1b000
MA 120,84,184
buffer_load_dwordx4 v1, s[20:23], s51 offen sc1 lds
MA 124,76,156
s_add_u32 m0, s43, 0x8000
s_add_u32 s50, s44, 0x3a8000
MA 124,80,172
buffer_load_dwordx4 v2, s[8:11], s50 offen lds
MA 124,84,188
s_add_u32 m0, s43, 0x9000
s_add_u32 s51, s44, 0x3a8000
s_waitcnt lgkmcnt(4)
MA 128,64,144
TR 76,6,53248
s_waitcnt lgkmcnt(3)
MA 128,68,160
TR 78,6,53760
s_waitcnt lgkmcnt(2)
MA 128,72,176
TR 80,6,61440
MA 132,64,148
TR 82,6,61952
MA 132,68,164
TR 84,8,4096
MA 132,72,180
TR 86,8,4608
MA 136,64,152
buffer_load_dwordx4 v2, s[12:15], s51 offen lds
MA 136,68,168
s_add_u32 m0, s43, 0x1a000
s_add_u32 s50, s46, 0x1c000
MA 136,72,184
buffer_load_dwordx4 v1, s[20:23], s50 offen sc1 lds
MA 140,64,156
s_add_u32 m0, s43, 0x1b000
s_add_u32 s51, s46, 0x1d000
MA 140,68,172
buffer_load_dwordx4 v1, s[20:23], s51 offen sc1 lds
MA 140,72,188
s_add_u32 m0, s43, 0xa000
s_add_u32 s50, s44, 0x3f0000
s_waitcnt lgkmcnt(4)
MA 144,76,144
s_waitcnt vmcnt(10)
s_waitcnt lgkmcnt(0)
s_barrier
MA 144,80,160
TR 64,5,0
MA 144,84,176
TR 66,5,512
MA 148,76,148
TR 68,5,8192
MA 148,80,164
TR 70,5,8704
MA 148,84,180
TR 72,5,16384
MA 152,76,152
TR 74,5,16896
MA 152,80,168
buffer_load_dwordx4 v2, s[8:11], s50 offen lds
MA 152,84,184
s_add_u32 m0, s43, 0xb000
s_add_u32 s51, s44, 0x3f0000
MA 156,76,156
buffer_load_dwordx4 v2, s[12:15], s51 offen lds
MA 156,80,172
s_add_u32 m0, s43, 0x1c000
s_add_u32 s50, s46, 0x1e000
MA 156,84,188
buffer_load_dwordx4 v1, s[20:23], s50 offen sc1 lds
s_waitcnt lgkmcnt(0)
MA 160,64,96
s_add_u32 m0, s43, 0x1d000
s_add_u32 s51, s46, 0x1f000
TR 76,6,0
MA 160,68,112
TR 78,6,512
MA 160,72,128
TR 80,6,8192
MA 164,64,100
TR 82,6,8704
MA 164,68,116
TR 84,6,16384
MA 164,72,132
TR 86,6,16896
MA 168,64,104
buffer_load_dwordx4 v1, s[20:23], s51 offen sc1 lds
MA 168,68,120
s_add_u32 m0, s43, 0xc000
s_add_u32 s50, s44, 0x438000
MA 168,72,136
buffer_load_dwordx4 v2, s[8:11], s50 offen lds
MA 172,64,108
s_add_u32 m0, s43, 0xd000
s_add_u32 s51, s44, 0x438000
MA 172,68,124
buffer_load_dwordx4 v2, s[12:15], s51 offen lds
MA 172,72,140
s_add_u32 m0, s43, 0x1e000
s_add_u32 s50, s46, 0x20000
s_waitcnt lgkmcnt(0)
MA 176,76,96
TR 64,5,4096
MA 176,80,112
TR 66,5,4608
MA 176,84,128
TR 68,5,12288
MA 180,76,100
TR 70,5,12800
MA 180,80,116
TR 72,5,20480
MA 180,84,132
TR 74,5,20992
MA 184,76,104
buffer_load_dwordx4 v1, s[20:23], s50 offen sc1 lds
MA 184,80,120
s_add_u32 m0, s43, 0x1f000
s_add_u32 s51, s46, 0x21000
MA 184,84,136
buffer_load_dwordx4 v1, s[20:23], s51 offen sc1 lds
MA 188,76,108
s_add_u32 m0, s43, 0xe000
s_add_u32 s50, s44, 0x480000
MA 188,80,124
buffer_load_dwordx4 v2, s[8:11], s50 offen lds
MA 188,84,140
s_add_u32 m0, s43, 0xf000
s_add_u32 s51, s44, 0x480000
s_waitcnt lgkmcnt(0)
MA 192,64,96
TR 76,6,4096
MA 192,68,112
TR 78,6,4608
MA 192,72,128
TR 80,6,12288
MA 196,64,100
TR 82,6,12800
MA 196,68,116
TR 84,6,20480
MA 196,72,132
TR 86,6,20992
MA 200,64,104
buffer_load_dwordx4 v2, s[12:15], s51 offen lds
MA 200,68,120
s_add_u32 m0, s43, 0x20000
s_add_u32 s50, s46, 0x22000
MA 200,72,136
buffer_load_dwordx4 v1, s[20:23], s50 offen sc1 lds
MA 204,64,108
s_add_u32 m0, s43, 0x21000
s_add_u32 s51, s46, 0x23000
MA 204,68,124
buffer_load_dwordx4 v1, s[20:23], s51 offen sc1 lds
MA 204,72,140
s_add_u32 m0, s43, 0x10000
s_add_u32 s50, s44, 0x4c8000
s_waitcnt lgkmcnt(0)
MA 208,76,96
s_waitcnt vmcnt(10)
s_barrier
MA 208,80,112
TR 64,5,24576
TR 66,5,25088
MA 208,84,128
ds_read_b128 a[192:195], v12 offset:16384
ds_read_b128 a[196:199], v12 offset:17408
MA 212,76,100
ds_read_b128 a[200:203], v12 offset:18432
ds_read_b128 a[204:207], v12 offset:19456
MA 212,80,116
TR 68,5,32768
TR 70,5,33280
MA 212,84,132
ds_read_b128 a[208:211], v12 offset:24576
ds_read_b128 a[212:215], v12 offset:25600
MA 216,76,104
ds_read_b128 a[216:219], v12 offset:26624
ds_read_b128 a[220:223], v12 offset:27648
MA 216,80,120
TR 72,5,40960
TR 74,5,41472
MA 216,84,136
ds_read_b128 a[224:227], v12 offset:32768
ds_read_b128 a[228:231], v12 offset:33792
MA 220,76,108
ds_read_b128 a[232:235], v12 offset:34816
ds_read_b128 a[236:239], v12 offset:35840
MA 220,80,124
buffer_load_dwordx4 v2, s[8:11], s50 offen lds
MA 220,84,140
s_add_u32 m0, s43, 0x11000
s_add_u32 s51, s44, 0x4c8000
s_waitcnt lgkmcnt(15)
MA 96,64,192
TR 76,6,24576
s_waitcnt lgkmcnt(15)
MA 100,64,196
TR 78,6,25088
s_waitcnt lgkmcnt(15)
MA 104,64,200
TR 80,6,32768
s_waitcnt lgkmcnt(15)
MA 108,64,204
TR 82,6,33280
s_waitcnt lgkmcnt(13)
MA 96,68,208
TR 84,6,40960
s_waitcnt lgkmcnt(13)
MA 100,68,212
TR 86,6,41472
s_waitcnt lgkmcnt(13)
MA 104,68,216
buffer_load_dwordx4 v2, s[12:15], s51 offen lds
s_waitcnt lgkmcnt(12)
MA 108,68,220
s_add_u32 m0, s43, 0x0
s_add_u32 s50, s44, 0x288080
s_waitcnt lgkmcnt(9)
MA 96,72,224
buffer_load_dwordx4 v2, s[8:11], s50 offen lds
s_waitcnt lgkmcnt(8)
MA 100,72,228
s_add_u32 m0, s43, 0x1000
s_add_u32 s51, s44, 0x288080
s_waitcnt lgkmcnt(7)
MA 104,72,232
buffer_load_dwordx4 v2, s[12:15], s51 offen lds
s_waitcnt lgkmcnt(6)
MA 108,72,236
s_add_u32 m0, s43, 0x2000
s_add_u32 s50, s44, 0x2d0080
s_waitcnt lgkmcnt(4)
MA 112,76,192
TR 64,5,28672
s_waitcnt lgkmcnt(3)
MA 112,80,208
TR 66,5,29184
s_waitcnt lgkmcnt(2)
MA 112,84,224
TR 68,5,36864
MA 116,76,196
TR 70,5,37376
MA 116,80,212
TR 72,5,45056
MA 116,84,228
TR 74,5,45568
MA 120,76,200
buffer_load_dwordx4 v2, s[8:11], s50 offen lds
MA 120,80,216
s_add_u32 m0, s43, 0x3000
s_add_u32 s51, s44, 0x2d0080
MA 120,84,232
buffer_load_dwordx4 v2, s[12:15], s51 offen lds
MA 124,76,204
s_add_u32 m0, s43, 0x4000
s_add_u32 s50, s44, 0x318080
MA 124,80,220
buffer_load_dwordx4 v2, s[8:11], s50 offen lds
MA 124,84,236
s_add_u32 m0, s43, 0x5000
s_add_u32 s51, s44, 0x318080
s_waitcnt lgkmcnt(4)
MA 128,64,192
TR 76,6,28672
s_waitcnt lgkmcnt(3)
MA 128,68,208
TR 78,6,29184
s_waitcnt lgkmcnt(2)
MA 128,72,224
TR 80,6,36864
MA 132,64,196
TR 82,6,37376
MA 132,68,212
TR 84,6,45056
MA 132,72,228
TR 86,6,45568
MA 136,64,200
buffer_load_dwordx4 v2, s[12:15], s51 offen lds
MA 136,68,216
MA 136,72,232
MA 140,64,204
MA 140,68,220
MA 140,72,236
s_waitcnt lgkmcnt(4)
MA 144,76,192
s_waitcnt vmcnt(6)
s_waitcnt lgkmcnt(0)
s_barrier
s_add_u32 m0, s43, 0x6000
s_add_u32 s50, s44, 0x360080
MA 144,80,208
TR 64,5,49152
TR 66,5,49664
MA 144,84,224
ds_read_b128 a[240:243], v12 offset:40960
ds_read_b128 a[244:247], v12 offset:41984
MA 148,76,196
ds_read_b128 a[248:251], v12 offset:43008
ds_read_b128 a[252:255], v12 offset:44032
MA 148,80,212
TR 68,5,57344
TR 70,5,57856
MA 148,84,228
ds_read_b128 v[224:227], v12 offset:49152
ds_read_b128 v[228:231], v12 offset:50176
MA 152,76,200
ds_read_b128 v[232:235], v12 offset:51200
ds_read_b128 v[236:239], v12 offset:52224
MA 152,80,216
TR 72,7,0
TR 74,7,512
MA 152,84,232
ds_read_b128 v[240:243], v12 offset:57344
ds_read_b128 v[244:247], v12 offset:58368
MA 156,76,204
ds_read_b128 v[248:251], v12 offset:59392
ds_read_b128 v[252:255], v12 offset:60416
MA 156,80,220
buffer_load_dwordx4 v2, s[8:11], s50 offen lds
MA 156,84,236
s_add_u32 m0, s43, 0x7000
s_add_u32 s51, s44, 0x360080
s_waitcnt lgkmcnt(15)
MA 96,64,240
TR 76,6,49152
s_waitcnt lgkmcnt(15)
MA 100,64,244
TR 78,6,49664
s_waitcnt lgkmcnt(15)
MA 104,64,248
TR 80,6,57344
s_waitcnt lgkmcnt(15)
MA 108,64,252
TR 82,6,57856
s_waitcnt lgkmcnt(13)
v_mfma_f32_16x16x32_bf16 v[96:99], v[68:71], v[224:227], v[96:99]
TR 84,8,0
s_waitcnt lgkmcnt(13)
v_mfma_f32_16x16x32_bf16 v[100:103], v[68:71], v[228:231], v[100:103]
TR 86,8,512
s_waitcnt lgkmcnt(13)
v_mfma_f32_16x16x32_bf16 v[104:107], v[68:71], v[232:235], v[104:107]
buffer_load_dwordx4 v2, s[12:15], s51 offen lds
s_waitcnt lgkmcnt(12)
v_mfma_f32_16x16x32_bf16 v[108:111], v[68:71], v[236:239], v[108:111]
s_add_u32 m0, s43, 0x8000
s_add_u32 s50, s44, 0x3a8080
s_waitcnt lgkmcnt(9)
v_mfma_f32_16x16x32_bf16 v[96:99], v[72:75], v[240:243], v[96:99]
buffer_load_dwordx4 v2, s[8:11], s50 offen lds
s_waitcnt lgkmcnt(8)
v_mfma_f32_16x16x32_bf16 v[100:103], v[72:75], v[244:247], v[100:103]
s_add_u32 m0, s43, 0x9000
s_add_u32 s51, s44, 0x3a8080
s_waitcnt lgkmcnt(7)
v_mfma_f32_16x16x32_bf16 v[104:107], v[72:75], v[248:251], v[104:107]
buffer_load_dwordx4 v2, s[12:15], s51 offen lds
s_waitcnt lgkmcnt(6)
v_mfma_f32_16x16x32_bf16 v[108:111], v[72:75], v[252:255], v[108:111]
s_add_u32 m0, s43, 0xa000
s_add_u32 s50, s44, 0x3f0080
s_waitcnt lgkmcnt(4)
MA 112,76,240
TR 64,5,53248
s_waitcnt lgkmcnt(3)
v_mfma_f32_16x16x32_bf16 v[112:115], v[80:83], v[224:227], v[112:115]
TR 66,5,53760
s_waitcnt lgkmcnt(2)
v_mfma_f32_16x16x32_bf16 v[112:115], v[84:87], v[240:243], v[112:115]
TR 68,5,61440
MA 116,76,244
TR 70,5,61952
v_mfma_f32_16x16x32_bf16 v[116:119], v[80:83], v[228:231], v[116:119]
TR 72,7,4096
v_mfma_f32_16x16x32_bf16 v[116:119], v[84:87], v[244:247], v[116:119]
TR 74,7,4608
MA 120,76,248
buffer_load_dwordx4 v2, s[8:11], s50 offen lds
v_mfma_f32_16x16x32_bf16 v[120:123], v[80:83], v[232:235], v[120:123]
s_add_u32 m0, s43, 0xb000
s_add_u32 s51, s44, 0x3f0080
v_mfma_f32_16x16x32_bf16 v[120:123], v[84:87], v[248:251], v[120:123]
buffer_load_dwordx4 v2, s[12:15], s51 offen lds
MA 124,76,252
v_mfma_f32_16x16x32_bf16 v[124:127], v[80:83], v[236:239], v[124:127]
v_mfma_f32_16x16x32_bf16 v[124:127], v[84:87], v[252:255], v[124:127]
s_waitcnt lgkmcnt(4)
MA 128,64,240
TR 76,6,53248
s_waitcnt lgkmcnt(3)
v_mfma_f32_16x16x32_bf16 v[128:131], v[68:71], v[224:227], v[128:131]
TR 78,6,53760
s_waitcnt lgkmcnt(2)
v_mfma_f32_16x16x32_bf16 v[128:131], v[72:75], v[240:243], v[128:131]
TR 80,6,61440
MA 132,64,244
TR 82,6,61952
v_mfma_f32_16x16x32_bf16 v[132:135], v[68:71], v[228:231], v[132:135]
TR 84,8,4096
v_mfma_f32_16x16x32_bf16 v[132:135], v[72:75], v[244:247], v[132:135]
TR 86,8,4608
MA 136,64,248
v_mfma_f32_16x16x32_bf16 v[136:139], v[68:71], v[232:235], v[136:139]
v_mfma_f32_16x16x32_bf16 v[136:139], v[72:75], v[248:251], v[136:139]
MA 140,64,252
v_mfma_f32_16x16x32_bf16 v[140:143], v[68:71], v[236:239], v[140:143]
v_mfma_f32_16x16x32_bf16 v[140:143], v[72:75], v[252:255], v[140:143]
s_waitcnt lgkmcnt(4)
MA 144,76,240
s_waitcnt vmcnt(6)
s_waitcnt lgkmcnt(0)
s_barrier
s_add_u32 m0, s43, 0xc000
s_add_u32 s50, s44, 0x438080
v_mfma_f32_16x16x32_bf16 v[144:147], v[80:83], v[224:227], v[144:147]
TR 64,5,0
v_mfma_f32_16x16x32_bf16 v[144:147], v[84:87], v[240:243], v[144:147]
TR 66,5,512
MA 148,76,244
TR 68,5,8192
v_mfma_f32_16x16x32_bf16 v[148:151], v[80:83], v[228:231], v[148:151]
TR 70,5,8704
v_mfma_f32_16x16x32_bf16 v[148:151], v[84:87], v[244:247], v[148:151]
TR 72,5,16384
MA 152,76,248
TR 74,5,16896
v_mfma_f32_16x16x32_bf16 v[152:155], v[80:83], v[232:235], v[152:155]
buffer_load_dwordx4 v2, s[8:11], s50 offen lds
v_mfma_f32_16x16x32_bf16 v[152:155], v[84:87], v[248:251], v[152:155]
s_add_u32 m0, s43, 0xd000
s_add_u32 s51, s44, 0x438080
MA 156,76,252
buffer_load_dwordx4 v2, s[12:15], s51 offen lds
v_mfma_f32_16x16x32_bf16 v[156:159], v[80:83], v[236:239], v[156:159]
s_add_u32 m0, s43, 0xe000
s_add_u32 s50, s44, 0x480080
v_mfma_f32_16x16x32_bf16 v[156:159], v[84:87], v[252:255], v[156:159]
buffer_load_dwordx4 v2, s[8:11], s50 offen lds
s_waitcnt lgkmcnt(0)
MA 160,64,144
s_add_u32 m0, s43, 0xf000
TR 76,6,0
MA 160,68,160
s_add_u32 s51, s44, 0x480080
TR 78,6,512
MA 160,72,176
TR 80,6,8192
MA 164,64,148
TR 82,6,8704
MA 164,68,164
TR 84,6,16384
v_mul_f32 v128, v96, v128
MA 164,72,180
TR 86,6,16896
v_mul_f32 v129, v97, v129
MA 168,64,152
buffer_load_dwordx4 v2, s[12:15], s51 offen lds
MA 168,68,168
s_add_u32 m0, s43, 0x10000
v_exp_f32 v96, -v96
MA 168,72,184
s_add_u32 s50, s44, 0x4c8080
v_exp_f32 v97, -v97
MA 172,64,156
v_mul_f32 v130, v98, v130
v_mul_f32 v131, v99, v131
MA 172,68,172
v_exp_f32 v98, -v98
MA 172,72,188
buffer_load_dwordx4 v2, s[8:11], s50 offen lds
s_waitcnt lgkmcnt(0)
MA 176,76,144
s_add_u32 m0, s43, 0x11000
TR 64,5,4096
v_mul_f32 v144, v112, v144
MA 176,80,160
s_add_u32 s51, s44, 0x4c8080
TR 66,5,4608
v_mul_f32 v145, v113, v145
MA 176,84,176
TR 68,5,12288
v_mul_f32 v146, v114, v146
MA 180,76,148
TR 70,5,12800
v_mul_f32 v147, v115, v147
MA 180,80,164
TR 72,5,20480
v_add_f32 v96, 1.0, v96
MA 180,84,180
TR 74,5,20992
v_add_f32 v97, 1.0, v97
MA 184,76,152
buffer_load_dwordx4 v2, s[12:15], s51 offen lds
MA 184,80,168
v_exp_f32 v99, -v99
MA 184,84,184
v_exp_f32 v112, -v112
MA 188,76,156
v_exp_f32 v113, -v113
MA 188,80,172
v_exp_f32 v114, -v114
MA 188,84,188
v_add_f32 v98, 1.0, v98
s_waitcnt lgkmcnt(0)
MA 192,64,144
TR 76,6,4096
v_add_f32 v99, 1.0, v99
MA 192,68,160
TR 78,6,4608
v_add_f32 v112, 1.0, v112
MA 192,72,176
TR 80,6,12288
v_add_f32 v113, 1.0, v113
MA 196,64,148
TR 82,6,12800
v_add_f32 v114, 1.0, v114
MA 196,68,164
TR 84,6,20480
v_mul_f32 v132, v100, v132
MA 196,72,180
TR 86,6,20992
MA 200,64,152
v_exp_f32 v115, -v115
MA 200,68,168
v_rcp_f32 v96, v96
MA 200,72,184
v_rcp_f32 v97, v97
MA 204,64,156
v_rcp_f32 v98, v98
MA 204,68,172
v_rcp_f32 v99, v99
MA 204,72,188
v_add_f32 v115, 1.0, v115
s_waitcnt lgkmcnt(0)
MA 208,76,144
s_waitcnt vmcnt(6)
s_barrier
s_add_u32 m0, s43, 0x0
v_rcp_f32 v112, v112
MA 208,80,160
s_add_u32 s50, s44, 0x100
TR 64,5,24576
v_mul_f32 v128, v128, v96
MA 208,84,176
TR 66,5,25088
v_mul_f32 v129, v129, v97
MA 212,76,148
TR 68,5,32768
v_mul_f32 v130, v130, v98
MA 212,80,164
TR 70,5,33280
v_mul_f32 v131, v131, v99
MA 212,84,180
TR 72,5,40960
v_mul_f32 v144, v144, v112
MA 216,76,152
TR 74,5,41472
v_cvt_pk_bf16_f32 v96, v128, v129
MA 216,80,168
buffer_load_dwordx4 v2, s[8:11], s50 offen lds
MA 216,84,184
s_add_u32 m0, s43, 0x1000
v_rcp_f32 v113, v113
MA 220,76,156
s_add_u32 s51, s44, 0x100
v_rcp_f32 v114, v114
MA 220,80,172
v_rcp_f32 v115, v115
MA 220,84,188
v_mul_f32 v145, v145, v113
s_waitcnt lgkmcnt(0)
MA 160,64,192
TR 76,6,24576
v_mul_f32 v146, v146, v114
MA 160,68,208
TR 78,6,25088
v_mul_f32 v147, v147, v115
MA 160,72,224
TR 80,6,32768
v_cvt_pk_bf16_f32 v97, v130, v131
MA 164,64,196
TR 82,6,33280
v_cvt_pk_bf16_f32 v98, v144, v145
MA 164,68,212
TR 84,6,40960
v_cvt_pk_bf16_f32 v99, v146, v147
MA 164,72,228
TR 86,6,41472
v_mul_f32 v133, v101, v133
MA 168,64,200
buffer_load_dwordx4 v2, s[12:15], s51 offen lds
MA 168,68,216
s_add_u32 m0, s43, 0x2000
ds_write_b128 v11, v[96:99] offset:0
MA 168,72,232
s_add_u32 s50, s44, 0x48100
v_exp_f32 v100, -v100
MA 172,64,204
v_exp_f32 v101, -v101
MA 172,68,220
v_and_b32 v62, 63, v0
v_cmp_gt_u32 vcc, 9, v62
s_mul_i32 s82, s41, 36
s_mul_i32 s83, s40, 9
s_add_u32 s82, s82, s83
v_add_u32 v62, s82, v62
v_mul_u32_u24 v62, 9216, v62
v_cndmask_b32 v62, -4, v62, vcc
MA 172,72,236
buffer_load_dwordx4 v2, s[8:11], s50 offen lds
s_waitcnt lgkmcnt(1)
MA 176,76,192
s_add_u32 m0, s43, 0x3000
TR 64,5,28672
s_add_u32 s83, s44, 384
MA 176,80,208
s_add_u32 s51, s44, 0x48100
TR 66,5,29184
v_mul_f32 v134, v102, v134
MA 176,84,224
TR 68,5,36864
v_mul_f32 v135, v103, v135
MA 180,76,196
TR 70,5,37376
v_mul_f32 v148, v116, v148
MA 180,80,212
TR 72,5,45056
v_mul_f32 v149, v117, v149
MA 180,84,228
TR 74,5,45568
v_mul_f32 v150, v118, v150
MA 184,76,200
buffer_load_dwordx4 v2, s[12:15], s51 offen lds
MA 184,80,216
s_add_u32 m0, s43, 0x4000
v_exp_f32 v102, -v102
MA 184,84,232
s_add_u32 s50, s44, 0x90100
v_exp_f32 v103, -v103
MA 188,76,204
v_exp_f32 v116, -v116
MA 188,80,220
v_exp_f32 v117, -v117
MA 188,84,236
buffer_load_dwordx4 v2, s[8:11], s50 offen lds
s_waitcnt lgkmcnt(0)
MA 192,64,192
s_add_u32 m0, s43, 0x5000
TR 76,6,28672
v_mul_f32 v151, v119, v151
MA 192,68,208
s_add_u32 s51, s44, 0x90100
TR 78,6,29184
v_add_f32 v100, 1.0, v100
MA 192,72,224
TR 80,6,36864
v_add_f32 v101, 1.0, v101
MA 196,64,196
TR 82,6,37376
v_add_f32 v102, 1.0, v102
MA 196,68,212
TR 84,6,45056
v_add_f32 v103, 1.0, v103
MA 196,72,228
TR 86,6,45568
v_add_f32 v116, 1.0, v116
MA 200,64,200
buffer_load_dwordx4 v2, s[12:15], s51 offen lds
MA 200,68,216
buffer_load_dword v60, v62, s[8:11], s83 offen
v_add_f32 v117, 1.0, v117
MA 200,72,232
buffer_load_dword v60, v62, s[12:15], s83 offen
s_add_u32 s83, s44, 512
MA 204,64,204
v_exp_f32 v118, -v118
MA 204,68,220
v_exp_f32 v119, -v119
MA 204,72,236
v_add_f32 v118, 1.0, v118
s_waitcnt lgkmcnt(0)
MA 208,76,192
s_waitcnt vmcnt(8)
s_barrier
s_add_u32 m0, s43, 0x6000
v_rcp_f32 v100, v100
MA 208,80,208
s_add_u32 s50, s44, 0xd8100
TR 64,5,49152
v_add_f32 v119, 1.0, v119
MA 208,84,224
TR 66,5,49664
v_mul_f32 v132, v132, v100
MA 212,76,196
TR 68,5,57344
v_mul_f32 v136, v104, v136
MA 212,80,212
TR 70,5,57856
v_mul_f32 v137, v105, v137
MA 212,84,228
TR 72,7,0
v_mul_f32 v138, v106, v138
MA 216,76,200
TR 74,7,512
v_mul_f32 v139, v107, v139
MA 216,80,216
buffer_load_dwordx4 v2, s[8:11], s50 offen lds
MA 216,84,232
s_add_u32 m0, s43, 0x7000
v_rcp_f32 v101, v101
MA 220,76,204
s_add_u32 s51, s44, 0xd8100
v_rcp_f32 v102, v102
MA 220,80,220
v_rcp_f32 v103, v103
MA 220,84,236
v_mul_f32 v133, v133, v101
s_waitcnt lgkmcnt(0)
MA 160,64,240
TR 76,6,49152
v_mul_f32 v134, v134, v102
v_mfma_f32_16x16x32_bf16 v[160:163], v[68:71], v[224:227], v[160:163]
TR 78,6,49664
v_mul_f32 v135, v135, v103
v_mfma_f32_16x16x32_bf16 v[160:163], v[72:75], v[240:243], v[160:163]
TR 80,6,57344
v_cvt_pk_bf16_f32 v100, v132, v133
MA 164,64,244
TR 82,6,57856
v_cvt_pk_bf16_f32 v101, v134, v135
v_mfma_f32_16x16x32_bf16 v[164:167], v[68:71], v[228:231], v[164:167]
TR 84,8,0
v_mul_f32 v152, v120, v152
v_mfma_f32_16x16x32_bf16 v[164:167], v[72:75], v[244:247], v[164:167]
TR 86,8,512
v_mul_f32 v153, v121, v153
MA 168,64,248
buffer_load_dwordx4 v2, s[12:15], s51 offen lds
v_mfma_f32_16x16x32_bf16 v[168:171], v[68:71], v[232:235], v[168:171]
s_add_u32 m0, s43, 0x8000
v_rcp_f32 v116, v116
v_mfma_f32_16x16x32_bf16 v[168:171], v[72:75], v[248:251], v[168:171]
s_add_u32 s50, s44, 0x120100
v_rcp_f32 v117, v117
MA 172,64,252
v_rcp_f32 v118, v118
v_mfma_f32_16x16x32_bf16 v[172:175], v[68:71], v[236:239], v[172:175]
v_rcp_f32 v119, v119
v_mfma_f32_16x16x32_bf16 v[172:175], v[72:75], v[252:255], v[172:175]
buffer_load_dwordx4 v2, s[8:11], s50 offen lds
s_waitcnt lgkmcnt(0)
MA 176,76,240
s_add_u32 m0, s43, 0x9000
TR 64,5,53248
v_mul_f32 v148, v148, v116
v_mfma_f32_16x16x32_bf16 v[176:179], v[80:83], v[224:227], v[176:179]
s_add_u32 s51, s44, 0x120100
TR 66,5,53760
v_mul_f32 v149, v149, v117
v_mfma_f32_16x16x32_bf16 v[176:179], v[84:87], v[240:243], v[176:179]
TR 68,5,61440
v_mul_f32 v150, v150, v118
MA 180,76,244
TR 70,5,61952
v_mul_f32 v151, v151, v119
v_mfma_f32_16x16x32_bf16 v[180:183], v[80:83], v[228:231], v[180:183]
TR 72,7,4096
v_cvt_pk_bf16_f32 v102, v148, v149
v_mfma_f32_16x16x32_bf16 v[180:183], v[84:87], v[244:247], v[180:183]
TR 74,7,4608
v_cvt_pk_bf16_f32 v103, v150, v151
MA 184,76,248
buffer_load_dwordx4 v2, s[12:15], s51 offen lds
v_mfma_f32_16x16x32_bf16 v[184:187], v[80:83], v[232:235], v[184:187]
s_add_u32 m0, s43, 0xa000
ds_write_b128 v11, v[100:103] offset:1024
v_mfma_f32_16x16x32_bf16 v[184:187], v[84:87], v[248:251], v[184:187]
s_add_u32 s50, s44, 0x168100
v_exp_f32 v104, -v104
MA 188,76,252
v_exp_f32 v105, -v105
v_mfma_f32_16x16x32_bf16 v[188:191], v[80:83], v[236:239], v[188:191]
v_exp_f32 v106, -v106
v_mfma_f32_16x16x32_bf16 v[188:191], v[84:87], v[252:255], v[188:191]
buffer_load_dwordx4 v2, s[8:11], s50 offen lds
s_waitcnt lgkmcnt(1)
MA 192,64,240
s_add_u32 m0, s43, 0xb000
TR 76,6,53248
v_mul_f32 v154, v122, v154
v_mfma_f32_16x16x32_bf16 v[192:195], v[68:71], v[224:227], v[192:195]
s_add_u32 s51, s44, 0x168100
TR 78,6,53760
v_mul_f32 v155, v123, v155
v_mfma_f32_16x16x32_bf16 v[192:195], v[72:75], v[240:243], v[192:195]
TR 80,6,61440
v_add_f32 v104, 1.0, v104
MA 196,64,244
TR 82,6,61952
v_add_f32 v105, 1.0, v105
v_mfma_f32_16x16x32_bf16 v[196:199], v[68:71], v[228:231], v[196:199]
TR 84,8,4096
v_add_f32 v106, 1.0, v106
v_mfma_f32_16x16x32_bf16 v[196:199], v[72:75], v[244:247], v[196:199]
TR 86,8,4608
MA 200,64,248
buffer_load_dwordx4 v2, s[12:15], s51 offen lds
v_mfma_f32_16x16x32_bf16 v[200:203], v[68:71], v[232:235], v[200:203]
buffer_load_dword v60, v62, s[8:11], s83 offen
v_mfma_f32_16x16x32_bf16 v[200:203], v[72:75], v[248:251], v[200:203]
buffer_load_dword v60, v62, s[12:15], s83 offen
MA 204,64,252
v_exp_f32 v107, -v107
v_mfma_f32_16x16x32_bf16 v[204:207], v[68:71], v[236:239], v[204:207]
v_exp_f32 v120, -v120
v_mfma_f32_16x16x32_bf16 v[204:207], v[72:75], v[252:255], v[204:207]
v_add_f32 v107, 1.0, v107
s_waitcnt lgkmcnt(0)
MA 208,76,240
s_waitcnt vmcnt(10)
s_barrier
s_add_u32 m0, s43, 0xc000
v_exp_f32 v121, -v121
v_mfma_f32_16x16x32_bf16 v[208:211], v[80:83], v[224:227], v[208:211]
s_add_u32 s50, s44, 0x1b0100
TR 64,5,0
v_add_f32 v120, 1.0, v120
v_mfma_f32_16x16x32_bf16 v[208:211], v[84:87], v[240:243], v[208:211]
TR 66,5,512
v_add_f32 v121, 1.0, v121
MA 212,76,244
TR 68,5,8192
v_mfma_f32_16x16x32_bf16 v[212:215], v[80:83], v[228:231], v[212:215]
TR 70,5,8704
v_mfma_f32_16x16x32_bf16 v[212:215], v[84:87], v[244:247], v[212:215]
TR 72,5,16384
MA 216,76,248
TR 74,5,16896
v_mfma_f32_16x16x32_bf16 v[216:219], v[80:83], v[232:235], v[216:219]
buffer_load_dwordx4 v2, s[8:11], s50 offen lds
v_mfma_f32_16x16x32_bf16 v[216:219], v[84:87], v[248:251], v[216:219]
s_add_u32 m0, s43, 0xd000
v_exp_f32 v122, -v122
MA 220,76,252
s_add_u32 s51, s44, 0x1b0100
v_exp_f32 v123, -v123
v_mfma_f32_16x16x32_bf16 v[220:223], v[80:83], v[236:239], v[220:223]
v_rcp_f32 v104, v104
v_mfma_f32_16x16x32_bf16 v[220:223], v[84:87], v[252:255], v[220:223]
v_add_f32 v122, 1.0, v122
v_rcp_f32 v105, v105
v_rcp_f32 v106, v106
v_rcp_f32 v107, v107
v_rcp_f32 v120, v120
v_rcp_f32 v121, v121
v_rcp_f32 v122, v122
v_add_f32 v123, 1.0, v123
v_rcp_f32 v123, v123
v_mul_f32 v136, v136, v104
v_mul_f32 v137, v137, v105
v_mul_f32 v138, v138, v106
v_mul_f32 v139, v139, v107
v_mul_f32 v152, v152, v120
v_mul_f32 v153, v153, v121
v_mul_f32 v154, v154, v122
v_mul_f32 v155, v155, v123
v_cvt_pk_bf16_f32 v104, v136, v137
v_cvt_pk_bf16_f32 v105, v138, v139
v_cvt_pk_bf16_f32 v106, v152, v153
v_cvt_pk_bf16_f32 v107, v154, v155
ds_write_b128 v11, v[104:107] offset:2048
v_mul_f32 v140, v108, v140
v_exp_f32 v108, -v108
v_mul_f32 v141, v109, v141
v_exp_f32 v109, -v109
v_mul_f32 v142, v110, v142
v_exp_f32 v110, -v110
v_mul_f32 v143, v111, v143
v_exp_f32 v111, -v111
v_mul_f32 v156, v124, v156
v_exp_f32 v124, -v124
v_mul_f32 v157, v125, v157
v_exp_f32 v125, -v125
v_mul_f32 v158, v126, v158
v_exp_f32 v126, -v126
v_mul_f32 v159, v127, v159
v_exp_f32 v127, -v127
v_add_f32 v108, 1.0, v108
v_rcp_f32 v108, v108
v_add_f32 v109, 1.0, v109
v_rcp_f32 v109, v109
v_add_f32 v110, 1.0, v110
v_rcp_f32 v110, v110
v_add_f32 v111, 1.0, v111
v_rcp_f32 v111, v111
v_add_f32 v124, 1.0, v124
v_rcp_f32 v124, v124
v_add_f32 v125, 1.0, v125
v_rcp_f32 v125, v125
v_add_f32 v126, 1.0, v126
v_rcp_f32 v126, v126
v_add_f32 v127, 1.0, v127
v_rcp_f32 v127, v127
v_mul_f32 v140, v140, v108
v_mul_f32 v141, v141, v109
v_mul_f32 v142, v142, v110
v_mul_f32 v143, v143, v111
v_mul_f32 v156, v156, v124
v_mul_f32 v157, v157, v125
v_mul_f32 v158, v158, v126
v_mul_f32 v159, v159, v127
v_cvt_pk_bf16_f32 v108, v140, v141
v_cvt_pk_bf16_f32 v109, v142, v143
v_cvt_pk_bf16_f32 v110, v156, v157
v_cvt_pk_bf16_f32 v111, v158, v159
ds_write_b128 v11, v[108:111] offset:3072
s_waitcnt lgkmcnt(2)
v_mfma_f32_16x16x32_bf16 v[96:99], v[64:67], a[0:3], 0
TR 76,6,0
MA 96,68,16
TR 78,6,512
MA 96,72,32
TR 80,6,8192
v_mfma_f32_16x16x32_bf16 v[100:103], v[64:67], a[4:7], 0
TR 82,6,8704
MA 100,68,20
TR 84,6,16384
v_mul_f32 v192, v160, v192
MA 100,72,36
TR 86,6,16896
v_mul_f32 v193, v161, v193
v_mfma_f32_16x16x32_bf16 v[104:107], v[64:67], a[8:11], 0
buffer_load_dwordx4 v2, s[12:15], s51 offen lds
MA 104,68,24
s_add_u32 m0, s43, 0xe000
v_exp_f32 v160, -v160
MA 104,72,40
s_add_u32 s50, s44, 0x1f8100
v_exp_f32 v161, -v161
v_mfma_f32_16x16x32_bf16 v[108:111], v[64:67], a[12:15], 0
v_lshrrev_b32 v62, 2, v0
v_and_b32 v60, 0xcf, v0
v_cmp_eq_u32 vcc, v60, v0
v_and_or_b32 v62, v62, 48, v60
v_and_b32 v62, 63, v62
v_lshl_add_u32 v62, s41, 8, v62
v_lshlrev_b32 v62, 7, v62
v_cndmask_b32 v62, -4, v62, vcc
MA 108,68,28
s_add_u32 s83, s45, 0
v_mul_f32 v194, v162, v194
v_mul_f32 v195, v163, v195
MA 108,72,44
buffer_load_dwordx4 v2, s[8:11], s50 offen lds
s_waitcnt lgkmcnt(0)
v_mfma_f32_16x16x32_bf16 v[112:115], v[76:79], a[0:3], 0
s_add_u32 m0, s43, 0xf000
TR 64,5,4096
v_mul_f32 v208, v176, v208
MA 112,80,16
s_add_u32 s51, s44, 0x1f8100
TR 66,5,4608
v_mul_f32 v209, v177, v209
MA 112,84,32
TR 68,5,12288
v_mul_f32 v210, v178, v210
v_mfma_f32_16x16x32_bf16 v[116:119], v[76:79], a[4:7], 0
TR 70,5,12800
v_mul_f32 v211, v179, v211
MA 116,80,20
TR 72,5,20480
v_add_f32 v160, 1.0, v160
MA 116,84,36
TR 74,5,20992
v_add_f32 v161, 1.0, v161
v_mfma_f32_16x16x32_bf16 v[120:123], v[76:79], a[8:11], 0
buffer_load_dwordx4 v2, s[12:15], s51 offen lds
MA 120,80,24
s_add_u32 m0, s43, 0x10000
v_exp_f32 v162, -v162
MA 120,84,40
s_add_u32 s50, s44, 0x240100
v_exp_f32 v163, -v163
v_mfma_f32_16x16x32_bf16 v[124:127], v[76:79], a[12:15], 0
v_exp_f32 v176, -v176
MA 124,80,28
v_exp_f32 v177, -v177
MA 124,84,44
buffer_load_dwordx4 v2, s[8:11], s50 offen lds
s_waitcnt lgkmcnt(0)
v_mfma_f32_16x16x32_bf16 v[128:131], v[64:67], a[0:3], 0
s_add_u32 m0, s43, 0x11000
TR 76,6,4096
v_add_f32 v162, 1.0, v162
MA 128,68,16
s_add_u32 s51, s44, 0x240100
TR 78,6,4608
v_add_f32 v163, 1.0, v163
MA 128,72,32
TR 80,6,12288
v_add_f32 v176, 1.0, v176
v_mfma_f32_16x16x32_bf16 v[132:135], v[64:67], a[4:7], 0
TR 82,6,12800
v_add_f32 v177, 1.0, v177
MA 132,68,20
TR 84,6,20480
MA 132,72,36
TR 86,6,20992
v_mfma_f32_16x16x32_bf16 v[136:139], v[64:67], a[8:11], 0
buffer_load_dwordx4 v2, s[12:15], s51 offen lds
MA 136,68,24
buffer_load_dword v60, v62, s[16:19], s83 offen
s_add_u32 s83, s45, 8192
MA 136,72,40
v_exp_f32 v178, -v178
v_mfma_f32_16x16x32_bf16 v[140:143], v[64:67], a[12:15], 0
v_exp_f32 v179, -v179
MA 140,68,28
v_rcp_f32 v160, v160
MA 140,72,44
v_add_f32 v178, 1.0, v178
s_waitcnt lgkmcnt(0)
v_mfma_f32_16x16x32_bf16 v[144:147], v[76:79], a[0:3], 0
s_waitcnt vmcnt(9)
s_barrier
s_add_u32 m0, s43, 0x0
v_rcp_f32 v161, v161
MA 144,80,16
s_add_u32 s50, s44, 0x288100
TR 64,5,24576
v_add_f32 v179, 1.0, v179
MA 144,84,32
TR 66,5,25088
v_mul_f32 v192, v192, v160
v_mfma_f32_16x16x32_bf16 v[148:151], v[76:79], a[4:7], 0
TR 68,5,32768
v_mul_f32 v193, v193, v161
MA 148,80,20
TR 70,5,33280
v_cvt_pk_bf16_f32 v160, v192, v193
MA 148,84,36
TR 72,5,40960
v_mul_f32 v196, v164, v196
v_mfma_f32_16x16x32_bf16 v[152:155], v[76:79], a[8:11], 0
TR 74,5,41472
v_mul_f32 v197, v165, v197
MA 152,80,24
buffer_load_dwordx4 v2, s[8:11], s50 offen lds
MA 152,84,40
s_add_u32 m0, s43, 0x1000
v_rcp_f32 v162, v162
v_mfma_f32_16x16x32_bf16 v[156:159], v[76:79], a[12:15], 0
s_add_u32 s51, s44, 0x288100
v_rcp_f32 v163, v163
MA 156,80,28
v_rcp_f32 v176, v176
MA 156,84,44
v_mul_f32 v194, v194, v162
s_waitcnt lgkmcnt(0)
MA 96,64,48
TR 76,6,24576
v_mul_f32 v195, v195, v163
MA 96,68,64
TR 78,6,25088
v_mul_f32 v208, v208, v176
MA 96,72,80
TR 80,6,32768
v_cvt_pk_bf16_f32 v161, v194, v195
MA 100,64,52
TR 82,6,33280
v_mul_f32 v198, v166, v198
MA 100,68,68
TR 84,6,40960
v_mul_f32 v199, v167, v199
MA 100,72,84
TR 86,6,41472
v_mul_f32 v212, v180, v212
MA 104,64,56
buffer_load_dwordx4 v2, s[12:15], s51 offen lds
MA 104,68,72
s_add_u32 m0, s43, 0x2000
v_rcp_f32 v177, v177
MA 104,72,88
s_add_u32 s50, s44, 0x2d0100
v_rcp_f32 v178, v178
MA 108,64,60
v_rcp_f32 v179, v179
MA 108,68,76
v_exp_f32 v164, -v164
MA 108,72,92
buffer_load_dwordx4 v2, s[8:11], s50 offen lds
s_waitcnt lgkmcnt(0)
MA 112,76,48
s_add_u32 m0, s43, 0x3000
TR 64,5,28672
v_mul_f32 v209, v209, v177
MA 112,80,64
s_add_u32 s51, s44, 0x2d0100
TR 66,5,29184
v_mul_f32 v210, v210, v178
MA 112,84,80
TR 68,5,36864
v_mul_f32 v211, v211, v179
MA 116,76,52
TR 70,5,37376
v_cvt_pk_bf16_f32 v162, v208, v209
MA 116,80,68
TR 72,5,45056
v_cvt_pk_bf16_f32 v163, v210, v211
MA 116,84,84
TR 74,5,45568
v_mul_f32 v213, v181, v213
MA 120,76,56
buffer_load_dwordx4 v2, s[12:15], s51 offen lds
MA 120,80,72
s_add_u32 m0, s43, 0x4000
ds_write_b128 v11, v[160:163] offset:16384
MA 120,84,88
s_add_u32 s50, s44, 0x318100
v_exp_f32 v165, -v165
MA 124,76,60
v_exp_f32 v166, -v166
MA 124,80,76
v_exp_f32 v167, -v167
MA 124,84,92
buffer_load_dwordx4 v2, s[8:11], s50 offen lds
s_waitcnt lgkmcnt(1)
MA 128,64,48
s_add_u32 m0, s43, 0x5000
TR 76,6,28672
v_mul_f32 v214, v182, v214
MA 128,68,64
s_add_u32 s51, s44, 0x318100
TR 78,6,29184
v_mul_f32 v215, v183, v215
MA 128,72,80
TR 80,6,36864
v_add_f32 v164, 1.0, v164
MA 132,64,52
TR 82,6,37376
v_add_f32 v165, 1.0, v165
MA 132,68,68
TR 84,6,45056
v_add_f32 v166, 1.0, v166
MA 132,72,84
TR 86,6,45568
v_add_f32 v167, 1.0, v167
MA 136,64,56
buffer_load_dwordx4 v2, s[12:15], s51 offen lds
MA 136,68,72
buffer_load_dword v60, v62, s[16:19], s83 offen
s_add_u32 s83, s45, 16384
MA 136,72,88
v_exp_f32 v180, -v180
MA 140,64,60
v_exp_f32 v181, -v181
MA 140,68,76
v_exp_f32 v182, -v182
MA 140,72,92
v_add_f32 v180, 1.0, v180
s_waitcnt lgkmcnt(0)
MA 144,76,48
s_waitcnt vmcnt(8)
s_barrier
s_add_u32 m0, s43, 0x6000
v_exp_f32 v183, -v183
MA 144,80,64
s_add_u32 s50, s44, 0x360100
TR 64,5,49152
v_add_f32 v181, 1.0, v181
MA 144,84,80
TR 66,5,49664
v_add_f32 v182, 1.0, v182
MA 148,76,52
TR 68,5,57344
v_add_f32 v183, 1.0, v183
MA 148,80,68
TR 70,5,57856
v_mul_f32 v200, v168, v200
MA 148,84,84
TR 72,7,0
v_mul_f32 v201, v169, v201
MA 152,76,56
TR 74,7,512
v_mul_f32 v202, v170, v202
MA 152,80,72
buffer_load_dwordx4 v2, s[8:11], s50 offen lds
MA 152,84,88
s_add_u32 m0, s43, 0x7000
v_rcp_f32 v164, v164
MA 156,76,60
s_add_u32 s51, s44, 0x360100
v_rcp_f32 v165, v165
MA 156,80,76
v_rcp_f32 v166, v166
MA 156,84,92
v_mul_f32 v196, v196, v164
s_waitcnt lgkmcnt(0)
MA 96,64,96
TR 76,6,49152
v_mul_f32 v197, v197, v165
MA 96,68,112
TR 78,6,49664
v_mul_f32 v198, v198, v166
MA 96,72,128
TR 80,6,57344
v_cvt_pk_bf16_f32 v164, v196, v197
MA 100,64,100
TR 82,6,57856
v_mul_f32 v203, v171, v203
MA 100,68,116
TR 84,8,0
v_mul_f32 v216, v184, v216
MA 100,72,132
TR 86,8,512
v_mul_f32 v217, v185, v217
MA 104,64,104
buffer_load_dwordx4 v2, s[12:15], s51 offen lds
MA 104,68,120
s_add_u32 m0, s43, 0x8000
v_rcp_f32 v167, v167
MA 104,72,136
s_add_u32 s50, s44, 0x3a8100
v_rcp_f32 v180, v180
MA 108,64,108
v_rcp_f32 v181, v181
MA 108,68,124
v_rcp_f32 v182, v182
MA 108,72,140
buffer_load_dwordx4 v2, s[8:11], s50 offen lds
s_waitcnt lgkmcnt(0)
MA 112,76,96
s_add_u32 m0, s43, 0x9000
TR 64,5,53248
v_mul_f32 v199, v199, v167
MA 112,80,112
s_add_u32 s51, s44, 0x3a8100
TR 66,5,53760
v_mul_f32 v212, v212, v180
MA 112,84,128
TR 68,5,61440
v_mul_f32 v213, v213, v181
MA 116,76,100
TR 70,5,61952
v_mul_f32 v214, v214, v182
MA 116,80,116
TR 72,7,4096
v_cvt_pk_bf16_f32 v165, v198, v199
MA 116,84,132
TR 74,7,4608
v_cvt_pk_bf16_f32 v166, v212, v213
MA 120,76,104
buffer_load_dwordx4 v2, s[12:15], s51 offen lds
MA 120,80,120
s_add_u32 m0, s43, 0xa000
v_rcp_f32 v183, v183
MA 120,84,136
s_add_u32 s50, s44, 0x3f0100
v_exp_f32 v168, -v168
MA 124,76,108
v_exp_f32 v169, -v169
MA 124,80,124
v_exp_f32 v170, -v170
MA 124,84,140
buffer_load_dwordx4 v2, s[8:11], s50 offen lds
s_waitcnt lgkmcnt(0)
MA 128,64,96
s_add_u32 m0, s43, 0xb000
TR 76,6,53248
v_mul_f32 v215, v215, v183
MA 128,68,112
s_add_u32 s51, s44, 0x3f0100
TR 78,6,53760
v_cvt_pk_bf16_f32 v167, v214, v215
MA 128,72,128
TR 80,6,61440
v_mul_f32 v218, v186, v218
MA 132,64,100
TR 82,6,61952
v_mul_f32 v219, v187, v219
MA 132,68,116
TR 84,8,4096
v_add_f32 v168, 1.0, v168
MA 132,72,132
TR 86,8,4608
v_add_f32 v169, 1.0, v169
MA 136,64,104
buffer_load_dwordx4 v2, s[12:15], s51 offen lds
MA 136,68,120
buffer_load_dword v60, v62, s[16:19], s83 offen
s_add_u32 s83, s45, 24576
v_add_f32 v170, 1.0, v170
MA 136,72,136
ds_write_b128 v11, v[164:167] offset:17408
MA 140,64,108
v_exp_f32 v171, -v171
MA 140,68,124
v_exp_f32 v184, -v184
MA 140,72,140
v_add_f32 v171, 1.0, v171
s_waitcnt lgkmcnt(1)
MA 144,76,96
s_waitcnt vmcnt(8)
s_waitcnt lgkmcnt(0)
s_barrier
s_add_u32 m0, s43, 0xc000
v_exp_f32 v185, -v185
MA 144,80,112
s_add_u32 s50, s44, 0x438100
TR 64,5,0
v_add_f32 v184, 1.0, v184
MA 144,84,128
TR 66,5,512
v_add_f32 v185, 1.0, v185
MA 148,76,100
TR 68,5,8192
MA 148,80,116
TR 70,5,8704
MA 148,84,132
TR 72,5,16384
MA 152,76,104
TR 74,5,16896
MA 152,80,120
buffer_load_dwordx4 v2, s[8:11], s50 offen lds
MA 152,84,136
s_add_u32 m0, s43, 0xd000
v_exp_f32 v186, -v186
MA 156,76,108
s_add_u32 s51, s44, 0x438100
v_exp_f32 v187, -v187
MA 156,80,124
v_rcp_f32 v168, v168
MA 156,84,140
v_add_f32 v186, 1.0, v186
s_waitcnt lgkmcnt(0)
MA 96,64,144
TR 76,6,0
v_add_f32 v187, 1.0, v187
MA 96,68,160
TR 78,6,512
v_mul_f32 v200, v200, v168
MA 96,72,176
TR 80,6,8192
v_mul_f32 v204, v172, v204
MA 100,64,148
TR 82,6,8704
v_mul_f32 v205, v173, v205
MA 100,68,164
TR 84,6,16384
v_mul_f32 v206, v174, v206
MA 100,72,180
TR 86,6,16896
v_mul_f32 v207, v175, v207
MA 104,64,152
buffer_load_dwordx4 v2, s[12:15], s51 offen lds
MA 104,68,168
s_add_u32 m0, s43, 0xe000
v_rcp_f32 v169, v169
MA 104,72,184
s_add_u32 s50, s44, 0x480100
v_rcp_f32 v170, v170
MA 108,64,156
v_rcp_f32 v171, v171
MA 108,68,172
v_rcp_f32 v184, v184
MA 108,72,188
buffer_load_dwordx4 v2, s[8:11], s50 offen lds
s_waitcnt lgkmcnt(0)
MA 112,76,144
s_add_u32 m0, s43, 0xf000
TR 64,5,4096
v_mul_f32 v201, v201, v169
MA 112,80,160
s_add_u32 s51, s44, 0x480100
TR 66,5,4608
v_mul_f32 v202, v202, v170
MA 112,84,176
TR 68,5,12288
v_mul_f32 v203, v203, v171
MA 116,76,148
TR 70,5,12800
v_mul_f32 v216, v216, v184
MA 116,80,164
TR 72,5,20480
v_cvt_pk_bf16_f32 v168, v200, v201
MA 116,84,180
TR 74,5,20992
v_cvt_pk_bf16_f32 v169, v202, v203
MA 120,76,152
buffer_load_dwordx4 v2, s[12:15], s51 offen lds
MA 120,80,168
s_add_u32 m0, s43, 0x10000
v_rcp_f32 v185, v185
MA 120,84,184
s_add_u32 s50, s44, 0x4c8100
v_rcp_f32 v186, v186
MA 124,76,156
v_rcp_f32 v187, v187
MA 124,80,172
v_exp_f32 v172, -v172
MA 124,84,188
buffer_load_dwordx4 v2, s[8:11], s50 offen lds
s_waitcnt lgkmcnt(0)
MA 128,64,144
s_add_u32 m0, s43, 0x11000
TR 76,6,4096
v_mul_f32 v217, v217, v185
MA 128,68,160
s_add_u32 s51, s44, 0x4c8100
TR 78,6,4608
v_mul_f32 v218, v218, v186
MA 128,72,176
TR 80,6,12288
v_mul_f32 v219, v219, v187
MA 132,64,148
TR 82,6,12800
v_cvt_pk_bf16_f32 v170, v216, v217
MA 132,68,164
TR 84,6,20480
v_cvt_pk_bf16_f32 v171, v218, v219
MA 132,72,180
TR 86,6,20992
v_mul_f32 v220, v188, v220
MA 136,64,152
buffer_load_dwordx4 v2, s[12:15], s51 offen lds
MA 136,68,168
buffer_load_dword v60, v62, s[16:19], s83 offen
v_lshlrev_b32 v62, 7, v0
s_mov_b32 s83, L_A_p2-L_k1_A
MA 136,72,184
ds_write_b128 v11, v[168:171] offset:18432
MA 140,64,156
v_exp_f32 v173, -v173
MA 140,68,172
v_exp_f32 v174, -v174
MA 140,72,188
v_mul_f32 v221, v189, v221
s_waitcnt lgkmcnt(1)
MA 144,76,144
s_waitcnt vmcnt(8)
s_waitcnt lgkmcnt(0)
s_barrier
s_add_u32 m0, s43, 0x0
v_exp_f32 v175, -v175
MA 144,80,160
s_add_u32 s50, s44, 0x180
TR 64,5,24576
v_mul_f32 v222, v190, v222
MA 144,84,176
TR 66,5,25088
v_mul_f32 v223, v191, v223
MA 148,76,148
TR 68,5,32768
v_add_f32 v172, 1.0, v172
MA 148,80,164
TR 70,5,33280
v_add_f32 v173, 1.0, v173
MA 148,84,180
TR 72,5,40960
v_add_f32 v174, 1.0, v174
MA 152,76,152
TR 74,5,41472
v_add_f32 v175, 1.0, v175
MA 152,80,168
buffer_load_dwordx4 v2, s[8:11], s50 offen lds
MA 152,84,184
s_add_u32 m0, s43, 0x1000
v_exp_f32 v188, -v188
MA 156,76,156
s_add_u32 s51, s44, 0x180
v_exp_f32 v189, -v189
MA 156,80,172
v_exp_f32 v190, -v190
MA 156,84,188
v_add_f32 v188, 1.0, v188
s_waitcnt lgkmcnt(0)
MA 96,64,192
TR 76,6,24576
v_add_f32 v189, 1.0, v189
MA 96,68,208
TR 78,6,25088
v_add_f32 v190, 1.0, v190
MA 96,72,224
TR 80,6,32768
MA 100,64,196
TR 82,6,33280
MA 100,68,212
TR 84,6,40960
MA 100,72,228
TR 86,6,41472
MA 104,64,200
buffer_load_dwordx4 v2, s[12:15], s51 offen lds
MA 104,68,216
s_add_u32 m0, s43, 0x2000
v_exp_f32 v191, -v191
MA 104,72,232
s_add_u32 s50, s44, 0x48180
v_rcp_f32 v172, v172
MA 108,64,204
v_rcp_f32 v173, v173
MA 108,68,220
v_rcp_f32 v174, v174
MA 108,72,236
buffer_load_dwordx4 v2, s[8:11], s50 offen lds
s_waitcnt lgkmcnt(0)
MA 112,76,192
s_add_u32 m0, s43, 0x3000
TR 64,5,28672
v_add_f32 v191, 1.0, v191
MA 112,80,208
s_add_u32 s51, s44, 0x48180
TR 66,5,29184
v_mul_f32 v204, v204, v172
MA 112,84,224
TR 68,5,36864
v_mul_f32 v205, v205, v173
MA 116,76,196
TR 70,5,37376
v_mul_f32 v206, v206, v174
MA 116,80,212
TR 72,5,45056
v_cvt_pk_bf16_f32 v172, v204, v205
MA 116,84,228
TR 74,5,45568
MA 120,76,200
buffer_load_dwordx4 v2, s[12:15], s51 offen lds
MA 120,80,216
s_add_u32 m0, s43, 0x4000
v_rcp_f32 v175, v175
MA 120,84,232
s_add_u32 s50, s44, 0x90180
v_rcp_f32 v188, v188
MA 124,76,204
v_rcp_f32 v189, v189
MA 124,80,220
v_rcp_f32 v190, v190
MA 124,84,236
buffer_load_dwordx4 v2, s[8:11], s50 offen lds
s_waitcnt lgkmcnt(0)
MA 128,64,192
s_add_u32 m0, s43, 0x5000
TR 76,6,28672
v_mul_f32 v207, v207, v175
MA 128,68,208
s_add_u32 s51, s44, 0x90180
TR 78,6,29184
v_mul_f32 v220, v220, v188
MA 128,72,224
TR 80,6,36864
v_mul_f32 v221, v221, v189
MA 132,64,196
TR 82,6,37376
v_mul_f32 v222, v222, v190
MA 132,68,212
TR 84,6,45056
v_cvt_pk_bf16_f32 v173, v206, v207
MA 132,72,228
TR 86,6,45568
v_cvt_pk_bf16_f32 v174, v220, v221
MA 136,64,200
buffer_load_dwordx4 v2, s[12:15], s51 offen lds
MA 136,68,216
buffer_load_dword v60, v62, s[92:95], s83 offen
MA 136,72,232
v_rcp_f32 v191, v191
MA 140,64,204
v_mul_f32 v223, v223, v191
v_cvt_pk_bf16_f32 v175, v222, v223
MA 140,68,220
MA 140,72,236
s_waitcnt lgkmcnt(0)
MA 144,76,192
s_waitcnt vmcnt(8)
s_barrier
s_add_u32 m0, s43, 0x6000
ds_write_b128 v11, v[172:175] offset:19456
MA 144,80,208
s_add_u32 s50, s44, 0xd8180
TR 64,5,49152
MA 144,84,224
TR 66,5,49664
MA 148,76,196
TR 68,5,57344
MA 148,80,212
TR 70,5,57856
MA 148,84,228
TR 72,7,0
MA 152,76,200
TR 74,7,512
MA 152,80,216
buffer_load_dwordx4 v2, s[8:11], s50 offen lds
MA 152,84,232
s_add_u32 m0, s43, 0x7000
MA 156,76,204
s_add_u32 s51, s44, 0xd8180
MA 156,80,220
MA 156,84,236
s_waitcnt lgkmcnt(0)
MA 96,64,240
TR 76,6,49152
v_mfma_f32_16x16x32_bf16 v[96:99], v[68:71], v[224:227], v[96:99]
TR 78,6,49664
v_mfma_f32_16x16x32_bf16 v[96:99], v[72:75], v[240:243], v[96:99]
TR 80,6,57344
MA 100,64,244
TR 82,6,57856
v_mfma_f32_16x16x32_bf16 v[100:103], v[68:71], v[228:231], v[100:103]
TR 84,8,0
v_mfma_f32_16x16x32_bf16 v[100:103], v[72:75], v[244:247], v[100:103]
TR 86,8,512
MA 104,64,248
buffer_load_dwordx4 v2, s[12:15], s51 offen lds
v_mfma_f32_16x16x32_bf16 v[104:107], v[68:71], v[232:235], v[104:107]
s_add_u32 m0, s43, 0x8000
v_mfma_f32_16x16x32_bf16 v[104:107], v[72:75], v[248:251], v[104:107]
s_add_u32 s50, s44, 0x120180
MA 108,64,252
v_mfma_f32_16x16x32_bf16 v[108:111], v[68:71], v[236:239], v[108:111]
v_mfma_f32_16x16x32_bf16 v[108:111], v[72:75], v[252:255], v[108:111]
buffer_load_dwordx4 v2, s[8:11], s50 offen lds
s_waitcnt lgkmcnt(0)
MA 112,76,240
s_add_u32 m0, s43, 0x9000
TR 64,5,53248
v_mfma_f32_16x16x32_bf16 v[112:115], v[80:83], v[224:227], v[112:115]
s_add_u32 s51, s44, 0x120180
TR 66,5,53760
v_mfma_f32_16x16x32_bf16 v[112:115], v[84:87], v[240:243], v[112:115]
TR 68,5,61440
MA 116,76,244
TR 70,5,61952
v_mfma_f32_16x16x32_bf16 v[116:119], v[80:83], v[228:231], v[116:119]
TR 72,7,4096
v_mfma_f32_16x16x32_bf16 v[116:119], v[84:87], v[244:247], v[116:119]
TR 74,7,4608
MA 120,76,248
buffer_load_dwordx4 v2, s[12:15], s51 offen lds
v_mfma_f32_16x16x32_bf16 v[120:123], v[80:83], v[232:235], v[120:123]
s_add_u32 m0, s43, 0xa000
v_mfma_f32_16x16x32_bf16 v[120:123], v[84:87], v[248:251], v[120:123]
s_add_u32 s50, s44, 0x168180
MA 124,76,252
v_mfma_f32_16x16x32_bf16 v[124:127], v[80:83], v[236:239], v[124:127]
v_mfma_f32_16x16x32_bf16 v[124:127], v[84:87], v[252:255], v[124:127]
buffer_load_dwordx4 v2, s[8:11], s50 offen lds
s_waitcnt lgkmcnt(0)
MA 128,64,240
s_add_u32 m0, s43, 0xb000
TR 76,6,53248
v_mfma_f32_16x16x32_bf16 v[128:131], v[68:71], v[224:227], v[128:131]
s_add_u32 s51, s44, 0x168180
TR 78,6,53760
v_mfma_f32_16x16x32_bf16 v[128:131], v[72:75], v[240:243], v[128:131]
TR 80,6,61440
MA 132,64,244
TR 82,6,61952
v_mfma_f32_16x16x32_bf16 v[132:135], v[68:71], v[228:231], v[132:135]
TR 84,8,4096
v_mfma_f32_16x16x32_bf16 v[132:135], v[72:75], v[244:247], v[132:135]
TR 86,8,4608
MA 136,64,248
buffer_load_dwordx4 v2, s[12:15], s51 offen lds
v_mfma_f32_16x16x32_bf16 v[136:139], v[68:71], v[232:235], v[136:139]
v_mfma_f32_16x16x32_bf16 v[136:139], v[72:75], v[248:251], v[136:139]
MA 140,64,252
v_mfma_f32_16x16x32_bf16 v[140:143], v[68:71], v[236:239], v[140:143]
v_mfma_f32_16x16x32_bf16 v[140:143], v[72:75], v[252:255], v[140:143]
s_waitcnt lgkmcnt(0)
MA 144,76,240
s_waitcnt vmcnt(7)
s_barrier
s_add_u32 m0, s43, 0xc000
v_mfma_f32_16x16x32_bf16 v[144:147], v[80:83], v[224:227], v[144:147]
s_add_u32 s50, s44, 0x1b0180
TR 64,5,0
v_mfma_f32_16x16x32_bf16 v[144:147], v[84:87], v[240:243], v[144:147]
TR 66,5,512
MA 148,76,244
TR 68,5,8192
v_mfma_f32_16x16x32_bf16 v[148:151], v[80:83], v[228:231], v[148:151]
TR 70,5,8704
v_mfma_f32_16x16x32_bf16 v[148:151], v[84:87], v[244:247], v[148:151]
TR 72,5,16384
MA 152,76,248
TR 74,5,16896
v_mfma_f32_16x16x32_bf16 v[152:155], v[80:83], v[232:235], v[152:155]
buffer_load_dwordx4 v2, s[8:11], s50 offen lds
v_mfma_f32_16x16x32_bf16 v[152:155], v[84:87], v[248:251], v[152:155]
s_add_u32 m0, s43, 0xd000
MA 156,76,252
s_add_u32 s51, s44, 0x1b0180
v_mfma_f32_16x16x32_bf16 v[156:159], v[80:83], v[236:239], v[156:159]
v_mfma_f32_16x16x32_bf16 v[156:159], v[84:87], v[252:255], v[156:159]
s_waitcnt lgkmcnt(0)
v_mfma_f32_16x16x32_bf16 v[160:163], v[64:67], a[0:3], 0
TR 76,6,0
MA 160,68,16
TR 78,6,512
MA 160,72,32
TR 80,6,8192
v_mfma_f32_16x16x32_bf16 v[164:167], v[64:67], a[4:7], 0
TR 82,6,8704
MA 164,68,20
TR 84,6,16384
v_mul_f32 v128, v96, v128
MA 164,72,36
TR 86,6,16896
v_mul_f32 v129, v97, v129
v_mfma_f32_16x16x32_bf16 v[168:171], v[64:67], a[8:11], 0
buffer_load_dwordx4 v2, s[12:15], s51 offen lds
MA 168,68,24
s_add_u32 m0, s43, 0xe000
v_exp_f32 v96, -v96
MA 168,72,40
s_add_u32 s50, s44, 0x1f8180
v_exp_f32 v97, -v97
v_mfma_f32_16x16x32_bf16 v[172:175], v[64:67], a[12:15], 0
v_mul_f32 v130, v98, v130
v_mul_f32 v131, v99, v131
MA 172,68,28
v_exp_f32 v98, -v98
MA 172,72,44
buffer_load_dwordx4 v2, s[8:11], s50 offen lds
s_waitcnt lgkmcnt(0)
v_mfma_f32_16x16x32_bf16 v[176:179], v[76:79], a[0:3], 0
s_add_u32 m0, s43, 0xf000
TR 64,5,4096
v_mul_f32 v144, v112, v144
MA 176,80,16
s_add_u32 s51, s44, 0x1f8180
TR 66,5,4608
v_mul_f32 v145, v113, v145
MA 176,84,32
TR 68,5,12288
v_mul_f32 v146, v114, v146
v_mfma_f32_16x16x32_bf16 v[180:183], v[76:79], a[4:7], 0
TR 70,5,12800
v_mul_f32 v147, v115, v147
MA 180,80,20
TR 72,5,20480
v_add_f32 v96, 1.0, v96
MA 180,84,36
TR 74,5,20992
v_add_f32 v97, 1.0, v97
v_mfma_f32_16x16x32_bf16 v[184:187], v[76:79], a[8:11], 0
buffer_load_dwordx4 v2, s[12:15], s51 offen lds
MA 184,80,24
s_add_u32 m0, s43, 0x10000
v_exp_f32 v99, -v99
MA 184,84,40
s_add_u32 s50, s44, 0x240180
v_exp_f32 v112, -v112
v_mfma_f32_16x16x32_bf16 v[188:191], v[76:79], a[12:15], 0
v_exp_f32 v113, -v113
MA 188,80,28
v_exp_f32 v114, -v114
MA 188,84,44
buffer_load_dwordx4 v2, s[8:11], s50 offen lds
s_waitcnt lgkmcnt(0)
v_mfma_f32_16x16x32_bf16 v[192:195], v[64:67], a[0:3], 0
s_add_u32 m0, s43, 0x11000
TR 76,6,4096
v_add_f32 v98, 1.0, v98
MA 192,68,16
s_add_u32 s51, s44, 0x240180
TR 78,6,4608
v_add_f32 v99, 1.0, v99
MA 192,72,32
TR 80,6,12288
v_add_f32 v112, 1.0, v112
v_mfma_f32_16x16x32_bf16 v[196:199], v[64:67], a[4:7], 0
TR 82,6,12800
v_add_f32 v113, 1.0, v113
MA 196,68,20
TR 84,6,20480
v_add_f32 v114, 1.0, v114
MA 196,72,36
TR 86,6,20992
v_mul_f32 v132, v100, v132
v_mfma_f32_16x16x32_bf16 v[200:203], v[64:67], a[8:11], 0
buffer_load_dwordx4 v2, s[12:15], s51 offen lds
MA 200,68,24
v_exp_f32 v115, -v115
MA 200,72,40
v_rcp_f32 v96, v96
v_mfma_f32_16x16x32_bf16 v[204:207], v[64:67], a[12:15], 0
v_rcp_f32 v97, v97
MA 204,68,28
v_rcp_f32 v98, v98
MA 204,72,44
v_add_f32 v115, 1.0, v115
s_waitcnt lgkmcnt(0)
v_mfma_f32_16x16x32_bf16 v[208:211], v[76:79], a[0:3], 0
s_waitcnt vmcnt(6)
s_barrier
s_add_u32 m0, s43, 0x0
v_rcp_f32 v99, v99
MA 208,80,16
s_add_u32 s50, s44, 0x288180
TR 64,5,24576
v_mul_f32 v128, v128, v96
MA 208,84,32
TR 66,5,25088
v_mul_f32 v129, v129, v97
v_mfma_f32_16x16x32_bf16 v[212:215], v[76:79], a[4:7], 0
TR 68,5,32768
v_mul_f32 v130, v130, v98
MA 212,80,20
TR 70,5,33280
v_mul_f32 v131, v131, v99
MA 212,84,36
TR 72,5,40960
v_cvt_pk_bf16_f32 v96, v128, v129
v_mfma_f32_16x16x32_bf16 v[216:219], v[76:79], a[8:11], 0
TR 74,5,41472
v_cvt_pk_bf16_f32 v97, v130, v131
MA 216,80,24
buffer_load_dwordx4 v2, s[8:11], s50 offen lds
MA 216,84,40
s_add_u32 m0, s43, 0x1000
v_rcp_f32 v112, v112
v_mfma_f32_16x16x32_bf16 v[220:223], v[76:79], a[12:15], 0
s_add_u32 s51, s44, 0x288180
v_rcp_f32 v113, v113
MA 220,80,28
v_rcp_f32 v114, v114
MA 220,84,44
v_mul_f32 v144, v144, v112
s_waitcnt lgkmcnt(0)
MA 160,64,48
TR 76,6,24576
v_mul_f32 v145, v145, v113
MA 160,68,64
TR 78,6,25088
v_mul_f32 v146, v146, v114
MA 160,72,80
TR 80,6,32768
v_cvt_pk_bf16_f32 v98, v144, v145
MA 164,64,52
TR 82,6,33280
v_mul_f32 v133, v101, v133
MA 164,68,68
TR 84,6,40960
v_mul_f32 v134, v102, v134
MA 164,72,84
TR 86,6,41472
v_mul_f32 v135, v103, v135
MA 168,64,56
buffer_load_dwordx4 v2, s[12:15], s51 offen lds
MA 168,68,72
s_add_u32 m0, s43, 0x2000
v_rcp_f32 v115, v115
MA 168,72,88
s_add_u32 s50, s44, 0x2d0180
v_exp_f32 v100, -v100
MA 172,64,60
v_exp_f32 v101, -v101
MA 172,68,76
v_exp_f32 v102, -v102
MA 172,72,92
buffer_load_dwordx4 v2, s[8:11], s50 offen lds
s_waitcnt lgkmcnt(0)
MA 176,76,48
s_add_u32 m0, s43, 0x3000
TR 64,5,28672
v_mul_f32 v147, v147, v115
MA 176,80,64
s_add_u32 s51, s44, 0x2d0180
TR 66,5,29184
v_cvt_pk_bf16_f32 v99, v146, v147
MA 176,84,80
TR 68,5,36864
v_mul_f32 v148, v116, v148
MA 180,76,52
TR 70,5,37376
v_mul_f32 v149, v117, v149
MA 180,80,68
TR 72,5,45056
v_mul_f32 v150, v118, v150
MA 180,84,84
TR 74,5,45568
v_mul_f32 v151, v119, v151
MA 184,76,56
buffer_load_dwordx4 v2, s[12:15], s51 offen lds
MA 184,80,72
s_add_u32 m0, s43, 0x4000
ds_write_b128 v11, v[96:99] offset:32768
MA 184,84,88
s_add_u32 s50, s44, 0x318180
v_exp_f32 v103, -v103
MA 188,76,60
v_exp_f32 v116, -v116
MA 188,80,76
v_exp_f32 v117, -v117
MA 188,84,92
buffer_load_dwordx4 v2, s[8:11], s50 offen lds
s_waitcnt lgkmcnt(1)
MA 192,64,48
s_add_u32 m0, s43, 0x5000
TR 76,6,28672
v_add_f32 v100, 1.0, v100
MA 192,68,64
s_add_u32 s51, s44, 0x318180
TR 78,6,29184
v_add_f32 v101, 1.0, v101
MA 192,72,80
TR 80,6,36864
v_add_f32 v102, 1.0, v102
MA 196,64,52
TR 82,6,37376
v_add_f32 v103, 1.0, v103
MA 196,68,68
TR 84,6,45056
v_add_f32 v116, 1.0, v116
MA 196,72,84
TR 86,6,45568
v_add_f32 v117, 1.0, v117
MA 200,64,56
buffer_load_dwordx4 v2, s[12:15], s51 offen lds
MA 200,68,72
v_exp_f32 v118, -v118
MA 200,72,88
v_exp_f32 v119, -v119
MA 204,64,60
v_rcp_f32 v100, v100
MA 204,68,76
v_rcp_f32 v101, v101
MA 204,72,92
v_add_f32 v118, 1.0, v118
s_waitcnt lgkmcnt(0)
MA 208,76,48
s_waitcnt vmcnt(6)
s_barrier
s_add_u32 m0, s43, 0x6000
v_rcp_f32 v102, v102
MA 208,80,64
s_add_u32 s50, s44, 0x360180
TR 64,5,49152
v_add_f32 v119, 1.0, v119
MA 208,84,80
TR 66,5,49664
v_mul_f32 v132, v132, v100
MA 212,76,52
TR 68,5,57344
v_mul_f32 v133, v133, v101
MA 212,80,68
TR 70,5,57856
v_mul_f32 v134, v134, v102
MA 212,84,84
TR 72,7,0
v_cvt_pk_bf16_f32 v100, v132, v133
MA 216,76,56
TR 74,7,512
v_mul_f32 v136, v104, v136
MA 216,80,72
buffer_load_dwordx4 v2, s[8:11], s50 offen lds
MA 216,84,88
s_add_u32 m0, s43, 0x7000
v_rcp_f32 v103, v103
MA 220,76,60
s_add_u32 s51, s44, 0x360180
v_rcp_f32 v116, v116
MA 220,80,76
v_rcp_f32 v117, v117
MA 220,84,92
v_mul_f32 v135, v135, v103
s_waitcnt lgkmcnt(0)
MA 160,64,96
TR 76,6,49152
v_mul_f32 v148, v148, v116
MA 160,68,112
TR 78,6,49664
v_mul_f32 v149, v149, v117
MA 160,72,128
TR 80,6,57344
v_cvt_pk_bf16_f32 v101, v134, v135
MA 164,64,100
TR 82,6,57856
v_cvt_pk_bf16_f32 v102, v148, v149
MA 164,68,116
TR 84,8,0
v_mul_f32 v137, v105, v137
MA 164,72,132
TR 86,8,512
v_mul_f32 v138, v106, v138
MA 168,64,104
buffer_load_dwordx4 v2, s[12:15], s51 offen lds
MA 168,68,120
s_add_u32 m0, s43, 0x8000
v_rcp_f32 v118, v118
MA 168,72,136
s_add_u32 s50, s44, 0x3a8180
v_rcp_f32 v119, v119
MA 172,64,108
v_exp_f32 v104, -v104
MA 172,68,124
v_exp_f32 v105, -v105
MA 172,72,140
buffer_load_dwordx4 v2, s[8:11], s50 offen lds
s_waitcnt lgkmcnt(0)
MA 176,76,96
s_add_u32 m0, s43, 0x9000
TR 64,5,53248
v_mul_f32 v150, v150, v118
MA 176,80,112
s_add_u32 s51, s44, 0x3a8180
TR 66,5,53760
v_mul_f32 v151, v151, v119
MA 176,84,128
TR 68,5,61440
v_cvt_pk_bf16_f32 v103, v150, v151
MA 180,76,100
TR 70,5,61952
v_mul_f32 v139, v107, v139
MA 180,80,116
TR 72,7,4096
v_mul_f32 v152, v120, v152
MA 180,84,132
TR 74,7,4608
v_mul_f32 v153, v121, v153
MA 184,76,104
buffer_load_dwordx4 v2, s[12:15], s51 offen lds
MA 184,80,120
s_add_u32 m0, s43, 0xa000
ds_write_b128 v11, v[100:103] offset:33792
MA 184,84,136
s_add_u32 s50, s44, 0x3f0180
v_exp_f32 v106, -v106
MA 188,76,108
v_exp_f32 v107, -v107
MA 188,80,124
v_exp_f32 v120, -v120
MA 188,84,140
buffer_load_dwordx4 v2, s[8:11], s50 offen lds
s_waitcnt lgkmcnt(1)
MA 192,64,96
s_add_u32 m0, s43, 0xb000
TR 76,6,53248
v_mul_f32 v154, v122, v154
MA 192,68,112
s_add_u32 s51, s44, 0x3f0180
TR 78,6,53760
v_mul_f32 v155, v123, v155
MA 192,72,128
TR 80,6,61440
v_add_f32 v104, 1.0, v104
MA 196,64,100
TR 82,6,61952
v_add_f32 v105, 1.0, v105
MA 196,68,116
TR 84,8,4096
v_add_f32 v106, 1.0, v106
MA 196,72,132
TR 86,8,4608
v_add_f32 v107, 1.0, v107
MA 200,64,104
buffer_load_dwordx4 v2, s[12:15], s51 offen lds
MA 200,68,120
v_exp_f32 v121, -v121
MA 200,72,136
v_exp_f32 v122, -v122
MA 204,64,108
v_exp_f32 v123, -v123
MA 204,68,124
v_rcp_f32 v104, v104
MA 204,72,140
v_add_f32 v120, 1.0, v120
s_waitcnt lgkmcnt(0)
MA 208,76,96
s_waitcnt vmcnt(6)
s_barrier
s_add_u32 m0, s43, 0xc000
v_rcp_f32 v105, v105
MA 208,80,112
s_add_u32 s50, s44, 0x438180
TR 64,5,0
v_add_f32 v121, 1.0, v121
MA 208,84,128
TR 66,5,512
v_add_f32 v122, 1.0, v122
MA 212,76,100
TR 68,5,8192
v_add_f32 v123, 1.0, v123
MA 212,80,116
TR 70,5,8704
v_mul_f32 v136, v136, v104
MA 212,84,132
TR 72,5,16384
v_mul_f32 v137, v137, v105
MA 216,76,104
TR 74,5,16896
v_cvt_pk_bf16_f32 v104, v136, v137
MA 216,80,120
buffer_load_dwordx4 v2, s[8:11], s50 offen lds
MA 216,84,136
s_add_u32 m0, s43, 0xd000
v_rcp_f32 v106, v106
MA 220,76,108
s_add_u32 s51, s44, 0x438180
v_rcp_f32 v107, v107
MA 220,80,124
v_rcp_f32 v120, v120
MA 220,84,140
v_mul_f32 v138, v138, v106
s_waitcnt lgkmcnt(0)
MA 160,64,144
TR 76,6,0
v_mul_f32 v139, v139, v107
MA 160,68,160
TR 78,6,512
v_mul_f32 v152, v152, v120
MA 160,72,176
TR 80,6,8192
v_cvt_pk_bf16_f32 v105, v138, v139
MA 164,64,148
TR 82,6,8704
v_mul_f32 v140, v108, v140
MA 164,68,164
TR 84,6,16384
v_mul_f32 v141, v109, v141
MA 164,72,180
TR 86,6,16896
v_mul_f32 v142, v110, v142
MA 168,64,152
buffer_load_dwordx4 v2, s[12:15], s51 offen lds
MA 168,68,168
s_add_u32 m0, s43, 0xe000
v_rcp_f32 v121, v121
MA 168,72,184
s_add_u32 s50, s44, 0x480180
v_rcp_f32 v122, v122
MA 172,64,156
v_rcp_f32 v123, v123
MA 172,68,172
v_exp_f32 v108, -v108
MA 172,72,188
buffer_load_dwordx4 v2, s[8:11], s50 offen lds
s_waitcnt lgkmcnt(0)
MA 176,76,144
s_add_u32 m0, s43, 0xf000
TR 64,5,4096
v_mul_f32 v153, v153, v121
MA 176,80,160
s_add_u32 s51, s44, 0x480180
TR 66,5,4608
v_mul_f32 v154, v154, v122
MA 176,84,176
TR 68,5,12288
v_mul_f32 v155, v155, v123
MA 180,76,148
TR 70,5,12800
v_cvt_pk_bf16_f32 v106, v152, v153
MA 180,80,164
TR 72,5,20480
v_cvt_pk_bf16_f32 v107, v154, v155
MA 180,84,180
TR 74,5,20992
v_mul_f32 v143, v111, v143
MA 184,76,152
buffer_load_dwordx4 v2, s[12:15], s51 offen lds
MA 184,80,168
s_add_u32 m0, s43, 0x10000
ds_write_b128 v11, v[104:107] offset:34816
MA 184,84,184
s_add_u32 s50, s44, 0x4c8180
v_exp_f32 v109, -v109
MA 188,76,156
v_exp_f32 v110, -v110
MA 188,80,172
v_exp_f32 v111, -v111
MA 188,84,188
buffer_load_dwordx4 v2, s[8:11], s50 offen lds
s_waitcnt lgkmcnt(1)
MA 192,64,144
s_add_u32 m0, s43, 0x11000
TR 76,6,4096
v_mul_f32 v156, v124, v156
MA 192,68,160
s_add_u32 s51, s44, 0x4c8180
TR 78,6,4608
v_mul_f32 v157, v125, v157
MA 192,72,176
TR 80,6,12288
v_mul_f32 v158, v126, v158
MA 196,64,148
TR 82,6,12800
v_mul_f32 v159, v127, v159
MA 196,68,164
TR 84,6,20480
v_add_f32 v108, 1.0, v108
MA 196,72,180
TR 86,6,20992
v_add_f32 v109, 1.0, v109
MA 200,64,152
buffer_load_dwordx4 v2, s[12:15], s51 offen lds
MA 200,68,168
v_exp_f32 v124, -v124
MA 200,72,184
v_exp_f32 v125, -v125
MA 204,64,156
v_exp_f32 v126, -v126
MA 204,68,172
v_exp_f32 v127, -v127
MA 204,72,188
v_add_f32 v110, 1.0, v110
s_waitcnt lgkmcnt(0)
MA 208,76,144
s_waitcnt vmcnt(6)
s_barrier
s_add_u32 m0, s43, 0x0
v_rcp_f32 v108, v108
MA 208,80,160
s_add_u32 s50, s44, 0x200
TR 64,5,24576
v_add_f32 v111, 1.0, v111
MA 208,84,176
TR 66,5,25088
v_add_f32 v124, 1.0, v124
MA 212,76,148
TR 68,5,32768
v_add_f32 v125, 1.0, v125
MA 212,80,164
TR 70,5,33280
v_add_f32 v126, 1.0, v126
MA 212,84,180
TR 72,5,40960
v_add_f32 v127, 1.0, v127
MA 216,76,152
TR 74,5,41472
v_mul_f32 v140, v140, v108
MA 216,80,168
buffer_load_dwordx4 v2, s[8:11], s50 offen lds
MA 216,84,184
s_add_u32 m0, s43, 0x1000
v_rcp_f32 v109, v109
MA 220,76,156
s_add_u32 s51, s44, 0x200
v_rcp_f32 v110, v110
MA 220,80,172
v_rcp_f32 v111, v111
MA 220,84,188
v_mul_f32 v141, v141, v109
s_waitcnt lgkmcnt(0)
MA 160,64,192
TR 76,6,24576
v_mul_f32 v142, v142, v110
MA 160,68,208
TR 78,6,25088
v_mul_f32 v143, v143, v111
MA 160,72,224
TR 80,6,32768
v_cvt_pk_bf16_f32 v108, v140, v141
MA 164,64,196
TR 82,6,33280
v_cvt_pk_bf16_f32 v109, v142, v143
MA 164,68,212
TR 84,6,40960
MA 164,72,228
TR 86,6,41472
MA 168,64,200
buffer_load_dwordx4 v2, s[12:15], s51 offen lds
MA 168,68,216
s_add_u32 m0, s43, 0x2000
v_rcp_f32 v124, v124
MA 168,72,232
s_add_u32 s50, s44, 0x48200
v_rcp_f32 v125, v125
MA 172,64,204
v_rcp_f32 v126, v126
MA 172,68,220
v_rcp_f32 v127, v127
MA 172,72,236
buffer_load_dwordx4 v2, s[8:11], s50 offen lds
s_waitcnt lgkmcnt(0)
MA 176,76,192
s_add_u32 m0, s43, 0x3000
TR 64,5,28672
v_mul_f32 v156, v156, v124
MA 176,80,208
s_add_u32 s51, s44, 0x48200
TR 66,5,29184
v_mul_f32 v157, v157, v125
MA 176,84,224
TR 68,5,36864
v_mul_f32 v158, v158, v126
MA 180,76,196
TR 70,5,37376
v_mul_f32 v159, v159, v127
MA 180,80,212
TR 72,5,45056
v_cvt_pk_bf16_f32 v110, v156, v157
MA 180,84,228
TR 74,5,45568
v_cvt_pk_bf16_f32 v111, v158, v159
MA 184,76,200
buffer_load_dwordx4 v2, s[12:15], s51 offen lds
MA 184,80,216
s_add_u32 m0, s43, 0x4000
ds_write_b128 v11, v[108:111] offset:35840
MA 184,84,232
s_add_u32 s50, s44, 0x90200
MA 188,76,204
MA 188,80,220
MA 188,84,236
buffer_load_dwordx4 v2, s[8:11], s50 offen lds
s_waitcnt lgkmcnt(1)
MA 192,64,192
s_add_u32 m0, s43, 0x5000
TR 76,6,28672
MA 192,68,208
s_add_u32 s51, s44, 0x90200
TR 78,6,29184
MA 192,72,224
TR 80,6,36864
MA 196,64,196
TR 82,6,37376
MA 196,68,212
TR 84,6,45056
MA 196,72,228
TR 86,6,45568
MA 200,64,200
buffer_load_dwordx4 v2, s[12:15], s51 offen lds
MA 200,68,216
MA 200,72,232
MA 204,64,204
MA 204,68,220
MA 204,72,236
s_waitcnt lgkmcnt(0)
MA 208,76,192
s_waitcnt vmcnt(6)
s_barrier
s_add_u32 m0, s43, 0x6000
MA 208,80,208
s_add_u32 s50, s44, 0xd8200
TR 64,5,49152
MA 208,84,224
TR 66,5,49664
MA 212,76,196
TR 68,5,57344
MA 212,80,212
TR 70,5,57856
MA 212,84,228
TR 72,7,0
MA 216,76,200
TR 74,7,512
MA 216,80,216
buffer_load_dwordx4 v2, s[8:11], s50 offen lds
MA 216,84,232
s_add_u32 m0, s43, 0x7000
MA 220,76,204
s_add_u32 s51, s44, 0xd8200
MA 220,80,220
MA 220,84,236
s_waitcnt lgkmcnt(0)
MA 160,64,240
TR 76,6,49152
v_mfma_f32_16x16x32_bf16 v[160:163], v[68:71], v[224:227], v[160:163]
TR 78,6,49664
v_mfma_f32_16x16x32_bf16 v[160:163], v[72:75], v[240:243], v[160:163]
TR 80,6,57344
MA 164,64,244
TR 82,6,57856
v_mfma_f32_16x16x32_bf16 v[164:167], v[68:71], v[228:231], v[164:167]
TR 84,8,0
v_mfma_f32_16x16x32_bf16 v[164:167], v[72:75], v[244:247], v[164:167]
TR 86,8,512
MA 168,64,248
buffer_load_dwordx4 v2, s[12:15], s51 offen lds
v_mfma_f32_16x16x32_bf16 v[168:171], v[68:71], v[232:235], v[168:171]
s_add_u32 m0, s43, 0x8000
v_mfma_f32_16x16x32_bf16 v[168:171], v[72:75], v[248:251], v[168:171]
s_add_u32 s50, s44, 0x120200
MA 172,64,252
v_mfma_f32_16x16x32_bf16 v[172:175], v[68:71], v[236:239], v[172:175]
v_mfma_f32_16x16x32_bf16 v[172:175], v[72:75], v[252:255], v[172:175]
buffer_load_dwordx4 v2, s[8:11], s50 offen lds
s_waitcnt lgkmcnt(0)
MA 176,76,240
s_add_u32 m0, s43, 0x9000
TR 64,5,53248
v_mfma_f32_16x16x32_bf16 v[176:179], v[80:83], v[224:227], v[176:179]
s_add_u32 s51, s44, 0x120200
TR 66,5,53760
v_mfma_f32_16x16x32_bf16 v[176:179], v[84:87], v[240:243], v[176:179]
TR 68,5,61440
MA 180,76,244
TR 70,5,61952
v_mfma_f32_16x16x32_bf16 v[180:183], v[80:83], v[228:231], v[180:183]
TR 72,7,4096
v_mfma_f32_16x16x32_bf16 v[180:183], v[84:87], v[244:247], v[180:183]
TR 74,7,4608
MA 184,76,248
buffer_load_dwordx4 v2, s[12:15], s51 offen lds
v_mfma_f32_16x16x32_bf16 v[184:187], v[80:83], v[232:235], v[184:187]
s_add_u32 m0, s43, 0xa000
v_mfma_f32_16x16x32_bf16 v[184:187], v[84:87], v[248:251], v[184:187]
s_add_u32 s50, s44, 0x168200
MA 188,76,252
v_mfma_f32_16x16x32_bf16 v[188:191], v[80:83], v[236:239], v[188:191]
v_mfma_f32_16x16x32_bf16 v[188:191], v[84:87], v[252:255], v[188:191]
buffer_load_dwordx4 v2, s[8:11], s50 offen lds
s_waitcnt lgkmcnt(0)
MA 192,64,240
s_add_u32 m0, s43, 0xb000
TR 76,6,53248
v_mfma_f32_16x16x32_bf16 v[192:195], v[68:71], v[224:227], v[192:195]
s_add_u32 s51, s44, 0x168200
TR 78,6,53760
v_mfma_f32_16x16x32_bf16 v[192:195], v[72:75], v[240:243], v[192:195]
TR 80,6,61440
MA 196,64,244
TR 82,6,61952
v_mfma_f32_16x16x32_bf16 v[196:199], v[68:71], v[228:231], v[196:199]
TR 84,8,4096
v_mfma_f32_16x16x32_bf16 v[196:199], v[72:75], v[244:247], v[196:199]
TR 86,8,4608
MA 200,64,248
buffer_load_dwordx4 v2, s[12:15], s51 offen lds
v_mfma_f32_16x16x32_bf16 v[200:203], v[68:71], v[232:235], v[200:203]
v_mfma_f32_16x16x32_bf16 v[200:203], v[72:75], v[248:251], v[200:203]
MA 204,64,252
v_mfma_f32_16x16x32_bf16 v[204:207], v[68:71], v[236:239], v[204:207]
v_mfma_f32_16x16x32_bf16 v[204:207], v[72:75], v[252:255], v[204:207]
s_waitcnt lgkmcnt(0)
MA 208,76,240
s_waitcnt vmcnt(6)
s_barrier
s_add_u32 m0, s43, 0xc000
v_mfma_f32_16x16x32_bf16 v[208:211], v[80:83], v[224:227], v[208:211]
s_add_u32 s50, s44, 0x1b0200
TR 64,5,0
v_mfma_f32_16x16x32_bf16 v[208:211], v[84:87], v[240:243], v[208:211]
TR 66,5,512
MA 212,76,244
TR 68,5,8192
v_mfma_f32_16x16x32_bf16 v[212:215], v[80:83], v[228:231], v[212:215]
TR 70,5,8704
v_mfma_f32_16x16x32_bf16 v[212:215], v[84:87], v[244:247], v[212:215]
TR 72,5,16384
MA 216,76,248
TR 74,5,16896
v_mfma_f32_16x16x32_bf16 v[216:219], v[80:83], v[232:235], v[216:219]
buffer_load_dwordx4 v2, s[8:11], s50 offen lds
v_mfma_f32_16x16x32_bf16 v[216:219], v[84:87], v[248:251], v[216:219]
s_add_u32 m0, s43, 0xd000
MA 220,76,252
s_add_u32 s51, s44, 0x1b0200
v_mfma_f32_16x16x32_bf16 v[220:223], v[80:83], v[236:239], v[220:223]
v_mfma_f32_16x16x32_bf16 v[220:223], v[84:87], v[252:255], v[220:223]
s_waitcnt lgkmcnt(0)
v_mfma_f32_16x16x32_bf16 v[96:99], v[64:67], a[0:3], 0
TR 76,6,0
MA 96,68,16
TR 78,6,512
MA 96,72,32
TR 80,6,8192
v_mfma_f32_16x16x32_bf16 v[100:103], v[64:67], a[4:7], 0
TR 82,6,8704
MA 100,68,20
TR 84,6,16384
v_mul_f32 v192, v160, v192
MA 100,72,36
TR 86,6,16896
v_mul_f32 v193, v161, v193
v_mfma_f32_16x16x32_bf16 v[104:107], v[64:67], a[8:11], 0
buffer_load_dwordx4 v2, s[12:15], s51 offen lds
MA 104,68,24
s_add_u32 m0, s43, 0xe000
v_exp_f32 v160, -v160
MA 104,72,40
s_add_u32 s50, s44, 0x1f8200
v_exp_f32 v161, -v161
v_mfma_f32_16x16x32_bf16 v[108:111], v[64:67], a[12:15], 0
v_mul_f32 v194, v162, v194
v_mul_f32 v195, v163, v195
MA 108,68,28
v_exp_f32 v162, -v162
MA 108,72,44
buffer_load_dwordx4 v2, s[8:11], s50 offen lds
s_waitcnt lgkmcnt(0)
v_mfma_f32_16x16x32_bf16 v[112:115], v[76:79], a[0:3], 0
s_add_u32 m0, s43, 0xf000
TR 64,5,4096
v_mul_f32 v208, v176, v208
MA 112,80,16
s_add_u32 s51, s44, 0x1f8200
TR 66,5,4608
v_mul_f32 v209, v177, v209
MA 112,84,32
TR 68,5,12288
v_mul_f32 v210, v178, v210
v_mfma_f32_16x16x32_bf16 v[116:119], v[76:79], a[4:7], 0
TR 70,5,12800
v_mul_f32 v211, v179, v211
MA 116,80,20
TR 72,5,20480
v_add_f32 v160, 1.0, v160
MA 116,84,36
TR 74,5,20992
v_add_f32 v161, 1.0, v161
v_mfma_f32_16x16x32_bf16 v[120:123], v[76:79], a[8:11], 0
buffer_load_dwordx4 v2, s[12:15], s51 offen lds
MA 120,80,24
s_add_u32 m0, s43, 0x10000
v_exp_f32 v163, -v163
MA 120,84,40
s_add_u32 s50, s44, 0x240200
v_exp_f32 v176, -v176
v_mfma_f32_16x16x32_bf16 v[124:127], v[76:79], a[12:15], 0
v_exp_f32 v177, -v177
MA 124,80,28
v_exp_f32 v178, -v178
MA 124,84,44
buffer_load_dwordx4 v2, s[8:11], s50 offen lds
s_waitcnt lgkmcnt(0)
v_mfma_f32_16x16x32_bf16 v[128:131], v[64:67], a[0:3], 0
s_add_u32 m0, s43, 0x11000
TR 76,6,4096
v_add_f32 v162, 1.0, v162
MA 128,68,16
s_add_u32 s51, s44, 0x240200
TR 78,6,4608
v_add_f32 v163, 1.0, v163
MA 128,72,32
TR 80,6,12288
v_add_f32 v176, 1.0, v176
v_mfma_f32_16x16x32_bf16 v[132:135], v[64:67], a[4:7], 0
TR 82,6,12800
v_add_f32 v177, 1.0, v177
MA 132,68,20
TR 84,6,20480
v_add_f32 v178, 1.0, v178
MA 132,72,36
TR 86,6,20992
v_mul_f32 v196, v164, v196
v_mfma_f32_16x16x32_bf16 v[136:139], v[64:67], a[8:11], 0
buffer_load_dwordx4 v2, s[12:15], s51 offen lds
MA 136,68,24
v_exp_f32 v179, -v179
MA 136,72,40
v_rcp_f32 v160, v160
v_mfma_f32_16x16x32_bf16 v[140:143], v[64:67], a[12:15], 0
v_rcp_f32 v161, v161
MA 140,68,28
v_rcp_f32 v162, v162
MA 140,72,44
v_add_f32 v179, 1.0, v179
s_waitcnt lgkmcnt(0)
v_mfma_f32_16x16x32_bf16 v[144:147], v[76:79], a[0:3], 0
s_waitcnt vmcnt(6)
s_barrier
s_add_u32 m0, s43, 0x0
v_rcp_f32 v163, v163
MA 144,80,16
s_add_u32 s50, s44, 0x288200
TR 64,5,24576
v_mul_f32 v192, v192, v160
MA 144,84,32
TR 66,5,25088
v_mul_f32 v193, v193, v161
v_mfma_f32_16x16x32_bf16 v[148:151], v[76:79], a[4:7], 0
TR 68,5,32768
v_mul_f32 v194, v194, v162
MA 148,80,20
TR 70,5,33280
v_mul_f32 v195, v195, v163
MA 148,84,36
TR 72,5,40960
v_cvt_pk_bf16_f32 v160, v192, v193
v_mfma_f32_16x16x32_bf16 v[152:155], v[76:79], a[8:11], 0
TR 74,5,41472
v_cvt_pk_bf16_f32 v161, v194, v195
MA 152,80,24
buffer_load_dwordx4 v2, s[8:11], s50 offen lds
MA 152,84,40
s_add_u32 m0, s43, 0x1000
v_rcp_f32 v176, v176
v_mfma_f32_16x16x32_bf16 v[156:159], v[76:79], a[12:15], 0
s_add_u32 s51, s44, 0x288200
v_rcp_f32 v177, v177
MA 156,80,28
v_rcp_f32 v178, v178
MA 156,84,44
v_mul_f32 v208, v208, v176
s_waitcnt lgkmcnt(0)
MA 96,64,48
TR 76,6,24576
v_mul_f32 v209, v209, v177
MA 96,68,64
TR 78,6,25088
v_mul_f32 v210, v210, v178
MA 96,72,80
TR 80,6,32768
v_cvt_pk_bf16_f32 v162, v208, v209
MA 100,64,52
TR 82,6,33280
v_mul_f32 v197, v165, v197
MA 100,68,68
TR 84,6,40960
v_mul_f32 v198, v166, v198
MA 100,72,84
TR 86,6,41472
v_mul_f32 v199, v167, v199
MA 104,64,56
buffer_load_dwordx4 v2, s[12:15], s51 offen lds
MA 104,68,72
s_add_u32 m0, s43, 0x2000
ds_read_b128 a[0:3], v12 offset:0
v_mul_f32 v212, v180, v212
MA 104,72,88
s_add_u32 s50, s44, 0x2d0200
ds_read_b128 a[4:7], v12 offset:1024
v_mul_f32 v213, v181, v213
MA 108,64,60
ds_read_b128 a[8:11], v12 offset:2048
v_mul_f32 v214, v182, v214
MA 108,68,76
ds_read_b128 a[12:15], v12 offset:3072
v_mul_f32 v215, v183, v215
MA 108,72,92
buffer_load_dwordx4 v2, s[8:11], s50 offen lds
s_waitcnt lgkmcnt(4)
MA 112,76,48
s_add_u32 m0, s43, 0x3000
TR 64,5,28672
MA 112,80,64
s_add_u32 s51, s44, 0x2d0200
TR 66,5,29184
MA 112,84,80
TR 68,5,36864
MA 116,76,52
TR 70,5,37376
MA 116,80,68
TR 72,5,45056
MA 116,84,84
TR 74,5,45568
MA 120,76,56
buffer_load_dwordx4 v2, s[12:15], s51 offen lds
MA 120,80,72
s_add_u32 m0, s43, 0x4000
ds_read_b128 a[16:19], v12 offset:8192
MA 120,84,88
s_add_u32 s50, s44, 0x318200
ds_read_b128 a[20:23], v12 offset:9216
MA 124,76,60
ds_read_b128 a[24:27], v12 offset:10240
MA 124,80,76
ds_read_b128 a[28:31], v12 offset:11264
MA 124,84,92
buffer_load_dwordx4 v2, s[8:11], s50 offen lds
s_waitcnt lgkmcnt(4)
MA 128,64,48
s_add_u32 m0, s43, 0x5000
TR 76,6,28672
MA 128,68,64
s_add_u32 s51, s44, 0x318200
TR 78,6,29184
MA 128,72,80
TR 80,6,36864
MA 132,64,52
TR 82,6,37376
MA 132,68,68
TR 84,6,45056
MA 132,72,84
TR 86,6,45568
MA 136,64,56
buffer_load_dwordx4 v2, s[12:15], s51 offen lds
MA 136,68,72
ds_read_b128 a[32:35], v12 offset:16384
MA 136,72,88
ds_read_b128 a[36:39], v12 offset:17408
MA 140,64,60
v_rcp_f32 v179, v179
MA 140,68,76
v_exp_f32 v164, -v164
MA 140,72,92
v_mul_f32 v211, v211, v179
s_waitcnt lgkmcnt(2)
MA 144,76,48
s_waitcnt vmcnt(6)
s_waitcnt lgkmcnt(0)
s_barrier
s_add_u32 m0, s43, 0x6000
ds_read_b128 a[40:43], v12 offset:18432
MA 144,80,64
s_add_u32 s50, s44, 0x360200
TR 64,5,49152
v_cvt_pk_bf16_f32 v163, v210, v211
MA 144,84,80
TR 66,5,49664
v_add_f32 v164, 1.0, v164
MA 148,76,52
TR 68,5,57344
MA 148,80,68
TR 70,5,57856
MA 148,84,84
TR 72,7,0
MA 152,76,56
TR 74,7,512
MA 152,80,72
buffer_load_dwordx4 v2, s[8:11], s50 offen lds
MA 152,84,88
s_add_u32 m0, s43, 0x7000
ds_write_b128 v11, v[160:163] offset:49152
MA 156,76,60
s_add_u32 s51, s44, 0x360200
ds_read_b128 a[44:47], v12 offset:19456
MA 156,80,76
v_exp_f32 v165, -v165
MA 156,84,92
v_add_f32 v165, 1.0, v165
s_waitcnt lgkmcnt(2)
MA 96,64,96
TR 76,6,49152
MA 96,68,112
TR 78,6,49664
MA 96,72,128
TR 80,6,57344
MA 100,64,100
TR 82,6,57856
MA 100,68,116
TR 84,8,0
MA 100,72,132
TR 86,8,512
MA 104,64,104
buffer_load_dwordx4 v2, s[12:15], s51 offen lds
MA 104,68,120
s_add_u32 m0, s43, 0x8000
ds_read_b128 a[48:51], v12 offset:24576
MA 104,72,136
s_add_u32 s50, s44, 0x3a8200
ds_read_b128 a[52:55], v12 offset:25600
MA 108,64,108
ds_read_b128 a[56:59], v12 offset:26624
MA 108,68,124
ds_read_b128 a[60:63], v12 offset:27648
MA 108,72,140
buffer_load_dwordx4 v2, s[8:11], s50 offen lds
s_waitcnt lgkmcnt(4)
MA 112,76,96
s_add_u32 m0, s43, 0x9000
TR 64,5,53248
MA 112,80,112
s_add_u32 s51, s44, 0x3a8200
TR 66,5,53760
MA 112,84,128
TR 68,5,61440
MA 116,76,100
TR 70,5,61952
MA 116,80,116
TR 72,7,4096
MA 116,84,132
TR 74,7,4608
MA 120,76,104
buffer_load_dwordx4 v2, s[12:15], s51 offen lds
MA 120,80,120
s_add_u32 m0, s43, 0xa000
ds_read_b128 a[64:67], v12 offset:32768
MA 120,84,136
s_add_u32 s50, s44, 0x3f0200
ds_read_b128 a[68:71], v12 offset:33792
MA 124,76,108
ds_read_b128 a[72:75], v12 offset:34816
MA 124,80,124
ds_read_b128 a[76:79], v12 offset:35840
MA 124,84,140
buffer_load_dwordx4 v2, s[8:11], s50 offen lds
s_waitcnt lgkmcnt(4)
MA 128,64,96
s_add_u32 m0, s43, 0xb000
TR 76,6,53248
MA 128,68,112
s_add_u32 s51, s44, 0x3f0200
TR 78,6,53760
MA 128,72,128
TR 80,6,61440
MA 132,64,100
TR 82,6,61952
MA 132,68,116
TR 84,8,4096
MA 132,72,132
TR 86,8,4608
MA 136,64,104
buffer_load_dwordx4 v2, s[12:15], s51 offen lds
MA 136,68,120
ds_read_b128 a[80:83], v12 offset:40960
MA 136,72,136
ds_read_b128 a[84:87], v12 offset:41984
MA 140,64,108
v_exp_f32 v166, -v166
MA 140,68,124
v_exp_f32 v167, -v167
MA 140,72,140
v_add_f32 v166, 1.0, v166
s_waitcnt lgkmcnt(2)
MA 144,76,96
s_waitcnt vmcnt(6)
s_waitcnt lgkmcnt(0)
s_barrier
s_add_u32 m0, s43, 0xc000
ds_read_b128 a[88:91], v12 offset:43008
MA 144,80,112
s_add_u32 s50, s44, 0x438200
TR 64,5,0
v_add_f32 v167, 1.0, v167
MA 144,84,128
TR 66,5,512
MA 148,76,100
TR 68,5,8192
MA 148,80,116
TR 70,5,8704
MA 148,84,132
TR 72,5,16384
MA 152,76,104
TR 74,5,16896
MA 152,80,120
buffer_load_dwordx4 v2, s[8:11], s50 offen lds
MA 152,84,136
s_add_u32 m0, s43, 0xd000
ds_read_b128 a[92:95], v12 offset:44032
MA 156,76,108
s_add_u32 s51, s44, 0x438200
v_exp_f32 v180, -v180
MA 156,80,124
v_exp_f32 v181, -v181
MA 156,84,140
v_add_f32 v180, 1.0, v180
s_waitcnt lgkmcnt(1)
MA 96,64,144
TR 76,6,0
v_add_f32 v181, 1.0, v181
MA 96,68,160
TR 78,6,512
MA 96,72,176
TR 80,6,8192
MA 100,64,148
TR 82,6,8704
MA 100,68,164
TR 84,6,16384
MA 100,72,180
TR 86,6,16896
MA 104,64,152
buffer_load_dwordx4 v2, s[12:15], s51 offen lds
MA 104,68,168
s_add_u32 m0, s43, 0xe000
v_exp_f32 v182, -v182
MA 104,72,184
s_add_u32 s50, s44, 0x480200
v_exp_f32 v183, -v183
MA 108,64,156
v_rcp_f32 v164, v164
MA 108,68,172
v_rcp_f32 v165, v165
MA 108,72,188
buffer_load_dwordx4 v2, s[8:11], s50 offen lds
s_waitcnt lgkmcnt(0)
MA 112,76,144
s_add_u32 m0, s43, 0xf000
TR 64,5,4096
v_add_f32 v182, 1.0, v182
MA 112,80,160
s_add_u32 s51, s44, 0x480200
TR 66,5,4608
v_add_f32 v183, 1.0, v183
MA 112,84,176
TR 68,5,12288
v_mul_f32 v196, v196, v164
MA 116,76,148
TR 70,5,12800
v_mul_f32 v197, v197, v165
MA 116,80,164
TR 72,5,20480
v_cvt_pk_bf16_f32 v164, v196, v197
MA 116,84,180
TR 74,5,20992
v_mul_f32 v200, v168, v200
MA 120,76,152
buffer_load_dwordx4 v2, s[12:15], s51 offen lds
MA 120,80,168
s_add_u32 m0, s43, 0x10000
v_rcp_f32 v166, v166
MA 120,84,184
s_add_u32 s50, s44, 0x4c8200
v_rcp_f32 v167, v167
MA 124,76,156
v_rcp_f32 v180, v180
MA 124,80,172
v_rcp_f32 v181, v181
MA 124,84,188
buffer_load_dwordx4 v2, s[8:11], s50 offen lds
s_waitcnt lgkmcnt(0)
MA 128,64,144
s_add_u32 m0, s43, 0x11000
TR 76,6,4096
v_mul_f32 v198, v198, v166
MA 128,68,160
s_add_u32 s51, s44, 0x4c8200
TR 78,6,4608
v_mul_f32 v199, v199, v167
MA 128,72,176
TR 80,6,12288
v_mul_f32 v212, v212, v180
MA 132,64,148
TR 82,6,12800
v_mul_f32 v213, v213, v181
MA 132,68,164
TR 84,6,20480
v_cvt_pk_bf16_f32 v165, v198, v199
MA 132,72,180
TR 86,6,20992
v_cvt_pk_bf16_f32 v166, v212, v213
MA 136,64,152
buffer_load_dwordx4 v2, s[12:15], s51 offen lds
MA 136,68,168
v_rcp_f32 v182, v182
MA 136,72,184
v_rcp_f32 v183, v183
MA 140,64,156
v_exp_f32 v168, -v168
MA 140,68,172
v_mul_f32 v214, v214, v182
v_mul_f32 v215, v215, v183
MA 140,72,188
v_cvt_pk_bf16_f32 v167, v214, v215
s_waitcnt lgkmcnt(0)
MA 144,76,144
s_waitcnt vmcnt(6)
s_barrier
s_add_u32 m0, s43, 0x0
ds_write_b128 v11, v[164:167] offset:50176
MA 144,80,160
s_add_u32 s50, s45, 0x0
TR 64,5,24576
v_mul_f32 v201, v169, v201
MA 144,84,176
TR 66,5,25088
v_mul_f32 v202, v170, v202
MA 148,76,148
TR 68,5,32768
v_mul_f32 v203, v171, v203
MA 148,80,164
TR 70,5,33280
v_mul_f32 v216, v184, v216
MA 148,84,180
TR 72,5,40960
v_mul_f32 v217, v185, v217
MA 152,76,152
TR 74,5,41472
v_mul_f32 v218, v186, v218
MA 152,80,168
buffer_load_dwordx4 v3, s[16:19], s50 offen lds
MA 152,84,184
s_add_u32 m0, s43, 0x1000
v_exp_f32 v169, -v169
MA 156,76,156
s_add_u32 s51, s45, 0x9000
v_exp_f32 v170, -v170
MA 156,80,172
v_exp_f32 v171, -v171
MA 156,84,188
v_mul_f32 v219, v187, v219
s_waitcnt lgkmcnt(0)
MA 96,64,192
TR 76,6,24576
v_add_f32 v168, 1.0, v168
MA 96,68,208
TR 78,6,25088
v_add_f32 v169, 1.0, v169
MA 96,72,224
TR 80,6,32768
v_add_f32 v170, 1.0, v170
MA 100,64,196
TR 82,6,33280
v_add_f32 v171, 1.0, v171
MA 100,68,212
TR 84,6,40960
MA 100,72,228
TR 86,6,41472
MA 104,64,200
buffer_load_dwordx4 v3, s[16:19], s51 offen lds
MA 104,68,216
s_add_u32 m0, s43, 0x2000
v_exp_f32 v184, -v184
MA 104,72,232
s_add_u32 s50, s45, 0x12000
v_exp_f32 v185, -v185
MA 108,64,204
v_exp_f32 v186, -v186
MA 108,68,220
v_exp_f32 v187, -v187
MA 108,72,236
buffer_load_dwordx4 v3, s[16:19], s50 offen lds
s_waitcnt lgkmcnt(0)
MA 112,76,192
s_add_u32 m0, s43, 0x3000
TR 64,5,28672
v_add_f32 v184, 1.0, v184
MA 112,80,208
s_add_u32 s51, s45, 0x1b000
TR 66,5,29184
v_add_f32 v185, 1.0, v185
MA 112,84,224
TR 68,5,36864
v_add_f32 v186, 1.0, v186
MA 116,76,196
TR 70,5,37376
v_add_f32 v187, 1.0, v187
MA 116,80,212
TR 72,5,45056
v_mul_f32 v204, v172, v204
MA 116,84,228
TR 74,5,45568
v_mul_f32 v205, v173, v205
MA 120,76,200
buffer_load_dwordx4 v3, s[16:19], s51 offen lds
MA 120,80,216
s_add_u32 m0, s43, 0x4000
v_rcp_f32 v168, v168
MA 120,84,232
s_add_u32 s50, s45, 0x24000
v_rcp_f32 v169, v169
MA 124,76,204
v_rcp_f32 v170, v170
MA 124,80,220
v_rcp_f32 v171, v171
MA 124,84,236
buffer_load_dwordx4 v3, s[16:19], s50 offen lds
s_waitcnt lgkmcnt(0)
MA 128,64,192
s_add_u32 m0, s43, 0x5000
TR 76,6,28672
v_mul_f32 v200, v200, v168
MA 128,68,208
s_add_u32 s51, s45, 0x2d000
TR 78,6,29184
v_mul_f32 v201, v201, v169
MA 128,72,224
TR 80,6,36864
v_mul_f32 v202, v202, v170
MA 132,64,196
TR 82,6,37376
v_mul_f32 v203, v203, v171
MA 132,68,212
TR 84,6,45056
v_cvt_pk_bf16_f32 v168, v200, v201
MA 132,72,228
TR 86,6,45568
v_cvt_pk_bf16_f32 v169, v202, v203
MA 136,64,200
buffer_load_dwordx4 v3, s[16:19], s51 offen lds
MA 136,68,216
v_rcp_f32 v184, v184
MA 136,72,232
v_rcp_f32 v185, v185
MA 140,64,204
v_rcp_f32 v186, v186
MA 140,68,220
v_rcp_f32 v187, v187
MA 140,72,236
v_mul_f32 v216, v216, v184
s_waitcnt lgkmcnt(0)
MA 144,76,192
s_waitcnt vmcnt(6)
s_barrier
s_add_u32 m0, s43, 0x6000
v_exp_f32 v172, -v172
MA 144,80,208
s_add_u32 s50, s45, 0x36000
TR 64,5,49152
v_mul_f32 v217, v217, v185
MA 144,84,224
TR 66,5,49664
v_mul_f32 v218, v218, v186
MA 148,76,196
TR 68,5,57344
v_mul_f32 v219, v219, v187
MA 148,80,212
TR 70,5,57856
v_cvt_pk_bf16_f32 v170, v216, v217
MA 148,84,228
TR 72,7,0
v_cvt_pk_bf16_f32 v171, v218, v219
MA 152,76,200
TR 74,7,512
v_mul_f32 v206, v174, v206
MA 152,80,216
buffer_load_dwordx4 v3, s[16:19], s50 offen lds
MA 152,84,232
s_add_u32 m0, s43, 0x7000
ds_write_b128 v11, v[168:171] offset:51200
MA 156,76,204
s_add_u32 s51, s45, 0x3f000
v_exp_f32 v173, -v173
MA 156,80,220
v_exp_f32 v174, -v174
MA 156,84,236
v_mul_f32 v207, v175, v207
s_waitcnt lgkmcnt(1)
MA 96,64,240
TR 76,6,49152
v_mul_f32 v220, v188, v220
v_mfma_f32_16x16x32_bf16 v[96:99], v[68:71], v[224:227], v[96:99]
TR 78,6,49664
v_mul_f32 v221, v189, v221
v_mfma_f32_16x16x32_bf16 v[96:99], v[72:75], v[240:243], v[96:99]
TR 80,6,57344
v_mul_f32 v222, v190, v222
MA 100,64,244
TR 82,6,57856
v_mul_f32 v223, v191, v223
v_mfma_f32_16x16x32_bf16 v[100:103], v[68:71], v[228:231], v[100:103]
TR 84,8,0
v_add_f32 v172, 1.0, v172
v_mfma_f32_16x16x32_bf16 v[100:103], v[72:75], v[244:247], v[100:103]
TR 86,8,512
v_add_f32 v173, 1.0, v173
MA 104,64,248
buffer_load_dwordx4 v3, s[16:19], s51 offen lds
v_mfma_f32_16x16x32_bf16 v[104:107], v[68:71], v[232:235], v[104:107]
s_add_u32 m0, s43, 0x8000
v_exp_f32 v175, -v175
v_mfma_f32_16x16x32_bf16 v[104:107], v[72:75], v[248:251], v[104:107]
s_add_u32 s50, s45, 0x80
v_exp_f32 v188, -v188
MA 108,64,252
v_exp_f32 v189, -v189
v_mfma_f32_16x16x32_bf16 v[108:111], v[68:71], v[236:239], v[108:111]
v_exp_f32 v190, -v190
v_mfma_f32_16x16x32_bf16 v[108:111], v[72:75], v[252:255], v[108:111]
buffer_load_dwordx4 v3, s[16:19], s50 offen lds
s_waitcnt lgkmcnt(0)
MA 112,76,240
s_add_u32 m0, s43, 0x9000
TR 64,5,53248
v_add_f32 v174, 1.0, v174
v_mfma_f32_16x16x32_bf16 v[112:115], v[80:83], v[224:227], v[112:115]
s_add_u32 s51, s45, 0x9080
TR 66,5,53760
v_add_f32 v175, 1.0, v175
v_mfma_f32_16x16x32_bf16 v[112:115], v[84:87], v[240:243], v[112:115]
TR 68,5,61440
v_add_f32 v188, 1.0, v188
MA 116,76,244
TR 70,5,61952
v_add_f32 v189, 1.0, v189
v_mfma_f32_16x16x32_bf16 v[116:119], v[80:83], v[228:231], v[116:119]
TR 72,7,4096
v_add_f32 v190, 1.0, v190
v_mfma_f32_16x16x32_bf16 v[116:119], v[84:87], v[244:247], v[116:119]
TR 74,7,4608
MA 120,76,248
buffer_load_dwordx4 v3, s[16:19], s51 offen lds
v_mfma_f32_16x16x32_bf16 v[120:123], v[80:83], v[232:235], v[120:123]
s_add_u32 m0, s43, 0xa000
v_exp_f32 v191, -v191
v_mfma_f32_16x16x32_bf16 v[120:123], v[84:87], v[248:251], v[120:123]
s_add_u32 s50, s45, 0x12080
v_rcp_f32 v172, v172
MA 124,76,252
v_rcp_f32 v173, v173
v_mfma_f32_16x16x32_bf16 v[124:127], v[80:83], v[236:239], v[124:127]
v_rcp_f32 v174, v174
v_mfma_f32_16x16x32_bf16 v[124:127], v[84:87], v[252:255], v[124:127]
buffer_load_dwordx4 v3, s[16:19], s50 offen lds
s_waitcnt lgkmcnt(0)
MA 128,64,240
s_add_u32 m0, s43, 0xb000
TR 76,6,53248
v_add_f32 v191, 1.0, v191
v_mfma_f32_16x16x32_bf16 v[128:131], v[68:71], v[224:227], v[128:131]
s_add_u32 s51, s45, 0x1b080
TR 78,6,53760
v_mul_f32 v204, v204, v172
v_mfma_f32_16x16x32_bf16 v[128:131], v[72:75], v[240:243], v[128:131]
TR 80,6,61440
v_mul_f32 v205, v205, v173
MA 132,64,244
TR 82,6,61952
v_mul_f32 v206, v206, v174
v_mfma_f32_16x16x32_bf16 v[132:135], v[68:71], v[228:231], v[132:135]
TR 84,8,4096
v_cvt_pk_bf16_f32 v172, v204, v205
v_mfma_f32_16x16x32_bf16 v[132:135], v[72:75], v[244:247], v[132:135]
TR 86,8,4608
MA 136,64,248
buffer_load_dwordx4 v3, s[16:19], s51 offen lds
v_mfma_f32_16x16x32_bf16 v[136:139], v[68:71], v[232:235], v[136:139]
v_rcp_f32 v175, v175
v_mfma_f32_16x16x32_bf16 v[136:139], v[72:75], v[248:251], v[136:139]
v_rcp_f32 v188, v188
MA 140,64,252
v_rcp_f32 v189, v189
v_mfma_f32_16x16x32_bf16 v[140:143], v[68:71], v[236:239], v[140:143]
v_rcp_f32 v190, v190
v_mfma_f32_16x16x32_bf16 v[140:143], v[72:75], v[252:255], v[140:143]
v_mul_f32 v207, v207, v175
s_waitcnt lgkmcnt(0)
MA 144,76,240
s_waitcnt vmcnt(6)
s_barrier
L_A_p2:
v_bfe_u32 v88, v0, 4, 2
v_bfe_u32 v89, v0, 2, 2
v_lshlrev_b32 v5, 9, v88
v_lshl_add_u32 v5, v89, 7, v5
v_and_b32 v88, 1, v88
v_lshlrev_b32 v88, 1, v88
v_lshrrev_b32 v89, 1, v89
v_or_b32 v88, v88, v89
v_xor_b32 v88, s80, v88
v_lshl_add_u32 v5, v88, 5, v5
v_and_b32 v88, 3, v0
v_lshl_add_u32 v5, v88, 3, v5
v_xor_b32 v6, 32, v5
v_add_u32 v7, 0x10000, v5
v_add_u32 v8, 0x10000, v6
s_add_u32 m0, s43, 0xc000
v_rcp_f32 v191, v191
v_mfma_f32_16x16x32_bf16 v[144:147], v[80:83], v[224:227], v[144:147]
s_add_u32 s50, s45, 0x24080
TR 64,5,0
v_mul_f32 v220, v220, v188
v_mfma_f32_16x16x32_bf16 v[144:147], v[84:87], v[240:243], v[144:147]
TR 66,5,2048
v_mul_f32 v221, v221, v189
MA 148,76,244
TR 68,5,4096
v_mul_f32 v222, v222, v190
v_mfma_f32_16x16x32_bf16 v[148:151], v[80:83], v[228:231], v[148:151]
TR 70,5,6144
v_mul_f32 v223, v223, v191
v_mfma_f32_16x16x32_bf16 v[148:151], v[84:87], v[244:247], v[148:151]
TR 72,5,8192
v_cvt_pk_bf16_f32 v173, v206, v207
MA 152,76,248
TR 74,5,10240
v_cvt_pk_bf16_f32 v174, v220, v221
v_mfma_f32_16x16x32_bf16 v[152:155], v[80:83], v[232:235], v[152:155]
buffer_load_dwordx4 v3, s[16:19], s50 offen lds
v_mfma_f32_16x16x32_bf16 v[152:155], v[84:87], v[248:251], v[152:155]
s_add_u32 m0, s43, 0xd000
v_cvt_pk_bf16_f32 v175, v222, v223
MA 156,76,252
s_add_u32 s51, s45, 0x2d080
ds_write_b128 v11, v[172:175] offset:52224
v_mfma_f32_16x16x32_bf16 v[156:159], v[80:83], v[236:239], v[156:159]
v_mfma_f32_16x16x32_bf16 v[156:159], v[84:87], v[252:255], v[156:159]
s_waitcnt lgkmcnt(1)
v_mfma_f32_16x16x32_bf16 v[160:163], v[64:67], a[0:3], 0
TR 76,6,0
MA 160,68,16
TR 78,6,2048
MA 160,72,32
TR 80,6,4096
v_mfma_f32_16x16x32_bf16 v[164:167], v[64:67], a[4:7], 0
TR 82,6,6144
MA 164,68,20
TR 84,6,8192
v_mul_f32 v128, v96, v128
v_mul_f32 v129, v97, v129
MA 164,72,36
TR 86,6,10240
v_exp_f32 v96, -v96
v_mfma_f32_16x16x32_bf16 v[168:171], v[64:67], a[8:11], 0
buffer_load_dwordx4 v3, s[16:19], s51 offen lds
MA 168,68,24
s_add_u32 m0, s43, 0xe000
v_exp_f32 v97, -v97
v_mul_f32 v130, v98, v130
MA 168,72,40
s_add_u32 s50, s45, 0x36080
v_exp_f32 v98, -v98
v_mul_f32 v131, v99, v131
v_mfma_f32_16x16x32_bf16 v[172:175], v[64:67], a[12:15], 0
v_exp_f32 v99, -v99
v_mul_f32 v144, v112, v144
MA 172,68,28
v_exp_f32 v112, -v112
v_mul_f32 v145, v113, v145
MA 172,72,44
buffer_load_dwordx4 v3, s[16:19], s50 offen lds
s_waitcnt lgkmcnt(0)
v_mfma_f32_16x16x32_bf16 v[176:179], v[76:79], a[0:3], 0
s_add_u32 m0, s43, 0xf000
TR 64,5,12288
v_exp_f32 v113, -v113
MA 176,80,16
s_add_u32 s51, s45, 0x3f080
TR 66,5,14336
v_mul_f32 v146, v114, v146
v_mul_f32 v147, v115, v147
MA 176,84,32
TR 68,5,16384
v_exp_f32 v114, -v114
v_mfma_f32_16x16x32_bf16 v[180:183], v[76:79], a[4:7], 0
TR 70,5,18432
v_exp_f32 v115, -v115
MA 180,80,20
TR 72,5,20480
v_add_f32 v96, 1.0, v96
v_add_f32 v97, 1.0, v97
MA 180,84,36
TR 74,5,22528
v_rcp_f32 v96, v96
v_mfma_f32_16x16x32_bf16 v[184:187], v[76:79], a[8:11], 0
buffer_load_dwordx4 v3, s[16:19], s51 offen lds
MA 184,80,24
s_add_u32 m0, s43, 0x10000
v_rcp_f32 v97, v97
v_add_f32 v98, 1.0, v98
MA 184,84,40
s_add_u32 s50, s45, 0x48000
v_rcp_f32 v98, v98
v_add_f32 v99, 1.0, v99
v_mfma_f32_16x16x32_bf16 v[188:191], v[76:79], a[12:15], 0
v_rcp_f32 v99, v99
v_add_f32 v112, 1.0, v112
MA 188,80,28
v_rcp_f32 v112, v112
v_add_f32 v113, 1.0, v113
MA 188,84,44
buffer_load_dwordx4 v3, s[16:19], s50 offen lds
s_waitcnt lgkmcnt(0)
MA 160,64,48
s_add_u32 m0, s43, 0x11000
TR 76,6,12288
v_rcp_f32 v113, v113
MA 160,68,64
s_add_u32 s51, s45, 0x51000
TR 78,6,14336
v_add_f32 v114, 1.0, v114
v_add_f32 v115, 1.0, v115
MA 160,72,80
TR 80,6,16384
v_rcp_f32 v114, v114
MA 164,64,52
TR 82,6,18432
v_rcp_f32 v115, v115
MA 164,68,68
TR 84,6,20480
v_mul_f32 v128, v128, v96
v_mul_f32 v129, v129, v97
MA 164,72,84
TR 86,6,22528
v_mul_f32 v130, v130, v98
v_mul_f32 v131, v131, v99
MA 168,64,56
buffer_load_dwordx4 v3, s[16:19], s51 offen lds
MA 168,68,72
v_mul_f32 v144, v144, v112
v_mul_f32 v145, v145, v113
v_mul_f32 v146, v146, v114
MA 168,72,88
v_mul_f32 v147, v147, v115
v_cvt_pk_bf16_f32 v96, v128, v129
v_cvt_pk_bf16_f32 v97, v130, v131
MA 172,64,60
v_cvt_pk_bf16_f32 v98, v144, v145
v_cvt_pk_bf16_f32 v99, v146, v147
v_add_u32 v15, 0x10000, v11
MA 172,68,76
v_mul_f32 v132, v100, v132
v_exp_f32 v100, -v100
MA 172,72,92
v_mul_f32 v133, v101, v133
v_mul_f32 v134, v102, v134
s_waitcnt lgkmcnt(0)
MA 176,76,48
s_waitcnt vmcnt(6)
s_barrier
s_add_u32 m0, s43, 0x0
ds_read_b128 a[96:99], v12 offset:49152
v_exp_f32 v101, -v101
MA 176,80,64
s_add_u32 s50, s45, 0x48080
TR 64,5,24576
v_exp_f32 v102, -v102
MA 176,84,80
TR 66,5,26624
v_mul_f32 v135, v103, v135
v_mul_f32 v148, v116, v148
MA 180,76,52
TR 68,5,28672
v_exp_f32 v103, -v103
MA 180,80,68
TR 70,5,30720
v_exp_f32 v116, -v116
MA 180,84,84
TR 72,5,32768
v_mul_f32 v149, v117, v149
v_mul_f32 v150, v118, v150
MA 184,76,56
TR 74,5,34816
v_exp_f32 v117, -v117
MA 184,80,72
buffer_load_dwordx4 v3, s[16:19], s50 offen lds
MA 184,84,88
s_add_u32 m0, s43, 0x1000
ds_read_b128 a[100:103], v12 offset:50176
v_exp_f32 v118, -v118
MA 188,76,60
s_add_u32 s51, s45, 0x51080
ds_read_b128 a[104:107], v12 offset:51200
v_mul_f32 v151, v119, v151
v_add_f32 v100, 1.0, v100
MA 188,80,76
ds_read_b128 a[108:111], v12 offset:52224
v_exp_f32 v119, -v119
MA 188,84,92
ds_read_b128 a[112:115], v12 offset:57344
v_add_f32 v101, 1.0, v101
s_waitcnt lgkmcnt(4)
MA 160,64,96
TR 76,6,24576
v_rcp_f32 v100, v100
s_waitcnt lgkmcnt(1)
MA 160,68,112
TR 78,6,26624
v_rcp_f32 v101, v101
v_mfma_f32_16x16x32_bf16 v[192:195], v[72:75], a[0:3], 0
TR 80,6,28672
v_add_f32 v102, 1.0, v102
v_add_f32 v103, 1.0, v103
MA 164,64,100
TR 82,6,30720
v_rcp_f32 v102, v102
ds_read_b128 a[116:119], v12 offset:58368
s_waitcnt lgkmcnt(0)
MA 164,68,116
TR 84,6,32768
v_rcp_f32 v103, v103
v_mfma_f32_16x16x32_bf16 v[196:199], v[72:75], a[4:7], 0
TR 86,6,34816
v_add_f32 v116, 1.0, v116
v_add_f32 v117, 1.0, v117
MA 168,64,104
buffer_load_dwordx4 v3, s[16:19], s51 offen lds
ds_read_b128 a[120:123], v12 offset:59392
s_waitcnt lgkmcnt(0)
MA 168,68,120
s_add_u32 m0, s43, 0x2000
ds_read_b128 a[124:127], v12 offset:60416
v_rcp_f32 v116, v116
v_mfma_f32_16x16x32_bf16 v[200:203], v[72:75], a[8:11], 0
s_add_u32 s50, s45, 0x100
ds_write_b128 v15, v[96:99] offset:0
v_add_f32 v118, 1.0, v118
MA 172,64,108
v_rcp_f32 v117, v117
v_add_f32 v119, 1.0, v119
s_waitcnt lgkmcnt(1)
MA 172,68,124
v_rcp_f32 v118, v118
v_mul_f32 v132, v132, v100
v_mfma_f32_16x16x32_bf16 v[204:207], v[72:75], a[12:15], 0
buffer_load_dwordx4 v3, s[16:19], s50 offen lds
MA 176,76,96
s_add_u32 m0, s43, 0x3000
TR 64,5,36864
v_rcp_f32 v119, v119
MA 176,80,112
s_add_u32 s51, s45, 0x9100
TR 66,5,38912
v_mul_f32 v133, v133, v101
v_mul_f32 v134, v134, v102
v_mfma_f32_16x16x32_bf16 v[208:211], v[84:87], a[0:3], 0
TR 68,5,40960
v_mul_f32 v135, v135, v103
v_mul_f32 v148, v148, v116
MA 180,76,100
TR 70,5,43008
v_mul_f32 v149, v149, v117
v_mul_f32 v150, v150, v118
MA 180,80,116
TR 72,5,45056
v_mul_f32 v151, v151, v119
v_cvt_pk_bf16_f32 v100, v132, v133
v_mfma_f32_16x16x32_bf16 v[212:215], v[84:87], a[4:7], 0
TR 74,5,47104
v_cvt_pk_bf16_f32 v101, v134, v135
v_cvt_pk_bf16_f32 v102, v148, v149
MA 184,76,104
buffer_load_dwordx4 v3, s[16:19], s51 offen lds
MA 184,80,120
s_add_u32 m0, s43, 0x4000
v_cvt_pk_bf16_f32 v103, v150, v151
v_mul_f32 v136, v104, v136
v_mul_f32 v137, v105, v137
v_mfma_f32_16x16x32_bf16 v[216:219], v[84:87], a[8:11], 0
s_add_u32 s50, s45, 0x12100
ds_write_b128 v15, v[100:103] offset:1024
v_mul_f32 v138, v106, v138
MA 188,76,108
v_exp_f32 v104, -v104
v_mul_f32 v139, v107, v139
MA 188,80,124
v_exp_f32 v105, -v105
v_mul_f32 v152, v120, v152
v_mfma_f32_16x16x32_bf16 v[220:223], v[84:87], a[12:15], 0
buffer_load_dwordx4 v3, s[16:19], s50 offen lds
s_waitcnt lgkmcnt(1)
MA 192,64,16
s_add_u32 m0, s43, 0x5000
TR 76,6,36864
v_exp_f32 v106, -v106
MA 192,68,32
s_add_u32 s51, s45, 0x1b100
TR 78,6,38912
v_exp_f32 v107, -v107
MA 192,72,48
TR 80,6,40960
v_exp_f32 v120, -v120
MA 196,64,20
TR 82,6,43008
v_mul_f32 v153, v121, v153
v_mul_f32 v154, v122, v154
MA 196,68,36
TR 84,6,45056
v_exp_f32 v121, -v121
MA 196,72,52
TR 86,6,47104
v_exp_f32 v122, -v122
MA 200,64,24
buffer_load_dwordx4 v3, s[16:19], s51 offen lds
MA 200,68,40
v_mul_f32 v155, v123, v155
v_exp_f32 v123, -v123
MA 200,72,56
v_add_f32 v104, 1.0, v104
v_rcp_f32 v104, v104
MA 204,64,28
v_add_f32 v105, 1.0, v105
v_rcp_f32 v105, v105
MA 204,68,44
v_add_f32 v106, 1.0, v106
v_rcp_f32 v106, v106
MA 204,72,60
v_add_f32 v107, 1.0, v107
v_add_f32 v120, 1.0, v120
s_waitcnt lgkmcnt(0)
MA 208,76,16
s_waitcnt vmcnt(6)
s_barrier
s_add_u32 m0, s43, 0x6000
v_rcp_f32 v107, v107
v_add_f32 v121, 1.0, v121
MA 208,80,32
s_add_u32 s50, s45, 0x24100
TR 64,5,49152
v_rcp_f32 v120, v120
MA 208,84,48
TR 66,5,51200
v_rcp_f32 v121, v121
MA 212,76,20
TR 68,5,53248
v_add_f32 v122, 1.0, v122
v_add_f32 v123, 1.0, v123
MA 212,80,36
TR 70,5,55296
v_rcp_f32 v122, v122
MA 212,84,52
TR 72,5,57344
v_rcp_f32 v123, v123
MA 216,76,24
TR 74,5,59392
v_mul_f32 v136, v136, v104
v_mul_f32 v137, v137, v105
MA 216,80,40
buffer_load_dwordx4 v3, s[16:19], s50 offen lds
MA 216,84,56
s_add_u32 m0, s43, 0x7000
v_mul_f32 v138, v138, v106
v_mul_f32 v139, v139, v107
v_mul_f32 v152, v152, v120
MA 220,76,28
s_add_u32 s51, s45, 0x2d100
v_mul_f32 v153, v153, v121
v_mul_f32 v154, v154, v122
v_mul_f32 v155, v155, v123
MA 220,80,44
v_cvt_pk_bf16_f32 v104, v136, v137
v_cvt_pk_bf16_f32 v105, v138, v139
v_cvt_pk_bf16_f32 v106, v152, v153
MA 220,84,60
v_cvt_pk_bf16_f32 v107, v154, v155
v_mul_f32 v140, v108, v140
s_waitcnt lgkmcnt(0)
MA 192,64,64
TR 76,6,49152
v_exp_f32 v108, -v108
MA 192,68,80
TR 78,6,51200
v_mul_f32 v141, v109, v141
v_mul_f32 v142, v110, v142
MA 192,72,96
TR 80,6,53248
v_exp_f32 v109, -v109
MA 196,64,68
TR 82,6,55296
v_exp_f32 v110, -v110
MA 196,68,84
TR 84,6,57344
v_mul_f32 v143, v111, v143
v_mul_f32 v156, v124, v156
MA 196,72,100
TR 86,6,59392
v_exp_f32 v111, -v111
MA 200,64,72
buffer_load_dwordx4 v3, s[16:19], s51 offen lds
MA 200,68,88
s_add_u32 m0, s43, 0x8000
ds_write_b128 v15, v[104:107] offset:2048
v_mul_f32 v157, v125, v157
MA 200,72,104
s_add_u32 s50, s45, 0x36100
v_exp_f32 v124, -v124
v_mul_f32 v158, v126, v158
MA 204,64,76
v_exp_f32 v125, -v125
v_mul_f32 v159, v127, v159
MA 204,68,92
v_exp_f32 v126, -v126
v_add_f32 v108, 1.0, v108
MA 204,72,108
buffer_load_dwordx4 v3, s[16:19], s50 offen lds
s_waitcnt lgkmcnt(1)
MA 208,76,64
s_add_u32 m0, s43, 0x9000
TR 64,5,61440
v_exp_f32 v127, -v127
MA 208,80,80
s_add_u32 s51, s45, 0x3f100
TR 66,5,63488
v_rcp_f32 v108, v108
MA 208,84,96
TR 68,7,0
v_add_f32 v109, 1.0, v109
v_add_f32 v110, 1.0, v110
MA 212,76,68
TR 70,7,2048
v_rcp_f32 v109, v109
MA 212,80,84
TR 72,7,4096
v_rcp_f32 v110, v110
MA 212,84,100
TR 74,7,6144
v_add_f32 v111, 1.0, v111
v_add_f32 v124, 1.0, v124
MA 216,76,72
buffer_load_dwordx4 v3, s[16:19], s51 offen lds
MA 216,80,88
s_add_u32 m0, s43, 0xa000
v_rcp_f32 v111, v111
v_add_f32 v125, 1.0, v125
MA 216,84,104
s_add_u32 s50, s45, 0x48100
v_rcp_f32 v124, v124
v_add_f32 v126, 1.0, v126
MA 220,76,76
v_rcp_f32 v125, v125
v_add_f32 v127, 1.0, v127
MA 220,80,92
v_rcp_f32 v126, v126
v_mul_f32 v140, v140, v108
MA 220,84,108
buffer_load_dwordx4 v3, s[16:19], s50 offen lds
s_waitcnt lgkmcnt(0)
MA 192,64,112
s_add_u32 m0, s43, 0xb000
TR 76,6,61440
v_rcp_f32 v127, v127
v_mul_f32 v141, v141, v109
v_mul_f32 v142, v142, v110
v_mul_f32 v143, v143, v111
v_mul_f32 v156, v156, v124
v_mul_f32 v157, v157, v125
v_mul_f32 v158, v158, v126
v_mul_f32 v159, v159, v127
v_cvt_pk_bf16_f32 v108, v140, v141
v_cvt_pk_bf16_f32 v109, v142, v143
v_cvt_pk_bf16_f32 v110, v156, v157
v_cvt_pk_bf16_f32 v111, v158, v159
ds_write_b128 v15, v[108:111] offset:3072
s_waitcnt lgkmcnt(0)
s_barrier
ds_read_b128 a[128:131], v13 offset:0
s_waitcnt lgkmcnt(0)
MA 160,68,128
s_add_u32 s51, s45, 0x51100
TR 78,6,63488
ds_read_b128 a[132:135], v13 offset:1024
ds_read_b128 a[136:139], v13 offset:2048
ds_read_b128 a[140:143], v13 offset:3072
ds_read_b128 a[144:147], v13 offset:8192
s_waitcnt lgkmcnt(0)
MA 160,72,144
TR 80,8,0
MA 196,64,116
TR 82,8,2048
MA 164,68,132
TR 84,8,4096
ds_read_b128 a[148:151], v13 offset:9216
s_waitcnt lgkmcnt(0)
MA 164,72,148
TR 86,8,6144
MA 200,64,120
buffer_load_dwordx4 v3, s[16:19], s51 offen lds
MA 168,68,136
ds_read_b128 a[152:155], v13 offset:10240
s_waitcnt lgkmcnt(0)
MA 168,72,152
ds_read_b128 a[156:159], v13 offset:11264
MA 204,64,124
MA 172,68,140
s_waitcnt lgkmcnt(0)
MA 172,72,156
MA 208,76,112
s_waitcnt vmcnt(6)
s_barrier
s_add_u32 m0, s43, 0xc000
MA 176,80,128
s_add_u32 s50, s45, 0x180
TR 64,5,0
MA 176,84,144
TR 66,5,2048
MA 212,76,116
TR 68,5,4096
MA 180,80,132
TR 70,5,6144
MA 180,84,148
TR 72,5,8192
MA 216,76,120
TR 74,5,10240
MA 184,80,136
buffer_load_dwordx4 v3, s[16:19], s50 offen lds
MA 184,84,152
s_add_u32 m0, s43, 0xd000
MA 220,76,124
s_add_u32 s51, s45, 0x9180
MA 188,80,140
MA 188,84,156
v_min_u32 v48, 1, v0
v_mov_b32 v49, 1
v_lshlrev_b32 v48, 31, v48
s_waitcnt lgkmcnt(0)
MA 192,64,128
TR 76,6,0
MA 192,68,144
TR 78,6,2048
v_mfma_f32_16x16x32_bf16 v[224:227], v[72:75], a[0:3], 0
TR 80,6,4096
MA 196,64,132
TR 82,6,6144
MA 196,68,148
TR 84,6,8192
s_add_u32 s96, s49, 0x0
v_cvt_pk_bf16_f32 v96, v160, v161
v_mfma_f32_16x16x32_bf16 v[228:231], v[72:75], a[4:7], 0
TR 86,6,10240
v_cvt_pk_bf16_f32 v97, v162, v163
MA 200,64,136
buffer_load_dwordx4 v3, s[16:19], s51 offen lds
MA 200,68,152
s_add_u32 m0, s43, 0xe000
v_cvt_pk_bf16_f32 v98, v176, v177
v_cvt_pk_bf16_f32 v99, v178, v179
v_mfma_f32_16x16x32_bf16 v[232:235], v[72:75], a[8:11], 0
s_add_u32 s50, s45, 0x12180
buffer_store_dwordx4 v[96:99], v14, s[20:23], s96 offen offset:0 sc1
MA 204,64,140
v_cvt_pk_bf16_f32 v100, v164, v165
v_cvt_pk_bf16_f32 v101, v166, v167
MA 204,68,156
v_cvt_pk_bf16_f32 v102, v180, v181
v_cvt_pk_bf16_f32 v103, v182, v183
v_mfma_f32_16x16x32_bf16 v[236:239], v[72:75], a[12:15], 0
buffer_load_dwordx4 v3, s[16:19], s50 offen lds
s_waitcnt lgkmcnt(0)
MA 208,76,128
s_add_u32 m0, s43, 0xf000
TR 64,5,12288
v_cvt_pk_bf16_f32 v104, v168, v169
MA 208,80,144
s_add_u32 s51, s45, 0x1b180
TR 66,5,14336
v_cvt_pk_bf16_f32 v105, v170, v171
v_mfma_f32_16x16x32_bf16 v[240:243], v[84:87], a[0:3], 0
TR 68,5,16384
v_cvt_pk_bf16_f32 v106, v184, v185
MA 212,76,132
TR 70,5,18432
v_cvt_pk_bf16_f32 v107, v186, v187
MA 212,80,148
TR 72,5,20480
v_cvt_pk_bf16_f32 v108, v172, v173
v_mfma_f32_16x16x32_bf16 v[244:247], v[84:87], a[4:7], 0
TR 74,5,22528
v_cvt_pk_bf16_f32 v109, v174, v175
MA 216,76,136
buffer_load_dwordx4 v3, s[16:19], s51 offen lds
MA 216,80,152
s_add_u32 m0, s43, 0x10000
buffer_store_dwordx4 v[100:103], v14, s[20:23], s96 offen offset:1024 sc1
v_mfma_f32_16x16x32_bf16 v[248:251], v[84:87], a[8:11], 0
s_add_u32 s50, s45, 0x24180
v_cvt_pk_bf16_f32 v110, v188, v189
v_cvt_pk_bf16_f32 v111, v190, v191
MA 220,76,140
MA 220,80,156
v_mfma_f32_16x16x32_bf16 v[252:255], v[84:87], a[12:15], 0
buffer_load_dwordx4 v3, s[16:19], s50 offen lds
s_waitcnt lgkmcnt(0)
MA 224,64,16
s_add_u32 m0, s43, 0x11000
TR 76,6,12288
MA 224,68,32
s_add_u32 s51, s45, 0x2d180
TR 78,6,14336
MA 224,72,48
TR 80,6,16384
MA 228,64,20
TR 82,6,18432
MA 228,68,36
TR 84,6,20480
s_add_u32 s97, s49, 0x4000
v_cvt_pk_bf16_f32 v112, v192, v193
MA 228,72,52
TR 86,6,22528
v_cvt_pk_bf16_f32 v113, v194, v195
MA 232,64,24
buffer_load_dwordx4 v3, s[16:19], s51 offen lds
MA 232,68,40
buffer_store_dwordx4 v[104:107], v14, s[20:23], s96 offen offset:2048 sc1
MA 232,72,56
v_cvt_pk_bf16_f32 v114, v208, v209
v_cvt_pk_bf16_f32 v115, v210, v211
MA 236,64,28
v_cvt_pk_bf16_f32 v116, v196, v197
v_cvt_pk_bf16_f32 v117, v198, v199
MA 236,68,44
v_cvt_pk_bf16_f32 v118, v212, v213
v_cvt_pk_bf16_f32 v119, v214, v215
MA 236,72,60
v_cvt_pk_bf16_f32 v120, v200, v201
s_waitcnt lgkmcnt(0)
MA 240,76,16
s_waitcnt vmcnt(9)
s_barrier
s_add_u32 m0, s43, 0x0
v_cvt_pk_bf16_f32 v121, v202, v203
MA 240,80,32
s_add_u32 s50, s45, 0x36180
TR 64,5,24576
v_cvt_pk_bf16_f32 v122, v216, v217
MA 240,84,48
TR 66,5,26624
v_cvt_pk_bf16_f32 v123, v218, v219
MA 244,76,20
TR 68,5,28672
v_cvt_pk_bf16_f32 v124, v204, v205
MA 244,80,36
TR 70,5,30720
v_cvt_pk_bf16_f32 v125, v206, v207
MA 244,84,52
TR 72,5,32768
v_cvt_pk_bf16_f32 v126, v220, v221
MA 248,76,24
TR 74,5,34816
v_cvt_pk_bf16_f32 v127, v222, v223
MA 248,80,40
buffer_load_dwordx4 v3, s[16:19], s50 offen lds
MA 248,84,56
s_add_u32 m0, s43, 0x1000
buffer_store_dwordx4 v[108:111], v14, s[20:23], s96 offen offset:3072 sc1
MA 252,76,28
s_add_u32 s51, s45, 0x3f180
MA 252,80,44
MA 252,84,60
s_waitcnt lgkmcnt(0)
MA 224,64,64
TR 76,6,24576
MA 224,68,80
TR 78,6,26624
MA 224,72,96
TR 80,6,28672
MA 228,64,68
TR 82,6,30720
MA 228,68,84
TR 84,6,32768
MA 228,72,100
TR 86,6,34816
MA 232,64,72
buffer_load_dwordx4 v3, s[16:19], s51 offen lds
MA 232,68,88
s_add_u32 m0, s43, 0x2000
buffer_store_dwordx4 v[112:115], v14, s[20:23], s97 offen offset:0 sc1
MA 232,72,104
s_add_u32 s50, s45, 0x48180
MA 236,64,76
MA 236,68,92
MA 236,72,108
buffer_load_dwordx4 v3, s[16:19], s50 offen lds
s_waitcnt lgkmcnt(0)
MA 240,76,64
s_add_u32 m0, s43, 0x3000
TR 64,5,36864
MA 240,80,80
s_add_u32 s51, s45, 0x51180
TR 66,5,38912
MA 240,84,96
TR 68,5,40960
MA 244,76,68
TR 70,5,43008
MA 244,80,84
TR 72,5,45056
MA 244,84,100
TR 74,5,47104
MA 248,76,72
buffer_load_dwordx4 v3, s[16:19], s51 offen lds
MA 248,80,88
s_add_u32 m0, s43, 0x4000
buffer_store_dwordx4 v[116:119], v14, s[20:23], s97 offen offset:1024 sc1
MA 248,84,104
s_add_u32 s50, s45, 0x200
MA 252,76,76
MA 252,80,92
MA 252,84,108
buffer_load_dwordx4 v3, s[16:19], s50 offen lds
s_waitcnt lgkmcnt(0)
MA 224,64,112
s_add_u32 m0, s43, 0x5000
TR 76,6,36864
MA 224,68,128
s_add_u32 s51, s45, 0x9200
TR 78,6,38912
MA 224,72,144
TR 80,6,40960
MA 228,64,116
TR 82,6,43008
MA 228,68,132
TR 84,6,45056
MA 228,72,148
TR 86,6,47104
MA 232,64,120
buffer_load_dwordx4 v3, s[16:19], s51 offen lds
MA 232,68,136
buffer_store_dwordx4 v[120:123], v14, s[20:23], s97 offen offset:2048 sc1
MA 232,72,152
MA 236,64,124
MA 236,68,140
MA 236,72,156
s_waitcnt lgkmcnt(0)
MA 240,76,112
s_waitcnt vmcnt(11)
s_barrier
s_add_u32 m0, s43, 0x6000
MA 240,80,128
s_add_u32 s50, s45, 0x12200
TR 64,5,49152
MA 240,84,144
TR 66,5,51200
MA 244,76,116
TR 68,5,53248
MA 244,80,132
TR 70,5,55296
MA 244,84,148
TR 72,5,57344
MA 248,76,120
TR 74,5,59392
MA 248,80,136
buffer_load_dwordx4 v3, s[16:19], s50 offen lds
MA 248,84,152
s_add_u32 m0, s43, 0x7000
buffer_store_dwordx4 v[124:127], v14, s[20:23], s97 offen offset:3072 sc1
MA 252,76,124
s_add_u32 s51, s45, 0x1b200
MA 252,80,140
MA 252,84,156
s_waitcnt lgkmcnt(0)
v_mfma_f32_16x16x32_bf16 v[160:163], v[64:67], a[0:3], 0
TR 76,6,49152
MA 160,68,16
TR 78,6,51200
MA 160,72,32
TR 80,6,53248
v_mfma_f32_16x16x32_bf16 v[164:167], v[64:67], a[4:7], 0
TR 82,6,55296
MA 164,68,20
TR 84,6,57344
s_add_u32 s98, s49, 0x8000
v_cvt_pk_bf16_f32 v128, v224, v225
MA 164,72,36
TR 86,6,59392
v_cvt_pk_bf16_f32 v129, v226, v227
v_mfma_f32_16x16x32_bf16 v[168:171], v[64:67], a[8:11], 0
buffer_load_dwordx4 v3, s[16:19], s51 offen lds
MA 168,68,24
s_add_u32 m0, s43, 0x8000
v_cvt_pk_bf16_f32 v130, v240, v241
v_cvt_pk_bf16_f32 v131, v242, v243
MA 168,72,40
s_add_u32 s50, s45, 0x24200
buffer_store_dwordx4 v[128:131], v14, s[20:23], s98 offen offset:0 sc1
s_waitcnt vmcnt(12)
s_nop 0
v_mfma_f32_16x16x32_bf16 v[172:175], v[64:67], a[12:15], 0
v_cvt_pk_bf16_f32 v132, v228, v229
v_cvt_pk_bf16_f32 v133, v230, v231
MA 172,68,28
v_cvt_pk_bf16_f32 v134, v244, v245
v_cvt_pk_bf16_f32 v135, v246, v247
MA 172,72,44
buffer_load_dwordx4 v3, s[16:19], s50 offen lds
s_waitcnt lgkmcnt(0)
v_mfma_f32_16x16x32_bf16 v[176:179], v[76:79], a[0:3], 0
s_add_u32 m0, s43, 0x9000
TR 64,5,61440
v_cvt_pk_bf16_f32 v136, v232, v233
MA 176,80,16
s_add_u32 s51, s45, 0x2d200
TR 66,5,63488
v_cvt_pk_bf16_f32 v137, v234, v235
MA 176,84,32
TR 68,7,0
v_cvt_pk_bf16_f32 v138, v248, v249
v_mfma_f32_16x16x32_bf16 v[180:183], v[76:79], a[4:7], 0
TR 70,7,2048
v_cvt_pk_bf16_f32 v139, v250, v251
MA 180,80,20
TR 72,7,4096
v_cvt_pk_bf16_f32 v140, v236, v237
MA 180,84,36
TR 74,7,6144
v_cvt_pk_bf16_f32 v141, v238, v239
v_mfma_f32_16x16x32_bf16 v[184:187], v[76:79], a[8:11], 0
buffer_load_dwordx4 v3, s[16:19], s51 offen lds
MA 184,80,24
s_add_u32 m0, s43, 0xa000
buffer_store_dwordx4 v[132:135], v14, s[20:23], s98 offen offset:1024 sc1
MA 184,84,40
s_add_u32 s50, s45, 0x36200
v_cvt_pk_bf16_f32 v142, v252, v253
v_cvt_pk_bf16_f32 v143, v254, v255
v_mfma_f32_16x16x32_bf16 v[188:191], v[76:79], a[12:15], 0
MA 188,80,28
MA 188,84,44
buffer_load_dwordx4 v3, s[16:19], s50 offen lds
s_waitcnt lgkmcnt(0)
MA 160,64,48
s_add_u32 m0, s43, 0xb000
TR 76,6,61440
MA 160,68,64
s_add_u32 s51, s45, 0x3f200
TR 78,6,63488
MA 160,72,80
TR 80,8,0
MA 164,64,52
TR 82,8,2048
MA 164,68,68
TR 84,8,4096
MA 164,72,84
TR 86,8,6144
MA 168,64,56
buffer_load_dwordx4 v3, s[16:19], s51 offen lds
MA 168,68,72
buffer_store_dwordx4 v[136:139], v14, s[20:23], s98 offen offset:2048 sc1
MA 168,72,88
MA 172,64,60
MA 172,68,76
MA 172,72,92
s_waitcnt lgkmcnt(0)
MA 176,76,48
s_waitcnt vmcnt(11)
s_barrier
s_add_u32 m0, s43, 0xc000
buffer_store_dword v49, v48, s[20:23], s54 offen offset:0 sc1
MA 176,80,64
s_add_u32 s50, s45, 0x48200
TR 64,5,0
MA 176,84,80
TR 66,5,2048
MA 180,76,52
TR 68,5,4096
MA 180,80,68
TR 70,5,6144
MA 180,84,84
TR 72,5,8192
MA 184,76,56
TR 74,5,10240
MA 184,80,72
buffer_load_dwordx4 v3, s[16:19], s50 offen lds
MA 184,84,88
s_add_u32 m0, s43, 0xd000
buffer_store_dwordx4 v[140:143], v14, s[20:23], s98 offen offset:3072 sc1
MA 188,76,60
s_add_u32 s51, s45, 0x51200
MA 188,80,76
MA 188,84,92
s_waitcnt lgkmcnt(0)
MA 160,64,96
TR 76,6,0
MA 160,68,112
TR 78,6,2048
MA 160,72,128
TR 80,6,4096
MA 164,64,100
TR 82,6,6144
MA 164,68,116
TR 84,6,8192
MA 164,72,132
TR 86,6,10240
MA 168,64,104
buffer_load_dwordx4 v3, s[16:19], s51 offen lds
MA 168,68,120
s_add_u32 m0, s43, 0xe000
MA 168,72,136
s_add_u32 s50, s45, 0x280
s_waitcnt vmcnt(12)
s_nop 0
MA 172,64,108
MA 172,68,124
MA 172,72,140
buffer_load_dwordx4 v3, s[16:19], s50 offen lds
s_waitcnt lgkmcnt(0)
MA 176,76,96
s_add_u32 m0, s43, 0xf000
TR 64,5,12288
MA 176,80,112
s_add_u32 s51, s45, 0x9280
TR 66,5,14336
MA 176,84,128
TR 68,5,16384
MA 180,76,100
TR 70,5,18432
MA 180,80,116
TR 72,5,20480
MA 180,84,132
TR 74,5,22528
MA 184,76,104
buffer_load_dwordx4 v3, s[16:19], s51 offen lds
MA 184,80,120
s_add_u32 m0, s43, 0x10000
MA 184,84,136
s_add_u32 s50, s45, 0x12280
MA 188,76,108
MA 188,80,124
MA 188,84,140
buffer_load_dwordx4 v3, s[16:19], s50 offen lds
s_waitcnt lgkmcnt(0)
MA 160,64,144
s_add_u32 m0, s43, 0x11000
TR 76,6,12288
v_mfma_f32_16x16x32_bf16 v[192:195], v[68:71], a[0:3], 0
s_add_u32 s51, s45, 0x1b280
TR 78,6,14336
MA 192,72,16
TR 80,6,16384
MA 164,64,148
TR 82,6,18432
v_mfma_f32_16x16x32_bf16 v[196:199], v[68:71], a[4:7], 0
TR 84,6,20480
MA 196,72,20
TR 86,6,22528
MA 168,64,152
buffer_load_dwordx4 v3, s[16:19], s51 offen lds
v_mfma_f32_16x16x32_bf16 v[200:203], v[68:71], a[8:11], 0
MA 200,72,24
MA 172,64,156
v_mfma_f32_16x16x32_bf16 v[204:207], v[68:71], a[12:15], 0
MA 204,72,28
s_waitcnt lgkmcnt(0)
MA 176,76,144
s_waitcnt vmcnt(9)
s_barrier
s_add_u32 m0, s43, 0x0
buffer_store_dword v49, v48, s[20:23], s54 offen offset:4 sc1
v_mfma_f32_16x16x32_bf16 v[208:211], v[80:83], a[0:3], 0
s_add_u32 s50, s45, 0x24280
TR 64,5,24576
MA 208,84,16
TR 66,5,26624
MA 180,76,148
TR 68,5,28672
v_mfma_f32_16x16x32_bf16 v[212:215], v[80:83], a[4:7], 0
TR 70,5,30720
MA 212,84,20
TR 72,5,32768
MA 184,76,152
TR 74,5,34816
v_mfma_f32_16x16x32_bf16 v[216:219], v[80:83], a[8:11], 0
buffer_load_dwordx4 v3, s[16:19], s50 offen lds
MA 216,84,24
s_add_u32 m0, s43, 0x1000
MA 188,76,156
s_add_u32 s51, s45, 0x2d280
v_mfma_f32_16x16x32_bf16 v[220:223], v[80:83], a[12:15], 0
MA 220,84,28
s_waitcnt lgkmcnt(0)
MA 192,64,32
TR 76,6,24576
MA 192,68,48
TR 78,6,26624
MA 192,72,64
TR 80,6,28672
MA 196,64,36
TR 82,6,30720
MA 196,68,52
TR 84,6,32768
s_add_u32 s99, s49, 0xc000
v_cvt_pk_bf16_f32 v144, v160, v161
MA 196,72,68
TR 86,6,34816
v_cvt_pk_bf16_f32 v145, v162, v163
MA 200,64,40
buffer_load_dwordx4 v3, s[16:19], s51 offen lds
MA 200,68,56
s_add_u32 m0, s43, 0x2000
v_cvt_pk_bf16_f32 v146, v176, v177
v_cvt_pk_bf16_f32 v147, v178, v179
MA 200,72,72
s_add_u32 s50, s45, 0x36280
buffer_store_dwordx4 v[144:147], v14, s[20:23], s99 offen offset:0 sc1
s_waitcnt vmcnt(9)
s_nop 0
MA 204,64,44
v_cvt_pk_bf16_f32 v148, v164, v165
v_cvt_pk_bf16_f32 v149, v166, v167
MA 204,68,60
v_cvt_pk_bf16_f32 v150, v180, v181
v_cvt_pk_bf16_f32 v151, v182, v183
MA 204,72,76
buffer_load_dwordx4 v3, s[16:19], s50 offen lds
s_waitcnt lgkmcnt(0)
MA 208,76,32
s_add_u32 m0, s43, 0x3000
TR 64,5,36864
v_cvt_pk_bf16_f32 v152, v168, v169
MA 208,80,48
s_add_u32 s51, s45, 0x3f280
TR 66,5,38912
v_cvt_pk_bf16_f32 v153, v170, v171
MA 208,84,64
TR 68,5,40960
v_cvt_pk_bf16_f32 v154, v184, v185
MA 212,76,36
TR 70,5,43008
v_cvt_pk_bf16_f32 v155, v186, v187
MA 212,80,52
TR 72,5,45056
v_cvt_pk_bf16_f32 v156, v172, v173
MA 212,84,68
TR 74,5,47104
v_cvt_pk_bf16_f32 v157, v174, v175
MA 216,76,40
buffer_load_dwordx4 v3, s[16:19], s51 offen lds
MA 216,80,56
s_add_u32 m0, s43, 0x4000
buffer_store_dwordx4 v[148:151], v14, s[20:23], s99 offen offset:1024 sc1
MA 216,84,72
s_add_u32 s50, s45, 0x48280
v_cvt_pk_bf16_f32 v158, v188, v189
v_cvt_pk_bf16_f32 v159, v190, v191
MA 220,76,44
MA 220,80,60
MA 220,84,76
buffer_load_dwordx4 v3, s[16:19], s50 offen lds
s_waitcnt lgkmcnt(0)
MA 192,64,80
s_add_u32 m0, s43, 0x5000
TR 76,6,36864
MA 192,68,96
s_add_u32 s51, s45, 0x51280
TR 78,6,38912
MA 192,72,112
TR 80,6,40960
MA 196,64,84
TR 82,6,43008
MA 196,68,100
TR 84,6,45056
MA 196,72,116
TR 86,6,47104
MA 200,64,88
buffer_load_dwordx4 v3, s[16:19], s51 offen lds
MA 200,68,104
buffer_store_dwordx4 v[152:155], v14, s[20:23], s99 offen offset:2048 sc1
MA 200,72,120
MA 204,64,92
MA 204,68,108
MA 204,72,124
s_waitcnt lgkmcnt(0)
MA 208,76,80
s_waitcnt vmcnt(10)
s_barrier
s_add_u32 m0, s43, 0x6000
buffer_store_dword v49, v48, s[20:23], s54 offen offset:8 sc1
MA 208,80,96
s_add_u32 s50, s45, 0x300
TR 64,5,49152
MA 208,84,112
TR 66,5,51200
MA 212,76,84
TR 68,5,53248
MA 212,80,100
TR 70,5,55296
MA 212,84,116
TR 72,5,57344
MA 216,76,88
TR 74,5,59392
MA 216,80,104
buffer_load_dwordx4 v3, s[16:19], s50 offen lds
MA 216,84,120
s_add_u32 m0, s43, 0x7000
buffer_store_dwordx4 v[156:159], v14, s[20:23], s99 offen offset:3072 sc1
MA 220,76,92
s_add_u32 s51, s45, 0x9300
MA 220,80,108
MA 220,84,124
s_waitcnt lgkmcnt(0)
MA 192,64,128
TR 76,6,49152
MA 192,68,144
TR 78,6,51200
v_mfma_f32_16x16x32_bf16 v[224:227], v[72:75], a[0:3], 0
TR 80,6,53248
MA 196,64,132
TR 82,6,55296
MA 196,68,148
TR 84,6,57344
v_mfma_f32_16x16x32_bf16 v[228:231], v[72:75], a[4:7], 0
TR 86,6,59392
MA 200,64,136
buffer_load_dwordx4 v3, s[16:19], s51 offen lds
MA 200,68,152
s_add_u32 m0, s43, 0x8000
v_mfma_f32_16x16x32_bf16 v[232:235], v[72:75], a[8:11], 0
s_add_u32 s50, s45, 0x12300
MA 204,64,140
MA 204,68,156
v_mfma_f32_16x16x32_bf16 v[236:239], v[72:75], a[12:15], 0
buffer_load_dwordx4 v3, s[16:19], s50 offen lds
s_waitcnt lgkmcnt(0)
MA 208,76,128
s_add_u32 m0, s43, 0x9000
TR 64,5,61440
MA 208,80,144
s_add_u32 s51, s45, 0x1b300
TR 66,5,63488
v_mfma_f32_16x16x32_bf16 v[240:243], v[84:87], a[0:3], 0
TR 68,7,0
MA 212,76,132
TR 70,7,2048
MA 212,80,148
TR 72,7,4096
v_mfma_f32_16x16x32_bf16 v[244:247], v[84:87], a[4:7], 0
TR 74,7,6144
MA 216,76,136
buffer_load_dwordx4 v3, s[16:19], s51 offen lds
MA 216,80,152
s_add_u32 m0, s43, 0xa000
v_mfma_f32_16x16x32_bf16 v[248:251], v[84:87], a[8:11], 0
s_add_u32 s50, s45, 0x24300
MA 220,76,140
MA 220,80,156
v_mfma_f32_16x16x32_bf16 v[252:255], v[84:87], a[12:15], 0
buffer_load_dwordx4 v3, s[16:19], s50 offen lds
s_waitcnt lgkmcnt(0)
MA 224,64,16
s_add_u32 m0, s43, 0xb000
TR 76,6,61440
MA 224,68,32
s_add_u32 s51, s45, 0x2d300
TR 78,6,63488
MA 224,72,48
TR 80,8,0
MA 228,64,20
TR 82,8,2048
MA 228,68,36
TR 84,8,4096
s_add_u32 s96, s49, 0x10000
v_cvt_pk_bf16_f32 v96, v192, v193
MA 228,72,52
TR 86,8,6144
v_cvt_pk_bf16_f32 v97, v194, v195
MA 232,64,24
buffer_load_dwordx4 v3, s[16:19], s51 offen lds
MA 232,68,40
v_cvt_pk_bf16_f32 v98, v208, v209
v_cvt_pk_bf16_f32 v99, v210, v211
MA 232,72,56
buffer_store_dwordx4 v[96:99], v14, s[20:23], s96 offen offset:0 sc1
MA 236,64,28
v_cvt_pk_bf16_f32 v100, v196, v197
v_cvt_pk_bf16_f32 v101, v198, v199
MA 236,68,44
v_cvt_pk_bf16_f32 v102, v212, v213
v_cvt_pk_bf16_f32 v103, v214, v215
MA 236,72,60
v_cvt_pk_bf16_f32 v104, v200, v201
s_waitcnt lgkmcnt(0)
MA 240,76,16
s_waitcnt vmcnt(10)
s_barrier
s_add_u32 m0, s43, 0xc000
v_cvt_pk_bf16_f32 v105, v202, v203
MA 240,80,32
s_add_u32 s50, s45, 0x36300
TR 64,5,0
v_cvt_pk_bf16_f32 v106, v216, v217
MA 240,84,48
TR 66,5,2048
v_cvt_pk_bf16_f32 v107, v218, v219
MA 244,76,20
TR 68,5,4096
v_cvt_pk_bf16_f32 v108, v204, v205
MA 244,80,36
TR 70,5,6144
v_cvt_pk_bf16_f32 v109, v206, v207
MA 244,84,52
TR 72,5,8192
v_cvt_pk_bf16_f32 v110, v220, v221
MA 248,76,24
TR 74,5,10240
v_cvt_pk_bf16_f32 v111, v222, v223
MA 248,80,40
buffer_load_dwordx4 v3, s[16:19], s50 offen lds
MA 248,84,56
s_add_u32 m0, s43, 0xd000
buffer_store_dwordx4 v[100:103], v14, s[20:23], s96 offen offset:1024 sc1
MA 252,76,28
s_add_u32 s51, s45, 0x3f300
MA 252,80,44
MA 252,84,60
s_waitcnt lgkmcnt(0)
MA 224,64,64
TR 76,6,0
MA 224,68,80
TR 78,6,2048
MA 224,72,96
TR 80,6,4096
MA 228,64,68
TR 82,6,6144
MA 228,68,84
TR 84,6,8192
MA 228,72,100
TR 86,6,10240
MA 232,64,72
buffer_load_dwordx4 v3, s[16:19], s51 offen lds
MA 232,68,88
s_add_u32 m0, s43, 0xe000
buffer_store_dwordx4 v[104:107], v14, s[20:23], s96 offen offset:2048 sc1
MA 232,72,104
s_add_u32 s50, s45, 0x48300
s_waitcnt vmcnt(10)
s_nop 0
MA 236,64,76
MA 236,68,92
MA 236,72,108
buffer_load_dwordx4 v3, s[16:19], s50 offen lds
s_waitcnt lgkmcnt(0)
MA 240,76,64
s_add_u32 m0, s43, 0xf000
TR 64,5,12288
MA 240,80,80
s_add_u32 s51, s45, 0x51300
TR 66,5,14336
MA 240,84,96
TR 68,5,16384
MA 244,76,68
TR 70,5,18432
MA 244,80,84
TR 72,5,20480
MA 244,84,100
TR 74,5,22528
MA 248,76,72
buffer_load_dwordx4 v3, s[16:19], s51 offen lds
MA 248,80,88
s_add_u32 m0, s43, 0x10000
buffer_store_dwordx4 v[108:111], v14, s[20:23], s96 offen offset:3072 sc1
MA 248,84,104
s_add_u32 s50, s45, 0x380
MA 252,76,76
MA 252,80,92
MA 252,84,108
buffer_load_dwordx4 v3, s[16:19], s50 offen lds
s_waitcnt lgkmcnt(0)
MA 224,64,112
s_add_u32 m0, s43, 0x11000
TR 76,6,12288
MA 224,68,128
s_add_u32 s51, s45, 0x9380
TR 78,6,14336
MA 224,72,144
TR 80,6,16384
MA 228,64,116
TR 82,6,18432
MA 228,68,132
TR 84,6,20480
MA 228,72,148
TR 86,6,22528
MA 232,64,120
buffer_load_dwordx4 v3, s[16:19], s51 offen lds
MA 232,68,136
MA 232,72,152
MA 236,64,124
MA 236,68,140
MA 236,72,156
s_waitcnt lgkmcnt(0)
MA 240,76,112
s_waitcnt vmcnt(10)
s_barrier
s_add_u32 m0, s43, 0x0
buffer_store_dword v49, v48, s[20:23], s54 offen offset:12 sc1
MA 240,80,128
s_add_u32 s50, s45, 0x12380
TR 64,5,24576
MA 240,84,144
TR 66,5,26624
MA 244,76,116
TR 68,5,28672
MA 244,80,132
TR 70,5,30720
MA 244,84,148
TR 72,5,32768
MA 248,76,120
TR 74,5,34816
MA 248,80,136
buffer_load_dwordx4 v3, s[16:19], s50 offen lds
MA 248,84,152
s_add_u32 m0, s43, 0x1000
MA 252,76,124
s_add_u32 s51, s45, 0x1b380
MA 252,80,140
MA 252,84,156
s_waitcnt lgkmcnt(0)
v_mfma_f32_16x16x32_bf16 v[160:163], v[64:67], a[0:3], 0
TR 76,6,24576
MA 160,68,16
TR 78,6,26624
MA 160,72,32
TR 80,6,28672
v_mfma_f32_16x16x32_bf16 v[164:167], v[64:67], a[4:7], 0
TR 82,6,30720
MA 164,68,20
TR 84,6,32768
s_add_u32 s97, s49, 0x14000
v_cvt_pk_bf16_f32 v112, v224, v225
MA 164,72,36
TR 86,6,34816
v_cvt_pk_bf16_f32 v113, v226, v227
v_mfma_f32_16x16x32_bf16 v[168:171], v[64:67], a[8:11], 0
buffer_load_dwordx4 v3, s[16:19], s51 offen lds
MA 168,68,24
s_add_u32 m0, s43, 0x2000
v_cvt_pk_bf16_f32 v114, v240, v241
v_cvt_pk_bf16_f32 v115, v242, v243
MA 168,72,40
s_add_u32 s50, s45, 0x24380
buffer_store_dwordx4 v[112:115], v14, s[20:23], s97 offen offset:0 sc1
v_mfma_f32_16x16x32_bf16 v[172:175], v[64:67], a[12:15], 0
v_cvt_pk_bf16_f32 v116, v228, v229
v_cvt_pk_bf16_f32 v117, v230, v231
MA 172,68,28
v_cvt_pk_bf16_f32 v118, v244, v245
v_cvt_pk_bf16_f32 v119, v246, v247
MA 172,72,44
buffer_load_dwordx4 v3, s[16:19], s50 offen lds
s_waitcnt lgkmcnt(0)
v_mfma_f32_16x16x32_bf16 v[176:179], v[76:79], a[0:3], 0
s_add_u32 m0, s43, 0x3000
TR 64,5,36864
v_cvt_pk_bf16_f32 v120, v232, v233
MA 176,80,16
s_add_u32 s51, s45, 0x2d380
TR 66,5,38912
v_cvt_pk_bf16_f32 v121, v234, v235
MA 176,84,32
TR 68,5,40960
v_cvt_pk_bf16_f32 v122, v248, v249
v_mfma_f32_16x16x32_bf16 v[180:183], v[76:79], a[4:7], 0
TR 70,5,43008
v_cvt_pk_bf16_f32 v123, v250, v251
MA 180,80,20
TR 72,5,45056
v_cvt_pk_bf16_f32 v124, v236, v237
MA 180,84,36
TR 74,5,47104
v_cvt_pk_bf16_f32 v125, v238, v239
v_mfma_f32_16x16x32_bf16 v[184:187], v[76:79], a[8:11], 0
buffer_load_dwordx4 v3, s[16:19], s51 offen lds
MA 184,80,24
s_add_u32 m0, s43, 0x4000
buffer_store_dwordx4 v[116:119], v14, s[20:23], s97 offen offset:1024 sc1
MA 184,84,40
s_add_u32 s50, s45, 0x36380
v_cvt_pk_bf16_f32 v126, v252, v253
v_cvt_pk_bf16_f32 v127, v254, v255
v_mfma_f32_16x16x32_bf16 v[188:191], v[76:79], a[12:15], 0
MA 188,80,28
MA 188,84,44
buffer_load_dwordx4 v3, s[16:19], s50 offen lds
s_waitcnt lgkmcnt(0)
MA 160,64,48
s_add_u32 m0, s43, 0x5000
TR 76,6,36864
MA 160,68,64
s_add_u32 s51, s45, 0x3f380
TR 78,6,38912
MA 160,72,80
TR 80,6,40960
MA 164,64,52
TR 82,6,43008
MA 164,68,68
TR 84,6,45056
MA 164,72,84
TR 86,6,47104
MA 168,64,56
buffer_load_dwordx4 v3, s[16:19], s51 offen lds
MA 168,68,72
buffer_store_dwordx4 v[120:123], v14, s[20:23], s97 offen offset:2048 sc1
s_waitcnt vmcnt(12)
s_nop 0
MA 168,72,88
MA 172,64,60
MA 172,68,76
MA 172,72,92
s_waitcnt lgkmcnt(0)
MA 176,76,48
s_waitcnt vmcnt(10)
s_barrier
s_add_u32 m0, s43, 0x6000
buffer_store_dword v49, v48, s[20:23], s54 offen offset:16 sc1
MA 176,80,64
s_add_u32 s50, s45, 0x48380
TR 64,5,49152
MA 176,84,80
TR 66,5,51200
MA 180,76,52
TR 68,5,53248
MA 180,80,68
TR 70,5,55296
MA 180,84,84
TR 72,5,57344
MA 184,76,56
TR 74,5,59392
MA 184,80,72
buffer_load_dwordx4 v3, s[16:19], s50 offen lds
MA 184,84,88
s_add_u32 m0, s43, 0x7000
buffer_store_dwordx4 v[124:127], v14, s[20:23], s97 offen offset:3072 sc1
MA 188,76,60
s_add_u32 s51, s45, 0x51380
MA 188,80,76
MA 188,84,92
s_waitcnt lgkmcnt(0)
MA 160,64,96
TR 76,6,49152
MA 160,68,112
TR 78,6,51200
MA 160,72,128
TR 80,6,53248
MA 164,64,100
TR 82,6,55296
MA 164,68,116
TR 84,6,57344
MA 164,72,132
TR 86,6,59392
MA 168,64,104
buffer_load_dwordx4 v3, s[16:19], s51 offen lds
MA 168,68,120
s_add_u32 m0, s43, 0x8000
MA 168,72,136
s_add_u32 s50, s45, 0x400
MA 172,64,108
MA 172,68,124
MA 172,72,140
buffer_load_dwordx4 v3, s[16:19], s50 offen lds
s_waitcnt lgkmcnt(0)
MA 176,76,96
s_add_u32 m0, s43, 0x9000
TR 64,5,61440
MA 176,80,112
s_add_u32 s51, s45, 0x9400
TR 66,5,63488
MA 176,84,128
TR 68,7,0
MA 180,76,100
TR 70,7,2048
MA 180,80,116
TR 72,7,4096
MA 180,84,132
TR 74,7,6144
MA 184,76,104
buffer_load_dwordx4 v3, s[16:19], s51 offen lds
MA 184,80,120
s_add_u32 m0, s43, 0xa000
MA 184,84,136
s_add_u32 s50, s45, 0x12400
MA 188,76,108
MA 188,80,124
MA 188,84,140
buffer_load_dwordx4 v3, s[16:19], s50 offen lds
s_waitcnt lgkmcnt(0)
MA 160,64,144
s_add_u32 m0, s43, 0xb000
TR 76,6,61440
v_mfma_f32_16x16x32_bf16 v[192:195], v[68:71], a[0:3], 0
s_add_u32 s51, s45, 0x1b400
TR 78,6,63488
MA 192,72,16
TR 80,8,0
MA 164,64,148
TR 82,8,2048
v_mfma_f32_16x16x32_bf16 v[196:199], v[68:71], a[4:7], 0
TR 84,8,4096
MA 196,72,20
TR 86,8,6144
MA 168,64,152
buffer_load_dwordx4 v3, s[16:19], s51 offen lds
v_mfma_f32_16x16x32_bf16 v[200:203], v[68:71], a[8:11], 0
MA 200,72,24
MA 172,64,156
v_mfma_f32_16x16x32_bf16 v[204:207], v[68:71], a[12:15], 0
MA 204,72,28
s_waitcnt lgkmcnt(0)
MA 176,76,144
s_waitcnt vmcnt(9)
s_barrier
s_add_u32 m0, s43, 0xc000
v_mfma_f32_16x16x32_bf16 v[208:211], v[80:83], a[0:3], 0
s_add_u32 s50, s45, 0x24400
TR 64,5,0
MA 208,84,16
TR 66,5,2048
MA 180,76,148
TR 68,5,4096
v_mfma_f32_16x16x32_bf16 v[212:215], v[80:83], a[4:7], 0
TR 70,5,6144
MA 212,84,20
TR 72,5,8192
MA 184,76,152
TR 74,5,10240
v_mfma_f32_16x16x32_bf16 v[216:219], v[80:83], a[8:11], 0
buffer_load_dwordx4 v3, s[16:19], s50 offen lds
MA 216,84,24
s_add_u32 m0, s43, 0xd000
MA 188,76,156
s_add_u32 s51, s45, 0x2d400
v_mfma_f32_16x16x32_bf16 v[220:223], v[80:83], a[12:15], 0
MA 220,84,28
s_waitcnt lgkmcnt(0)
MA 192,64,32
TR 76,6,0
MA 192,68,48
TR 78,6,2048
MA 192,72,64
TR 80,6,4096
MA 196,64,36
TR 82,6,6144
MA 196,68,52
TR 84,6,8192
s_add_u32 s98, s49, 0x18000
v_cvt_pk_bf16_f32 v128, v160, v161
MA 196,72,68
TR 86,6,10240
v_cvt_pk_bf16_f32 v129, v162, v163
MA 200,64,40
buffer_load_dwordx4 v3, s[16:19], s51 offen lds
MA 200,68,56
s_add_u32 m0, s43, 0xe000
v_cvt_pk_bf16_f32 v130, v176, v177
v_cvt_pk_bf16_f32 v131, v178, v179
MA 200,72,72
s_add_u32 s50, s45, 0x36400
buffer_store_dwordx4 v[128:131], v14, s[20:23], s98 offen offset:0 sc1
s_waitcnt vmcnt(8)
s_nop 0
MA 204,64,44
v_cvt_pk_bf16_f32 v132, v164, v165
v_cvt_pk_bf16_f32 v133, v166, v167
MA 204,68,60
v_cvt_pk_bf16_f32 v134, v180, v181
v_cvt_pk_bf16_f32 v135, v182, v183
MA 204,72,76
buffer_load_dwordx4 v3, s[16:19], s50 offen lds
s_waitcnt lgkmcnt(0)
MA 208,76,32
s_add_u32 m0, s43, 0xf000
TR 64,5,12288
v_cvt_pk_bf16_f32 v136, v168, v169
MA 208,80,48
s_add_u32 s51, s45, 0x3f400
TR 66,5,14336
v_cvt_pk_bf16_f32 v137, v170, v171
MA 208,84,64
TR 68,5,16384
v_cvt_pk_bf16_f32 v138, v184, v185
MA 212,76,36
TR 70,5,18432
v_cvt_pk_bf16_f32 v139, v186, v187
MA 212,80,52
TR 72,5,20480
v_cvt_pk_bf16_f32 v140, v172, v173
MA 212,84,68
TR 74,5,22528
v_cvt_pk_bf16_f32 v141, v174, v175
MA 216,76,40
buffer_load_dwordx4 v3, s[16:19], s51 offen lds
MA 216,80,56
s_add_u32 m0, s43, 0x10000
buffer_store_dwordx4 v[132:135], v14, s[20:23], s98 offen offset:1024 sc1
MA 216,84,72
s_add_u32 s50, s45, 0x48400
v_cvt_pk_bf16_f32 v142, v188, v189
v_cvt_pk_bf16_f32 v143, v190, v191
MA 220,76,44
MA 220,80,60
MA 220,84,76
buffer_load_dwordx4 v3, s[16:19], s50 offen lds
s_waitcnt lgkmcnt(0)
MA 192,64,80
s_add_u32 m0, s43, 0x11000
TR 76,6,12288
MA 192,68,96
s_add_u32 s51, s45, 0x51400
TR 78,6,14336
MA 192,72,112
TR 80,6,16384
MA 196,64,84
TR 82,6,18432
MA 196,68,100
TR 84,6,20480
MA 196,72,116
TR 86,6,22528
MA 200,64,88
buffer_load_dwordx4 v3, s[16:19], s51 offen lds
MA 200,68,104
buffer_store_dwordx4 v[136:139], v14, s[20:23], s98 offen offset:2048 sc1
MA 200,72,120
MA 204,64,92
MA 204,68,108
MA 204,72,124
s_waitcnt lgkmcnt(0)
MA 208,76,80
s_waitcnt vmcnt(9)
s_barrier
buffer_store_dword v49, v48, s[20:23], s54 offen offset:20 sc1
MA 208,80,96
TR 64,5,24576
MA 208,84,112
TR 66,5,26624
MA 212,76,84
TR 68,5,28672
MA 212,80,100
TR 70,5,30720
MA 212,84,116
TR 72,5,32768
MA 216,76,88
TR 74,5,34816
MA 216,80,104
buffer_store_dwordx4 v[140:143], v14, s[20:23], s98 offen offset:3072 sc1
MA 216,84,120
MA 220,76,92
MA 220,80,108
MA 220,84,124
s_waitcnt lgkmcnt(0)
MA 192,64,128
TR 76,6,24576
MA 192,68,144
TR 78,6,26624
v_mfma_f32_16x16x32_bf16 v[224:227], v[72:75], a[0:3], 0
TR 80,6,28672
MA 196,64,132
TR 82,6,30720
MA 196,68,148
TR 84,6,32768
v_mfma_f32_16x16x32_bf16 v[228:231], v[72:75], a[4:7], 0
TR 86,6,34816
MA 200,64,136
MA 200,68,152
v_mfma_f32_16x16x32_bf16 v[232:235], v[72:75], a[8:11], 0
MA 204,64,140
MA 204,68,156
v_mfma_f32_16x16x32_bf16 v[236:239], v[72:75], a[12:15], 0
s_waitcnt lgkmcnt(0)
MA 208,76,128
TR 64,5,36864
MA 208,80,144
TR 66,5,38912
v_mfma_f32_16x16x32_bf16 v[240:243], v[84:87], a[0:3], 0
TR 68,5,40960
MA 212,76,132
TR 70,5,43008
MA 212,80,148
TR 72,5,45056
v_mfma_f32_16x16x32_bf16 v[244:247], v[84:87], a[4:7], 0
TR 74,5,47104
MA 216,76,136
MA 216,80,152
v_mfma_f32_16x16x32_bf16 v[248:251], v[84:87], a[8:11], 0
MA 220,76,140
MA 220,80,156
v_mfma_f32_16x16x32_bf16 v[252:255], v[84:87], a[12:15], 0
s_waitcnt lgkmcnt(0)
MA 224,64,16
TR 76,6,36864
MA 224,68,32
TR 78,6,38912
MA 224,72,48
TR 80,6,40960
MA 228,64,20
TR 82,6,43008
MA 228,68,36
TR 84,6,45056
s_add_u32 s99, s49, 0x1c000
v_cvt_pk_bf16_f32 v144, v192, v193
MA 228,72,52
TR 86,6,47104
v_cvt_pk_bf16_f32 v145, v194, v195
MA 232,64,24
v_cvt_pk_bf16_f32 v146, v208, v209
v_cvt_pk_bf16_f32 v147, v210, v211
MA 232,68,40
buffer_store_dwordx4 v[144:147], v14, s[20:23], s99 offen offset:0 sc1
MA 232,72,56
v_cvt_pk_bf16_f32 v148, v196, v197
v_cvt_pk_bf16_f32 v149, v198, v199
MA 236,64,28
v_cvt_pk_bf16_f32 v150, v212, v213
v_cvt_pk_bf16_f32 v151, v214, v215
MA 236,68,44
v_cvt_pk_bf16_f32 v152, v200, v201
v_cvt_pk_bf16_f32 v153, v202, v203
MA 236,72,60
v_cvt_pk_bf16_f32 v154, v216, v217
s_waitcnt lgkmcnt(0)
MA 240,76,16
s_waitcnt vmcnt(4)
s_barrier
v_cvt_pk_bf16_f32 v155, v218, v219
v_cvt_pk_bf16_f32 v156, v204, v205
MA 240,80,32
TR 64,5,49152
v_cvt_pk_bf16_f32 v157, v206, v207
MA 240,84,48
TR 66,5,51200
v_cvt_pk_bf16_f32 v158, v220, v221
MA 244,76,20
TR 68,5,53248
v_cvt_pk_bf16_f32 v159, v222, v223
MA 244,80,36
TR 70,5,55296
MA 244,84,52
TR 72,5,57344
MA 248,76,24
TR 74,5,59392
MA 248,80,40
buffer_store_dwordx4 v[148:151], v14, s[20:23], s99 offen offset:1024 sc1
MA 248,84,56
MA 252,76,28
MA 252,80,44
MA 252,84,60
s_waitcnt lgkmcnt(0)
MA 224,64,64
TR 76,6,49152
MA 224,68,80
TR 78,6,51200
MA 224,72,96
TR 80,6,53248
MA 228,64,68
TR 82,6,55296
MA 228,68,84
TR 84,6,57344
MA 228,72,100
TR 86,6,59392
MA 232,64,72
buffer_store_dwordx4 v[152:155], v14, s[20:23], s99 offen offset:2048 sc1
MA 232,68,88
s_waitcnt vmcnt(3)
s_nop 0
MA 232,72,104
MA 236,64,76
MA 236,68,92
MA 236,72,108
s_waitcnt lgkmcnt(0)
MA 240,76,64
TR 64,5,61440
MA 240,80,80
TR 66,5,63488
MA 240,84,96
TR 68,7,0
MA 244,76,68
TR 70,7,2048
MA 244,80,84
TR 72,7,4096
MA 244,84,100
TR 74,7,6144
MA 248,76,72
buffer_store_dwordx4 v[156:159], v14, s[20:23], s99 offen offset:3072 sc1
MA 248,80,88
MA 248,84,104
MA 252,76,76
MA 252,80,92
MA 252,84,108
s_waitcnt lgkmcnt(0)
MA 224,64,112
TR 76,6,61440
MA 224,68,128
TR 78,6,63488
MA 224,72,144
TR 80,8,0
MA 228,64,116
TR 82,8,2048
MA 228,68,132
TR 84,8,4096
MA 228,72,148
TR 86,8,6144
MA 232,64,120
MA 232,68,136
MA 232,72,152
MA 236,64,124
MA 236,68,140
MA 236,72,156
s_waitcnt lgkmcnt(0)
MA 240,76,112
MA 240,80,128
MA 240,84,144
MA 244,76,116
MA 244,80,132
MA 244,84,148
MA 248,76,120
MA 248,80,136
MA 248,84,152
MA 252,76,124
MA 252,80,140
MA 252,84,156
s_nop 7
s_add_u32 s96, s49, 0x20000
v_cvt_pk_bf16_f32 v96, v224, v225
v_cvt_pk_bf16_f32 v97, v226, v227
v_cvt_pk_bf16_f32 v98, v240, v241
v_cvt_pk_bf16_f32 v99, v242, v243
v_cvt_pk_bf16_f32 v100, v228, v229
v_cvt_pk_bf16_f32 v101, v230, v231
v_cvt_pk_bf16_f32 v102, v244, v245
v_cvt_pk_bf16_f32 v103, v246, v247
v_cvt_pk_bf16_f32 v104, v232, v233
v_cvt_pk_bf16_f32 v105, v234, v235
v_cvt_pk_bf16_f32 v106, v248, v249
v_cvt_pk_bf16_f32 v107, v250, v251
v_cvt_pk_bf16_f32 v108, v236, v237
v_cvt_pk_bf16_f32 v109, v238, v239
v_cvt_pk_bf16_f32 v110, v252, v253
v_cvt_pk_bf16_f32 v111, v254, v255
buffer_store_dwordx4 v[96:99], v14, s[20:23], s96 offen offset:0 sc1
buffer_store_dwordx4 v[100:103], v14, s[20:23], s96 offen offset:1024 sc1
buffer_store_dwordx4 v[104:107], v14, s[20:23], s96 offen offset:2048 sc1
buffer_store_dwordx4 v[108:111], v14, s[20:23], s96 offen offset:3072 sc1
s_mov_b32 s78, 0x1c0
s_mov_b32 s77, 0
s_branch L_tail
L_k1_A_end:
L_k1_B:
s_mul_i32 s44, s42, 320
s_sub_u32 s44, s44, 576
s_mul_i32 s45, s44, 1152
s_lshl_b32 s44, s44, 1
s_mov_b32 s52, 9088
s_and_b32 s81, s42, 1
s_mul_i32 s53, s81, 36864
s_add_u32 s53, s53, 5234688
s_lshl_b32 s81, s81, 1
s_lshr_b32 s82, s80, 1
s_add_u32 s81, s81, s82
v_bfe_u32 v88, v0, 4, 2
v_bfe_u32 v89, v0, 2, 2
v_lshlrev_b32 v5, 10, v88
v_lshl_add_u32 v5, v89, 7, v5
v_and_b32 v88, 1, v88
v_lshlrev_b32 v88, 1, v88
v_lshrrev_b32 v89, 1, v89
v_or_b32 v88, v88, v89
v_xor_b32 v88, s80, v88
v_lshl_add_u32 v5, v88, 5, v5
v_and_b32 v88, 3, v0
v_lshl_add_u32 v5, v88, 3, v5
v_xor_b32 v6, 32, v5
v_add_u32 v7, 0x10000, v5
v_add_u32 v8, 0x10000, v6
s_lshl_b32 s82, s80, 12
s_and_b32 s83, s40, 1
s_lshl_b32 s83, s83, 12
s_add_u32 s83, s83, 73728
v_add_u32 v12, s83, v1
v_add_u32 v13, 0x10000, v12
v_add_u32 v11, s82, v12
s_lshl_b32 s82, s40, 12
v_add_u32 v14, s82, v1
s_getpc_b64 s[92:93]
L_pc4:
s_sub_u32 s92, s92, L_pc4-L_k1_B
s_subb_u32 s93, s93, 0
s_mov_b32 s94, L_code_end-L_k1_B
s_mov_b32 s95, 0x20000
s_waitcnt vmcnt(0) lgkmcnt(0)
s_barrier
s_cmp_lg_u32 s40, 0
s_cbranch_scc1 L_B_hs_oth
s_mov_b32 s99, 1
s_atomic_add s99, s[96:97], 0x0 glc
L_B_hs_oth:
s_mul_i32 s82, s41, 331776
s_add_u32 s82, s82, s44
s_add_u32 s82, s82, 128
v_lshrrev_b32 v160, 3, v0
v_mul_u32_u24 v160, 9216, v160
v_and_b32 v161, 7, v0
v_lshl_add_u32 v160, v161, 4, v160
s_add_u32 s83, s82, 36864
buffer_load_dwordx4 v[164:167], v160, s[8:11], s82 offen offset:0
buffer_load_dwordx4 v[164:167], v160, s[12:15], s82 offen offset:0
buffer_load_dwordx4 v[164:167], v160, s[8:11], s83 offen offset:0
buffer_load_dwordx4 v[164:167], v160, s[12:15], s83 offen offset:0
buffer_load_dwordx4 v[164:167], v160, s[8:11], s82 offen offset:128
buffer_load_dwordx4 v[164:167], v160, s[12:15], s82 offen offset:128
buffer_load_dwordx4 v[164:167], v160, s[8:11], s83 offen offset:128
buffer_load_dwordx4 v[164:167], v160, s[12:15], s83 offen offset:128
s_add_u32 m0, s43, 0x0
s_add_u32 s50, s44, 0x0
buffer_load_dwordx4 v2, s[8:11], s50 offen lds
s_add_u32 m0, s43, 0x1000
s_add_u32 s51, s44, 0x0
buffer_load_dwordx4 v2, s[12:15], s51 offen lds
s_add_u32 m0, s43, 0x2000
s_add_u32 s50, s44, 0x48000
buffer_load_dwordx4 v2, s[8:11], s50 offen lds
s_add_u32 m0, s43, 0x3000
s_add_u32 s51, s44, 0x48000
buffer_load_dwordx4 v2, s[12:15], s51 offen lds
s_add_u32 m0, s43, 0x4000
s_add_u32 s50, s44, 0x90000
buffer_load_dwordx4 v2, s[8:11], s50 offen lds
s_add_u32 m0, s43, 0x5000
s_add_u32 s51, s44, 0x90000
buffer_load_dwordx4 v2, s[12:15], s51 offen lds
s_add_u32 m0, s43, 0x6000
s_add_u32 s50, s44, 0xd8000
buffer_load_dwordx4 v2, s[8:11], s50 offen lds
s_add_u32 m0, s43, 0x7000
s_add_u32 s51, s44, 0xd8000
buffer_load_dwordx4 v2, s[12:15], s51 offen lds
s_add_u32 m0, s43, 0x8000
s_add_u32 s50, s44, 0x120000
buffer_load_dwordx4 v2, s[8:11], s50 offen lds
s_add_u32 m0, s43, 0x9000
s_add_u32 s51, s44, 0x120000
buffer_load_dwordx4 v2, s[12:15], s51 offen lds
s_add_u32 m0, s43, 0xa000
s_add_u32 s50, s44, 0x168000
buffer_load_dwordx4 v2, s[8:11], s50 offen lds
s_add_u32 m0, s43, 0xb000
s_add_u32 s51, s44, 0x168000
buffer_load_dwordx4 v2, s[12:15], s51 offen lds
s_add_u32 m0, s43, 0xc000
s_add_u32 s50, s44, 0x80
buffer_load_dwordx4 v2, s[8:11], s50 offen lds
s_add_u32 m0, s43, 0xd000
s_add_u32 s51, s44, 0x80
buffer_load_dwordx4 v2, s[12:15], s51 offen lds
s_add_u32 m0, s43, 0xe000
s_add_u32 s50, s44, 0x48080
buffer_load_dwordx4 v2, s[8:11], s50 offen lds
s_add_u32 m0, s43, 0xf000
s_add_u32 s51, s44, 0x48080
buffer_load_dwordx4 v2, s[12:15], s51 offen lds
s_add_u32 m0, s43, 0x10000
s_add_u32 s50, s44, 0x90080
buffer_load_dwordx4 v2, s[8:11], s50 offen lds
s_add_u32 m0, s43, 0x11000
s_add_u32 s51, s44, 0x90080
buffer_load_dwordx4 v2, s[12:15], s51 offen lds
s_cmp_lg_u32 s40, 0
s_cbranch_scc1 L_B_hs_done
s_mov_b32 s83, 0x40000
s_waitcnt lgkmcnt(0)
s_or_b32 s98, s99, 15
s_add_u32 s99, s99, 1
L_B_hs_spin:
s_cmp_gt_u32 s99, s98
s_cbranch_scc1 L_B_hs_done
s_sub_u32 s83, s83, 1
s_cbranch_scc1 L_B_hs_done
s_sleep 8
s_add_u32 s99, s99, 4
s_cmp_gt_u32 s99, s98
s_cbranch_scc1 L_B_hs_near
s_sleep 0
L_B_hs_near:
s_mov_b32 s99, 0
s_atomic_add s99, s[96:97], 0x0 glc
s_waitcnt lgkmcnt(0)
s_branch L_B_hs_spin
L_B_hs_done:
s_barrier
s_add_u32 m0, s43, 0x12000
s_add_u32 s50, s46, 0x0
buffer_load_dwordx4 v1, s[20:23], s50 offen sc1 lds
s_add_u32 m0, s43, 0x13000
s_add_u32 s51, s46, 0x1000
buffer_load_dwordx4 v1, s[20:23], s51 offen sc1 lds
s_add_u32 m0, s43, 0x14000
s_add_u32 s50, s46, 0x2000
buffer_load_dwordx4 v1, s[20:23], s50 offen sc1 lds
s_add_u32 m0, s43, 0x15000
s_add_u32 s51, s46, 0x3000
buffer_load_dwordx4 v1, s[20:23], s51 offen sc1 lds
s_add_u32 m0, s43, 0x16000
s_add_u32 s50, s46, 0x4000
buffer_load_dwordx4 v1, s[20:23], s50 offen sc1 lds
s_add_u32 m0, s43, 0x17000
s_add_u32 s51, s46, 0x5000
buffer_load_dwordx4 v1, s[20:23], s51 offen sc1 lds
s_add_u32 m0, s43, 0x18000
s_add_u32 s50, s46, 0x6000
buffer_load_dwordx4 v1, s[20:23], s50 offen sc1 lds
s_add_u32 m0, s43, 0x19000
s_add_u32 s51, s46, 0x7000
buffer_load_dwordx4 v1, s[20:23], s51 offen sc1 lds
s_add_u32 m0, s43, 0x1a000
s_add_u32 s50, s46, 0x8000
buffer_load_dwordx4 v1, s[20:23], s50 offen sc1 lds
s_add_u32 m0, s43, 0x1b000
s_add_u32 s51, s46, 0x9000
buffer_load_dwordx4 v1, s[20:23], s51 offen sc1 lds
s_add_u32 m0, s43, 0x1c000
s_add_u32 s50, s46, 0xa000
buffer_load_dwordx4 v1, s[20:23], s50 offen sc1 lds
s_add_u32 m0, s43, 0x1d000
s_add_u32 s51, s46, 0xb000
buffer_load_dwordx4 v1, s[20:23], s51 offen sc1 lds
s_waitcnt vmcnt(6)
s_barrier
TR 64,5,0
TR 66,5,512
ds_read_b128 a[0:3], v12 offset:0
ds_read_b128 a[4:7], v12 offset:1024
ds_read_b128 a[8:11], v12 offset:2048
ds_read_b128 a[12:15], v12 offset:3072
TR 68,5,8192
TR 70,5,8704
ds_read_b128 a[16:19], v12 offset:8192
ds_read_b128 a[20:23], v12 offset:9216
ds_read_b128 a[24:27], v12 offset:10240
ds_read_b128 a[28:31], v12 offset:11264
TR 72,5,16384
TR 74,5,16896
ds_read_b128 a[32:35], v12 offset:16384
ds_read_b128 a[36:39], v12 offset:17408
ds_read_b128 a[40:43], v12 offset:18432
ds_read_b128 a[44:47], v12 offset:19456
s_waitcnt lgkmcnt(15)
v_mfma_f32_16x16x32_bf16 v[96:99], v[64:67], a[0:3], 0
TR 76,6,0
s_waitcnt lgkmcnt(15)
v_mfma_f32_16x16x32_bf16 v[100:103], v[64:67], a[4:7], 0
TR 78,6,512
s_waitcnt lgkmcnt(15)
v_mfma_f32_16x16x32_bf16 v[104:107], v[64:67], a[8:11], 0
TR 80,6,8192
s_waitcnt lgkmcnt(15)
v_mfma_f32_16x16x32_bf16 v[108:111], v[64:67], a[12:15], 0
TR 82,6,8704
s_waitcnt lgkmcnt(13)
MA 96,68,16
TR 84,6,16384
s_waitcnt lgkmcnt(13)
MA 100,68,20
TR 86,6,16896
s_waitcnt lgkmcnt(13)
MA 104,68,24
s_waitcnt lgkmcnt(12)
MA 108,68,28
s_waitcnt lgkmcnt(9)
MA 96,72,32
s_waitcnt lgkmcnt(8)
MA 100,72,36
s_waitcnt lgkmcnt(7)
MA 104,72,40
s_waitcnt lgkmcnt(6)
MA 108,72,44
s_waitcnt lgkmcnt(4)
v_mfma_f32_16x16x32_bf16 v[112:115], v[76:79], a[0:3], 0
TR 64,5,4096
s_waitcnt lgkmcnt(3)
MA 112,80,16
TR 66,5,4608
s_waitcnt lgkmcnt(2)
MA 112,84,32
TR 68,5,12288
v_mfma_f32_16x16x32_bf16 v[116:119], v[76:79], a[4:7], 0
TR 70,5,12800
MA 116,80,20
TR 72,5,20480
MA 116,84,36
TR 74,5,20992
v_mfma_f32_16x16x32_bf16 v[120:123], v[76:79], a[8:11], 0
MA 120,80,24
MA 120,84,40
v_mfma_f32_16x16x32_bf16 v[124:127], v[76:79], a[12:15], 0
MA 124,80,28
MA 124,84,44
s_waitcnt lgkmcnt(4)
v_mfma_f32_16x16x32_bf16 v[128:131], v[64:67], a[0:3], 0
TR 76,6,4096
s_waitcnt lgkmcnt(3)
MA 128,68,16
TR 78,6,4608
s_waitcnt lgkmcnt(2)
MA 128,72,32
TR 80,6,12288
v_mfma_f32_16x16x32_bf16 v[132:135], v[64:67], a[4:7], 0
TR 82,6,12800
MA 132,68,20
TR 84,6,20480
MA 132,72,36
TR 86,6,20992
v_mfma_f32_16x16x32_bf16 v[136:139], v[64:67], a[8:11], 0
MA 136,68,24
MA 136,72,40
v_mfma_f32_16x16x32_bf16 v[140:143], v[64:67], a[12:15], 0
MA 140,68,28
MA 140,72,44
s_waitcnt lgkmcnt(4)
v_mfma_f32_16x16x32_bf16 v[144:147], v[76:79], a[0:3], 0
s_waitcnt vmcnt(0)
s_waitcnt lgkmcnt(0)
s_barrier
s_add_u32 m0, s43, 0x1e000
s_add_u32 s50, s46, 0xc000
MA 144,80,16
TR 64,5,24576
TR 66,5,25088
MA 144,84,32
ds_read_b128 a[48:51], v12 offset:24576
ds_read_b128 a[52:55], v12 offset:25600
v_mfma_f32_16x16x32_bf16 v[148:151], v[76:79], a[4:7], 0
ds_read_b128 a[56:59], v12 offset:26624
ds_read_b128 a[60:63], v12 offset:27648
MA 148,80,20
TR 68,5,32768
TR 70,5,33280
MA 148,84,36
ds_read_b128 a[64:67], v12 offset:32768
ds_read_b128 a[68:71], v12 offset:33792
v_mfma_f32_16x16x32_bf16 v[152:155], v[76:79], a[8:11], 0
ds_read_b128 a[72:75], v12 offset:34816
ds_read_b128 a[76:79], v12 offset:35840
MA 152,80,24
TR 72,5,40960
TR 74,5,41472
MA 152,84,40
ds_read_b128 a[80:83], v12 offset:40960
ds_read_b128 a[84:87], v12 offset:41984
v_mfma_f32_16x16x32_bf16 v[156:159], v[76:79], a[12:15], 0
ds_read_b128 a[88:91], v12 offset:43008
ds_read_b128 a[92:95], v12 offset:44032
MA 156,80,28
buffer_load_dwordx4 v1, s[20:23], s50 offen sc1 lds
MA 156,84,44
s_add_u32 m0, s43, 0x1f000
s_add_u32 s51, s46, 0xd000
s_waitcnt lgkmcnt(15)
MA 96,64,48
TR 76,6,24576
s_waitcnt lgkmcnt(15)
MA 100,64,52
TR 78,6,25088
s_waitcnt lgkmcnt(15)
MA 104,64,56
TR 80,6,32768
s_waitcnt lgkmcnt(15)
MA 108,64,60
TR 82,6,33280
s_waitcnt lgkmcnt(13)
MA 96,68,64
TR 84,6,40960
s_waitcnt lgkmcnt(13)
MA 100,68,68
TR 86,6,41472
s_waitcnt lgkmcnt(13)
MA 104,68,72
buffer_load_dwordx4 v1, s[20:23], s51 offen sc1 lds
s_waitcnt lgkmcnt(12)
MA 108,68,76
s_add_u32 m0, s43, 0x0
s_add_u32 s50, s44, 0x1b0000
s_waitcnt lgkmcnt(9)
MA 96,72,80
buffer_load_dwordx4 v2, s[8:11], s50 offen lds
s_waitcnt lgkmcnt(8)
MA 100,72,84
s_add_u32 m0, s43, 0x1000
s_add_u32 s51, s44, 0x1b0000
s_waitcnt lgkmcnt(7)
MA 104,72,88
buffer_load_dwordx4 v2, s[12:15], s51 offen lds
s_waitcnt lgkmcnt(6)
MA 108,72,92
s_add_u32 m0, s43, 0x20000
s_add_u32 s50, s46, 0xe000
s_waitcnt lgkmcnt(4)
MA 112,76,48
TR 64,5,28672
s_waitcnt lgkmcnt(3)
MA 112,80,64
TR 66,5,29184
s_waitcnt lgkmcnt(2)
MA 112,84,80
TR 68,5,36864
MA 116,76,52
TR 70,5,37376
MA 116,80,68
TR 72,5,45056
MA 116,84,84
TR 74,5,45568
MA 120,76,56
buffer_load_dwordx4 v1, s[20:23], s50 offen sc1 lds
MA 120,80,72
s_add_u32 m0, s43, 0x21000
s_add_u32 s51, s46, 0xf000
MA 120,84,88
buffer_load_dwordx4 v1, s[20:23], s51 offen sc1 lds
MA 124,76,60
s_add_u32 m0, s43, 0x2000
s_add_u32 s50, s44, 0x1f8000
MA 124,80,76
buffer_load_dwordx4 v2, s[8:11], s50 offen lds
MA 124,84,92
s_add_u32 m0, s43, 0x3000
s_add_u32 s51, s44, 0x1f8000
s_waitcnt lgkmcnt(4)
MA 128,64,48
TR 76,6,28672
s_waitcnt lgkmcnt(3)
MA 128,68,64
TR 78,6,29184
s_waitcnt lgkmcnt(2)
MA 128,72,80
TR 80,6,36864
MA 132,64,52
TR 82,6,37376
MA 132,68,68
TR 84,6,45056
MA 132,72,84
TR 86,6,45568
MA 136,64,56
buffer_load_dwordx4 v2, s[12:15], s51 offen lds
MA 136,68,72
s_add_u32 m0, s43, 0x22000
s_add_u32 s50, s46, 0x10000
MA 136,72,88
buffer_load_dwordx4 v1, s[20:23], s50 offen sc1 lds
MA 140,64,60
s_add_u32 m0, s43, 0x23000
s_add_u32 s51, s46, 0x11000
MA 140,68,76
buffer_load_dwordx4 v1, s[20:23], s51 offen sc1 lds
MA 140,72,92
s_add_u32 m0, s43, 0x4000
s_add_u32 s50, s44, 0x240000
s_waitcnt lgkmcnt(4)
MA 144,76,48
s_waitcnt lgkmcnt(0)
s_barrier
MA 144,80,64
TR 64,5,49152
MA 144,84,80
TR 66,5,49664
MA 148,76,52
TR 68,5,57344
MA 148,80,68
TR 70,5,57856
MA 148,84,84
TR 72,7,0
MA 152,76,56
TR 74,7,512
MA 152,80,72
buffer_load_dwordx4 v2, s[8:11], s50 offen lds
MA 152,84,88
s_add_u32 m0, s43, 0x5000
s_add_u32 s51, s44, 0x240000
MA 156,76,60
buffer_load_dwordx4 v2, s[12:15], s51 offen lds
MA 156,80,76
s_add_u32 m0, s43, 0x6000
s_add_u32 s50, s44, 0xd8080
MA 156,84,92
buffer_load_dwordx4 v2, s[8:11], s50 offen lds
s_waitcnt lgkmcnt(0)
v_mfma_f32_16x16x32_bf16 v[160:163], v[64:67], a[0:3], 0
s_add_u32 m0, s43, 0x7000
s_add_u32 s51, s44, 0xd8080
TR 76,6,49152
MA 160,68,16
TR 78,6,49664
MA 160,72,32
TR 80,6,57344
v_mfma_f32_16x16x32_bf16 v[164:167], v[64:67], a[4:7], 0
TR 82,6,57856
MA 164,68,20
TR 84,8,0
MA 164,72,36
TR 86,8,512
v_mfma_f32_16x16x32_bf16 v[168:171], v[64:67], a[8:11], 0
buffer_load_dwordx4 v2, s[12:15], s51 offen lds
MA 168,68,24
s_add_u32 m0, s43, 0x8000
s_add_u32 s50, s44, 0x120080
MA 168,72,40
buffer_load_dwordx4 v2, s[8:11], s50 offen lds
v_mfma_f32_16x16x32_bf16 v[172:175], v[64:67], a[12:15], 0
s_add_u32 m0, s43, 0x9000
s_add_u32 s51, s44, 0x120080
MA 172,68,28
buffer_load_dwordx4 v2, s[12:15], s51 offen lds
MA 172,72,44
s_add_u32 m0, s43, 0xa000
s_add_u32 s50, s44, 0x168080
s_waitcnt lgkmcnt(0)
v_mfma_f32_16x16x32_bf16 v[176:179], v[76:79], a[0:3], 0
TR 64,5,53248
MA 176,80,16
TR 66,5,53760
MA 176,84,32
TR 68,5,61440
v_mfma_f32_16x16x32_bf16 v[180:183], v[76:79], a[4:7], 0
TR 70,5,61952
MA 180,80,20
TR 72,7,4096
MA 180,84,36
TR 74,7,4608
v_mfma_f32_16x16x32_bf16 v[184:187], v[76:79], a[8:11], 0
buffer_load_dwordx4 v2, s[8:11], s50 offen lds
MA 184,80,24
s_add_u32 m0, s43, 0xb000
s_add_u32 s51, s44, 0x168080
MA 184,84,40
buffer_load_dwordx4 v2, s[12:15], s51 offen lds
v_mfma_f32_16x16x32_bf16 v[188:191], v[76:79], a[12:15], 0
MA 188,80,28
MA 188,84,44
s_waitcnt lgkmcnt(0)
v_mfma_f32_16x16x32_bf16 v[192:195], v[64:67], a[0:3], 0
TR 76,6,53248
MA 192,68,16
TR 78,6,53760
MA 192,72,32
TR 80,6,61440
v_mfma_f32_16x16x32_bf16 v[196:199], v[64:67], a[4:7], 0
TR 82,6,61952
MA 196,68,20
TR 84,8,4096
MA 196,72,36
TR 86,8,4608
v_mfma_f32_16x16x32_bf16 v[200:203], v[64:67], a[8:11], 0
MA 200,68,24
MA 200,72,40
v_mfma_f32_16x16x32_bf16 v[204:207], v[64:67], a[12:15], 0
MA 204,68,28
MA 204,72,44
s_waitcnt lgkmcnt(0)
v_mfma_f32_16x16x32_bf16 v[208:211], v[76:79], a[0:3], 0
s_waitcnt vmcnt(6)
s_barrier
s_add_u32 m0, s43, 0x24000
s_add_u32 s50, s46, 0x12000
MA 208,80,16
TR 64,5,0
TR 66,5,512
MA 208,84,32
ds_read_b128 a[96:99], v12 offset:49152
ds_read_b128 a[100:103], v12 offset:50176
v_mfma_f32_16x16x32_bf16 v[212:215], v[76:79], a[4:7], 0
ds_read_b128 a[104:107], v12 offset:51200
ds_read_b128 a[108:111], v12 offset:52224
MA 212,80,20
TR 68,5,8192
TR 70,5,8704
MA 212,84,36
ds_read_b128 a[112:115], v12 offset:57344
ds_read_b128 a[116:119], v12 offset:58368
v_mfma_f32_16x16x32_bf16 v[216:219], v[76:79], a[8:11], 0
ds_read_b128 a[120:123], v12 offset:59392
ds_read_b128 a[124:127], v12 offset:60416
MA 216,80,24
TR 72,5,16384
TR 74,5,16896
MA 216,84,40
ds_read_b128 a[128:131], v13 offset:0
ds_read_b128 a[132:135], v13 offset:1024
v_mfma_f32_16x16x32_bf16 v[220:223], v[76:79], a[12:15], 0
ds_read_b128 a[136:139], v13 offset:2048
ds_read_b128 a[140:143], v13 offset:3072
MA 220,80,28
buffer_load_dwordx4 v1, s[20:23], s50 offen sc1 lds
MA 220,84,44
s_add_u32 m0, s43, 0x25000
s_add_u32 s51, s46, 0x13000
s_waitcnt lgkmcnt(15)
MA 96,64,96
TR 76,6,0
s_waitcnt lgkmcnt(15)
MA 100,64,100
TR 78,6,512
s_waitcnt lgkmcnt(15)
MA 104,64,104
TR 80,6,8192
s_waitcnt lgkmcnt(15)
MA 108,64,108
TR 82,6,8704
s_waitcnt lgkmcnt(13)
MA 96,68,112
TR 84,6,16384
s_waitcnt lgkmcnt(13)
MA 100,68,116
TR 86,6,16896
s_waitcnt lgkmcnt(13)
MA 104,68,120
buffer_load_dwordx4 v1, s[20:23], s51 offen sc1 lds
s_waitcnt lgkmcnt(12)
MA 108,68,124
s_add_u32 m0, s43, 0xc000
s_add_u32 s50, s44, 0x288000
s_waitcnt lgkmcnt(9)
MA 96,72,128
buffer_load_dwordx4 v2, s[8:11], s50 offen lds
s_waitcnt lgkmcnt(8)
MA 100,72,132
s_add_u32 m0, s43, 0xd000
s_add_u32 s51, s44, 0x288000
s_waitcnt lgkmcnt(7)
MA 104,72,136
buffer_load_dwordx4 v2, s[12:15], s51 offen lds
s_waitcnt lgkmcnt(6)
MA 108,72,140
s_add_u32 m0, s43, 0x12000
s_add_u32 s50, s46, 0x14000
s_waitcnt lgkmcnt(4)
MA 112,76,96
TR 64,5,4096
s_waitcnt lgkmcnt(3)
MA 112,80,112
TR 66,5,4608
s_waitcnt lgkmcnt(2)
MA 112,84,128
TR 68,5,12288
MA 116,76,100
TR 70,5,12800
MA 116,80,116
TR 72,5,20480
MA 116,84,132
TR 74,5,20992
MA 120,76,104
buffer_load_dwordx4 v1, s[20:23], s50 offen sc1 lds
MA 120,80,120
s_add_u32 m0, s43, 0x13000
s_add_u32 s51, s46, 0x15000
MA 120,84,136
buffer_load_dwordx4 v1, s[20:23], s51 offen sc1 lds
MA 124,76,108
s_add_u32 m0, s43, 0xe000
s_add_u32 s50, s44, 0x2d0000
MA 124,80,124
buffer_load_dwordx4 v2, s[8:11], s50 offen lds
MA 124,84,140
s_add_u32 m0, s43, 0xf000
s_add_u32 s51, s44, 0x2d0000
s_waitcnt lgkmcnt(4)
MA 128,64,96
TR 76,6,4096
s_waitcnt lgkmcnt(3)
MA 128,68,112
TR 78,6,4608
s_waitcnt lgkmcnt(2)
MA 128,72,128
TR 80,6,12288
MA 132,64,100
TR 82,6,12800
MA 132,68,116
TR 84,6,20480
MA 132,72,132
TR 86,6,20992
MA 136,64,104
buffer_load_dwordx4 v2, s[12:15], s51 offen lds
MA 136,68,120
s_add_u32 m0, s43, 0x14000
s_add_u32 s50, s46, 0x16000
MA 136,72,136
buffer_load_dwordx4 v1, s[20:23], s50 offen sc1 lds
MA 140,64,108
s_add_u32 m0, s43, 0x15000
s_add_u32 s51, s46, 0x17000
MA 140,68,124
buffer_load_dwordx4 v1, s[20:23], s51 offen sc1 lds
MA 140,72,140
s_add_u32 m0, s43, 0x10000
s_add_u32 s50, s44, 0x318000
s_waitcnt lgkmcnt(4)
MA 144,76,96
s_waitcnt vmcnt(10)
s_waitcnt lgkmcnt(0)
s_barrier
MA 144,80,112
TR 64,5,24576
MA 144,84,128
TR 66,5,25088
MA 148,76,100
TR 68,5,32768
MA 148,80,116
TR 70,5,33280
MA 148,84,132
TR 72,5,40960
MA 152,76,104
TR 74,5,41472
MA 152,80,120
buffer_load_dwordx4 v2, s[8:11], s50 offen lds
MA 152,84,136
s_add_u32 m0, s43, 0x11000
s_add_u32 s51, s44, 0x318000
MA 156,76,108
buffer_load_dwordx4 v2, s[12:15], s51 offen lds
MA 156,80,124
s_add_u32 m0, s43, 0x0
s_add_u32 s50, s44, 0x1b0080
MA 156,84,140
buffer_load_dwordx4 v2, s[8:11], s50 offen lds
s_waitcnt lgkmcnt(0)
MA 160,64,48
s_add_u32 m0, s43, 0x1000
s_add_u32 s51, s44, 0x1b0080
TR 76,6,24576
MA 160,68,64
TR 78,6,25088
MA 160,72,80
TR 80,6,32768
MA 164,64,52
TR 82,6,33280
MA 164,68,68
TR 84,6,40960
MA 164,72,84
TR 86,6,41472
MA 168,64,56
buffer_load_dwordx4 v2, s[12:15], s51 offen lds
MA 168,68,72
s_add_u32 m0, s43, 0x2000
s_add_u32 s50, s44, 0x1f8080
MA 168,72,88
buffer_load_dwordx4 v2, s[8:11], s50 offen lds
MA 172,64,60
s_add_u32 m0, s43, 0x3000
s_add_u32 s51, s44, 0x1f8080
MA 172,68,76
buffer_load_dwordx4 v2, s[12:15], s51 offen lds
MA 172,72,92
s_add_u32 m0, s43, 0x4000
s_add_u32 s50, s44, 0x240080
s_waitcnt lgkmcnt(0)
MA 176,76,48
TR 64,5,28672
MA 176,80,64
TR 66,5,29184
MA 176,84,80
TR 68,5,36864
MA 180,76,52
TR 70,5,37376
MA 180,80,68
TR 72,5,45056
MA 180,84,84
TR 74,5,45568
MA 184,76,56
buffer_load_dwordx4 v2, s[8:11], s50 offen lds
MA 184,80,72
s_add_u32 m0, s43, 0x5000
s_add_u32 s51, s44, 0x240080
MA 184,84,88
buffer_load_dwordx4 v2, s[12:15], s51 offen lds
MA 188,76,60
MA 188,80,76
MA 188,84,92
s_waitcnt lgkmcnt(0)
MA 192,64,48
TR 76,6,28672
MA 192,68,64
TR 78,6,29184
MA 192,72,80
TR 80,6,36864
MA 196,64,52
TR 82,6,37376
MA 196,68,68
TR 84,6,45056
MA 196,72,84
TR 86,6,45568
MA 200,64,56
MA 200,68,72
MA 200,72,88
MA 204,64,60
MA 204,68,76
MA 204,72,92
s_waitcnt lgkmcnt(0)
MA 208,76,48
s_waitcnt vmcnt(6)
s_barrier
s_add_u32 m0, s43, 0x16000
s_add_u32 s50, s46, 0x18000
MA 208,80,64
TR 64,5,49152
TR 66,5,49664
MA 208,84,80
ds_read_b128 a[144:147], v13 offset:8192
ds_read_b128 a[148:151], v13 offset:9216
MA 212,76,52
ds_read_b128 a[152:155], v13 offset:10240
ds_read_b128 a[156:159], v13 offset:11264
MA 212,80,68
TR 68,5,57344
TR 70,5,57856
MA 212,84,84
ds_read_b128 a[160:163], v12 offset:0
ds_read_b128 a[164:167], v12 offset:1024
MA 216,76,56
ds_read_b128 a[168:171], v12 offset:2048
ds_read_b128 a[172:175], v12 offset:3072
MA 216,80,72
TR 72,7,0
TR 74,7,512
MA 216,84,88
ds_read_b128 a[176:179], v12 offset:8192
ds_read_b128 a[180:183], v12 offset:9216
MA 220,76,60
ds_read_b128 a[184:187], v12 offset:10240
ds_read_b128 a[188:191], v12 offset:11264
MA 220,80,76
buffer_load_dwordx4 v1, s[20:23], s50 offen sc1 lds
MA 220,84,92
s_add_u32 m0, s43, 0x17000
s_add_u32 s51, s46, 0x19000
s_waitcnt lgkmcnt(15)
MA 96,64,144
TR 76,6,49152
s_waitcnt lgkmcnt(15)
MA 100,64,148
TR 78,6,49664
s_waitcnt lgkmcnt(15)
MA 104,64,152
TR 80,6,57344
s_waitcnt lgkmcnt(15)
MA 108,64,156
TR 82,6,57856
s_waitcnt lgkmcnt(13)
MA 96,68,160
TR 84,8,0
s_waitcnt lgkmcnt(13)
MA 100,68,164
TR 86,8,512
s_waitcnt lgkmcnt(13)
MA 104,68,168
buffer_load_dwordx4 v1, s[20:23], s51 offen sc1 lds
s_waitcnt lgkmcnt(12)
MA 108,68,172
s_add_u32 m0, s43, 0x6000
s_add_u32 s50, s44, 0x360000
s_waitcnt lgkmcnt(9)
MA 96,72,176
buffer_load_dwordx4 v2, s[8:11], s50 offen lds
s_waitcnt lgkmcnt(8)
MA 100,72,180
s_add_u32 m0, s43, 0x7000
s_add_u32 s51, s44, 0x360000
s_waitcnt lgkmcnt(7)
MA 104,72,184
buffer_load_dwordx4 v2, s[12:15], s51 offen lds
s_waitcnt lgkmcnt(6)
MA 108,72,188
s_add_u32 m0, s43, 0x18000
s_add_u32 s50, s46, 0x1a000
s_waitcnt lgkmcnt(4)
MA 112,76,144
TR 64,5,53248
s_waitcnt lgkmcnt(3)
MA 112,80,160
TR 66,5,53760
s_waitcnt lgkmcnt(2)
MA 112,84,176
TR 68,5,61440
MA 116,76,148
TR 70,5,61952
MA 116,80,164
TR 72,7,4096
MA 116,84,180
TR 74,7,4608
MA 120,76,152
buffer_load_dwordx4 v1, s[20:23], s50 offen sc1 lds
MA 120,80,168
s_add_u32 m0, s43, 0x19000
s_add_u32 s51, s46, 0x1b000
MA 120,84,184
buffer_load_dwordx4 v1, s[20:23], s51 offen sc1 lds
MA 124,76,156
s_add_u32 m0, s43, 0x8000
s_add_u32 s50, s44, 0x3a8000
MA 124,80,172
buffer_load_dwordx4 v2, s[8:11], s50 offen lds
MA 124,84,188
s_add_u32 m0, s43, 0x9000
s_add_u32 s51, s44, 0x3a8000
s_waitcnt lgkmcnt(4)
MA 128,64,144
TR 76,6,53248
s_waitcnt lgkmcnt(3)
MA 128,68,160
TR 78,6,53760
s_waitcnt lgkmcnt(2)
MA 128,72,176
TR 80,6,61440
MA 132,64,148
TR 82,6,61952
MA 132,68,164
TR 84,8,4096
MA 132,72,180
TR 86,8,4608
MA 136,64,152
buffer_load_dwordx4 v2, s[12:15], s51 offen lds
MA 136,68,168
s_add_u32 m0, s43, 0x1a000
s_add_u32 s50, s46, 0x1c000
MA 136,72,184
buffer_load_dwordx4 v1, s[20:23], s50 offen sc1 lds
MA 140,64,156
s_add_u32 m0, s43, 0x1b000
s_add_u32 s51, s46, 0x1d000
MA 140,68,172
buffer_load_dwordx4 v1, s[20:23], s51 offen sc1 lds
MA 140,72,188
s_add_u32 m0, s43, 0xa000
s_add_u32 s50, s44, 0x3f0000
s_waitcnt lgkmcnt(4)
MA 144,76,144
s_waitcnt vmcnt(10)
s_waitcnt lgkmcnt(0)
s_barrier
MA 144,80,160
TR 64,5,0
MA 144,84,176
TR 66,5,512
MA 148,76,148
TR 68,5,8192
MA 148,80,164
TR 70,5,8704
MA 148,84,180
TR 72,5,16384
MA 152,76,152
TR 74,5,16896
MA 152,80,168
buffer_load_dwordx4 v2, s[8:11], s50 offen lds
MA 152,84,184
s_add_u32 m0, s43, 0xb000
s_add_u32 s51, s44, 0x3f0000
MA 156,76,156
buffer_load_dwordx4 v2, s[12:15], s51 offen lds
MA 156,80,172
s_add_u32 m0, s43, 0x1c000
s_add_u32 s50, s46, 0x1e000
MA 156,84,188
buffer_load_dwordx4 v1, s[20:23], s50 offen sc1 lds
s_waitcnt lgkmcnt(0)
MA 160,64,96
s_add_u32 m0, s43, 0x1d000
s_add_u32 s51, s46, 0x1f000
TR 76,6,0
MA 160,68,112
TR 78,6,512
MA 160,72,128
TR 80,6,8192
MA 164,64,100
TR 82,6,8704
MA 164,68,116
TR 84,6,16384
MA 164,72,132
TR 86,6,16896
MA 168,64,104
buffer_load_dwordx4 v1, s[20:23], s51 offen sc1 lds
MA 168,68,120
s_add_u32 m0, s43, 0xc000
s_add_u32 s50, s44, 0x438000
MA 168,72,136
buffer_load_dwordx4 v2, s[8:11], s50 offen lds
MA 172,64,108
s_add_u32 m0, s43, 0xd000
s_add_u32 s51, s44, 0x438000
MA 172,68,124
buffer_load_dwordx4 v2, s[12:15], s51 offen lds
MA 172,72,140
s_add_u32 m0, s43, 0x1e000
s_add_u32 s50, s46, 0x20000
s_waitcnt lgkmcnt(0)
MA 176,76,96
TR 64,5,4096
MA 176,80,112
TR 66,5,4608
MA 176,84,128
TR 68,5,12288
MA 180,76,100
TR 70,5,12800
MA 180,80,116
TR 72,5,20480
MA 180,84,132
TR 74,5,20992
MA 184,76,104
buffer_load_dwordx4 v1, s[20:23], s50 offen sc1 lds
MA 184,80,120
s_add_u32 m0, s43, 0x1f000
s_add_u32 s51, s46, 0x21000
MA 184,84,136
buffer_load_dwordx4 v1, s[20:23], s51 offen sc1 lds
MA 188,76,108
s_add_u32 m0, s43, 0xe000
s_add_u32 s50, s44, 0x480000
MA 188,80,124
buffer_load_dwordx4 v2, s[8:11], s50 offen lds
MA 188,84,140
s_add_u32 m0, s43, 0xf000
s_add_u32 s51, s44, 0x480000
s_waitcnt lgkmcnt(0)
MA 192,64,96
TR 76,6,4096
MA 192,68,112
TR 78,6,4608
MA 192,72,128
TR 80,6,12288
MA 196,64,100
TR 82,6,12800
MA 196,68,116
TR 84,6,20480
MA 196,72,132
TR 86,6,20992
MA 200,64,104
buffer_load_dwordx4 v2, s[12:15], s51 offen lds
MA 200,68,120
s_add_u32 m0, s43, 0x20000
s_add_u32 s50, s46, 0x22000
MA 200,72,136
buffer_load_dwordx4 v1, s[20:23], s50 offen sc1 lds
MA 204,64,108
s_add_u32 m0, s43, 0x21000
s_add_u32 s51, s46, 0x23000
MA 204,68,124
buffer_load_dwordx4 v1, s[20:23], s51 offen sc1 lds
MA 204,72,140
s_add_u32 m0, s43, 0x10000
s_add_u32 s50, s44, 0x4c8000
s_waitcnt lgkmcnt(0)
MA 208,76,96
s_waitcnt vmcnt(10)
s_barrier
MA 208,80,112
TR 64,5,24576
TR 66,5,25088
MA 208,84,128
ds_read_b128 a[192:195], v12 offset:16384
ds_read_b128 a[196:199], v12 offset:17408
MA 212,76,100
ds_read_b128 a[200:203], v12 offset:18432
ds_read_b128 a[204:207], v12 offset:19456
MA 212,80,116
TR 68,5,32768
TR 70,5,33280
MA 212,84,132
ds_read_b128 a[208:211], v12 offset:24576
ds_read_b128 a[212:215], v12 offset:25600
MA 216,76,104
ds_read_b128 a[216:219], v12 offset:26624
ds_read_b128 a[220:223], v12 offset:27648
MA 216,80,120
TR 72,5,40960
TR 74,5,41472
MA 216,84,136
ds_read_b128 a[224:227], v12 offset:32768
ds_read_b128 a[228:231], v12 offset:33792
MA 220,76,108
ds_read_b128 a[232:235], v12 offset:34816
ds_read_b128 a[236:239], v12 offset:35840
MA 220,80,124
buffer_load_dwordx4 v2, s[8:11], s50 offen lds
MA 220,84,140
s_add_u32 m0, s43, 0x11000
s_add_u32 s51, s44, 0x4c8000
s_waitcnt lgkmcnt(15)
MA 96,64,192
TR 76,6,24576
s_waitcnt lgkmcnt(15)
MA 100,64,196
TR 78,6,25088
s_waitcnt lgkmcnt(15)
MA 104,64,200
TR 80,6,32768
s_waitcnt lgkmcnt(15)
MA 108,64,204
TR 82,6,33280
s_waitcnt lgkmcnt(13)
MA 96,68,208
TR 84,6,40960
s_waitcnt lgkmcnt(13)
MA 100,68,212
TR 86,6,41472
s_waitcnt lgkmcnt(13)
MA 104,68,216
buffer_load_dwordx4 v2, s[12:15], s51 offen lds
s_waitcnt lgkmcnt(12)
MA 108,68,220
s_add_u32 m0, s43, 0x0
s_add_u32 s50, s44, 0x288080
s_waitcnt lgkmcnt(9)
MA 96,72,224
buffer_load_dwordx4 v2, s[8:11], s50 offen lds
s_waitcnt lgkmcnt(8)
MA 100,72,228
s_add_u32 m0, s43, 0x1000
s_add_u32 s51, s44, 0x288080
s_waitcnt lgkmcnt(7)
MA 104,72,232
buffer_load_dwordx4 v2, s[12:15], s51 offen lds
s_waitcnt lgkmcnt(6)
MA 108,72,236
s_add_u32 m0, s43, 0x2000
s_add_u32 s50, s44, 0x2d0080
s_waitcnt lgkmcnt(4)
MA 112,76,192
TR 64,5,28672
s_waitcnt lgkmcnt(3)
MA 112,80,208
TR 66,5,29184
s_waitcnt lgkmcnt(2)
MA 112,84,224
TR 68,5,36864
MA 116,76,196
TR 70,5,37376
MA 116,80,212
TR 72,5,45056
MA 116,84,228
TR 74,5,45568
MA 120,76,200
buffer_load_dwordx4 v2, s[8:11], s50 offen lds
MA 120,80,216
s_add_u32 m0, s43, 0x3000
s_add_u32 s51, s44, 0x2d0080
MA 120,84,232
buffer_load_dwordx4 v2, s[12:15], s51 offen lds
MA 124,76,204
s_add_u32 m0, s43, 0x4000
s_add_u32 s50, s44, 0x318080
MA 124,80,220
buffer_load_dwordx4 v2, s[8:11], s50 offen lds
MA 124,84,236
s_add_u32 m0, s43, 0x5000
s_add_u32 s51, s44, 0x318080
s_waitcnt lgkmcnt(4)
MA 128,64,192
TR 76,6,28672
s_waitcnt lgkmcnt(3)
MA 128,68,208
TR 78,6,29184
s_waitcnt lgkmcnt(2)
MA 128,72,224
TR 80,6,36864
MA 132,64,196
TR 82,6,37376
MA 132,68,212
TR 84,6,45056
MA 132,72,228
TR 86,6,45568
MA 136,64,200
buffer_load_dwordx4 v2, s[12:15], s51 offen lds
MA 136,68,216
MA 136,72,232
MA 140,64,204
MA 140,68,220
MA 140,72,236
s_waitcnt lgkmcnt(4)
MA 144,76,192
s_waitcnt vmcnt(6)
s_waitcnt lgkmcnt(0)
s_barrier
s_add_u32 m0, s43, 0x6000
s_add_u32 s50, s44, 0x360080
MA 144,80,208
TR 64,5,49152
TR 66,5,49664
MA 144,84,224
ds_read_b128 a[240:243], v12 offset:40960
ds_read_b128 a[244:247], v12 offset:41984
MA 148,76,196
ds_read_b128 a[248:251], v12 offset:43008
ds_read_b128 a[252:255], v12 offset:44032
MA 148,80,212
TR 68,5,57344
TR 70,5,57856
MA 148,84,228
ds_read_b128 v[224:227], v12 offset:49152
ds_read_b128 v[228:231], v12 offset:50176
MA 152,76,200
ds_read_b128 v[232:235], v12 offset:51200
ds_read_b128 v[236:239], v12 offset:52224
MA 152,80,216
TR 72,7,0
TR 74,7,512
MA 152,84,232
ds_read_b128 v[240:243], v12 offset:57344
ds_read_b128 v[244:247], v12 offset:58368
MA 156,76,204
ds_read_b128 v[248:251], v12 offset:59392
ds_read_b128 v[252:255], v12 offset:60416
MA 156,80,220
buffer_load_dwordx4 v2, s[8:11], s50 offen lds
MA 156,84,236
s_add_u32 m0, s43, 0x7000
s_add_u32 s51, s44, 0x360080
s_waitcnt lgkmcnt(15)
MA 96,64,240
TR 76,6,49152
s_waitcnt lgkmcnt(15)
MA 100,64,244
TR 78,6,49664
s_waitcnt lgkmcnt(15)
MA 104,64,248
TR 80,6,57344
s_waitcnt lgkmcnt(15)
MA 108,64,252
TR 82,6,57856
s_waitcnt lgkmcnt(13)
v_mfma_f32_16x16x32_bf16 v[96:99], v[68:71], v[224:227], v[96:99]
TR 84,8,0
s_waitcnt lgkmcnt(13)
v_mfma_f32_16x16x32_bf16 v[100:103], v[68:71], v[228:231], v[100:103]
TR 86,8,512
s_waitcnt lgkmcnt(13)
v_mfma_f32_16x16x32_bf16 v[104:107], v[68:71], v[232:235], v[104:107]
buffer_load_dwordx4 v2, s[12:15], s51 offen lds
s_waitcnt lgkmcnt(12)
v_mfma_f32_16x16x32_bf16 v[108:111], v[68:71], v[236:239], v[108:111]
s_add_u32 m0, s43, 0x8000
s_add_u32 s50, s44, 0x3a8080
s_waitcnt lgkmcnt(9)
v_mfma_f32_16x16x32_bf16 v[96:99], v[72:75], v[240:243], v[96:99]
buffer_load_dwordx4 v2, s[8:11], s50 offen lds
s_waitcnt lgkmcnt(8)
v_mfma_f32_16x16x32_bf16 v[100:103], v[72:75], v[244:247], v[100:103]
s_add_u32 m0, s43, 0x9000
s_add_u32 s51, s44, 0x3a8080
s_waitcnt lgkmcnt(7)
v_mfma_f32_16x16x32_bf16 v[104:107], v[72:75], v[248:251], v[104:107]
buffer_load_dwordx4 v2, s[12:15], s51 offen lds
s_waitcnt lgkmcnt(6)
v_mfma_f32_16x16x32_bf16 v[108:111], v[72:75], v[252:255], v[108:111]
s_add_u32 m0, s43, 0xa000
s_add_u32 s50, s44, 0x3f0080
s_waitcnt lgkmcnt(4)
MA 112,76,240
TR 64,5,53248
s_waitcnt lgkmcnt(3)
v_mfma_f32_16x16x32_bf16 v[112:115], v[80:83], v[224:227], v[112:115]
TR 66,5,53760
s_waitcnt lgkmcnt(2)
v_mfma_f32_16x16x32_bf16 v[112:115], v[84:87], v[240:243], v[112:115]
TR 68,5,61440
MA 116,76,244
TR 70,5,61952
v_mfma_f32_16x16x32_bf16 v[116:119], v[80:83], v[228:231], v[116:119]
TR 72,7,4096
v_mfma_f32_16x16x32_bf16 v[116:119], v[84:87], v[244:247], v[116:119]
TR 74,7,4608
MA 120,76,248
buffer_load_dwordx4 v2, s[8:11], s50 offen lds
v_mfma_f32_16x16x32_bf16 v[120:123], v[80:83], v[232:235], v[120:123]
s_add_u32 m0, s43, 0xb000
s_add_u32 s51, s44, 0x3f0080
v_mfma_f32_16x16x32_bf16 v[120:123], v[84:87], v[248:251], v[120:123]
buffer_load_dwordx4 v2, s[12:15], s51 offen lds
MA 124,76,252
v_mfma_f32_16x16x32_bf16 v[124:127], v[80:83], v[236:239], v[124:127]
v_mfma_f32_16x16x32_bf16 v[124:127], v[84:87], v[252:255], v[124:127]
s_waitcnt lgkmcnt(4)
MA 128,64,240
TR 76,6,53248
s_waitcnt lgkmcnt(3)
v_mfma_f32_16x16x32_bf16 v[128:131], v[68:71], v[224:227], v[128:131]
TR 78,6,53760
s_waitcnt lgkmcnt(2)
v_mfma_f32_16x16x32_bf16 v[128:131], v[72:75], v[240:243], v[128:131]
TR 80,6,61440
MA 132,64,244
TR 82,6,61952
v_mfma_f32_16x16x32_bf16 v[132:135], v[68:71], v[228:231], v[132:135]
TR 84,8,4096
v_mfma_f32_16x16x32_bf16 v[132:135], v[72:75], v[244:247], v[132:135]
TR 86,8,4608
MA 136,64,248
v_mfma_f32_16x16x32_bf16 v[136:139], v[68:71], v[232:235], v[136:139]
v_mfma_f32_16x16x32_bf16 v[136:139], v[72:75], v[248:251], v[136:139]
MA 140,64,252
v_mfma_f32_16x16x32_bf16 v[140:143], v[68:71], v[236:239], v[140:143]
v_mfma_f32_16x16x32_bf16 v[140:143], v[72:75], v[252:255], v[140:143]
s_waitcnt lgkmcnt(4)
MA 144,76,240
s_waitcnt vmcnt(6)
s_waitcnt lgkmcnt(0)
s_barrier
s_add_u32 m0, s43, 0xc000
s_add_u32 s50, s44, 0x438080
v_mfma_f32_16x16x32_bf16 v[144:147], v[80:83], v[224:227], v[144:147]
TR 64,5,0
v_mfma_f32_16x16x32_bf16 v[144:147], v[84:87], v[240:243], v[144:147]
TR 66,5,512
MA 148,76,244
TR 68,5,8192
v_mfma_f32_16x16x32_bf16 v[148:151], v[80:83], v[228:231], v[148:151]
TR 70,5,8704
v_mfma_f32_16x16x32_bf16 v[148:151], v[84:87], v[244:247], v[148:151]
TR 72,5,16384
MA 152,76,248
TR 74,5,16896
v_mfma_f32_16x16x32_bf16 v[152:155], v[80:83], v[232:235], v[152:155]
buffer_load_dwordx4 v2, s[8:11], s50 offen lds
v_mfma_f32_16x16x32_bf16 v[152:155], v[84:87], v[248:251], v[152:155]
s_add_u32 m0, s43, 0xd000
s_add_u32 s51, s44, 0x438080
MA 156,76,252
buffer_load_dwordx4 v2, s[12:15], s51 offen lds
v_mfma_f32_16x16x32_bf16 v[156:159], v[80:83], v[236:239], v[156:159]
s_add_u32 m0, s43, 0xe000
s_add_u32 s50, s44, 0x480080
v_mfma_f32_16x16x32_bf16 v[156:159], v[84:87], v[252:255], v[156:159]
buffer_load_dwordx4 v2, s[8:11], s50 offen lds
s_waitcnt lgkmcnt(0)
MA 160,64,144
s_add_u32 m0, s43, 0xf000
TR 76,6,0
MA 160,68,160
s_add_u32 s51, s44, 0x480080
TR 78,6,512
MA 160,72,176
TR 80,6,8192
MA 164,64,148
TR 82,6,8704
MA 164,68,164
TR 84,6,16384
v_mul_f32 v128, v96, v128
MA 164,72,180
TR 86,6,16896
v_mul_f32 v129, v97, v129
MA 168,64,152
buffer_load_dwordx4 v2, s[12:15], s51 offen lds
MA 168,68,168
s_add_u32 m0, s43, 0x10000
v_exp_f32 v96, -v96
MA 168,72,184
s_add_u32 s50, s44, 0x4c8080
v_exp_f32 v97, -v97
MA 172,64,156
v_mul_f32 v130, v98, v130
v_mul_f32 v131, v99, v131
MA 172,68,172
v_exp_f32 v98, -v98
MA 172,72,188
buffer_load_dwordx4 v2, s[8:11], s50 offen lds
s_waitcnt lgkmcnt(0)
MA 176,76,144
s_add_u32 m0, s43, 0x11000
TR 64,5,4096
v_mul_f32 v144, v112, v144
MA 176,80,160
s_add_u32 s51, s44, 0x4c8080
TR 66,5,4608
v_mul_f32 v145, v113, v145
MA 176,84,176
TR 68,5,12288
v_mul_f32 v146, v114, v146
MA 180,76,148
TR 70,5,12800
v_mul_f32 v147, v115, v147
MA 180,80,164
TR 72,5,20480
v_add_f32 v96, 1.0, v96
MA 180,84,180
TR 74,5,20992
v_add_f32 v97, 1.0, v97
MA 184,76,152
buffer_load_dwordx4 v2, s[12:15], s51 offen lds
MA 184,80,168
v_exp_f32 v99, -v99
MA 184,84,184
v_exp_f32 v112, -v112
MA 188,76,156
v_exp_f32 v113, -v113
MA 188,80,172
v_exp_f32 v114, -v114
MA 188,84,188
v_add_f32 v98, 1.0, v98
s_waitcnt lgkmcnt(0)
MA 192,64,144
TR 76,6,4096
v_add_f32 v99, 1.0, v99
MA 192,68,160
TR 78,6,4608
v_add_f32 v112, 1.0, v112
MA 192,72,176
TR 80,6,12288
v_add_f32 v113, 1.0, v113
MA 196,64,148
TR 82,6,12800
v_add_f32 v114, 1.0, v114
MA 196,68,164
TR 84,6,20480
v_mul_f32 v132, v100, v132
MA 196,72,180
TR 86,6,20992
MA 200,64,152
v_exp_f32 v115, -v115
MA 200,68,168
v_rcp_f32 v96, v96
MA 200,72,184
v_rcp_f32 v97, v97
MA 204,64,156
v_rcp_f32 v98, v98
MA 204,68,172
v_rcp_f32 v99, v99
MA 204,72,188
v_add_f32 v115, 1.0, v115
s_waitcnt lgkmcnt(0)
MA 208,76,144
s_waitcnt vmcnt(6)
s_barrier
s_add_u32 m0, s43, 0x0
v_rcp_f32 v112, v112
MA 208,80,160
s_add_u32 s50, s44, 0x100
TR 64,5,24576
v_mul_f32 v128, v128, v96
MA 208,84,176
TR 66,5,25088
v_mul_f32 v129, v129, v97
MA 212,76,148
TR 68,5,32768
v_mul_f32 v130, v130, v98
MA 212,80,164
TR 70,5,33280
v_mul_f32 v131, v131, v99
MA 212,84,180
TR 72,5,40960
v_mul_f32 v144, v144, v112
MA 216,76,152
TR 74,5,41472
v_cvt_pk_bf16_f32 v96, v128, v129
MA 216,80,168
buffer_load_dwordx4 v2, s[8:11], s50 offen lds
MA 216,84,184
s_add_u32 m0, s43, 0x1000
v_rcp_f32 v113, v113
MA 220,76,156
s_add_u32 s51, s44, 0x100
v_rcp_f32 v114, v114
MA 220,80,172
v_rcp_f32 v115, v115
MA 220,84,188
v_mul_f32 v145, v145, v113
s_waitcnt lgkmcnt(0)
MA 160,64,192
TR 76,6,24576
v_mul_f32 v146, v146, v114
MA 160,68,208
TR 78,6,25088
v_mul_f32 v147, v147, v115
MA 160,72,224
TR 80,6,32768
v_cvt_pk_bf16_f32 v97, v130, v131
MA 164,64,196
TR 82,6,33280
v_cvt_pk_bf16_f32 v98, v144, v145
MA 164,68,212
TR 84,6,40960
v_cvt_pk_bf16_f32 v99, v146, v147
MA 164,72,228
TR 86,6,41472
v_mul_f32 v133, v101, v133
MA 168,64,200
buffer_load_dwordx4 v2, s[12:15], s51 offen lds
MA 168,68,216
s_add_u32 m0, s43, 0x2000
ds_write_b128 v11, v[96:99] offset:0
MA 168,72,232
s_add_u32 s50, s44, 0x48100
v_exp_f32 v100, -v100
MA 172,64,204
v_exp_f32 v101, -v101
MA 172,68,220
v_and_b32 v62, 63, v0
v_cmp_gt_u32 vcc, 9, v62
s_mul_i32 s82, s41, 36
s_mul_i32 s83, s40, 9
s_add_u32 s82, s82, s83
v_add_u32 v62, s82, v62
v_mul_u32_u24 v62, 9216, v62
v_cndmask_b32 v62, -4, v62, vcc
MA 172,72,236
buffer_load_dwordx4 v2, s[8:11], s50 offen lds
s_waitcnt lgkmcnt(1)
MA 176,76,192
s_add_u32 m0, s43, 0x3000
TR 64,5,28672
s_add_u32 s83, s44, 384
MA 176,80,208
s_add_u32 s51, s44, 0x48100
TR 66,5,29184
v_mul_f32 v134, v102, v134
MA 176,84,224
TR 68,5,36864
v_mul_f32 v135, v103, v135
MA 180,76,196
TR 70,5,37376
v_mul_f32 v148, v116, v148
MA 180,80,212
TR 72,5,45056
v_mul_f32 v149, v117, v149
MA 180,84,228
TR 74,5,45568
v_mul_f32 v150, v118, v150
MA 184,76,200
buffer_load_dwordx4 v2, s[12:15], s51 offen lds
MA 184,80,216
s_add_u32 m0, s43, 0x4000
v_exp_f32 v102, -v102
MA 184,84,232
s_add_u32 s50, s44, 0x90100
v_exp_f32 v103, -v103
MA 188,76,204
v_exp_f32 v116, -v116
MA 188,80,220
v_exp_f32 v117, -v117
MA 188,84,236
buffer_load_dwordx4 v2, s[8:11], s50 offen lds
s_waitcnt lgkmcnt(0)
MA 192,64,192
s_add_u32 m0, s43, 0x5000
TR 76,6,28672
v_mul_f32 v151, v119, v151
MA 192,68,208
s_add_u32 s51, s44, 0x90100
TR 78,6,29184
v_add_f32 v100, 1.0, v100
MA 192,72,224
TR 80,6,36864
v_add_f32 v101, 1.0, v101
MA 196,64,196
TR 82,6,37376
v_add_f32 v102, 1.0, v102
MA 196,68,212
TR 84,6,45056
v_add_f32 v103, 1.0, v103
MA 196,72,228
TR 86,6,45568
v_add_f32 v116, 1.0, v116
MA 200,64,200
buffer_load_dwordx4 v2, s[12:15], s51 offen lds
MA 200,68,216
buffer_load_dword v60, v62, s[8:11], s83 offen
v_add_f32 v117, 1.0, v117
MA 200,72,232
buffer_load_dword v60, v62, s[12:15], s83 offen
s_add_u32 s83, s44, 512
MA 204,64,204
v_exp_f32 v118, -v118
MA 204,68,220
v_exp_f32 v119, -v119
MA 204,72,236
v_add_f32 v118, 1.0, v118
s_waitcnt lgkmcnt(0)
MA 208,76,192
s_waitcnt vmcnt(8)
s_barrier
s_add_u32 m0, s43, 0x6000
v_rcp_f32 v100, v100
MA 208,80,208
s_add_u32 s50, s44, 0xd8100
TR 64,5,49152
v_add_f32 v119, 1.0, v119
MA 208,84,224
TR 66,5,49664
v_mul_f32 v132, v132, v100
MA 212,76,196
TR 68,5,57344
v_mul_f32 v136, v104, v136
MA 212,80,212
TR 70,5,57856
v_mul_f32 v137, v105, v137
MA 212,84,228
TR 72,7,0
v_mul_f32 v138, v106, v138
MA 216,76,200
TR 74,7,512
v_mul_f32 v139, v107, v139
MA 216,80,216
buffer_load_dwordx4 v2, s[8:11], s50 offen lds
MA 216,84,232
s_add_u32 m0, s43, 0x7000
v_rcp_f32 v101, v101
MA 220,76,204
s_add_u32 s51, s44, 0xd8100
v_rcp_f32 v102, v102
MA 220,80,220
v_rcp_f32 v103, v103
MA 220,84,236
v_mul_f32 v133, v133, v101
s_waitcnt lgkmcnt(0)
MA 160,64,240
TR 76,6,49152
v_mul_f32 v134, v134, v102
v_mfma_f32_16x16x32_bf16 v[160:163], v[68:71], v[224:227], v[160:163]
TR 78,6,49664
v_mul_f32 v135, v135, v103
v_mfma_f32_16x16x32_bf16 v[160:163], v[72:75], v[240:243], v[160:163]
TR 80,6,57344
v_cvt_pk_bf16_f32 v100, v132, v133
MA 164,64,244
TR 82,6,57856
v_cvt_pk_bf16_f32 v101, v134, v135
v_mfma_f32_16x16x32_bf16 v[164:167], v[68:71], v[228:231], v[164:167]
TR 84,8,0
v_mul_f32 v152, v120, v152
v_mfma_f32_16x16x32_bf16 v[164:167], v[72:75], v[244:247], v[164:167]
TR 86,8,512
v_mul_f32 v153, v121, v153
MA 168,64,248
buffer_load_dwordx4 v2, s[12:15], s51 offen lds
v_mfma_f32_16x16x32_bf16 v[168:171], v[68:71], v[232:235], v[168:171]
s_add_u32 m0, s43, 0x8000
v_rcp_f32 v116, v116
v_mfma_f32_16x16x32_bf16 v[168:171], v[72:75], v[248:251], v[168:171]
s_add_u32 s50, s44, 0x120100
v_rcp_f32 v117, v117
MA 172,64,252
v_rcp_f32 v118, v118
v_mfma_f32_16x16x32_bf16 v[172:175], v[68:71], v[236:239], v[172:175]
v_rcp_f32 v119, v119
v_mfma_f32_16x16x32_bf16 v[172:175], v[72:75], v[252:255], v[172:175]
buffer_load_dwordx4 v2, s[8:11], s50 offen lds
s_waitcnt lgkmcnt(0)
MA 176,76,240
s_add_u32 m0, s43, 0x9000
TR 64,5,53248
v_mul_f32 v148, v148, v116
v_mfma_f32_16x16x32_bf16 v[176:179], v[80:83], v[224:227], v[176:179]
s_add_u32 s51, s44, 0x120100
TR 66,5,53760
v_mul_f32 v149, v149, v117
v_mfma_f32_16x16x32_bf16 v[176:179], v[84:87], v[240:243], v[176:179]
TR 68,5,61440
v_mul_f32 v150, v150, v118
MA 180,76,244
TR 70,5,61952
v_mul_f32 v151, v151, v119
v_mfma_f32_16x16x32_bf16 v[180:183], v[80:83], v[228:231], v[180:183]
TR 72,7,4096
v_cvt_pk_bf16_f32 v102, v148, v149
v_mfma_f32_16x16x32_bf16 v[180:183], v[84:87], v[244:247], v[180:183]
TR 74,7,4608
v_cvt_pk_bf16_f32 v103, v150, v151
MA 184,76,248
buffer_load_dwordx4 v2, s[12:15], s51 offen lds
v_mfma_f32_16x16x32_bf16 v[184:187], v[80:83], v[232:235], v[184:187]
s_add_u32 m0, s43, 0xa000
ds_write_b128 v11, v[100:103] offset:1024
v_mfma_f32_16x16x32_bf16 v[184:187], v[84:87], v[248:251], v[184:187]
s_add_u32 s50, s44, 0x168100
v_exp_f32 v104, -v104
MA 188,76,252
v_exp_f32 v105, -v105
v_mfma_f32_16x16x32_bf16 v[188:191], v[80:83], v[236:239], v[188:191]
v_exp_f32 v106, -v106
v_mfma_f32_16x16x32_bf16 v[188:191], v[84:87], v[252:255], v[188:191]
buffer_load_dwordx4 v2, s[8:11], s50 offen lds
s_waitcnt lgkmcnt(1)
MA 192,64,240
s_add_u32 m0, s43, 0xb000
TR 76,6,53248
v_mul_f32 v154, v122, v154
v_mfma_f32_16x16x32_bf16 v[192:195], v[68:71], v[224:227], v[192:195]
s_add_u32 s51, s44, 0x168100
TR 78,6,53760
v_mul_f32 v155, v123, v155
v_mfma_f32_16x16x32_bf16 v[192:195], v[72:75], v[240:243], v[192:195]
TR 80,6,61440
v_add_f32 v104, 1.0, v104
MA 196,64,244
TR 82,6,61952
v_add_f32 v105, 1.0, v105
v_mfma_f32_16x16x32_bf16 v[196:199], v[68:71], v[228:231], v[196:199]
TR 84,8,4096
v_add_f32 v106, 1.0, v106
v_mfma_f32_16x16x32_bf16 v[196:199], v[72:75], v[244:247], v[196:199]
TR 86,8,4608
MA 200,64,248
buffer_load_dwordx4 v2, s[12:15], s51 offen lds
v_mfma_f32_16x16x32_bf16 v[200:203], v[68:71], v[232:235], v[200:203]
buffer_load_dword v60, v62, s[8:11], s83 offen
v_mfma_f32_16x16x32_bf16 v[200:203], v[72:75], v[248:251], v[200:203]
buffer_load_dword v60, v62, s[12:15], s83 offen
s_add_u32 s83, s52, 0
MA 204,64,252
v_exp_f32 v107, -v107
v_mfma_f32_16x16x32_bf16 v[204:207], v[68:71], v[236:239], v[204:207]
v_exp_f32 v120, -v120
v_mfma_f32_16x16x32_bf16 v[204:207], v[72:75], v[252:255], v[204:207]
v_add_f32 v107, 1.0, v107
s_waitcnt lgkmcnt(0)
MA 208,76,240
s_waitcnt vmcnt(10)
s_barrier
s_add_u32 m0, s43, 0xc000
v_exp_f32 v121, -v121
v_mfma_f32_16x16x32_bf16 v[208:211], v[80:83], v[224:227], v[208:211]
s_add_u32 s50, s44, 0x1b0100
TR 64,5,0
v_add_f32 v120, 1.0, v120
v_mfma_f32_16x16x32_bf16 v[208:211], v[84:87], v[240:243], v[208:211]
TR 66,5,512
v_add_f32 v121, 1.0, v121
MA 212,76,244
TR 68,5,8192
v_mfma_f32_16x16x32_bf16 v[212:215], v[80:83], v[228:231], v[212:215]
TR 70,5,8704
v_mfma_f32_16x16x32_bf16 v[212:215], v[84:87], v[244:247], v[212:215]
TR 72,5,16384
MA 216,76,248
TR 74,5,16896
v_mfma_f32_16x16x32_bf16 v[216:219], v[80:83], v[232:235], v[216:219]
buffer_load_dwordx4 v2, s[8:11], s50 offen lds
v_mfma_f32_16x16x32_bf16 v[216:219], v[84:87], v[248:251], v[216:219]
s_add_u32 m0, s43, 0xd000
v_exp_f32 v122, -v122
MA 220,76,252
s_add_u32 s51, s44, 0x1b0100
v_exp_f32 v123, -v123
v_mfma_f32_16x16x32_bf16 v[220:223], v[80:83], v[236:239], v[220:223]
v_rcp_f32 v104, v104
v_mfma_f32_16x16x32_bf16 v[220:223], v[84:87], v[252:255], v[220:223]
v_add_f32 v122, 1.0, v122
v_rcp_f32 v105, v105
v_rcp_f32 v106, v106
v_rcp_f32 v107, v107
v_rcp_f32 v120, v120
v_rcp_f32 v121, v121
v_rcp_f32 v122, v122
v_add_f32 v123, 1.0, v123
v_rcp_f32 v123, v123
v_mul_f32 v136, v136, v104
v_mul_f32 v137, v137, v105
v_mul_f32 v138, v138, v106
v_mul_f32 v139, v139, v107
v_mul_f32 v152, v152, v120
v_mul_f32 v153, v153, v121
v_mul_f32 v154, v154, v122
v_mul_f32 v155, v155, v123
v_cvt_pk_bf16_f32 v104, v136, v137
v_cvt_pk_bf16_f32 v105, v138, v139
v_cvt_pk_bf16_f32 v106, v152, v153
v_cvt_pk_bf16_f32 v107, v154, v155
ds_write_b128 v11, v[104:107] offset:2048
v_mul_f32 v140, v108, v140
v_exp_f32 v108, -v108
v_mul_f32 v141, v109, v141
v_exp_f32 v109, -v109
v_mul_f32 v142, v110, v142
v_exp_f32 v110, -v110
v_mul_f32 v143, v111, v143
v_exp_f32 v111, -v111
v_mul_f32 v156, v124, v156
v_exp_f32 v124, -v124
v_mul_f32 v157, v125, v157
v_exp_f32 v125, -v125
v_mul_f32 v158, v126, v158
v_exp_f32 v126, -v126
v_mul_f32 v159, v127, v159
v_exp_f32 v127, -v127
v_add_f32 v108, 1.0, v108
v_rcp_f32 v108, v108
v_add_f32 v109, 1.0, v109
v_rcp_f32 v109, v109
v_add_f32 v110, 1.0, v110
v_rcp_f32 v110, v110
v_add_f32 v111, 1.0, v111
v_rcp_f32 v111, v111
v_add_f32 v124, 1.0, v124
v_rcp_f32 v124, v124
v_add_f32 v125, 1.0, v125
v_rcp_f32 v125, v125
v_add_f32 v126, 1.0, v126
v_rcp_f32 v126, v126
v_add_f32 v127, 1.0, v127
v_rcp_f32 v127, v127
v_mul_f32 v140, v140, v108
v_mul_f32 v141, v141, v109
v_mul_f32 v142, v142, v110
v_mul_f32 v143, v143, v111
v_mul_f32 v156, v156, v124
v_mul_f32 v157, v157, v125
v_mul_f32 v158, v158, v126
v_mul_f32 v159, v159, v127
v_cvt_pk_bf16_f32 v108, v140, v141
v_cvt_pk_bf16_f32 v109, v142, v143
v_cvt_pk_bf16_f32 v110, v156, v157
v_cvt_pk_bf16_f32 v111, v158, v159
ds_write_b128 v11, v[108:111] offset:3072
s_waitcnt lgkmcnt(2)
v_mfma_f32_16x16x32_bf16 v[96:99], v[64:67], a[0:3], 0
TR 76,6,0
MA 96,68,16
TR 78,6,512
MA 96,72,32
TR 80,6,8192
v_mfma_f32_16x16x32_bf16 v[100:103], v[64:67], a[4:7], 0
TR 82,6,8704
MA 100,68,20
TR 84,6,16384
v_mul_f32 v192, v160, v192
MA 100,72,36
TR 86,6,16896
v_mul_f32 v193, v161, v193
v_mfma_f32_16x16x32_bf16 v[104:107], v[64:67], a[8:11], 0
buffer_load_dwordx4 v2, s[12:15], s51 offen lds
MA 104,68,24
s_add_u32 m0, s43, 0xe000
v_exp_f32 v160, -v160
MA 104,72,40
s_add_u32 s50, s44, 0x1f8100
v_exp_f32 v161, -v161
v_mfma_f32_16x16x32_bf16 v[108:111], v[64:67], a[12:15], 0
v_mul_f32 v194, v162, v194
v_mul_f32 v195, v163, v195
MA 108,68,28
v_exp_f32 v162, -v162
MA 108,72,44
buffer_load_dwordx4 v2, s[8:11], s50 offen lds
s_waitcnt lgkmcnt(0)
v_mfma_f32_16x16x32_bf16 v[112:115], v[76:79], a[0:3], 0
s_add_u32 m0, s43, 0xf000
TR 64,5,4096
v_mul_f32 v208, v176, v208
MA 112,80,16
s_add_u32 s51, s44, 0x1f8100
TR 66,5,4608
v_mul_f32 v209, v177, v209
MA 112,84,32
TR 68,5,12288
v_mul_f32 v210, v178, v210
v_mfma_f32_16x16x32_bf16 v[116:119], v[76:79], a[4:7], 0
TR 70,5,12800
v_mul_f32 v211, v179, v211
MA 116,80,20
TR 72,5,20480
v_add_f32 v160, 1.0, v160
MA 116,84,36
TR 74,5,20992
v_add_f32 v161, 1.0, v161
v_mfma_f32_16x16x32_bf16 v[120:123], v[76:79], a[8:11], 0
buffer_load_dwordx4 v2, s[12:15], s51 offen lds
MA 120,80,24
s_add_u32 m0, s43, 0x10000
v_exp_f32 v163, -v163
MA 120,84,40
s_add_u32 s50, s44, 0x240100
v_exp_f32 v176, -v176
v_mfma_f32_16x16x32_bf16 v[124:127], v[76:79], a[12:15], 0
v_exp_f32 v177, -v177
MA 124,80,28
v_exp_f32 v178, -v178
MA 124,84,44
buffer_load_dwordx4 v2, s[8:11], s50 offen lds
s_waitcnt lgkmcnt(0)
v_mfma_f32_16x16x32_bf16 v[128:131], v[64:67], a[0:3], 0
s_add_u32 m0, s43, 0x11000
TR 76,6,4096
v_add_f32 v162, 1.0, v162
MA 128,68,16
s_add_u32 s51, s44, 0x240100
TR 78,6,4608
v_add_f32 v163, 1.0, v163
MA 128,72,32
TR 80,6,12288
v_add_f32 v176, 1.0, v176
v_mfma_f32_16x16x32_bf16 v[132:135], v[64:67], a[4:7], 0
TR 82,6,12800
v_add_f32 v177, 1.0, v177
MA 132,68,20
TR 84,6,20480
v_add_f32 v178, 1.0, v178
MA 132,72,36
TR 86,6,20992
v_mul_f32 v196, v164, v196
v_mfma_f32_16x16x32_bf16 v[136:139], v[64:67], a[8:11], 0
buffer_load_dwordx4 v2, s[12:15], s51 offen lds
MA 136,68,24
buffer_load_dword v60, v62, s[8:11], s83 offen
MA 136,72,40
buffer_load_dword v60, v62, s[12:15], s83 offen
v_mfma_f32_16x16x32_bf16 v[140:143], v[64:67], a[12:15], 0
v_exp_f32 v179, -v179
MA 140,68,28
v_rcp_f32 v160, v160
MA 140,72,44
v_add_f32 v179, 1.0, v179
s_waitcnt lgkmcnt(0)
v_mfma_f32_16x16x32_bf16 v[144:147], v[76:79], a[0:3], 0
s_waitcnt vmcnt(10)
s_barrier
s_add_u32 m0, s43, 0x0
v_rcp_f32 v161, v161
MA 144,80,16
s_add_u32 s50, s44, 0x288100
TR 64,5,24576
v_mul_f32 v192, v192, v160
MA 144,84,32
TR 66,5,25088
v_mul_f32 v193, v193, v161
v_mfma_f32_16x16x32_bf16 v[148:151], v[76:79], a[4:7], 0
TR 68,5,32768
v_cvt_pk_bf16_f32 v160, v192, v193
MA 148,80,20
TR 70,5,33280
v_mul_f32 v197, v165, v197
MA 148,84,36
TR 72,5,40960
v_mul_f32 v198, v166, v198
v_mfma_f32_16x16x32_bf16 v[152:155], v[76:79], a[8:11], 0
TR 74,5,41472
v_mul_f32 v199, v167, v199
MA 152,80,24
buffer_load_dwordx4 v2, s[8:11], s50 offen lds
MA 152,84,40
s_add_u32 m0, s43, 0x1000
v_rcp_f32 v162, v162
v_mfma_f32_16x16x32_bf16 v[156:159], v[76:79], a[12:15], 0
s_add_u32 s51, s44, 0x288100
v_rcp_f32 v163, v163
MA 156,80,28
v_rcp_f32 v176, v176
MA 156,84,44
v_mul_f32 v194, v194, v162
s_waitcnt lgkmcnt(0)
MA 96,64,48
TR 76,6,24576
v_mul_f32 v195, v195, v163
MA 96,68,64
TR 78,6,25088
v_mul_f32 v208, v208, v176
MA 96,72,80
TR 80,6,32768
v_cvt_pk_bf16_f32 v161, v194, v195
MA 100,64,52
TR 82,6,33280
v_mul_f32 v212, v180, v212
MA 100,68,68
TR 84,6,40960
v_mul_f32 v213, v181, v213
MA 100,72,84
TR 86,6,41472
v_mul_f32 v214, v182, v214
MA 104,64,56
buffer_load_dwordx4 v2, s[12:15], s51 offen lds
MA 104,68,72
s_add_u32 m0, s43, 0x2000
v_rcp_f32 v177, v177
MA 104,72,88
s_add_u32 s50, s44, 0x2d0100
v_rcp_f32 v178, v178
MA 108,64,60
v_rcp_f32 v179, v179
MA 108,68,76
v_exp_f32 v164, -v164
MA 108,72,92
buffer_load_dwordx4 v2, s[8:11], s50 offen lds
s_waitcnt lgkmcnt(0)
MA 112,76,48
s_add_u32 m0, s43, 0x3000
TR 64,5,28672
v_mul_f32 v209, v209, v177
MA 112,80,64
s_add_u32 s51, s44, 0x2d0100
TR 66,5,29184
v_mul_f32 v210, v210, v178
MA 112,84,80
TR 68,5,36864
v_mul_f32 v211, v211, v179
MA 116,76,52
TR 70,5,37376
v_cvt_pk_bf16_f32 v162, v208, v209
MA 116,80,68
TR 72,5,45056
v_cvt_pk_bf16_f32 v163, v210, v211
MA 116,84,84
TR 74,5,45568
v_mul_f32 v215, v183, v215
MA 120,76,56
buffer_load_dwordx4 v2, s[12:15], s51 offen lds
MA 120,80,72
s_add_u32 m0, s43, 0x4000
ds_write_b128 v11, v[160:163] offset:16384
MA 120,84,88
s_add_u32 s50, s44, 0x318100
v_exp_f32 v165, -v165
MA 124,76,60
v_exp_f32 v166, -v166
MA 124,80,76
v_exp_f32 v167, -v167
MA 124,84,92
buffer_load_dwordx4 v2, s[8:11], s50 offen lds
s_waitcnt lgkmcnt(1)
MA 128,64,48
s_add_u32 m0, s43, 0x5000
TR 76,6,28672
v_add_f32 v164, 1.0, v164
MA 128,68,64
s_add_u32 s51, s44, 0x318100
TR 78,6,29184
v_add_f32 v165, 1.0, v165
MA 128,72,80
TR 80,6,36864
v_add_f32 v166, 1.0, v166
MA 132,64,52
TR 82,6,37376
v_add_f32 v167, 1.0, v167
MA 132,68,68
TR 84,6,45056
MA 132,72,84
TR 86,6,45568
MA 136,64,56
buffer_load_dwordx4 v2, s[12:15], s51 offen lds
MA 136,68,72
v_exp_f32 v180, -v180
MA 136,72,88
v_exp_f32 v181, -v181
MA 140,64,60
v_exp_f32 v182, -v182
MA 140,68,76
v_exp_f32 v183, -v183
MA 140,72,92
v_add_f32 v180, 1.0, v180
s_waitcnt lgkmcnt(0)
MA 144,76,48
s_waitcnt vmcnt(8)
s_barrier
s_add_u32 m0, s43, 0x6000
v_rcp_f32 v164, v164
MA 144,80,64
s_add_u32 s50, s44, 0x360100
TR 64,5,49152
v_add_f32 v181, 1.0, v181
MA 144,84,80
TR 66,5,49664
v_add_f32 v182, 1.0, v182
MA 148,76,52
TR 68,5,57344
v_add_f32 v183, 1.0, v183
MA 148,80,68
TR 70,5,57856
v_mul_f32 v196, v196, v164
MA 148,84,84
TR 72,7,0
v_mul_f32 v200, v168, v200
MA 152,76,56
TR 74,7,512
v_mul_f32 v201, v169, v201
MA 152,80,72
buffer_load_dwordx4 v2, s[8:11], s50 offen lds
MA 152,84,88
s_add_u32 m0, s43, 0x7000
v_rcp_f32 v165, v165
MA 156,76,60
s_add_u32 s51, s44, 0x360100
v_rcp_f32 v166, v166
MA 156,80,76
v_rcp_f32 v167, v167
MA 156,84,92
v_mul_f32 v197, v197, v165
s_waitcnt lgkmcnt(0)
MA 96,64,96
TR 76,6,49152
v_mul_f32 v198, v198, v166
MA 96,68,112
TR 78,6,49664
v_mul_f32 v199, v199, v167
MA 96,72,128
TR 80,6,57344
v_cvt_pk_bf16_f32 v164, v196, v197
MA 100,64,100
TR 82,6,57856
v_cvt_pk_bf16_f32 v165, v198, v199
MA 100,68,116
TR 84,8,0
v_mul_f32 v202, v170, v202
MA 100,72,132
TR 86,8,512
v_mul_f32 v203, v171, v203
MA 104,64,104
buffer_load_dwordx4 v2, s[12:15], s51 offen lds
MA 104,68,120
s_add_u32 m0, s43, 0x8000
v_rcp_f32 v180, v180
MA 104,72,136
s_add_u32 s50, s44, 0x3a8100
v_rcp_f32 v181, v181
MA 108,64,108
v_rcp_f32 v182, v182
MA 108,68,124
v_rcp_f32 v183, v183
MA 108,72,140
buffer_load_dwordx4 v2, s[8:11], s50 offen lds
s_waitcnt lgkmcnt(0)
MA 112,76,96
s_add_u32 m0, s43, 0x9000
TR 64,5,53248
v_mul_f32 v212, v212, v180
MA 112,80,112
s_add_u32 s51, s44, 0x3a8100
TR 66,5,53760
v_mul_f32 v213, v213, v181
MA 112,84,128
TR 68,5,61440
v_mul_f32 v214, v214, v182
MA 116,76,100
TR 70,5,61952
v_mul_f32 v215, v215, v183
MA 116,80,116
TR 72,7,4096
v_cvt_pk_bf16_f32 v166, v212, v213
MA 116,84,132
TR 74,7,4608
v_cvt_pk_bf16_f32 v167, v214, v215
MA 120,76,104
buffer_load_dwordx4 v2, s[12:15], s51 offen lds
MA 120,80,120
s_add_u32 m0, s43, 0xa000
ds_write_b128 v11, v[164:167] offset:17408
MA 120,84,136
s_add_u32 s50, s44, 0x3f0100
v_exp_f32 v168, -v168
MA 124,76,108
v_exp_f32 v169, -v169
MA 124,80,124
v_exp_f32 v170, -v170
MA 124,84,140
buffer_load_dwordx4 v2, s[8:11], s50 offen lds
s_waitcnt lgkmcnt(1)
MA 128,64,96
s_add_u32 m0, s43, 0xb000
TR 76,6,53248
v_mul_f32 v216, v184, v216
MA 128,68,112
s_add_u32 s51, s44, 0x3f0100
TR 78,6,53760
v_mul_f32 v217, v185, v217
MA 128,72,128
TR 80,6,61440
v_mul_f32 v218, v186, v218
MA 132,64,100
TR 82,6,61952
v_mul_f32 v219, v187, v219
MA 132,68,116
TR 84,8,4096
v_add_f32 v168, 1.0, v168
MA 132,72,132
TR 86,8,4608
v_add_f32 v169, 1.0, v169
MA 136,64,104
buffer_load_dwordx4 v2, s[12:15], s51 offen lds
MA 136,68,120
v_exp_f32 v171, -v171
MA 136,72,136
v_exp_f32 v184, -v184
MA 140,64,108
v_exp_f32 v185, -v185
MA 140,68,124
v_exp_f32 v186, -v186
MA 140,72,140
v_add_f32 v170, 1.0, v170
s_waitcnt lgkmcnt(0)
MA 144,76,96
s_waitcnt vmcnt(6)
s_barrier
s_add_u32 m0, s43, 0xc000
v_exp_f32 v187, -v187
MA 144,80,112
s_add_u32 s50, s44, 0x438100
TR 64,5,0
v_add_f32 v171, 1.0, v171
MA 144,84,128
TR 66,5,512
v_add_f32 v184, 1.0, v184
MA 148,76,100
TR 68,5,8192
v_add_f32 v185, 1.0, v185
MA 148,80,116
TR 70,5,8704
v_add_f32 v186, 1.0, v186
MA 148,84,132
TR 72,5,16384
v_add_f32 v187, 1.0, v187
MA 152,76,104
TR 74,5,16896
v_mul_f32 v204, v172, v204
MA 152,80,120
buffer_load_dwordx4 v2, s[8:11], s50 offen lds
MA 152,84,136
s_add_u32 m0, s43, 0xd000
v_rcp_f32 v168, v168
MA 156,76,108
s_add_u32 s51, s44, 0x438100
v_rcp_f32 v169, v169
MA 156,80,124
v_rcp_f32 v170, v170
MA 156,84,140
v_mul_f32 v200, v200, v168
s_waitcnt lgkmcnt(0)
MA 96,64,144
TR 76,6,0
v_mul_f32 v201, v201, v169
MA 96,68,160
TR 78,6,512
v_mul_f32 v202, v202, v170
MA 96,72,176
TR 80,6,8192
v_cvt_pk_bf16_f32 v168, v200, v201
MA 100,64,148
TR 82,6,8704
v_mul_f32 v205, v173, v205
MA 100,68,164
TR 84,6,16384
v_mul_f32 v206, v174, v206
MA 100,72,180
TR 86,6,16896
v_mul_f32 v207, v175, v207
MA 104,64,152
buffer_load_dwordx4 v2, s[12:15], s51 offen lds
MA 104,68,168
s_add_u32 m0, s43, 0xe000
v_rcp_f32 v171, v171
MA 104,72,184
s_add_u32 s50, s44, 0x480100
v_rcp_f32 v184, v184
MA 108,64,156
v_rcp_f32 v185, v185
MA 108,68,172
v_rcp_f32 v186, v186
MA 108,72,188
buffer_load_dwordx4 v2, s[8:11], s50 offen lds
s_waitcnt lgkmcnt(0)
MA 112,76,144
s_add_u32 m0, s43, 0xf000
TR 64,5,4096
v_mul_f32 v203, v203, v171
MA 112,80,160
s_add_u32 s51, s44, 0x480100
TR 66,5,4608
v_mul_f32 v216, v216, v184
MA 112,84,176
TR 68,5,12288
v_mul_f32 v217, v217, v185
MA 116,76,148
TR 70,5,12800
v_mul_f32 v218, v218, v186
MA 116,80,164
TR 72,5,20480
v_cvt_pk_bf16_f32 v169, v202, v203
MA 116,84,180
TR 74,5,20992
v_cvt_pk_bf16_f32 v170, v216, v217
MA 120,76,152
buffer_load_dwordx4 v2, s[12:15], s51 offen lds
MA 120,80,168
s_add_u32 m0, s43, 0x10000
v_rcp_f32 v187, v187
MA 120,84,184
s_add_u32 s50, s44, 0x4c8100
v_exp_f32 v172, -v172
MA 124,76,156
v_exp_f32 v173, -v173
MA 124,80,172
v_exp_f32 v174, -v174
MA 124,84,188
buffer_load_dwordx4 v2, s[8:11], s50 offen lds
s_waitcnt lgkmcnt(0)
MA 128,64,144
s_add_u32 m0, s43, 0x11000
TR 76,6,4096
v_mul_f32 v219, v219, v187
MA 128,68,160
s_add_u32 s51, s44, 0x4c8100
TR 78,6,4608
v_cvt_pk_bf16_f32 v171, v218, v219
MA 128,72,176
TR 80,6,12288
v_mul_f32 v220, v188, v220
MA 132,64,148
TR 82,6,12800
v_mul_f32 v221, v189, v221
MA 132,68,164
TR 84,6,20480
v_mul_f32 v222, v190, v222
MA 132,72,180
TR 86,6,20992
v_mul_f32 v223, v191, v223
MA 136,64,152
buffer_load_dwordx4 v2, s[12:15], s51 offen lds
MA 136,68,168
ds_write_b128 v11, v[168:171] offset:18432
MA 136,72,184
v_exp_f32 v175, -v175
MA 140,64,156
v_exp_f32 v188, -v188
MA 140,68,172
v_exp_f32 v189, -v189
MA 140,72,188
v_add_f32 v172, 1.0, v172
s_waitcnt lgkmcnt(1)
MA 144,76,144
s_waitcnt vmcnt(6)
s_waitcnt lgkmcnt(0)
s_barrier
s_add_u32 m0, s43, 0x0
v_exp_f32 v190, -v190
MA 144,80,160
s_add_u32 s50, s44, 0x180
TR 64,5,24576
v_add_f32 v173, 1.0, v173
MA 144,84,176
TR 66,5,25088
v_add_f32 v174, 1.0, v174
MA 148,76,148
TR 68,5,32768
v_add_f32 v175, 1.0, v175
MA 148,80,164
TR 70,5,33280
v_add_f32 v188, 1.0, v188
MA 148,84,180
TR 72,5,40960
v_add_f32 v189, 1.0, v189
MA 152,76,152
TR 74,5,41472
v_add_f32 v190, 1.0, v190
MA 152,80,168
buffer_load_dwordx4 v2, s[8:11], s50 offen lds
MA 152,84,184
s_add_u32 m0, s43, 0x1000
v_exp_f32 v191, -v191
MA 156,76,156
s_add_u32 s51, s44, 0x180
v_rcp_f32 v172, v172
MA 156,80,172
v_rcp_f32 v173, v173
MA 156,84,188
v_add_f32 v191, 1.0, v191
s_waitcnt lgkmcnt(0)
MA 96,64,192
TR 76,6,24576
v_mul_f32 v204, v204, v172
MA 96,68,208
TR 78,6,25088
v_mul_f32 v205, v205, v173
MA 96,72,224
TR 80,6,32768
v_cvt_pk_bf16_f32 v172, v204, v205
MA 100,64,196
TR 82,6,33280
MA 100,68,212
TR 84,6,40960
MA 100,72,228
TR 86,6,41472
MA 104,64,200
buffer_load_dwordx4 v2, s[12:15], s51 offen lds
MA 104,68,216
s_add_u32 m0, s43, 0x2000
v_rcp_f32 v174, v174
MA 104,72,232
s_add_u32 s50, s44, 0x48180
v_rcp_f32 v175, v175
MA 108,64,204
v_rcp_f32 v188, v188
MA 108,68,220
v_rcp_f32 v189, v189
MA 108,72,236
buffer_load_dwordx4 v2, s[8:11], s50 offen lds
s_waitcnt lgkmcnt(0)
MA 112,76,192
s_add_u32 m0, s43, 0x3000
TR 64,5,28672
v_mul_f32 v206, v206, v174
MA 112,80,208
s_add_u32 s51, s44, 0x48180
TR 66,5,29184
v_mul_f32 v207, v207, v175
MA 112,84,224
TR 68,5,36864
v_mul_f32 v220, v220, v188
MA 116,76,196
TR 70,5,37376
v_mul_f32 v221, v221, v189
MA 116,80,212
TR 72,5,45056
v_cvt_pk_bf16_f32 v173, v206, v207
MA 116,84,228
TR 74,5,45568
v_cvt_pk_bf16_f32 v174, v220, v221
MA 120,76,200
buffer_load_dwordx4 v2, s[12:15], s51 offen lds
MA 120,80,216
s_add_u32 m0, s43, 0x4000
v_rcp_f32 v190, v190
MA 120,84,232
s_add_u32 s50, s44, 0x90180
v_rcp_f32 v191, v191
MA 124,76,204
v_lshrrev_b32 v62, 2, v0
v_and_b32 v60, 0xcf, v0
v_cmp_eq_u32 vcc, v60, v0
v_and_or_b32 v62, v62, 48, v60
v_and_b32 v62, 63, v62
v_lshl_add_u32 v62, s41, 8, v62
v_lshlrev_b32 v62, 7, v62
v_cndmask_b32 v62, -4, v62, vcc
MA 124,80,220
s_add_u32 s83, s45, 0
v_mul_f32 v222, v222, v190
v_mul_f32 v223, v223, v191
MA 124,84,236
buffer_load_dwordx4 v2, s[8:11], s50 offen lds
s_waitcnt lgkmcnt(0)
MA 128,64,192
s_add_u32 m0, s43, 0x5000
TR 76,6,28672
v_cvt_pk_bf16_f32 v175, v222, v223
MA 128,68,208
s_add_u32 s51, s44, 0x90180
TR 78,6,29184
MA 128,72,224
TR 80,6,36864
MA 132,64,196
TR 82,6,37376
MA 132,68,212
TR 84,6,45056
MA 132,72,228
TR 86,6,45568
MA 136,64,200
buffer_load_dwordx4 v2, s[12:15], s51 offen lds
MA 136,68,216
buffer_load_dword v60, v62, s[16:19], s83 offen
s_add_u32 s83, s45, 8192
MA 136,72,232
ds_write_b128 v11, v[172:175] offset:19456
MA 140,64,204
MA 140,68,220
MA 140,72,236
s_waitcnt lgkmcnt(1)
MA 144,76,192
s_waitcnt vmcnt(7)
s_waitcnt lgkmcnt(0)
s_barrier
s_add_u32 m0, s43, 0x6000
MA 144,80,208
s_add_u32 s50, s44, 0xd8180
TR 64,5,49152
MA 144,84,224
TR 66,5,49664
MA 148,76,196
TR 68,5,57344
MA 148,80,212
TR 70,5,57856
MA 148,84,228
TR 72,7,0
MA 152,76,200
TR 74,7,512
MA 152,80,216
buffer_load_dwordx4 v2, s[8:11], s50 offen lds
MA 152,84,232
s_add_u32 m0, s43, 0x7000
MA 156,76,204
s_add_u32 s51, s44, 0xd8180
MA 156,80,220
MA 156,84,236
s_waitcnt lgkmcnt(0)
MA 96,64,240
TR 76,6,49152
v_mfma_f32_16x16x32_bf16 v[96:99], v[68:71], v[224:227], v[96:99]
TR 78,6,49664
v_mfma_f32_16x16x32_bf16 v[96:99], v[72:75], v[240:243], v[96:99]
TR 80,6,57344
MA 100,64,244
TR 82,6,57856
v_mfma_f32_16x16x32_bf16 v[100:103], v[68:71], v[228:231], v[100:103]
TR 84,8,0
v_mfma_f32_16x16x32_bf16 v[100:103], v[72:75], v[244:247], v[100:103]
TR 86,8,512
MA 104,64,248
buffer_load_dwordx4 v2, s[12:15], s51 offen lds
v_mfma_f32_16x16x32_bf16 v[104:107], v[68:71], v[232:235], v[104:107]
s_add_u32 m0, s43, 0x8000
v_mfma_f32_16x16x32_bf16 v[104:107], v[72:75], v[248:251], v[104:107]
s_add_u32 s50, s44, 0x120180
MA 108,64,252
v_mfma_f32_16x16x32_bf16 v[108:111], v[68:71], v[236:239], v[108:111]
v_mfma_f32_16x16x32_bf16 v[108:111], v[72:75], v[252:255], v[108:111]
buffer_load_dwordx4 v2, s[8:11], s50 offen lds
s_waitcnt lgkmcnt(0)
MA 112,76,240
s_add_u32 m0, s43, 0x9000
TR 64,5,53248
v_mfma_f32_16x16x32_bf16 v[112:115], v[80:83], v[224:227], v[112:115]
s_add_u32 s51, s44, 0x120180
TR 66,5,53760
v_mfma_f32_16x16x32_bf16 v[112:115], v[84:87], v[240:243], v[112:115]
TR 68,5,61440
MA 116,76,244
TR 70,5,61952
v_mfma_f32_16x16x32_bf16 v[116:119], v[80:83], v[228:231], v[116:119]
TR 72,7,4096
v_mfma_f32_16x16x32_bf16 v[116:119], v[84:87], v[244:247], v[116:119]
TR 74,7,4608
MA 120,76,248
buffer_load_dwordx4 v2, s[12:15], s51 offen lds
v_mfma_f32_16x16x32_bf16 v[120:123], v[80:83], v[232:235], v[120:123]
s_add_u32 m0, s43, 0xa000
v_mfma_f32_16x16x32_bf16 v[120:123], v[84:87], v[248:251], v[120:123]
s_add_u32 s50, s44, 0x168180
MA 124,76,252
v_mfma_f32_16x16x32_bf16 v[124:127], v[80:83], v[236:239], v[124:127]
v_mfma_f32_16x16x32_bf16 v[124:127], v[84:87], v[252:255], v[124:127]
buffer_load_dwordx4 v2, s[8:11], s50 offen lds
s_waitcnt lgkmcnt(0)
MA 128,64,240
s_add_u32 m0, s43, 0xb000
TR 76,6,53248
v_mfma_f32_16x16x32_bf16 v[128:131], v[68:71], v[224:227], v[128:131]
s_add_u32 s51, s44, 0x168180
TR 78,6,53760
v_mfma_f32_16x16x32_bf16 v[128:131], v[72:75], v[240:243], v[128:131]
TR 80,6,61440
MA 132,64,244
TR 82,6,61952
v_mfma_f32_16x16x32_bf16 v[132:135], v[68:71], v[228:231], v[132:135]
TR 84,8,4096
v_mfma_f32_16x16x32_bf16 v[132:135], v[72:75], v[244:247], v[132:135]
TR 86,8,4608
MA 136,64,248
buffer_load_dwordx4 v2, s[12:15], s51 offen lds
v_mfma_f32_16x16x32_bf16 v[136:139], v[68:71], v[232:235], v[136:139]
buffer_load_dword v60, v62, s[16:19], s83 offen
s_add_u32 s83, s45, 16384
v_mfma_f32_16x16x32_bf16 v[136:139], v[72:75], v[248:251], v[136:139]
MA 140,64,252
v_mfma_f32_16x16x32_bf16 v[140:143], v[68:71], v[236:239], v[140:143]
v_mfma_f32_16x16x32_bf16 v[140:143], v[72:75], v[252:255], v[140:143]
s_waitcnt lgkmcnt(0)
MA 144,76,240
s_waitcnt vmcnt(8)
s_barrier
s_add_u32 m0, s43, 0xc000
v_mfma_f32_16x16x32_bf16 v[144:147], v[80:83], v[224:227], v[144:147]
s_add_u32 s50, s44, 0x1b0180
TR 64,5,0
v_mfma_f32_16x16x32_bf16 v[144:147], v[84:87], v[240:243], v[144:147]
TR 66,5,512
MA 148,76,244
TR 68,5,8192
v_mfma_f32_16x16x32_bf16 v[148:151], v[80:83], v[228:231], v[148:151]
TR 70,5,8704
v_mfma_f32_16x16x32_bf16 v[148:151], v[84:87], v[244:247], v[148:151]
TR 72,5,16384
MA 152,76,248
TR 74,5,16896
v_mfma_f32_16x16x32_bf16 v[152:155], v[80:83], v[232:235], v[152:155]
buffer_load_dwordx4 v2, s[8:11], s50 offen lds
v_mfma_f32_16x16x32_bf16 v[152:155], v[84:87], v[248:251], v[152:155]
s_add_u32 m0, s43, 0xd000
MA 156,76,252
s_add_u32 s51, s44, 0x1b0180
v_mfma_f32_16x16x32_bf16 v[156:159], v[80:83], v[236:239], v[156:159]
v_mfma_f32_16x16x32_bf16 v[156:159], v[84:87], v[252:255], v[156:159]
s_waitcnt lgkmcnt(0)
v_mfma_f32_16x16x32_bf16 v[160:163], v[64:67], a[0:3], 0
TR 76,6,0
MA 160,68,16
TR 78,6,512
MA 160,72,32
TR 80,6,8192
v_mfma_f32_16x16x32_bf16 v[164:167], v[64:67], a[4:7], 0
TR 82,6,8704
MA 164,68,20
TR 84,6,16384
v_mul_f32 v128, v96, v128
MA 164,72,36
TR 86,6,16896
v_mul_f32 v129, v97, v129
v_mfma_f32_16x16x32_bf16 v[168:171], v[64:67], a[8:11], 0
buffer_load_dwordx4 v2, s[12:15], s51 offen lds
MA 168,68,24
s_add_u32 m0, s43, 0xe000
v_exp_f32 v96, -v96
MA 168,72,40
s_add_u32 s50, s44, 0x1f8180
v_exp_f32 v97, -v97
v_mfma_f32_16x16x32_bf16 v[172:175], v[64:67], a[12:15], 0
v_mul_f32 v130, v98, v130
v_mul_f32 v131, v99, v131
MA 172,68,28
v_exp_f32 v98, -v98
MA 172,72,44
buffer_load_dwordx4 v2, s[8:11], s50 offen lds
s_waitcnt lgkmcnt(0)
v_mfma_f32_16x16x32_bf16 v[176:179], v[76:79], a[0:3], 0
s_add_u32 m0, s43, 0xf000
TR 64,5,4096
v_mul_f32 v144, v112, v144
MA 176,80,16
s_add_u32 s51, s44, 0x1f8180
TR 66,5,4608
v_mul_f32 v145, v113, v145
MA 176,84,32
TR 68,5,12288
v_mul_f32 v146, v114, v146
v_mfma_f32_16x16x32_bf16 v[180:183], v[76:79], a[4:7], 0
TR 70,5,12800
v_mul_f32 v147, v115, v147
MA 180,80,20
TR 72,5,20480
v_add_f32 v96, 1.0, v96
MA 180,84,36
TR 74,5,20992
v_add_f32 v97, 1.0, v97
v_mfma_f32_16x16x32_bf16 v[184:187], v[76:79], a[8:11], 0
buffer_load_dwordx4 v2, s[12:15], s51 offen lds
MA 184,80,24
s_add_u32 m0, s43, 0x10000
v_exp_f32 v99, -v99
MA 184,84,40
s_add_u32 s50, s44, 0x240180
v_exp_f32 v112, -v112
v_mfma_f32_16x16x32_bf16 v[188:191], v[76:79], a[12:15], 0
v_exp_f32 v113, -v113
MA 188,80,28
v_exp_f32 v114, -v114
MA 188,84,44
buffer_load_dwordx4 v2, s[8:11], s50 offen lds
s_waitcnt lgkmcnt(0)
v_mfma_f32_16x16x32_bf16 v[192:195], v[64:67], a[0:3], 0
s_add_u32 m0, s43, 0x11000
TR 76,6,4096
v_add_f32 v98, 1.0, v98
MA 192,68,16
s_add_u32 s51, s44, 0x240180
TR 78,6,4608
v_add_f32 v99, 1.0, v99
MA 192,72,32
TR 80,6,12288
v_add_f32 v112, 1.0, v112
v_mfma_f32_16x16x32_bf16 v[196:199], v[64:67], a[4:7], 0
TR 82,6,12800
v_add_f32 v113, 1.0, v113
MA 196,68,20
TR 84,6,20480
v_add_f32 v114, 1.0, v114
MA 196,72,36
TR 86,6,20992
v_mul_f32 v132, v100, v132
v_mfma_f32_16x16x32_bf16 v[200:203], v[64:67], a[8:11], 0
buffer_load_dwordx4 v2, s[12:15], s51 offen lds
MA 200,68,24
buffer_load_dword v60, v62, s[16:19], s83 offen
s_add_u32 s83, s45, 24576
MA 200,72,40
v_exp_f32 v115, -v115
v_mfma_f32_16x16x32_bf16 v[204:207], v[64:67], a[12:15], 0
v_rcp_f32 v96, v96
MA 204,68,28
v_rcp_f32 v97, v97
MA 204,72,44
v_add_f32 v115, 1.0, v115
s_waitcnt lgkmcnt(0)
v_mfma_f32_16x16x32_bf16 v[208:211], v[76:79], a[0:3], 0
s_waitcnt vmcnt(8)
s_barrier
s_add_u32 m0, s43, 0x0
v_rcp_f32 v98, v98
MA 208,80,16
s_add_u32 s50, s44, 0x288180
TR 64,5,24576
v_mul_f32 v128, v128, v96
MA 208,84,32
TR 66,5,25088
v_mul_f32 v129, v129, v97
v_mfma_f32_16x16x32_bf16 v[212:215], v[76:79], a[4:7], 0
TR 68,5,32768
v_mul_f32 v130, v130, v98
MA 212,80,20
TR 70,5,33280
v_cvt_pk_bf16_f32 v96, v128, v129
MA 212,84,36
TR 72,5,40960
v_mul_f32 v133, v101, v133
v_mfma_f32_16x16x32_bf16 v[216:219], v[76:79], a[8:11], 0
TR 74,5,41472
v_mul_f32 v134, v102, v134
MA 216,80,24
buffer_load_dwordx4 v2, s[8:11], s50 offen lds
MA 216,84,40
s_add_u32 m0, s43, 0x1000
v_rcp_f32 v99, v99
v_mfma_f32_16x16x32_bf16 v[220:223], v[76:79], a[12:15], 0
s_add_u32 s51, s44, 0x288180
v_rcp_f32 v112, v112
MA 220,80,28
v_rcp_f32 v113, v113
MA 220,84,44
v_mul_f32 v131, v131, v99
s_waitcnt lgkmcnt(0)
MA 160,64,48
TR 76,6,24576
v_mul_f32 v144, v144, v112
MA 160,68,64
TR 78,6,25088
v_mul_f32 v145, v145, v113
MA 160,72,80
TR 80,6,32768
v_cvt_pk_bf16_f32 v97, v130, v131
MA 164,64,52
TR 82,6,33280
v_cvt_pk_bf16_f32 v98, v144, v145
MA 164,68,68
TR 84,6,40960
v_mul_f32 v135, v103, v135
MA 164,72,84
TR 86,6,41472
v_mul_f32 v148, v116, v148
MA 168,64,56
buffer_load_dwordx4 v2, s[12:15], s51 offen lds
MA 168,68,72
s_add_u32 m0, s43, 0x2000
v_rcp_f32 v114, v114
MA 168,72,88
s_add_u32 s50, s44, 0x2d0180
v_rcp_f32 v115, v115
MA 172,64,60
v_exp_f32 v100, -v100
MA 172,68,76
v_exp_f32 v101, -v101
MA 172,72,92
buffer_load_dwordx4 v2, s[8:11], s50 offen lds
s_waitcnt lgkmcnt(0)
MA 176,76,48
s_add_u32 m0, s43, 0x3000
TR 64,5,28672
v_mul_f32 v146, v146, v114
MA 176,80,64
s_add_u32 s51, s44, 0x2d0180
TR 66,5,29184
v_mul_f32 v147, v147, v115
MA 176,84,80
TR 68,5,36864
v_cvt_pk_bf16_f32 v99, v146, v147
MA 180,76,52
TR 70,5,37376
v_mul_f32 v149, v117, v149
MA 180,80,68
TR 72,5,45056
v_mul_f32 v150, v118, v150
MA 180,84,84
TR 74,5,45568
v_mul_f32 v151, v119, v151
MA 184,76,56
buffer_load_dwordx4 v2, s[12:15], s51 offen lds
MA 184,80,72
s_add_u32 m0, s43, 0x4000
ds_write_b128 v11, v[96:99] offset:32768
MA 184,84,88
s_add_u32 s50, s44, 0x318180
v_exp_f32 v102, -v102
MA 188,76,60
v_exp_f32 v103, -v103
MA 188,80,76
v_exp_f32 v116, -v116
MA 188,84,92
buffer_load_dwordx4 v2, s[8:11], s50 offen lds
s_waitcnt lgkmcnt(1)
MA 192,64,48
s_add_u32 m0, s43, 0x5000
TR 76,6,28672
v_add_f32 v100, 1.0, v100
MA 192,68,64
s_add_u32 s51, s44, 0x318180
TR 78,6,29184
v_add_f32 v101, 1.0, v101
MA 192,72,80
TR 80,6,36864
v_add_f32 v102, 1.0, v102
MA 196,64,52
TR 82,6,37376
v_add_f32 v103, 1.0, v103
MA 196,68,68
TR 84,6,45056
v_add_f32 v116, 1.0, v116
MA 196,72,84
TR 86,6,45568
MA 200,64,56
buffer_load_dwordx4 v2, s[12:15], s51 offen lds
MA 200,68,72
buffer_load_dword v60, v62, s[16:19], s83 offen
v_lshlrev_b32 v62, 7, v0
s_mov_b32 s83, L_B_p2-L_k1_B
MA 200,72,88
v_exp_f32 v117, -v117
MA 204,64,60
v_exp_f32 v118, -v118
MA 204,68,76
v_exp_f32 v119, -v119
MA 204,72,92
v_add_f32 v117, 1.0, v117
s_waitcnt lgkmcnt(0)
MA 208,76,48
s_waitcnt vmcnt(8)
s_barrier
s_add_u32 m0, s43, 0x6000
v_rcp_f32 v100, v100
MA 208,80,64
s_add_u32 s50, s44, 0x360180
TR 64,5,49152
v_add_f32 v118, 1.0, v118
MA 208,84,80
TR 66,5,49664
v_add_f32 v119, 1.0, v119
MA 212,76,52
TR 68,5,57344
v_mul_f32 v132, v132, v100
MA 212,80,68
TR 70,5,57856
v_mul_f32 v136, v104, v136
MA 212,84,84
TR 72,7,0
v_mul_f32 v137, v105, v137
MA 216,76,56
TR 74,7,512
v_mul_f32 v138, v106, v138
MA 216,80,72
buffer_load_dwordx4 v2, s[8:11], s50 offen lds
MA 216,84,88
s_add_u32 m0, s43, 0x7000
v_rcp_f32 v101, v101
MA 220,76,60
s_add_u32 s51, s44, 0x360180
v_rcp_f32 v102, v102
MA 220,80,76
v_rcp_f32 v103, v103
MA 220,84,92
v_mul_f32 v133, v133, v101
s_waitcnt lgkmcnt(0)
MA 160,64,96
TR 76,6,49152
v_mul_f32 v134, v134, v102
MA 160,68,112
TR 78,6,49664
v_mul_f32 v135, v135, v103
MA 160,72,128
TR 80,6,57344
v_cvt_pk_bf16_f32 v100, v132, v133
MA 164,64,100
TR 82,6,57856
v_cvt_pk_bf16_f32 v101, v134, v135
MA 164,68,116
TR 84,8,0
v_mul_f32 v139, v107, v139
MA 164,72,132
TR 86,8,512
v_mul_f32 v152, v120, v152
MA 168,64,104
buffer_load_dwordx4 v2, s[12:15], s51 offen lds
MA 168,68,120
s_add_u32 m0, s43, 0x8000
v_rcp_f32 v116, v116
MA 168,72,136
s_add_u32 s50, s44, 0x3a8180
v_rcp_f32 v117, v117
MA 172,64,108
v_rcp_f32 v118, v118
MA 172,68,124
v_rcp_f32 v119, v119
MA 172,72,140
buffer_load_dwordx4 v2, s[8:11], s50 offen lds
s_waitcnt lgkmcnt(0)
MA 176,76,96
s_add_u32 m0, s43, 0x9000
TR 64,5,53248
v_mul_f32 v148, v148, v116
MA 176,80,112
s_add_u32 s51, s44, 0x3a8180
TR 66,5,53760
v_mul_f32 v149, v149, v117
MA 176,84,128
TR 68,5,61440
v_mul_f32 v150, v150, v118
MA 180,76,100
TR 70,5,61952
v_mul_f32 v151, v151, v119
MA 180,80,116
TR 72,7,4096
v_cvt_pk_bf16_f32 v102, v148, v149
MA 180,84,132
TR 74,7,4608
v_cvt_pk_bf16_f32 v103, v150, v151
MA 184,76,104
buffer_load_dwordx4 v2, s[12:15], s51 offen lds
MA 184,80,120
s_add_u32 m0, s43, 0xa000
ds_write_b128 v11, v[100:103] offset:33792
MA 184,84,136
s_add_u32 s50, s44, 0x3f0180
v_exp_f32 v104, -v104
MA 188,76,108
v_exp_f32 v105, -v105
MA 188,80,124
v_exp_f32 v106, -v106
MA 188,84,140
buffer_load_dwordx4 v2, s[8:11], s50 offen lds
s_waitcnt lgkmcnt(1)
MA 192,64,96
s_add_u32 m0, s43, 0xb000
TR 76,6,53248
v_mul_f32 v153, v121, v153
MA 192,68,112
s_add_u32 s51, s44, 0x3f0180
TR 78,6,53760
v_mul_f32 v154, v122, v154
MA 192,72,128
TR 80,6,61440
v_mul_f32 v155, v123, v155
MA 196,64,100
TR 82,6,61952
v_add_f32 v104, 1.0, v104
MA 196,68,116
TR 84,8,4096
v_add_f32 v105, 1.0, v105
MA 196,72,132
TR 86,8,4608
v_add_f32 v106, 1.0, v106
MA 200,64,104
buffer_load_dwordx4 v2, s[12:15], s51 offen lds
MA 200,68,120
buffer_load_dword v60, v62, s[92:95], s83 offen
MA 200,72,136
v_exp_f32 v107, -v107
MA 204,64,108
v_exp_f32 v120, -v120
MA 204,68,124
v_exp_f32 v121, -v121
MA 204,72,140
v_add_f32 v107, 1.0, v107
s_waitcnt lgkmcnt(0)
MA 208,76,96
s_waitcnt vmcnt(8)
s_barrier
s_add_u32 m0, s43, 0xc000
v_exp_f32 v122, -v122
MA 208,80,112
s_add_u32 s50, s44, 0x438180
TR 64,5,0
v_add_f32 v120, 1.0, v120
MA 208,84,128
TR 66,5,512
v_add_f32 v121, 1.0, v121
MA 212,76,100
TR 68,5,8192
v_add_f32 v122, 1.0, v122
MA 212,80,116
TR 70,5,8704
v_mul_f32 v140, v108, v140
MA 212,84,132
TR 72,5,16384
MA 216,76,104
TR 74,5,16896
MA 216,80,120
buffer_load_dwordx4 v2, s[8:11], s50 offen lds
MA 216,84,136
s_add_u32 m0, s43, 0xd000
v_exp_f32 v123, -v123
MA 220,76,108
s_add_u32 s51, s44, 0x438180
v_rcp_f32 v104, v104
MA 220,80,124
v_rcp_f32 v105, v105
MA 220,84,140
v_add_f32 v123, 1.0, v123
s_waitcnt lgkmcnt(0)
MA 160,64,144
TR 76,6,0
v_mul_f32 v136, v136, v104
MA 160,68,160
TR 78,6,512
v_mul_f32 v137, v137, v105
MA 160,72,176
TR 80,6,8192
v_cvt_pk_bf16_f32 v104, v136, v137
MA 164,64,148
TR 82,6,8704
v_mul_f32 v141, v109, v141
MA 164,68,164
TR 84,6,16384
v_mul_f32 v142, v110, v142
MA 164,72,180
TR 86,6,16896
v_mul_f32 v143, v111, v143
MA 168,64,152
buffer_load_dwordx4 v2, s[12:15], s51 offen lds
MA 168,68,168
s_add_u32 m0, s43, 0xe000
v_rcp_f32 v106, v106
MA 168,72,184
s_add_u32 s50, s44, 0x480180
v_rcp_f32 v107, v107
MA 172,64,156
v_rcp_f32 v120, v120
MA 172,68,172
v_rcp_f32 v121, v121
MA 172,72,188
buffer_load_dwordx4 v2, s[8:11], s50 offen lds
s_waitcnt lgkmcnt(0)
MA 176,76,144
s_add_u32 m0, s43, 0xf000
TR 64,5,4096
v_mul_f32 v138, v138, v106
MA 176,80,160
s_add_u32 s51, s44, 0x480180
TR 66,5,4608
v_mul_f32 v139, v139, v107
MA 176,84,176
TR 68,5,12288
v_mul_f32 v152, v152, v120
MA 180,76,148
TR 70,5,12800
v_mul_f32 v153, v153, v121
MA 180,80,164
TR 72,5,20480
v_cvt_pk_bf16_f32 v105, v138, v139
MA 180,84,180
TR 74,5,20992
v_cvt_pk_bf16_f32 v106, v152, v153
MA 184,76,152
buffer_load_dwordx4 v2, s[12:15], s51 offen lds
MA 184,80,168
s_add_u32 m0, s43, 0x10000
v_rcp_f32 v122, v122
MA 184,84,184
s_add_u32 s50, s44, 0x4c8180
v_rcp_f32 v123, v123
MA 188,76,156
v_exp_f32 v108, -v108
MA 188,80,172
v_exp_f32 v109, -v109
MA 188,84,188
buffer_load_dwordx4 v2, s[8:11], s50 offen lds
s_waitcnt lgkmcnt(0)
MA 192,64,144
s_add_u32 m0, s43, 0x11000
TR 76,6,4096
v_mul_f32 v154, v154, v122
MA 192,68,160
s_add_u32 s51, s44, 0x4c8180
TR 78,6,4608
v_mul_f32 v155, v155, v123
MA 192,72,176
TR 80,6,12288
v_cvt_pk_bf16_f32 v107, v154, v155
MA 196,64,148
TR 82,6,12800
v_mul_f32 v156, v124, v156
MA 196,68,164
TR 84,6,20480
v_mul_f32 v157, v125, v157
MA 196,72,180
TR 86,6,20992
v_mul_f32 v158, v126, v158
MA 200,64,152
buffer_load_dwordx4 v2, s[12:15], s51 offen lds
MA 200,68,168
ds_write_b128 v11, v[104:107] offset:34816
MA 200,72,184
v_exp_f32 v110, -v110
MA 204,64,156
v_exp_f32 v111, -v111
MA 204,68,172
v_exp_f32 v124, -v124
MA 204,72,188
v_mul_f32 v159, v127, v159
s_waitcnt lgkmcnt(1)
MA 208,76,144
s_waitcnt vmcnt(7)
s_waitcnt lgkmcnt(0)
s_barrier
s_add_u32 m0, s43, 0x0
v_exp_f32 v125, -v125
MA 208,80,160
s_add_u32 s50, s44, 0x200
TR 64,5,24576
v_add_f32 v108, 1.0, v108
MA 208,84,176
TR 66,5,25088
v_add_f32 v109, 1.0, v109
MA 212,76,148
TR 68,5,32768
v_add_f32 v110, 1.0, v110
MA 212,80,164
TR 70,5,33280
v_add_f32 v111, 1.0, v111
MA 212,84,180
TR 72,5,40960
v_add_f32 v124, 1.0, v124
MA 216,76,152
TR 74,5,41472
v_add_f32 v125, 1.0, v125
MA 216,80,168
buffer_load_dwordx4 v2, s[8:11], s50 offen lds
MA 216,84,184
s_add_u32 m0, s43, 0x1000
v_exp_f32 v126, -v126
MA 220,76,156
s_add_u32 s51, s44, 0x200
v_exp_f32 v127, -v127
MA 220,80,172
v_rcp_f32 v108, v108
MA 220,84,188
v_add_f32 v126, 1.0, v126
s_waitcnt lgkmcnt(0)
MA 160,64,192
TR 76,6,24576
v_add_f32 v127, 1.0, v127
MA 160,68,208
TR 78,6,25088
v_mul_f32 v140, v140, v108
MA 160,72,224
TR 80,6,32768
MA 164,64,196
TR 82,6,33280
MA 164,68,212
TR 84,6,40960
MA 164,72,228
TR 86,6,41472
MA 168,64,200
buffer_load_dwordx4 v2, s[12:15], s51 offen lds
MA 168,68,216
s_add_u32 m0, s43, 0x2000
v_rcp_f32 v109, v109
MA 168,72,232
s_add_u32 s50, s44, 0x48200
v_rcp_f32 v110, v110
MA 172,64,204
v_rcp_f32 v111, v111
MA 172,68,220
v_rcp_f32 v124, v124
MA 172,72,236
buffer_load_dwordx4 v2, s[8:11], s50 offen lds
s_waitcnt lgkmcnt(0)
MA 176,76,192
s_add_u32 m0, s43, 0x3000
TR 64,5,28672
v_mul_f32 v141, v141, v109
MA 176,80,208
s_add_u32 s51, s44, 0x48200
TR 66,5,29184
v_mul_f32 v142, v142, v110
MA 176,84,224
TR 68,5,36864
v_mul_f32 v143, v143, v111
MA 180,76,196
TR 70,5,37376
v_mul_f32 v156, v156, v124
MA 180,80,212
TR 72,5,45056
v_cvt_pk_bf16_f32 v108, v140, v141
MA 180,84,228
TR 74,5,45568
v_cvt_pk_bf16_f32 v109, v142, v143
MA 184,76,200
buffer_load_dwordx4 v2, s[12:15], s51 offen lds
MA 184,80,216
s_add_u32 m0, s43, 0x4000
v_rcp_f32 v125, v125
MA 184,84,232
s_add_u32 s50, s44, 0x90200
v_rcp_f32 v126, v126
MA 188,76,204
v_rcp_f32 v127, v127
MA 188,80,220
s_mul_i32 s82, s41, 18
v_add_u32 v62, s82, v0
v_cmp_gt_u32 vcc, 18, v0
v_lshlrev_b32 v62, 7, v62
s_nop 0
v_cndmask_b32 v62, -4, v62, vcc
MA 188,84,236
buffer_load_dwordx4 v2, s[8:11], s50 offen lds
s_waitcnt lgkmcnt(0)
MA 192,64,192
s_add_u32 m0, s43, 0x5000
TR 76,6,28672
v_mul_f32 v157, v157, v125
MA 192,68,208
s_add_u32 s51, s44, 0x90200
TR 78,6,29184
v_mul_f32 v158, v158, v126
MA 192,72,224
TR 80,6,36864
v_mul_f32 v159, v159, v127
MA 196,64,196
TR 82,6,37376
v_cvt_pk_bf16_f32 v110, v156, v157
MA 196,68,212
TR 84,6,45056
v_cvt_pk_bf16_f32 v111, v158, v159
MA 196,72,228
TR 86,6,45568
MA 200,64,200
buffer_load_dwordx4 v2, s[12:15], s51 offen lds
MA 200,68,216
buffer_load_dword v60, v62, s[16:19], s53 offen
MA 200,72,232
ds_write_b128 v11, v[108:111] offset:35840
MA 204,64,204
MA 204,68,220
MA 204,72,236
s_waitcnt lgkmcnt(1)
MA 208,76,192
s_waitcnt vmcnt(7)
s_waitcnt lgkmcnt(0)
s_barrier
s_add_u32 m0, s43, 0x6000
MA 208,80,208
s_add_u32 s50, s44, 0xd8200
TR 64,5,49152
MA 208,84,224
TR 66,5,49664
MA 212,76,196
TR 68,5,57344
MA 212,80,212
TR 70,5,57856
MA 212,84,228
TR 72,7,0
MA 216,76,200
TR 74,7,512
MA 216,80,216
buffer_load_dwordx4 v2, s[8:11], s50 offen lds
MA 216,84,232
s_add_u32 m0, s43, 0x7000
MA 220,76,204
s_add_u32 s51, s44, 0xd8200
MA 220,80,220
MA 220,84,236
s_waitcnt lgkmcnt(0)
MA 160,64,240
TR 76,6,49152
v_mfma_f32_16x16x32_bf16 v[160:163], v[68:71], v[224:227], v[160:163]
TR 78,6,49664
v_mfma_f32_16x16x32_bf16 v[160:163], v[72:75], v[240:243], v[160:163]
TR 80,6,57344
MA 164,64,244
TR 82,6,57856
v_mfma_f32_16x16x32_bf16 v[164:167], v[68:71], v[228:231], v[164:167]
TR 84,8,0
v_mfma_f32_16x16x32_bf16 v[164:167], v[72:75], v[244:247], v[164:167]
TR 86,8,512
MA 168,64,248
buffer_load_dwordx4 v2, s[12:15], s51 offen lds
v_mfma_f32_16x16x32_bf16 v[168:171], v[68:71], v[232:235], v[168:171]
s_add_u32 m0, s43, 0x8000
v_mfma_f32_16x16x32_bf16 v[168:171], v[72:75], v[248:251], v[168:171]
s_add_u32 s50, s44, 0x120200
MA 172,64,252
v_mfma_f32_16x16x32_bf16 v[172:175], v[68:71], v[236:239], v[172:175]
v_mfma_f32_16x16x32_bf16 v[172:175], v[72:75], v[252:255], v[172:175]
buffer_load_dwordx4 v2, s[8:11], s50 offen lds
s_waitcnt lgkmcnt(0)
MA 176,76,240
s_add_u32 m0, s43, 0x9000
TR 64,5,53248
v_mfma_f32_16x16x32_bf16 v[176:179], v[80:83], v[224:227], v[176:179]
s_add_u32 s51, s44, 0x120200
TR 66,5,53760
v_mfma_f32_16x16x32_bf16 v[176:179], v[84:87], v[240:243], v[176:179]
TR 68,5,61440
MA 180,76,244
TR 70,5,61952
v_mfma_f32_16x16x32_bf16 v[180:183], v[80:83], v[228:231], v[180:183]
TR 72,7,4096
v_mfma_f32_16x16x32_bf16 v[180:183], v[84:87], v[244:247], v[180:183]
TR 74,7,4608
MA 184,76,248
buffer_load_dwordx4 v2, s[12:15], s51 offen lds
v_mfma_f32_16x16x32_bf16 v[184:187], v[80:83], v[232:235], v[184:187]
s_add_u32 m0, s43, 0xa000
v_mfma_f32_16x16x32_bf16 v[184:187], v[84:87], v[248:251], v[184:187]
s_add_u32 s50, s44, 0x168200
MA 188,76,252
v_mfma_f32_16x16x32_bf16 v[188:191], v[80:83], v[236:239], v[188:191]
v_mfma_f32_16x16x32_bf16 v[188:191], v[84:87], v[252:255], v[188:191]
buffer_load_dwordx4 v2, s[8:11], s50 offen lds
s_waitcnt lgkmcnt(0)
MA 192,64,240
s_add_u32 m0, s43, 0xb000
TR 76,6,53248
v_mfma_f32_16x16x32_bf16 v[192:195], v[68:71], v[224:227], v[192:195]
s_add_u32 s51, s44, 0x168200
TR 78,6,53760
v_mfma_f32_16x16x32_bf16 v[192:195], v[72:75], v[240:243], v[192:195]
TR 80,6,61440
MA 196,64,244
TR 82,6,61952
v_mfma_f32_16x16x32_bf16 v[196:199], v[68:71], v[228:231], v[196:199]
TR 84,8,4096
v_mfma_f32_16x16x32_bf16 v[196:199], v[72:75], v[244:247], v[196:199]
TR 86,8,4608
MA 200,64,248
buffer_load_dwordx4 v2, s[12:15], s51 offen lds
v_mfma_f32_16x16x32_bf16 v[200:203], v[68:71], v[232:235], v[200:203]
v_mfma_f32_16x16x32_bf16 v[200:203], v[72:75], v[248:251], v[200:203]
MA 204,64,252
v_mfma_f32_16x16x32_bf16 v[204:207], v[68:71], v[236:239], v[204:207]
v_mfma_f32_16x16x32_bf16 v[204:207], v[72:75], v[252:255], v[204:207]
s_waitcnt lgkmcnt(0)
MA 208,76,240
s_waitcnt vmcnt(7)
s_barrier
s_add_u32 m0, s43, 0xc000
v_mfma_f32_16x16x32_bf16 v[208:211], v[80:83], v[224:227], v[208:211]
s_add_u32 s50, s44, 0x1b0200
TR 64,5,0
v_mfma_f32_16x16x32_bf16 v[208:211], v[84:87], v[240:243], v[208:211]
TR 66,5,512
MA 212,76,244
TR 68,5,8192
v_mfma_f32_16x16x32_bf16 v[212:215], v[80:83], v[228:231], v[212:215]
TR 70,5,8704
v_mfma_f32_16x16x32_bf16 v[212:215], v[84:87], v[244:247], v[212:215]
TR 72,5,16384
MA 216,76,248
TR 74,5,16896
v_mfma_f32_16x16x32_bf16 v[216:219], v[80:83], v[232:235], v[216:219]
buffer_load_dwordx4 v2, s[8:11], s50 offen lds
v_mfma_f32_16x16x32_bf16 v[216:219], v[84:87], v[248:251], v[216:219]
s_add_u32 m0, s43, 0xd000
MA 220,76,252
s_add_u32 s51, s44, 0x1b0200
v_mfma_f32_16x16x32_bf16 v[220:223], v[80:83], v[236:239], v[220:223]
v_mfma_f32_16x16x32_bf16 v[220:223], v[84:87], v[252:255], v[220:223]
s_waitcnt lgkmcnt(0)
v_mfma_f32_16x16x32_bf16 v[96:99], v[64:67], a[0:3], 0
TR 76,6,0
MA 96,68,16
TR 78,6,512
MA 96,72,32
TR 80,6,8192
v_mfma_f32_16x16x32_bf16 v[100:103], v[64:67], a[4:7], 0
TR 82,6,8704
MA 100,68,20
TR 84,6,16384
v_mul_f32 v192, v160, v192
MA 100,72,36
TR 86,6,16896
v_mul_f32 v193, v161, v193
v_mfma_f32_16x16x32_bf16 v[104:107], v[64:67], a[8:11], 0
buffer_load_dwordx4 v2, s[12:15], s51 offen lds
MA 104,68,24
s_add_u32 m0, s43, 0xe000
v_exp_f32 v160, -v160
MA 104,72,40
s_add_u32 s50, s44, 0x1f8200
v_exp_f32 v161, -v161
v_mfma_f32_16x16x32_bf16 v[108:111], v[64:67], a[12:15], 0
v_mul_f32 v194, v162, v194
v_mul_f32 v195, v163, v195
MA 108,68,28
v_exp_f32 v162, -v162
MA 108,72,44
buffer_load_dwordx4 v2, s[8:11], s50 offen lds
s_waitcnt lgkmcnt(0)
v_mfma_f32_16x16x32_bf16 v[112:115], v[76:79], a[0:3], 0
s_add_u32 m0, s43, 0xf000
TR 64,5,4096
v_mul_f32 v208, v176, v208
MA 112,80,16
s_add_u32 s51, s44, 0x1f8200
TR 66,5,4608
v_mul_f32 v209, v177, v209
MA 112,84,32
TR 68,5,12288
v_mul_f32 v210, v178, v210
v_mfma_f32_16x16x32_bf16 v[116:119], v[76:79], a[4:7], 0
TR 70,5,12800
v_mul_f32 v211, v179, v211
MA 116,80,20
TR 72,5,20480
v_add_f32 v160, 1.0, v160
MA 116,84,36
TR 74,5,20992
v_add_f32 v161, 1.0, v161
v_mfma_f32_16x16x32_bf16 v[120:123], v[76:79], a[8:11], 0
buffer_load_dwordx4 v2, s[12:15], s51 offen lds
MA 120,80,24
s_add_u32 m0, s43, 0x10000
v_exp_f32 v163, -v163
MA 120,84,40
s_add_u32 s50, s44, 0x240200
v_exp_f32 v176, -v176
v_mfma_f32_16x16x32_bf16 v[124:127], v[76:79], a[12:15], 0
v_exp_f32 v177, -v177
MA 124,80,28
v_exp_f32 v178, -v178
MA 124,84,44
buffer_load_dwordx4 v2, s[8:11], s50 offen lds
s_waitcnt lgkmcnt(0)
v_mfma_f32_16x16x32_bf16 v[128:131], v[64:67], a[0:3], 0
s_add_u32 m0, s43, 0x11000
TR 76,6,4096
v_add_f32 v162, 1.0, v162
MA 128,68,16
s_add_u32 s51, s44, 0x240200
TR 78,6,4608
v_add_f32 v163, 1.0, v163
MA 128,72,32
TR 80,6,12288
v_add_f32 v176, 1.0, v176
v_mfma_f32_16x16x32_bf16 v[132:135], v[64:67], a[4:7], 0
TR 82,6,12800
v_add_f32 v177, 1.0, v177
MA 132,68,20
TR 84,6,20480
v_add_f32 v178, 1.0, v178
MA 132,72,36
TR 86,6,20992
v_mul_f32 v196, v164, v196
v_mfma_f32_16x16x32_bf16 v[136:139], v[64:67], a[8:11], 0
buffer_load_dwordx4 v2, s[12:15], s51 offen lds
MA 136,68,24
v_exp_f32 v179, -v179
MA 136,72,40
v_rcp_f32 v160, v160
v_mfma_f32_16x16x32_bf16 v[140:143], v[64:67], a[12:15], 0
v_rcp_f32 v161, v161
MA 140,68,28
v_rcp_f32 v162, v162
MA 140,72,44
v_add_f32 v179, 1.0, v179
s_waitcnt lgkmcnt(0)
v_mfma_f32_16x16x32_bf16 v[144:147], v[76:79], a[0:3], 0
s_waitcnt vmcnt(6)
s_barrier
s_add_u32 m0, s43, 0x0
v_rcp_f32 v163, v163
MA 144,80,16
s_add_u32 s50, s44, 0x288200
TR 64,5,24576
v_mul_f32 v192, v192, v160
MA 144,84,32
TR 66,5,25088
v_mul_f32 v193, v193, v161
v_mfma_f32_16x16x32_bf16 v[148:151], v[76:79], a[4:7], 0
TR 68,5,32768
v_mul_f32 v194, v194, v162
MA 148,80,20
TR 70,5,33280
v_mul_f32 v195, v195, v163
MA 148,84,36
TR 72,5,40960
v_cvt_pk_bf16_f32 v160, v192, v193
v_mfma_f32_16x16x32_bf16 v[152:155], v[76:79], a[8:11], 0
TR 74,5,41472
v_cvt_pk_bf16_f32 v161, v194, v195
MA 152,80,24
buffer_load_dwordx4 v2, s[8:11], s50 offen lds
MA 152,84,40
s_add_u32 m0, s43, 0x1000
v_rcp_f32 v176, v176
v_mfma_f32_16x16x32_bf16 v[156:159], v[76:79], a[12:15], 0
s_add_u32 s51, s44, 0x288200
v_rcp_f32 v177, v177
MA 156,80,28
v_rcp_f32 v178, v178
MA 156,84,44
v_mul_f32 v208, v208, v176
s_waitcnt lgkmcnt(0)
MA 96,64,48
TR 76,6,24576
v_mul_f32 v209, v209, v177
MA 96,68,64
TR 78,6,25088
v_mul_f32 v210, v210, v178
MA 96,72,80
TR 80,6,32768
v_cvt_pk_bf16_f32 v162, v208, v209
MA 100,64,52
TR 82,6,33280
v_mul_f32 v197, v165, v197
MA 100,68,68
TR 84,6,40960
v_mul_f32 v198, v166, v198
MA 100,72,84
TR 86,6,41472
v_mul_f32 v199, v167, v199
MA 104,64,56
buffer_load_dwordx4 v2, s[12:15], s51 offen lds
MA 104,68,72
s_add_u32 m0, s43, 0x2000
v_rcp_f32 v179, v179
MA 104,72,88
s_add_u32 s50, s44, 0x2d0200
v_exp_f32 v164, -v164
MA 108,64,60
v_exp_f32 v165, -v165
MA 108,68,76
v_exp_f32 v166, -v166
MA 108,72,92
buffer_load_dwordx4 v2, s[8:11], s50 offen lds
s_waitcnt lgkmcnt(0)
MA 112,76,48
s_add_u32 m0, s43, 0x3000
TR 64,5,28672
v_mul_f32 v211, v211, v179
MA 112,80,64
s_add_u32 s51, s44, 0x2d0200
TR 66,5,29184
v_cvt_pk_bf16_f32 v163, v210, v211
MA 112,84,80
TR 68,5,36864
v_mul_f32 v212, v180, v212
MA 116,76,52
TR 70,5,37376
v_mul_f32 v213, v181, v213
MA 116,80,68
TR 72,5,45056
v_mul_f32 v214, v182, v214
MA 116,84,84
TR 74,5,45568
v_mul_f32 v215, v183, v215
MA 120,76,56
buffer_load_dwordx4 v2, s[12:15], s51 offen lds
MA 120,80,72
s_add_u32 m0, s43, 0x4000
ds_write_b128 v11, v[160:163] offset:49152
MA 120,84,88
s_add_u32 s50, s44, 0x318200
v_exp_f32 v167, -v167
MA 124,76,60
v_exp_f32 v180, -v180
MA 124,80,76
v_exp_f32 v181, -v181
MA 124,84,92
buffer_load_dwordx4 v2, s[8:11], s50 offen lds
s_waitcnt lgkmcnt(1)
MA 128,64,48
s_add_u32 m0, s43, 0x5000
TR 76,6,28672
v_add_f32 v164, 1.0, v164
MA 128,68,64
s_add_u32 s51, s44, 0x318200
TR 78,6,29184
v_add_f32 v165, 1.0, v165
MA 128,72,80
TR 80,6,36864
v_add_f32 v166, 1.0, v166
MA 132,64,52
TR 82,6,37376
v_add_f32 v167, 1.0, v167
MA 132,68,68
TR 84,6,45056
v_add_f32 v180, 1.0, v180
MA 132,72,84
TR 86,6,45568
v_add_f32 v181, 1.0, v181
MA 136,64,56
buffer_load_dwordx4 v2, s[12:15], s51 offen lds
MA 136,68,72
v_exp_f32 v182, -v182
MA 136,72,88
v_exp_f32 v183, -v183
MA 140,64,60
v_rcp_f32 v164, v164
MA 140,68,76
v_rcp_f32 v165, v165
MA 140,72,92
v_add_f32 v182, 1.0, v182
s_waitcnt lgkmcnt(0)
MA 144,76,48
s_waitcnt vmcnt(6)
s_barrier
s_add_u32 m0, s43, 0x6000
v_rcp_f32 v166, v166
MA 144,80,64
s_add_u32 s50, s44, 0x360200
TR 64,5,49152
v_add_f32 v183, 1.0, v183
MA 144,84,80
TR 66,5,49664
v_mul_f32 v196, v196, v164
MA 148,76,52
TR 68,5,57344
v_mul_f32 v197, v197, v165
MA 148,80,68
TR 70,5,57856
v_mul_f32 v198, v198, v166
MA 148,84,84
TR 72,7,0
v_cvt_pk_bf16_f32 v164, v196, v197
MA 152,76,56
TR 74,7,512
v_mul_f32 v200, v168, v200
MA 152,80,72
buffer_load_dwordx4 v2, s[8:11], s50 offen lds
MA 152,84,88
s_add_u32 m0, s43, 0x7000
v_rcp_f32 v167, v167
MA 156,76,60
s_add_u32 s51, s44, 0x360200
v_rcp_f32 v180, v180
MA 156,80,76
v_rcp_f32 v181, v181
MA 156,84,92
v_mul_f32 v199, v199, v167
s_waitcnt lgkmcnt(0)
MA 96,64,96
TR 76,6,49152
v_mul_f32 v212, v212, v180
MA 96,68,112
TR 78,6,49664
v_mul_f32 v213, v213, v181
MA 96,72,128
TR 80,6,57344
v_cvt_pk_bf16_f32 v165, v198, v199
MA 100,64,100
TR 82,6,57856
v_cvt_pk_bf16_f32 v166, v212, v213
MA 100,68,116
TR 84,8,0
v_mul_f32 v201, v169, v201
MA 100,72,132
TR 86,8,512
v_mul_f32 v202, v170, v202
MA 104,64,104
buffer_load_dwordx4 v2, s[12:15], s51 offen lds
MA 104,68,120
s_add_u32 m0, s43, 0x8000
v_rcp_f32 v182, v182
MA 104,72,136
s_add_u32 s50, s44, 0x3a8200
v_rcp_f32 v183, v183
MA 108,64,108
v_exp_f32 v168, -v168
MA 108,68,124
v_exp_f32 v169, -v169
MA 108,72,140
buffer_load_dwordx4 v2, s[8:11], s50 offen lds
s_waitcnt lgkmcnt(0)
MA 112,76,96
s_add_u32 m0, s43, 0x9000
TR 64,5,53248
v_mul_f32 v214, v214, v182
MA 112,80,112
s_add_u32 s51, s44, 0x3a8200
TR 66,5,53760
v_mul_f32 v215, v215, v183
MA 112,84,128
TR 68,5,61440
v_cvt_pk_bf16_f32 v167, v214, v215
MA 116,76,100
TR 70,5,61952
v_mul_f32 v203, v171, v203
MA 116,80,116
TR 72,7,4096
v_mul_f32 v216, v184, v216
MA 116,84,132
TR 74,7,4608
v_mul_f32 v217, v185, v217
MA 120,76,104
buffer_load_dwordx4 v2, s[12:15], s51 offen lds
MA 120,80,120
s_add_u32 m0, s43, 0xa000
ds_write_b128 v11, v[164:167] offset:50176
MA 120,84,136
s_add_u32 s50, s44, 0x3f0200
v_exp_f32 v170, -v170
MA 124,76,108
v_exp_f32 v171, -v171
MA 124,80,124
v_exp_f32 v184, -v184
MA 124,84,140
buffer_load_dwordx4 v2, s[8:11], s50 offen lds
s_waitcnt lgkmcnt(1)
MA 128,64,96
s_add_u32 m0, s43, 0xb000
TR 76,6,53248
v_mul_f32 v218, v186, v218
MA 128,68,112
s_add_u32 s51, s44, 0x3f0200
TR 78,6,53760
v_mul_f32 v219, v187, v219
MA 128,72,128
TR 80,6,61440
v_add_f32 v168, 1.0, v168
MA 132,64,100
TR 82,6,61952
v_add_f32 v169, 1.0, v169
MA 132,68,116
TR 84,8,4096
v_add_f32 v170, 1.0, v170
MA 132,72,132
TR 86,8,4608
v_add_f32 v171, 1.0, v171
MA 136,64,104
buffer_load_dwordx4 v2, s[12:15], s51 offen lds
MA 136,68,120
v_exp_f32 v185, -v185
MA 136,72,136
v_exp_f32 v186, -v186
MA 140,64,108
v_exp_f32 v187, -v187
MA 140,68,124
v_rcp_f32 v168, v168
MA 140,72,140
v_add_f32 v184, 1.0, v184
s_waitcnt lgkmcnt(0)
MA 144,76,96
s_waitcnt vmcnt(6)
s_barrier
s_add_u32 m0, s43, 0xc000
v_rcp_f32 v169, v169
MA 144,80,112
s_add_u32 s50, s44, 0x438200
TR 64,5,0
v_add_f32 v185, 1.0, v185
MA 144,84,128
TR 66,5,512
v_add_f32 v186, 1.0, v186
MA 148,76,100
TR 68,5,8192
v_add_f32 v187, 1.0, v187
MA 148,80,116
TR 70,5,8704
v_mul_f32 v200, v200, v168
MA 148,84,132
TR 72,5,16384
v_mul_f32 v201, v201, v169
MA 152,76,104
TR 74,5,16896
v_cvt_pk_bf16_f32 v168, v200, v201
MA 152,80,120
buffer_load_dwordx4 v2, s[8:11], s50 offen lds
MA 152,84,136
s_add_u32 m0, s43, 0xd000
v_rcp_f32 v170, v170
MA 156,76,108
s_add_u32 s51, s44, 0x438200
v_rcp_f32 v171, v171
MA 156,80,124
v_rcp_f32 v184, v184
MA 156,84,140
v_mul_f32 v202, v202, v170
s_waitcnt lgkmcnt(0)
MA 96,64,144
TR 76,6,0
v_mul_f32 v203, v203, v171
MA 96,68,160
TR 78,6,512
v_mul_f32 v216, v216, v184
MA 96,72,176
TR 80,6,8192
v_cvt_pk_bf16_f32 v169, v202, v203
MA 100,64,148
TR 82,6,8704
v_mul_f32 v204, v172, v204
MA 100,68,164
TR 84,6,16384
v_mul_f32 v205, v173, v205
MA 100,72,180
TR 86,6,16896
v_mul_f32 v206, v174, v206
MA 104,64,152
buffer_load_dwordx4 v2, s[12:15], s51 offen lds
MA 104,68,168
s_add_u32 m0, s43, 0xe000
v_rcp_f32 v185, v185
MA 104,72,184
s_add_u32 s50, s44, 0x480200
v_rcp_f32 v186, v186
MA 108,64,156
v_rcp_f32 v187, v187
MA 108,68,172
v_exp_f32 v172, -v172
MA 108,72,188
buffer_load_dwordx4 v2, s[8:11], s50 offen lds
s_waitcnt lgkmcnt(0)
MA 112,76,144
s_add_u32 m0, s43, 0xf000
TR 64,5,4096
v_mul_f32 v217, v217, v185
MA 112,80,160
s_add_u32 s51, s44, 0x480200
TR 66,5,4608
v_mul_f32 v218, v218, v186
MA 112,84,176
TR 68,5,12288
v_mul_f32 v219, v219, v187
MA 116,76,148
TR 70,5,12800
v_cvt_pk_bf16_f32 v170, v216, v217
MA 116,80,164
TR 72,5,20480
v_cvt_pk_bf16_f32 v171, v218, v219
MA 116,84,180
TR 74,5,20992
v_mul_f32 v207, v175, v207
MA 120,76,152
buffer_load_dwordx4 v2, s[12:15], s51 offen lds
MA 120,80,168
s_add_u32 m0, s43, 0x10000
ds_write_b128 v11, v[168:171] offset:51200
MA 120,84,184
s_add_u32 s50, s44, 0x4c8200
v_exp_f32 v173, -v173
MA 124,76,156
v_exp_f32 v174, -v174
MA 124,80,172
v_exp_f32 v175, -v175
MA 124,84,188
buffer_load_dwordx4 v2, s[8:11], s50 offen lds
s_waitcnt lgkmcnt(1)
MA 128,64,144
s_add_u32 m0, s43, 0x11000
TR 76,6,4096
v_mul_f32 v220, v188, v220
MA 128,68,160
s_add_u32 s51, s44, 0x4c8200
TR 78,6,4608
v_mul_f32 v221, v189, v221
MA 128,72,176
TR 80,6,12288
v_mul_f32 v222, v190, v222
MA 132,64,148
TR 82,6,12800
v_mul_f32 v223, v191, v223
MA 132,68,164
TR 84,6,20480
v_add_f32 v172, 1.0, v172
MA 132,72,180
TR 86,6,20992
v_add_f32 v173, 1.0, v173
MA 136,64,152
buffer_load_dwordx4 v2, s[12:15], s51 offen lds
MA 136,68,168
v_exp_f32 v188, -v188
MA 136,72,184
v_exp_f32 v189, -v189
MA 140,64,156
v_exp_f32 v190, -v190
MA 140,68,172
v_exp_f32 v191, -v191
MA 140,72,188
v_add_f32 v174, 1.0, v174
s_waitcnt lgkmcnt(0)
MA 144,76,144
s_waitcnt vmcnt(6)
s_barrier
s_add_u32 m0, s43, 0x0
v_rcp_f32 v172, v172
MA 144,80,160
s_add_u32 s50, s52, 0x0
TR 64,5,24576
v_add_f32 v175, 1.0, v175
MA 144,84,176
TR 66,5,25088
v_add_f32 v188, 1.0, v188
MA 148,76,148
TR 68,5,32768
v_add_f32 v189, 1.0, v189
MA 148,80,164
TR 70,5,33280
v_add_f32 v190, 1.0, v190
MA 148,84,180
TR 72,5,40960
v_add_f32 v191, 1.0, v191
MA 152,76,152
TR 74,5,41472
v_mul_f32 v204, v204, v172
MA 152,80,168
buffer_load_dwordx4 v2, s[8:11], s50 offen lds
MA 152,84,184
s_add_u32 m0, s43, 0x1000
v_rcp_f32 v173, v173
MA 156,76,156
s_add_u32 s51, s52, 0x0
v_rcp_f32 v174, v174
MA 156,80,172
v_rcp_f32 v175, v175
MA 156,84,188
v_mul_f32 v205, v205, v173
s_waitcnt lgkmcnt(0)
MA 96,64,192
TR 76,6,24576
v_mul_f32 v206, v206, v174
MA 96,68,208
TR 78,6,25088
v_mul_f32 v207, v207, v175
MA 96,72,224
TR 80,6,32768
v_cvt_pk_bf16_f32 v172, v204, v205
MA 100,64,196
TR 82,6,33280
v_cvt_pk_bf16_f32 v173, v206, v207
MA 100,68,212
TR 84,6,40960
MA 100,72,228
TR 86,6,41472
MA 104,64,200
buffer_load_dwordx4 v2, s[12:15], s51 offen lds
MA 104,68,216
s_add_u32 m0, s43, 0x2000
v_rcp_f32 v188, v188
MA 104,72,232
s_add_u32 s50, s52, 0x48000
v_rcp_f32 v189, v189
MA 108,64,204
v_rcp_f32 v190, v190
MA 108,68,220
v_rcp_f32 v191, v191
MA 108,72,236
buffer_load_dwordx4 v2, s[8:11], s50 offen lds
s_waitcnt lgkmcnt(0)
MA 112,76,192
s_add_u32 m0, s43, 0x3000
TR 64,5,28672
v_mul_f32 v220, v220, v188
MA 112,80,208
s_add_u32 s51, s52, 0x48000
TR 66,5,29184
v_mul_f32 v221, v221, v189
MA 112,84,224
TR 68,5,36864
v_mul_f32 v222, v222, v190
MA 116,76,196
TR 70,5,37376
v_mul_f32 v223, v223, v191
MA 116,80,212
TR 72,5,45056
v_cvt_pk_bf16_f32 v174, v220, v221
MA 116,84,228
TR 74,5,45568
v_cvt_pk_bf16_f32 v175, v222, v223
MA 120,76,200
buffer_load_dwordx4 v2, s[12:15], s51 offen lds
MA 120,80,216
s_add_u32 m0, s43, 0x4000
ds_write_b128 v11, v[172:175] offset:52224
MA 120,84,232
s_add_u32 s50, s52, 0x90000
MA 124,76,204
MA 124,80,220
MA 124,84,236
buffer_load_dwordx4 v2, s[8:11], s50 offen lds
s_waitcnt lgkmcnt(1)
MA 128,64,192
s_add_u32 m0, s43, 0x5000
TR 76,6,28672
MA 128,68,208
s_add_u32 s51, s52, 0x90000
TR 78,6,29184
MA 128,72,224
TR 80,6,36864
MA 132,64,196
TR 82,6,37376
MA 132,68,212
TR 84,6,45056
MA 132,72,228
TR 86,6,45568
MA 136,64,200
buffer_load_dwordx4 v2, s[12:15], s51 offen lds
MA 136,68,216
MA 136,72,232
MA 140,64,204
MA 140,68,220
MA 140,72,236
s_waitcnt lgkmcnt(0)
MA 144,76,192
s_waitcnt vmcnt(6)
s_barrier
s_add_u32 m0, s43, 0x6000
MA 144,80,208
s_add_u32 s50, s52, 0xd8000
TR 64,5,49152
MA 144,84,224
TR 66,5,49664
MA 148,76,196
TR 68,5,57344
MA 148,80,212
TR 70,5,57856
MA 148,84,228
TR 72,7,0
MA 152,76,200
TR 74,7,512
MA 152,80,216
buffer_load_dwordx4 v2, s[8:11], s50 offen lds
MA 152,84,232
s_add_u32 m0, s43, 0x7000
MA 156,76,204
s_add_u32 s51, s52, 0xd8000
MA 156,80,220
MA 156,84,236
s_waitcnt lgkmcnt(0)
MA 96,64,240
TR 76,6,49152
v_mfma_f32_16x16x32_bf16 v[96:99], v[68:71], v[224:227], v[96:99]
TR 78,6,49664
v_mfma_f32_16x16x32_bf16 v[96:99], v[72:75], v[240:243], v[96:99]
TR 80,6,57344
MA 100,64,244
TR 82,6,57856
v_mfma_f32_16x16x32_bf16 v[100:103], v[68:71], v[228:231], v[100:103]
TR 84,8,0
v_mfma_f32_16x16x32_bf16 v[100:103], v[72:75], v[244:247], v[100:103]
TR 86,8,512
MA 104,64,248
buffer_load_dwordx4 v2, s[12:15], s51 offen lds
v_mfma_f32_16x16x32_bf16 v[104:107], v[68:71], v[232:235], v[104:107]
s_add_u32 m0, s43, 0x8000
v_mfma_f32_16x16x32_bf16 v[104:107], v[72:75], v[248:251], v[104:107]
s_add_u32 s50, s52, 0x120000
MA 108,64,252
v_mfma_f32_16x16x32_bf16 v[108:111], v[68:71], v[236:239], v[108:111]
v_mfma_f32_16x16x32_bf16 v[108:111], v[72:75], v[252:255], v[108:111]
buffer_load_dwordx4 v2, s[8:11], s50 offen lds
s_waitcnt lgkmcnt(0)
MA 112,76,240
s_add_u32 m0, s43, 0x9000
TR 64,5,53248
v_mfma_f32_16x16x32_bf16 v[112:115], v[80:83], v[224:227], v[112:115]
s_add_u32 s51, s52, 0x120000
TR 66,5,53760
v_mfma_f32_16x16x32_bf16 v[112:115], v[84:87], v[240:243], v[112:115]
TR 68,5,61440
MA 116,76,244
TR 70,5,61952
v_mfma_f32_16x16x32_bf16 v[116:119], v[80:83], v[228:231], v[116:119]
TR 72,7,4096
v_mfma_f32_16x16x32_bf16 v[116:119], v[84:87], v[244:247], v[116:119]
TR 74,7,4608
MA 120,76,248
buffer_load_dwordx4 v2, s[12:15], s51 offen lds
v_mfma_f32_16x16x32_bf16 v[120:123], v[80:83], v[232:235], v[120:123]
s_add_u32 m0, s43, 0xa000
v_mfma_f32_16x16x32_bf16 v[120:123], v[84:87], v[248:251], v[120:123]
s_add_u32 s50, s52, 0x168000
MA 124,76,252
v_mfma_f32_16x16x32_bf16 v[124:127], v[80:83], v[236:239], v[124:127]
v_mfma_f32_16x16x32_bf16 v[124:127], v[84:87], v[252:255], v[124:127]
buffer_load_dwordx4 v2, s[8:11], s50 offen lds
s_waitcnt lgkmcnt(0)
MA 128,64,240
s_add_u32 m0, s43, 0xb000
TR 76,6,53248
v_mfma_f32_16x16x32_bf16 v[128:131], v[68:71], v[224:227], v[128:131]
s_add_u32 s51, s52, 0x168000
TR 78,6,53760
v_mfma_f32_16x16x32_bf16 v[128:131], v[72:75], v[240:243], v[128:131]
TR 80,6,61440
MA 132,64,244
TR 82,6,61952
v_mfma_f32_16x16x32_bf16 v[132:135], v[68:71], v[228:231], v[132:135]
TR 84,8,4096
v_mfma_f32_16x16x32_bf16 v[132:135], v[72:75], v[244:247], v[132:135]
TR 86,8,4608
MA 136,64,248
buffer_load_dwordx4 v2, s[12:15], s51 offen lds
v_mfma_f32_16x16x32_bf16 v[136:139], v[68:71], v[232:235], v[136:139]
v_mfma_f32_16x16x32_bf16 v[136:139], v[72:75], v[248:251], v[136:139]
MA 140,64,252
v_mfma_f32_16x16x32_bf16 v[140:143], v[68:71], v[236:239], v[140:143]
v_mfma_f32_16x16x32_bf16 v[140:143], v[72:75], v[252:255], v[140:143]
s_waitcnt lgkmcnt(0)
MA 144,76,240
s_waitcnt vmcnt(6)
s_barrier
v_bfe_u32 v88, v0, 4, 2
v_bfe_u32 v89, v0, 2, 2
v_lshlrev_b32 v5, 10, v88
v_lshl_add_u32 v5, v89, 7, v5
v_and_b32 v88, 1, v88
v_lshlrev_b32 v88, 1, v88
v_lshrrev_b32 v89, 1, v89
v_or_b32 v88, v88, v89
v_xor_b32 v88, s81, v88
v_lshl_add_u32 v5, v88, 5, v5
v_and_b32 v88, 3, v0
v_lshl_add_u32 v5, v88, 3, v5
v_xor_b32 v6, 32, v5
v_add_u32 v7, 0x10000, v5
v_add_u32 v8, 0x10000, v6
s_add_u32 m0, s43, 0xc000
v_mfma_f32_16x16x32_bf16 v[144:147], v[80:83], v[224:227], v[144:147]
s_add_u32 s50, s52, 0x1b0000
TR 64,5,0
v_mfma_f32_16x16x32_bf16 v[144:147], v[84:87], v[240:243], v[144:147]
TR 66,5,512
MA 148,76,244
TR 68,5,8192
v_mfma_f32_16x16x32_bf16 v[148:151], v[80:83], v[228:231], v[148:151]
TR 70,5,8704
v_mfma_f32_16x16x32_bf16 v[148:151], v[84:87], v[244:247], v[148:151]
TR 72,5,16384
MA 152,76,248
TR 74,5,16896
v_mfma_f32_16x16x32_bf16 v[152:155], v[80:83], v[232:235], v[152:155]
buffer_load_dwordx4 v2, s[8:11], s50 offen lds
v_mfma_f32_16x16x32_bf16 v[152:155], v[84:87], v[248:251], v[152:155]
s_add_u32 m0, s43, 0xd000
MA 156,76,252
s_add_u32 s51, s52, 0x1b0000
v_mfma_f32_16x16x32_bf16 v[156:159], v[80:83], v[236:239], v[156:159]
v_mfma_f32_16x16x32_bf16 v[156:159], v[84:87], v[252:255], v[156:159]
s_lshl_b32 s82, s80, 2
v_add_u32 v63, s82, v12
s_waitcnt lgkmcnt(0)
v_mfma_f32_16x16x32_bf16 v[160:163], v[64:67], a[0:3], 0
TR 76,5,4096
MA 160,68,16
TR 78,5,4608
MA 160,72,32
TR 80,5,12288
v_mfma_f32_16x16x32_bf16 v[164:167], v[64:67], a[4:7], 0
TR 82,5,12800
MA 164,68,20
TR 84,5,20480
v_mul_f32 v128, v96, v128
MA 164,72,36
TR 86,5,20992
v_mul_f32 v129, v97, v129
v_mfma_f32_16x16x32_bf16 v[168:171], v[64:67], a[8:11], 0
buffer_load_dwordx4 v2, s[12:15], s51 offen lds
MA 168,68,24
s_add_u32 m0, s43, 0xe000
s_add_u32 s50, s52, 0x1f8000
v_exp_f32 v96, -v96
MA 168,72,40
buffer_load_dwordx4 v2, s[8:11], s50 offen lds
v_mfma_f32_16x16x32_bf16 v[172:175], v[64:67], a[12:15], 0
s_add_u32 m0, s43, 0xf000
s_add_u32 s51, s52, 0x1f8000
v_exp_f32 v97, -v97
MA 172,68,28
buffer_load_dwordx4 v2, s[12:15], s51 offen lds
MA 172,72,44
s_add_u32 m0, s43, 0x10000
s_add_u32 s50, s52, 0x240000
s_waitcnt lgkmcnt(0)
v_mfma_f32_16x16x32_bf16 v[176:179], v[76:79], a[0:3], 0
s_waitcnt vmcnt(4)
s_barrier
v_mul_f32 v130, v98, v130
v_mul_f32 v131, v99, v131
MA 176,80,16
TR 64,5,24576
v_mul_f32 v144, v112, v144
MA 176,84,32
TR 66,5,25088
v_mul_f32 v145, v113, v145
v_mfma_f32_16x16x32_bf16 v[180:183], v[76:79], a[4:7], 0
TR 68,5,32768
v_mul_f32 v146, v114, v146
MA 180,80,20
TR 70,5,33280
v_mul_f32 v147, v115, v147
MA 180,84,36
TR 72,5,40960
v_add_f32 v96, 1.0, v96
v_mfma_f32_16x16x32_bf16 v[184:187], v[76:79], a[8:11], 0
TR 74,5,41472
v_add_f32 v97, 1.0, v97
MA 184,80,24
buffer_load_dwordx4 v2, s[8:11], s50 offen lds
MA 184,84,40
s_add_u32 m0, s43, 0x11000
s_add_u32 s51, s52, 0x240000
v_exp_f32 v98, -v98
v_mfma_f32_16x16x32_bf16 v[188:191], v[76:79], a[12:15], 0
buffer_load_dwordx4 v2, s[12:15], s51 offen lds
MA 188,80,28
s_add_u32 m0, s43, 0x0
s_add_u32 s50, s52, 0x288000
v_exp_f32 v99, -v99
MA 188,84,44
buffer_load_dwordx4 v2, s[8:11], s50 offen lds
s_waitcnt lgkmcnt(0)
MA 160,64,48
s_add_u32 m0, s43, 0x1000
s_add_u32 s51, s52, 0x288000
TR 76,5,28672
MA 160,68,64
TR 78,5,29184
v_add_f32 v98, 1.0, v98
MA 160,72,80
TR 80,5,36864
v_add_f32 v99, 1.0, v99
MA 164,64,52
TR 82,5,37376
MA 164,68,68
TR 84,5,45056
MA 164,72,84
TR 86,5,45568
MA 168,64,56
buffer_load_dwordx4 v2, s[12:15], s51 offen lds
MA 168,68,72
s_add_u32 m0, s43, 0x2000
s_add_u32 s50, s52, 0x2d0000
ds_read_b128 a[0:3], v12 offset:0
MA 168,72,88
buffer_load_dwordx4 v2, s[8:11], s50 offen lds
MA 172,64,60
s_add_u32 m0, s43, 0x3000
s_add_u32 s51, s52, 0x2d0000
v_exp_f32 v112, -v112
MA 172,68,76
buffer_load_dwordx4 v2, s[12:15], s51 offen lds
MA 172,72,92
s_add_u32 m0, s43, 0x4000
s_add_u32 s50, s52, 0x318000
s_waitcnt lgkmcnt(1)
MA 176,76,48
s_waitcnt vmcnt(4)
s_waitcnt lgkmcnt(0)
s_barrier
ds_read_b128 a[4:7], v12 offset:1024
v_add_f32 v112, 1.0, v112
MA 176,80,64
TR 64,5,49152
MA 176,84,80
TR 66,5,49664
MA 180,76,52
TR 68,5,57344
MA 180,80,68
TR 70,5,57856
MA 180,84,84
TR 72,7,0
MA 184,76,56
TR 74,7,512
MA 184,80,72
buffer_load_dwordx4 v2, s[8:11], s50 offen lds
MA 184,84,88
s_add_u32 m0, s43, 0x5000
s_add_u32 s51, s52, 0x318000
ds_read_b128 a[8:11], v12 offset:2048
MA 188,76,60
buffer_load_dwordx4 v2, s[12:15], s51 offen lds
MA 188,80,76
s_add_u32 m0, s43, 0x6000
s_add_u32 s50, s52, 0x360000
ds_read_b128 a[12:15], v12 offset:3072
MA 188,84,92
buffer_load_dwordx4 v2, s[8:11], s50 offen lds
s_waitcnt lgkmcnt(2)
MA 160,64,96
s_add_u32 m0, s43, 0x7000
s_add_u32 s51, s52, 0x360000
TR 76,5,53248
MA 160,68,112
TR 78,5,53760
MA 160,72,128
TR 80,5,61440
MA 164,64,100
TR 82,5,61952
MA 164,68,116
TR 84,7,4096
MA 164,72,132
TR 86,7,4608
MA 168,64,104
buffer_load_dwordx4 v2, s[12:15], s51 offen lds
MA 168,68,120
s_add_u32 m0, s43, 0x8000
s_add_u32 s50, s52, 0x3a8000
ds_read_b128 a[16:19], v12 offset:8192
MA 168,72,136
buffer_load_dwordx4 v2, s[8:11], s50 offen lds
MA 172,64,108
s_add_u32 m0, s43, 0x9000
s_add_u32 s51, s52, 0x3a8000
v_exp_f32 v113, -v113
MA 172,68,124
buffer_load_dwordx4 v2, s[12:15], s51 offen lds
MA 172,72,140
s_add_u32 m0, s43, 0xa000
s_add_u32 s50, s52, 0x3f0000
s_waitcnt lgkmcnt(1)
MA 176,76,96
s_waitcnt vmcnt(4)
s_waitcnt lgkmcnt(0)
s_barrier
ds_read_b128 a[20:23], v12 offset:9216
v_add_f32 v113, 1.0, v113
MA 176,80,112
TR 64,5,0
MA 176,84,128
TR 66,5,512
MA 180,76,100
TR 68,5,8192
MA 180,80,116
TR 70,5,8704
MA 180,84,132
TR 72,5,16384
MA 184,76,104
TR 74,5,16896
MA 184,80,120
buffer_load_dwordx4 v2, s[8:11], s50 offen lds
MA 184,84,136
s_add_u32 m0, s43, 0xb000
s_add_u32 s51, s52, 0x3f0000
ds_read_b128 a[24:27], v12 offset:10240
MA 188,76,108
buffer_load_dwordx4 v2, s[12:15], s51 offen lds
MA 188,80,124
s_add_u32 m0, s43, 0xc000
s_add_u32 s50, s52, 0x438000
ds_read_b128 a[28:31], v12 offset:11264
MA 188,84,140
buffer_load_dwordx4 v2, s[8:11], s50 offen lds
s_waitcnt lgkmcnt(2)
MA 160,64,144
s_add_u32 m0, s43, 0xd000
s_add_u32 s51, s52, 0x438000
TR 76,5,4096
v_exp_f32 v114, -v114
MA 160,68,160
TR 78,5,4608
v_exp_f32 v115, -v115
MA 160,72,176
TR 80,5,12288
v_rcp_f32 v96, v96
MA 164,64,148
TR 82,5,12800
v_rcp_f32 v97, v97
MA 164,68,164
TR 84,5,20480
v_rcp_f32 v98, v98
MA 164,72,180
TR 86,5,20992
v_rcp_f32 v99, v99
MA 168,64,152
buffer_load_dwordx4 v2, s[12:15], s51 offen lds
MA 168,68,168
s_add_u32 m0, s43, 0xe000
s_add_u32 s50, s52, 0x480000
ds_read_b128 a[32:35], v12 offset:16384
v_rcp_f32 v112, v112
MA 168,72,184
buffer_load_dwordx4 v2, s[8:11], s50 offen lds
MA 172,64,156
s_add_u32 m0, s43, 0xf000
s_add_u32 s51, s52, 0x480000
v_rcp_f32 v113, v113
v_add_f32 v114, 1.0, v114
MA 172,68,172
buffer_load_dwordx4 v2, s[12:15], s51 offen lds
MA 172,72,188
s_add_u32 m0, s43, 0x10000
s_add_u32 s50, s52, 0x4c8000
v_rcp_f32 v114, v114
s_waitcnt lgkmcnt(1)
MA 176,76,144
s_waitcnt vmcnt(4)
s_waitcnt lgkmcnt(0)
s_barrier
ds_read_b128 a[36:39], v12 offset:17408
v_add_f32 v115, 1.0, v115
v_mul_f32 v128, v128, v96
MA 176,80,160
TR 64,5,24576
v_rcp_f32 v115, v115
MA 176,84,176
TR 66,5,25088
v_mul_f32 v129, v129, v97
v_mul_f32 v130, v130, v98
MA 180,76,148
TR 68,5,32768
v_mul_f32 v131, v131, v99
v_mul_f32 v144, v144, v112
MA 180,80,164
TR 70,5,33280
v_mul_f32 v145, v145, v113
v_mul_f32 v146, v146, v114
MA 180,84,180
TR 72,5,40960
v_mul_f32 v147, v147, v115
v_cvt_pk_bf16_f32 v96, v128, v129
MA 184,76,152
TR 74,5,41472
v_cvt_pk_bf16_f32 v97, v130, v131
v_cvt_pk_bf16_f32 v98, v144, v145
MA 184,80,168
buffer_load_dwordx4 v2, s[8:11], s50 offen lds
MA 184,84,184
s_add_u32 m0, s43, 0x11000
s_add_u32 s51, s52, 0x4c8000
ds_read_b128 a[40:43], v12 offset:18432
v_cvt_pk_bf16_f32 v99, v146, v147
MA 188,76,156
buffer_load_dwordx4 v2, s[12:15], s51 offen lds
MA 188,80,172
s_add_u32 m0, s43, 0x0
s_add_u32 s50, s45, 0x0
ds_read_b128 a[44:47], v12 offset:19456
v_add_u32 v15, 0x10000, v11
MA 188,84,188
buffer_load_dwordx4 v3, s[16:19], s50 offen lds
s_waitcnt lgkmcnt(2)
MA 160,64,192
s_add_u32 m0, s43, 0x1000
s_add_u32 s51, s45, 0x9000
TR 76,5,28672
v_mul_f32 v132, v100, v132
MA 160,68,208
TR 78,5,29184
v_exp_f32 v100, -v100
MA 160,72,224
TR 80,5,36864
v_mul_f32 v133, v101, v133
v_mul_f32 v134, v102, v134
MA 164,64,196
TR 82,5,37376
v_exp_f32 v101, -v101
MA 164,68,212
TR 84,5,45056
v_exp_f32 v102, -v102
MA 164,72,228
TR 86,5,45568
v_mul_f32 v135, v103, v135
v_mul_f32 v148, v116, v148
MA 168,64,200
buffer_load_dwordx4 v3, s[16:19], s51 offen lds
MA 168,68,216
s_add_u32 m0, s43, 0x2000
s_add_u32 s50, s45, 0x12000
ds_write_b128 v15, v[96:99] offset:0
v_mul_f32 v149, v117, v149
MA 168,72,232
buffer_load_dwordx4 v3, s[16:19], s50 offen lds
MA 172,64,204
s_add_u32 m0, s43, 0x3000
s_add_u32 s51, s45, 0x1b000
v_exp_f32 v103, -v103
v_mul_f32 v150, v118, v150
MA 172,68,220
buffer_load_dwordx4 v3, s[16:19], s51 offen lds
MA 172,72,236
s_add_u32 m0, s43, 0x4000
s_add_u32 s50, s45, 0x24000
v_exp_f32 v116, -v116
s_waitcnt lgkmcnt(1)
MA 176,76,192
s_waitcnt vmcnt(4)
s_waitcnt lgkmcnt(0)
s_barrier
ds_read_b128 a[48:51], v12 offset:24576
v_exp_f32 v117, -v117
MA 176,80,208
TR 64,5,49152
v_exp_f32 v118, -v118
MA 176,84,224
TR 66,5,49664
v_mul_f32 v151, v119, v151
v_add_f32 v100, 1.0, v100
MA 180,76,196
TR 68,5,57344
v_exp_f32 v119, -v119
MA 180,80,212
TR 70,5,57856
v_rcp_f32 v100, v100
MA 180,84,228
TR 72,7,0
v_add_f32 v101, 1.0, v101
v_add_f32 v102, 1.0, v102
MA 184,76,200
TR 74,7,512
v_rcp_f32 v101, v101
MA 184,80,216
buffer_load_dwordx4 v3, s[16:19], s50 offen lds
MA 184,84,232
s_add_u32 m0, s43, 0x5000
s_add_u32 s51, s45, 0x2d000
ds_read_b128 a[52:55], v12 offset:25600
v_rcp_f32 v102, v102
MA 188,76,204
buffer_load_dwordx4 v3, s[16:19], s51 offen lds
MA 188,80,220
s_add_u32 m0, s43, 0x6000
s_add_u32 s50, s45, 0x36000
ds_read_b128 a[56:59], v12 offset:26624
v_add_f32 v103, 1.0, v103
MA 188,84,236
buffer_load_dwordx4 v3, s[16:19], s50 offen lds
s_waitcnt lgkmcnt(2)
MA 160,64,240
s_add_u32 m0, s43, 0x7000
s_add_u32 s51, s45, 0x3f000
TR 76,5,53248
v_rcp_f32 v103, v103
v_mfma_f32_16x16x32_bf16 v[160:163], v[68:71], v[224:227], v[160:163]
TR 78,5,53760
v_add_f32 v116, 1.0, v116
v_add_f32 v117, 1.0, v117
v_mfma_f32_16x16x32_bf16 v[160:163], v[72:75], v[240:243], v[160:163]
TR 80,5,61440
v_rcp_f32 v116, v116
MA 164,64,244
TR 82,5,61952
v_rcp_f32 v117, v117
v_mfma_f32_16x16x32_bf16 v[164:167], v[68:71], v[228:231], v[164:167]
TR 84,7,4096
v_add_f32 v118, 1.0, v118
v_add_f32 v119, 1.0, v119
v_mfma_f32_16x16x32_bf16 v[164:167], v[72:75], v[244:247], v[164:167]
TR 86,7,4608
v_rcp_f32 v118, v118
MA 168,64,248
buffer_load_dwordx4 v3, s[16:19], s51 offen lds
v_mfma_f32_16x16x32_bf16 v[168:171], v[68:71], v[232:235], v[168:171]
s_add_u32 m0, s43, 0x8000
s_add_u32 s50, s45, 0x80
ds_read_b128 a[60:63], v12 offset:27648
v_rcp_f32 v119, v119
v_mfma_f32_16x16x32_bf16 v[168:171], v[72:75], v[248:251], v[168:171]
buffer_load_dwordx4 v3, s[16:19], s50 offen lds
MA 172,64,252
s_add_u32 m0, s43, 0x9000
s_add_u32 s51, s45, 0x9080
v_mul_f32 v132, v132, v100
v_mul_f32 v133, v133, v101
v_mfma_f32_16x16x32_bf16 v[172:175], v[68:71], v[236:239], v[172:175]
buffer_load_dwordx4 v3, s[16:19], s51 offen lds
v_mfma_f32_16x16x32_bf16 v[172:175], v[72:75], v[252:255], v[172:175]
s_add_u32 m0, s43, 0xa000
s_add_u32 s50, s45, 0x12080
v_mul_f32 v134, v134, v102
s_waitcnt lgkmcnt(1)
MA 176,76,240
s_waitcnt vmcnt(4)
s_waitcnt lgkmcnt(0)
s_barrier
L_B_p2:
v_bfe_u32 v88, v0, 4, 2
v_bfe_u32 v89, v0, 2, 2
v_lshlrev_b32 v5, 9, v88
v_lshl_add_u32 v5, v89, 7, v5
v_and_b32 v88, 1, v88
v_lshlrev_b32 v88, 1, v88
v_lshrrev_b32 v89, 1, v89
v_or_b32 v88, v88, v89
v_xor_b32 v88, s80, v88
v_lshl_add_u32 v5, v88, 5, v5
v_and_b32 v88, 3, v0
v_lshl_add_u32 v5, v88, 3, v5
v_xor_b32 v6, 32, v5
v_add_u32 v7, 0x10000, v5
v_add_u32 v8, 0x10000, v6
ds_read_b128 a[64:67], v12 offset:32768
v_mul_f32 v135, v135, v103
v_mul_f32 v148, v148, v116
v_mfma_f32_16x16x32_bf16 v[176:179], v[80:83], v[224:227], v[176:179]
TR 64,5,0
v_mul_f32 v149, v149, v117
v_mul_f32 v150, v150, v118
v_mfma_f32_16x16x32_bf16 v[176:179], v[84:87], v[240:243], v[176:179]
TR 66,5,2048
v_mul_f32 v151, v151, v119
v_cvt_pk_bf16_f32 v100, v132, v133
MA 180,76,244
TR 68,5,4096
v_cvt_pk_bf16_f32 v101, v134, v135
v_cvt_pk_bf16_f32 v102, v148, v149
v_mfma_f32_16x16x32_bf16 v[180:183], v[80:83], v[228:231], v[180:183]
TR 70,5,6144
v_cvt_pk_bf16_f32 v103, v150, v151
v_mul_f32 v136, v104, v136
v_mfma_f32_16x16x32_bf16 v[180:183], v[84:87], v[244:247], v[180:183]
TR 72,5,8192
v_exp_f32 v104, -v104
MA 184,76,248
TR 74,5,10240
v_mul_f32 v137, v105, v137
v_mul_f32 v138, v106, v138
v_mfma_f32_16x16x32_bf16 v[184:187], v[80:83], v[232:235], v[184:187]
buffer_load_dwordx4 v3, s[16:19], s50 offen lds
v_mfma_f32_16x16x32_bf16 v[184:187], v[84:87], v[248:251], v[184:187]
s_add_u32 m0, s43, 0xb000
s_add_u32 s51, s45, 0x1b080
ds_write_b128 v15, v[100:103] offset:1024
v_mul_f32 v139, v107, v139
MA 188,76,252
buffer_load_dwordx4 v3, s[16:19], s51 offen lds
v_mfma_f32_16x16x32_bf16 v[188:191], v[80:83], v[236:239], v[188:191]
s_add_u32 m0, s43, 0xc000
s_add_u32 s50, s45, 0x24080
ds_read_b128 a[68:71], v12 offset:33792
v_exp_f32 v105, -v105
v_mfma_f32_16x16x32_bf16 v[188:191], v[84:87], v[252:255], v[188:191]
buffer_load_dwordx4 v3, s[16:19], s50 offen lds
s_waitcnt lgkmcnt(2)
v_mfma_f32_16x16x32_bf16 v[192:195], v[64:67], a[0:3], 0
s_add_u32 m0, s43, 0xd000
TR 76,6,0
v_exp_f32 v106, -v106
MA 192,68,16
s_add_u32 s51, s45, 0x2d080
TR 78,6,2048
v_exp_f32 v107, -v107
MA 192,72,32
TR 80,6,4096
v_mul_f32 v152, v120, v152
v_mul_f32 v153, v121, v153
v_mfma_f32_16x16x32_bf16 v[196:199], v[64:67], a[4:7], 0
TR 82,6,6144
v_exp_f32 v120, -v120
MA 196,68,20
TR 84,6,8192
v_exp_f32 v121, -v121
MA 196,72,36
TR 86,6,10240
v_mul_f32 v154, v122, v154
v_mul_f32 v155, v123, v155
v_mfma_f32_16x16x32_bf16 v[200:203], v[64:67], a[8:11], 0
buffer_load_dwordx4 v3, s[16:19], s51 offen lds
MA 200,68,24
s_add_u32 m0, s43, 0xe000
ds_read_b128 a[72:75], v12 offset:34816
v_exp_f32 v122, -v122
MA 200,72,40
s_add_u32 s50, s45, 0x36080
ds_read_b128 a[76:79], v12 offset:35840
v_exp_f32 v123, -v123
v_mfma_f32_16x16x32_bf16 v[204:207], v[64:67], a[12:15], 0
ds_read_b128 a[80:83], v12 offset:40960
v_add_f32 v104, 1.0, v104
v_add_f32 v105, 1.0, v105
MA 204,68,28
ds_read_b128 a[84:87], v12 offset:41984
v_rcp_f32 v104, v104
MA 204,72,44
buffer_load_dwordx4 v3, s[16:19], s50 offen lds
s_waitcnt lgkmcnt(4)
v_mfma_f32_16x16x32_bf16 v[208:211], v[76:79], a[0:3], 0
s_add_u32 m0, s43, 0xf000
TR 64,5,12288
v_rcp_f32 v105, v105
MA 208,80,16
s_add_u32 s51, s45, 0x3f080
TR 66,5,14336
v_add_f32 v106, 1.0, v106
v_add_f32 v107, 1.0, v107
MA 208,84,32
TR 68,5,16384
v_rcp_f32 v106, v106
v_mfma_f32_16x16x32_bf16 v[212:215], v[76:79], a[4:7], 0
TR 70,5,18432
v_rcp_f32 v107, v107
MA 212,80,20
TR 72,5,20480
v_add_f32 v120, 1.0, v120
v_add_f32 v121, 1.0, v121
MA 212,84,36
TR 74,5,22528
v_rcp_f32 v120, v120
v_mfma_f32_16x16x32_bf16 v[216:219], v[76:79], a[8:11], 0
buffer_load_dwordx4 v3, s[16:19], s51 offen lds
MA 216,80,24
s_add_u32 m0, s43, 0x10000
ds_read_b128 a[88:91], v12 offset:43008
v_rcp_f32 v121, v121
MA 216,84,40
s_add_u32 s50, s45, 0x48000
ds_read_b128 a[92:95], v12 offset:44032
v_add_f32 v122, 1.0, v122
v_add_f32 v123, 1.0, v123
v_mfma_f32_16x16x32_bf16 v[220:223], v[76:79], a[12:15], 0
ds_read_b128 a[96:99], v12 offset:49152
v_rcp_f32 v122, v122
MA 220,80,28
ds_read_b128 a[100:103], v12 offset:50176
v_rcp_f32 v123, v123
MA 220,84,44
buffer_load_dwordx4 v3, s[16:19], s50 offen lds
s_waitcnt lgkmcnt(4)
MA 192,64,48
s_add_u32 m0, s43, 0x11000
TR 76,6,12288
v_mul_f32 v136, v136, v104
v_mul_f32 v137, v137, v105
MA 192,68,64
s_add_u32 s51, s45, 0x51000
TR 78,6,14336
v_mul_f32 v138, v138, v106
v_mul_f32 v139, v139, v107
MA 192,72,80
TR 80,6,16384
v_mul_f32 v152, v152, v120
v_mul_f32 v153, v153, v121
MA 196,64,52
TR 82,6,18432
v_mul_f32 v154, v154, v122
v_mul_f32 v155, v155, v123
MA 196,68,68
TR 84,6,20480
v_cvt_pk_bf16_f32 v104, v136, v137
v_cvt_pk_bf16_f32 v105, v138, v139
MA 196,72,84
TR 86,6,22528
v_cvt_pk_bf16_f32 v106, v152, v153
v_cvt_pk_bf16_f32 v107, v154, v155
MA 200,64,56
buffer_load_dwordx4 v3, s[16:19], s51 offen lds
MA 200,68,72
ds_write_b128 v15, v[104:107] offset:2048
v_mul_f32 v140, v108, v140
s_waitcnt lgkmcnt(10)
MA 200,72,88
ds_read_b128 a[104:107], v12 offset:51200
v_exp_f32 v108, -v108
MA 204,64,60
v_mul_f32 v141, v109, v141
v_exp_f32 v109, -v109
MA 204,68,76
v_mul_f32 v142, v110, v142
v_exp_f32 v110, -v110
s_waitcnt lgkmcnt(10)
MA 204,72,92
v_mul_f32 v143, v111, v143
v_mul_f32 v156, v124, v156
s_waitcnt lgkmcnt(2)
MA 208,76,48
s_waitcnt vmcnt(6)
s_waitcnt lgkmcnt(0)
s_barrier
s_add_u32 m0, s43, 0x0
ds_read_b128 a[108:111], v12 offset:52224
v_exp_f32 v111, -v111
MA 208,80,64
s_add_u32 s50, s53, 0x0
TR 64,5,24576
v_exp_f32 v124, -v124
MA 208,84,80
TR 66,5,26624
v_mul_f32 v157, v125, v157
v_mul_f32 v158, v126, v158
MA 212,76,52
TR 68,5,28672
v_exp_f32 v125, -v125
MA 212,80,68
TR 70,5,30720
v_exp_f32 v126, -v126
MA 212,84,84
TR 72,5,32768
v_mul_f32 v159, v127, v159
v_add_f32 v108, 1.0, v108
MA 216,76,56
TR 74,5,34816
v_exp_f32 v127, -v127
MA 216,80,72
buffer_load_dwordx4 v3, s[16:19], s50 offen lds
MA 216,84,88
s_add_u32 m0, s43, 0x1000
ds_read_b128 a[112:115], v12 offset:57344
v_rcp_f32 v108, v108
MA 220,76,60
s_add_u32 s51, s45, 0x48080
ds_read_b128 a[116:119], v12 offset:58368
v_add_f32 v109, 1.0, v109
v_add_f32 v110, 1.0, v110
MA 220,80,76
ds_read_b128 a[120:123], v12 offset:59392
v_rcp_f32 v109, v109
MA 220,84,92
ds_read_b128 a[124:127], v12 offset:60416
v_add_f32 v111, 1.0, v111
s_waitcnt lgkmcnt(4)
MA 192,64,96
TR 76,6,24576
v_rcp_f32 v110, v110
s_waitcnt lgkmcnt(4)
MA 192,68,112
TR 78,6,26624
v_rcp_f32 v111, v111
v_mfma_f32_16x16x32_bf16 v[224:227], v[72:75], a[0:3], 0
TR 80,6,28672
v_add_f32 v124, 1.0, v124
v_add_f32 v125, 1.0, v125
MA 196,64,100
TR 82,6,30720
v_rcp_f32 v124, v124
s_waitcnt lgkmcnt(6)
MA 196,68,116
TR 84,6,32768
v_rcp_f32 v125, v125
v_mfma_f32_16x16x32_bf16 v[228:231], v[72:75], a[4:7], 0
TR 86,6,34816
v_add_f32 v126, 1.0, v126
v_add_f32 v127, 1.0, v127
MA 200,64,104
buffer_load_dwordx4 v3, s[16:19], s51 offen lds
s_waitcnt lgkmcnt(7)
MA 200,68,120
s_add_u32 m0, s43, 0x2000
v_rcp_f32 v126, v126
v_mul_f32 v140, v140, v108
v_mfma_f32_16x16x32_bf16 v[232:235], v[72:75], a[8:11], 0
s_add_u32 s50, s45, 0x51080
v_rcp_f32 v127, v127
v_mul_f32 v141, v141, v109
MA 204,64,108
v_mul_f32 v142, v142, v110
v_mul_f32 v143, v143, v111
v_mul_f32 v156, v156, v124
s_waitcnt lgkmcnt(6)
MA 204,68,124
v_mul_f32 v157, v157, v125
v_mul_f32 v158, v158, v126
v_mul_f32 v159, v159, v127
v_mfma_f32_16x16x32_bf16 v[236:239], v[72:75], a[12:15], 0
buffer_load_dwordx4 v3, s[16:19], s50 offen lds
s_waitcnt lgkmcnt(0)
MA 208,76,96
s_add_u32 m0, s43, 0x3000
TR 64,5,36864
v_cvt_pk_bf16_f32 v108, v140, v141
v_cvt_pk_bf16_f32 v109, v142, v143
MA 208,80,112
s_add_u32 s51, s53, 0x80
TR 66,5,38912
v_cvt_pk_bf16_f32 v110, v156, v157
v_cvt_pk_bf16_f32 v111, v158, v159
v_mfma_f32_16x16x32_bf16 v[240:243], v[84:87], a[0:3], 0
TR 68,5,40960
v_mul_f32 v176, v160, v176
v_mul_f32 v177, v161, v177
MA 212,76,100
TR 70,5,43008
v_exp_f32 v160, -v160
MA 212,80,116
TR 72,5,45056
v_exp_f32 v161, -v161
v_mfma_f32_16x16x32_bf16 v[244:247], v[84:87], a[4:7], 0
TR 74,5,47104
v_mul_f32 v178, v162, v178
v_mul_f32 v179, v163, v179
MA 216,76,104
buffer_load_dwordx4 v3, s[16:19], s51 offen lds
MA 216,80,120
s_add_u32 m0, s43, 0x4000
ds_write_b128 v15, v[108:111] offset:3072
v_add_f32 v160, 1.0, v160
v_mfma_f32_16x16x32_bf16 v[248:251], v[84:87], a[8:11], 0
s_add_u32 s50, s45, 0x100
v_exp_f32 v162, -v162
v_add_f32 v161, 1.0, v161
MA 220,76,108
v_exp_f32 v163, -v163
v_add_f32 v162, 1.0, v162
MA 220,80,124
v_rcp_f32 v160, v160
v_add_f32 v163, 1.0, v163
v_mfma_f32_16x16x32_bf16 v[252:255], v[84:87], a[12:15], 0
buffer_load_dwordx4 v3, s[16:19], s50 offen lds
s_waitcnt lgkmcnt(1)
MA 224,64,16
s_add_u32 m0, s43, 0x5000
TR 76,6,36864
v_rcp_f32 v161, v161
MA 224,68,32
s_add_u32 s51, s45, 0x9100
TR 78,6,38912
v_rcp_f32 v162, v162
MA 224,72,48
TR 80,6,40960
v_rcp_f32 v163, v163
MA 228,64,20
TR 82,6,43008
v_mul_f32 v176, v176, v160
v_mul_f32 v177, v177, v161
MA 228,68,36
TR 84,6,45056
v_mul_f32 v178, v178, v162
v_mul_f32 v179, v179, v163
MA 228,72,52
TR 86,6,47104
v_cvt_pk_bf16_f32 v160, v176, v177
v_cvt_pk_bf16_f32 v161, v178, v179
MA 232,64,24
buffer_load_dwordx4 v3, s[16:19], s51 offen lds
MA 232,68,40
ds_write_b64 v63, v[160:161] offset:0
v_mul_f32 v180, v164, v180
MA 232,72,56
v_exp_f32 v164, -v164
v_mul_f32 v181, v165, v181
MA 236,64,28
v_exp_f32 v165, -v165
v_mul_f32 v182, v166, v182
MA 236,68,44
v_exp_f32 v166, -v166
v_mul_f32 v183, v167, v183
MA 236,72,60
v_exp_f32 v167, -v167
s_waitcnt lgkmcnt(1)
MA 240,76,16
s_waitcnt vmcnt(6)
s_waitcnt lgkmcnt(0)
s_barrier
s_add_u32 m0, s43, 0x6000
ds_read_b128 a[128:131], v13 offset:0
v_add_f32 v164, 1.0, v164
MA 240,80,32
s_add_u32 s50, s45, 0x12100
TR 64,5,49152
v_rcp_f32 v164, v164
MA 240,84,48
TR 66,5,51200
v_add_f32 v165, 1.0, v165
v_add_f32 v166, 1.0, v166
MA 244,76,20
TR 68,5,53248
v_rcp_f32 v165, v165
MA 244,80,36
TR 70,5,55296
v_rcp_f32 v166, v166
MA 244,84,52
TR 72,5,57344
v_add_f32 v167, 1.0, v167
v_mul_f32 v180, v180, v164
MA 248,76,24
TR 74,5,59392
v_rcp_f32 v167, v167
MA 248,80,40
buffer_load_dwordx4 v3, s[16:19], s50 offen lds
MA 248,84,56
s_add_u32 m0, s43, 0x7000
ds_read_b128 a[132:135], v13 offset:1024
v_mul_f32 v181, v181, v165
v_mul_f32 v182, v182, v166
MA 252,76,28
s_add_u32 s51, s45, 0x1b100
ds_read_b128 a[136:139], v13 offset:2048
v_mul_f32 v183, v183, v167
v_cvt_pk_bf16_f32 v164, v180, v181
MA 252,80,44
ds_read_b128 a[140:143], v13 offset:3072
v_cvt_pk_bf16_f32 v165, v182, v183
v_mul_f32 v184, v168, v184
MA 252,84,60
ds_read_b128 a[144:147], v13 offset:8192
v_mul_f32 v185, v169, v185
s_waitcnt lgkmcnt(4)
MA 224,64,64
TR 76,6,49152
v_exp_f32 v168, -v168
MA 224,68,80
TR 78,6,51200
v_exp_f32 v169, -v169
MA 224,72,96
TR 80,6,53248
v_mul_f32 v186, v170, v186
v_mul_f32 v187, v171, v187
MA 228,64,68
TR 82,6,55296
v_exp_f32 v170, -v170
MA 228,68,84
TR 84,6,57344
v_exp_f32 v171, -v171
MA 228,72,100
TR 86,6,59392
v_add_f32 v168, 1.0, v168
v_add_f32 v169, 1.0, v169
MA 232,64,72
buffer_load_dwordx4 v3, s[16:19], s51 offen lds
MA 232,68,88
s_add_u32 m0, s43, 0x8000
ds_read_b128 a[148:151], v13 offset:9216
v_rcp_f32 v168, v168
MA 232,72,104
s_add_u32 s50, s45, 0x24100
ds_read_b128 a[152:155], v13 offset:10240
v_rcp_f32 v169, v169
MA 236,64,76
ds_read_b128 a[156:159], v13 offset:11264
v_add_f32 v170, 1.0, v170
v_add_f32 v171, 1.0, v171
MA 236,68,92
ds_write_b64 v63, v[164:165] offset:1024
v_mul_f32 v184, v184, v168
MA 236,72,108
buffer_load_dwordx4 v3, s[16:19], s50 offen lds
s_waitcnt lgkmcnt(4)
MA 240,76,64
s_add_u32 m0, s43, 0x9000
TR 64,5,61440
v_rcp_f32 v170, v170
MA 240,80,80
s_add_u32 s51, s45, 0x2d100
TR 66,5,63488
v_rcp_f32 v171, v171
MA 240,84,96
TR 68,7,0
v_mul_f32 v185, v185, v169
v_mul_f32 v186, v186, v170
MA 244,76,68
TR 70,7,2048
v_mul_f32 v187, v187, v171
v_cvt_pk_bf16_f32 v168, v184, v185
MA 244,80,84
TR 72,7,4096
v_cvt_pk_bf16_f32 v169, v186, v187
v_mul_f32 v188, v172, v188
MA 244,84,100
TR 74,7,6144
v_exp_f32 v172, -v172
MA 248,76,72
buffer_load_dwordx4 v3, s[16:19], s51 offen lds
MA 248,80,88
s_add_u32 m0, s43, 0xa000
ds_write_b64 v63, v[168:169] offset:2048
v_mul_f32 v189, v173, v189
MA 248,84,104
s_add_u32 s50, s45, 0x36100
v_exp_f32 v173, -v173
v_mul_f32 v190, v174, v190
MA 252,76,76
v_exp_f32 v174, -v174
v_mul_f32 v191, v175, v191
MA 252,80,92
v_exp_f32 v175, -v175
v_add_f32 v172, 1.0, v172
MA 252,84,108
buffer_load_dwordx4 v3, s[16:19], s50 offen lds
s_waitcnt lgkmcnt(1)
MA 224,64,112
s_add_u32 m0, s43, 0xb000
TR 76,6,61440
v_rcp_f32 v172, v172
MA 192,68,128
s_add_u32 s51, s45, 0x3f100
TR 78,6,63488
v_add_f32 v173, 1.0, v173
v_add_f32 v174, 1.0, v174
MA 192,72,144
TR 80,8,0
v_rcp_f32 v173, v173
MA 228,64,116
TR 82,8,2048
v_rcp_f32 v174, v174
MA 196,68,132
TR 84,8,4096
v_add_f32 v175, 1.0, v175
v_mul_f32 v188, v188, v172
MA 196,72,148
TR 86,8,6144
v_rcp_f32 v175, v175
MA 232,64,120
buffer_load_dwordx4 v3, s[16:19], s51 offen lds
MA 200,68,136
v_mul_f32 v189, v189, v173
v_mul_f32 v190, v190, v174
v_mul_f32 v191, v191, v175
MA 200,72,152
v_cvt_pk_bf16_f32 v172, v188, v189
v_cvt_pk_bf16_f32 v173, v190, v191
MA 236,64,124
MA 204,68,140
MA 204,72,156
s_waitcnt lgkmcnt(0)
MA 240,76,112
s_waitcnt vmcnt(6)
s_barrier
s_add_u32 m0, s43, 0xc000
ds_write_b64 v63, v[172:173] offset:3072
MA 208,80,128
s_add_u32 s50, s45, 0x48100
TR 64,5,0
MA 208,84,144
TR 66,5,2048
MA 244,76,116
TR 68,5,4096
MA 212,80,132
TR 70,5,6144
MA 212,84,148
TR 72,5,8192
MA 248,76,120
TR 74,5,10240
MA 216,80,136
buffer_load_dwordx4 v3, s[16:19], s50 offen lds
MA 216,84,152
s_add_u32 m0, s43, 0xd000
MA 252,76,124
s_add_u32 s51, s45, 0x51100
MA 220,80,140
MA 220,84,156
s_waitcnt lgkmcnt(0)
s_barrier
ds_read_b128 a[160:163], v12 offset:0
s_waitcnt lgkmcnt(0)
MA 192,64,160
TR 76,6,0
MA 224,68,128
TR 78,6,2048
MA 224,72,144
TR 80,6,4096
ds_read_b128 a[164:167], v12 offset:1024
s_waitcnt lgkmcnt(0)
MA 196,64,164
TR 82,6,6144
MA 228,68,132
TR 84,6,8192
MA 228,72,148
TR 86,6,10240
ds_read_b128 a[168:171], v12 offset:2048
s_waitcnt lgkmcnt(0)
MA 200,64,168
buffer_load_dwordx4 v3, s[16:19], s51 offen lds
MA 232,68,136
s_add_u32 m0, s43, 0xe000
ds_read_b128 a[172:175], v12 offset:3072
MA 232,72,152
s_add_u32 s50, s53, 0x100
s_waitcnt lgkmcnt(0)
MA 204,64,172
MA 236,68,140
MA 236,72,156
buffer_load_dwordx4 v3, s[16:19], s50 offen lds
MA 208,76,160
s_add_u32 m0, s43, 0xf000
TR 64,5,12288
MA 240,80,128
s_add_u32 s51, s45, 0x180
TR 66,5,14336
MA 240,84,144
TR 68,5,16384
MA 212,76,164
TR 70,5,18432
MA 244,80,132
TR 72,5,20480
MA 244,84,148
TR 74,5,22528
MA 216,76,168
buffer_load_dwordx4 v3, s[16:19], s51 offen lds
MA 248,80,136
s_add_u32 m0, s43, 0x10000
MA 248,84,152
s_add_u32 s50, s45, 0x9180
MA 220,76,172
MA 252,80,140
MA 252,84,156
buffer_load_dwordx4 v3, s[16:19], s50 offen lds
v_min_u32 v48, 1, v0
v_mov_b32 v49, 1
v_lshlrev_b32 v48, 31, v48
s_waitcnt lgkmcnt(0)
MA 224,64,160
s_add_u32 m0, s43, 0x11000
TR 76,6,12288
v_mfma_f32_16x16x32_bf16 v[16:19], v[68:71], a[0:3], 0
s_add_u32 s51, s45, 0x12180
TR 78,6,14336
MA 16,72,16
TR 80,6,16384
MA 228,64,164
TR 82,6,18432
v_mfma_f32_16x16x32_bf16 v[20:23], v[68:71], a[4:7], 0
TR 84,6,20480
s_add_u32 s96, s49, 0x0
v_cvt_pk_bf16_f32 v96, v192, v193
MA 20,72,20
TR 86,6,22528
v_cvt_pk_bf16_f32 v97, v194, v195
MA 232,64,168
buffer_load_dwordx4 v3, s[16:19], s51 offen lds
v_mfma_f32_16x16x32_bf16 v[24:27], v[68:71], a[8:11], 0
v_cvt_pk_bf16_f32 v98, v208, v209
v_cvt_pk_bf16_f32 v99, v210, v211
MA 24,72,24
buffer_store_dwordx4 v[96:99], v14, s[20:23], s96 offen offset:0 sc1
MA 236,64,172
v_cvt_pk_bf16_f32 v100, v196, v197
v_cvt_pk_bf16_f32 v101, v198, v199
v_mfma_f32_16x16x32_bf16 v[28:31], v[68:71], a[12:15], 0
v_cvt_pk_bf16_f32 v102, v212, v213
v_cvt_pk_bf16_f32 v103, v214, v215
MA 28,72,28
v_cvt_pk_bf16_f32 v104, v200, v201
s_waitcnt lgkmcnt(0)
MA 240,76,160
s_waitcnt vmcnt(7)
s_barrier
s_add_u32 m0, s43, 0x0
v_cvt_pk_bf16_f32 v105, v202, v203
v_mfma_f32_16x16x32_bf16 v[32:35], v[80:83], a[0:3], 0
s_add_u32 s50, s45, 0x1b180
TR 64,5,24576
v_cvt_pk_bf16_f32 v106, v216, v217
MA 32,84,16
TR 66,5,26624
v_cvt_pk_bf16_f32 v107, v218, v219
MA 244,76,164
TR 68,5,28672
v_cvt_pk_bf16_f32 v108, v204, v205
v_mfma_f32_16x16x32_bf16 v[36:39], v[80:83], a[4:7], 0
TR 70,5,30720
v_cvt_pk_bf16_f32 v109, v206, v207
MA 36,84,20
TR 72,5,32768
v_cvt_pk_bf16_f32 v110, v220, v221
MA 248,76,168
TR 74,5,34816
v_cvt_pk_bf16_f32 v111, v222, v223
v_mfma_f32_16x16x32_bf16 v[40:43], v[80:83], a[8:11], 0
buffer_load_dwordx4 v3, s[16:19], s50 offen lds
MA 40,84,24
s_add_u32 m0, s43, 0x1000
buffer_store_dwordx4 v[100:103], v14, s[20:23], s96 offen offset:1024 sc1
MA 252,76,172
s_add_u32 s51, s45, 0x24180
v_mfma_f32_16x16x32_bf16 v[44:47], v[80:83], a[12:15], 0
MA 44,84,28
s_waitcnt lgkmcnt(0)
MA 16,64,32
TR 76,6,24576
MA 16,68,48
TR 78,6,26624
MA 16,72,64
TR 80,6,28672
MA 20,64,36
TR 82,6,30720
MA 20,68,52
TR 84,6,32768
s_add_u32 s97, s49, 0x4000
v_cvt_pk_bf16_f32 v112, v224, v225
MA 20,72,68
TR 86,6,34816
v_cvt_pk_bf16_f32 v113, v226, v227
MA 24,64,40
buffer_load_dwordx4 v3, s[16:19], s51 offen lds
MA 24,68,56
s_add_u32 m0, s43, 0x2000
buffer_store_dwordx4 v[104:107], v14, s[20:23], s96 offen offset:2048 sc1
MA 24,72,72
s_add_u32 s50, s45, 0x2d180
v_cvt_pk_bf16_f32 v114, v240, v241
v_cvt_pk_bf16_f32 v115, v242, v243
MA 28,64,44
v_cvt_pk_bf16_f32 v116, v228, v229
v_cvt_pk_bf16_f32 v117, v230, v231
MA 28,68,60
v_cvt_pk_bf16_f32 v118, v244, v245
v_cvt_pk_bf16_f32 v119, v246, v247
MA 28,72,76
buffer_load_dwordx4 v3, s[16:19], s50 offen lds
s_waitcnt lgkmcnt(0)
MA 32,76,32
s_add_u32 m0, s43, 0x3000
TR 64,5,36864
v_cvt_pk_bf16_f32 v120, v232, v233
MA 32,80,48
s_add_u32 s51, s45, 0x36180
TR 66,5,38912
v_cvt_pk_bf16_f32 v121, v234, v235
MA 32,84,64
TR 68,5,40960
v_cvt_pk_bf16_f32 v122, v248, v249
MA 36,76,36
TR 70,5,43008
v_cvt_pk_bf16_f32 v123, v250, v251
MA 36,80,52
TR 72,5,45056
v_cvt_pk_bf16_f32 v124, v236, v237
MA 36,84,68
TR 74,5,47104
v_cvt_pk_bf16_f32 v125, v238, v239
MA 40,76,40
buffer_load_dwordx4 v3, s[16:19], s51 offen lds
MA 40,80,56
s_add_u32 m0, s43, 0x4000
buffer_store_dwordx4 v[108:111], v14, s[20:23], s96 offen offset:3072 sc1
MA 40,84,72
s_add_u32 s50, s45, 0x3f180
v_cvt_pk_bf16_f32 v126, v252, v253
v_cvt_pk_bf16_f32 v127, v254, v255
MA 44,76,44
MA 44,80,60
MA 44,84,76
buffer_load_dwordx4 v3, s[16:19], s50 offen lds
s_waitcnt lgkmcnt(0)
MA 16,64,80
s_add_u32 m0, s43, 0x5000
TR 76,6,36864
MA 16,68,96
s_add_u32 s51, s45, 0x48180
TR 78,6,38912
MA 16,72,112
TR 80,6,40960
MA 20,64,84
TR 82,6,43008
MA 20,68,100
TR 84,6,45056
MA 20,72,116
TR 86,6,47104
MA 24,64,88
buffer_load_dwordx4 v3, s[16:19], s51 offen lds
MA 24,68,104
buffer_store_dwordx4 v[112:115], v14, s[20:23], s97 offen offset:0 sc1
MA 24,72,120
MA 28,64,92
MA 28,68,108
MA 28,72,124
s_waitcnt lgkmcnt(0)
MA 32,76,80
s_waitcnt vmcnt(11)
s_barrier
s_add_u32 m0, s43, 0x6000
MA 32,80,96
s_add_u32 s50, s45, 0x51180
TR 64,5,49152
MA 32,84,112
TR 66,5,51200
MA 36,76,84
TR 68,5,53248
MA 36,80,100
TR 70,5,55296
MA 36,84,116
TR 72,5,57344
MA 40,76,88
TR 74,5,59392
MA 40,80,104
buffer_load_dwordx4 v3, s[16:19], s50 offen lds
MA 40,84,120
s_add_u32 m0, s43, 0x7000
buffer_store_dwordx4 v[116:119], v14, s[20:23], s97 offen offset:1024 sc1
MA 44,76,92
s_add_u32 s51, s53, 0x180
MA 44,80,108
MA 44,84,124
s_waitcnt lgkmcnt(0)
MA 16,64,128
TR 76,6,49152
MA 16,68,144
TR 78,6,51200
MA 16,72,160
TR 80,6,53248
MA 20,64,132
TR 82,6,55296
MA 20,68,148
TR 84,6,57344
MA 20,72,164
TR 86,6,59392
MA 24,64,136
buffer_load_dwordx4 v3, s[16:19], s51 offen lds
MA 24,68,152
s_add_u32 m0, s43, 0x8000
buffer_store_dwordx4 v[120:123], v14, s[20:23], s97 offen offset:2048 sc1
MA 24,72,168
s_add_u32 s50, s45, 0x200
MA 28,64,140
MA 28,68,156
MA 28,72,172
buffer_load_dwordx4 v3, s[16:19], s50 offen lds
s_waitcnt lgkmcnt(0)
MA 32,76,128
s_add_u32 m0, s43, 0x9000
TR 64,5,61440
MA 32,80,144
s_add_u32 s51, s45, 0x9200
TR 66,5,63488
MA 32,84,160
TR 68,7,0
MA 36,76,132
TR 70,7,2048
MA 36,80,148
TR 72,7,4096
MA 36,84,164
TR 74,7,6144
MA 40,76,136
buffer_load_dwordx4 v3, s[16:19], s51 offen lds
MA 40,80,152
s_add_u32 m0, s43, 0xa000
buffer_store_dwordx4 v[124:127], v14, s[20:23], s97 offen offset:3072 sc1
MA 40,84,168
s_add_u32 s50, s45, 0x12200
MA 44,76,140
MA 44,80,156
MA 44,84,172
buffer_load_dwordx4 v3, s[16:19], s50 offen lds
s_waitcnt lgkmcnt(0)
v_mfma_f32_16x16x32_bf16 v[192:195], v[64:67], a[0:3], 0
s_add_u32 m0, s43, 0xb000
TR 76,6,61440
MA 192,68,16
s_add_u32 s51, s45, 0x1b200
TR 78,6,63488
MA 192,72,32
TR 80,8,0
v_mfma_f32_16x16x32_bf16 v[196:199], v[64:67], a[4:7], 0
TR 82,8,2048
MA 196,68,20
TR 84,8,4096
s_add_u32 s98, s49, 0x8000
v_cvt_pk_bf16_f32 v128, v16, v17
MA 196,72,36
TR 86,8,6144
v_cvt_pk_bf16_f32 v129, v18, v19
v_mfma_f32_16x16x32_bf16 v[200:203], v[64:67], a[8:11], 0
buffer_load_dwordx4 v3, s[16:19], s51 offen lds
MA 200,68,24
s_waitcnt vmcnt(12)
s_nop 0
v_cvt_pk_bf16_f32 v130, v32, v33
MA 200,72,40
v_cvt_pk_bf16_f32 v131, v34, v35
v_cvt_pk_bf16_f32 v132, v20, v21
v_mfma_f32_16x16x32_bf16 v[204:207], v[64:67], a[12:15], 0
buffer_store_dwordx4 v[128:131], v14, s[20:23], s98 offen offset:0 sc1
MA 204,68,28
v_cvt_pk_bf16_f32 v133, v22, v23
v_cvt_pk_bf16_f32 v134, v36, v37
MA 204,72,44
v_cvt_pk_bf16_f32 v135, v38, v39
s_waitcnt lgkmcnt(0)
v_mfma_f32_16x16x32_bf16 v[208:211], v[76:79], a[0:3], 0
s_waitcnt vmcnt(11)
s_barrier
s_add_u32 m0, s43, 0xc000
buffer_store_dword v49, v48, s[20:23], s54 offen offset:0 sc1
MA 208,80,16
s_add_u32 s50, s45, 0x24200
TR 64,5,0
v_cvt_pk_bf16_f32 v136, v24, v25
MA 208,84,32
TR 66,5,2048
v_cvt_pk_bf16_f32 v137, v26, v27
v_mfma_f32_16x16x32_bf16 v[212:215], v[76:79], a[4:7], 0
TR 68,5,4096
v_cvt_pk_bf16_f32 v138, v40, v41
MA 212,80,20
TR 70,5,6144
v_cvt_pk_bf16_f32 v139, v42, v43
MA 212,84,36
TR 72,5,8192
v_cvt_pk_bf16_f32 v140, v28, v29
v_mfma_f32_16x16x32_bf16 v[216:219], v[76:79], a[8:11], 0
TR 74,5,10240
v_cvt_pk_bf16_f32 v141, v30, v31
MA 216,80,24
buffer_load_dwordx4 v3, s[16:19], s50 offen lds
MA 216,84,40
s_add_u32 m0, s43, 0xd000
buffer_store_dwordx4 v[132:135], v14, s[20:23], s98 offen offset:1024 sc1
v_mfma_f32_16x16x32_bf16 v[220:223], v[76:79], a[12:15], 0
s_add_u32 s51, s45, 0x2d200
v_cvt_pk_bf16_f32 v142, v44, v45
v_cvt_pk_bf16_f32 v143, v46, v47
MA 220,80,28
MA 220,84,44
s_waitcnt lgkmcnt(0)
MA 192,64,48
TR 76,6,0
MA 192,68,64
TR 78,6,2048
MA 192,72,80
TR 80,6,4096
MA 196,64,52
TR 82,6,6144
MA 196,68,68
TR 84,6,8192
MA 196,72,84
TR 86,6,10240
MA 200,64,56
buffer_load_dwordx4 v3, s[16:19], s51 offen lds
MA 200,68,72
s_add_u32 m0, s43, 0xe000
buffer_store_dwordx4 v[136:139], v14, s[20:23], s98 offen offset:2048 sc1
MA 200,72,88
s_add_u32 s50, s45, 0x36200
MA 204,64,60
MA 204,68,76
MA 204,72,92
buffer_load_dwordx4 v3, s[16:19], s50 offen lds
s_waitcnt lgkmcnt(0)
MA 208,76,48
s_add_u32 m0, s43, 0xf000
TR 64,5,12288
MA 208,80,64
s_add_u32 s51, s45, 0x3f200
TR 66,5,14336
MA 208,84,80
TR 68,5,16384
MA 212,76,52
TR 70,5,18432
MA 212,80,68
TR 72,5,20480
MA 212,84,84
TR 74,5,22528
MA 216,76,56
buffer_load_dwordx4 v3, s[16:19], s51 offen lds
MA 216,80,72
s_add_u32 m0, s43, 0x10000
buffer_store_dwordx4 v[140:143], v14, s[20:23], s98 offen offset:3072 sc1
MA 216,84,88
s_add_u32 s50, s45, 0x48200
MA 220,76,60
MA 220,80,76
MA 220,84,92
buffer_load_dwordx4 v3, s[16:19], s50 offen lds
s_waitcnt lgkmcnt(0)
MA 192,64,96
s_add_u32 m0, s43, 0x11000
TR 76,6,12288
MA 192,68,112
s_add_u32 s51, s45, 0x51200
TR 78,6,14336
MA 192,72,128
TR 80,6,16384
MA 196,64,100
TR 82,6,18432
MA 196,68,116
TR 84,6,20480
MA 196,72,132
TR 86,6,22528
MA 200,64,104
buffer_load_dwordx4 v3, s[16:19], s51 offen lds
MA 200,68,120
s_waitcnt vmcnt(13)
s_nop 0
MA 200,72,136
MA 204,64,108
MA 204,68,124
MA 204,72,140
s_waitcnt lgkmcnt(0)
MA 208,76,96
s_waitcnt vmcnt(11)
s_barrier
s_add_u32 m0, s43, 0x0
buffer_store_dword v49, v48, s[20:23], s54 offen offset:4 sc1
MA 208,80,112
s_add_u32 s50, s53, 0x200
TR 64,5,24576
MA 208,84,128
TR 66,5,26624
MA 212,76,100
TR 68,5,28672
MA 212,80,116
TR 70,5,30720
MA 212,84,132
TR 72,5,32768
MA 216,76,104
TR 74,5,34816
MA 216,80,120
buffer_load_dwordx4 v3, s[16:19], s50 offen lds
MA 216,84,136
s_add_u32 m0, s43, 0x1000
MA 220,76,108
s_add_u32 s51, s45, 0x280
MA 220,80,124
MA 220,84,140
s_waitcnt lgkmcnt(0)
MA 192,64,144
TR 76,6,24576
MA 192,68,160
TR 78,6,26624
v_mfma_f32_16x16x32_bf16 v[224:227], v[72:75], a[0:3], 0
TR 80,6,28672
MA 196,64,148
TR 82,6,30720
MA 196,68,164
TR 84,6,32768
v_mfma_f32_16x16x32_bf16 v[228:231], v[72:75], a[4:7], 0
TR 86,6,34816
MA 200,64,152
buffer_load_dwordx4 v3, s[16:19], s51 offen lds
MA 200,68,168
s_add_u32 m0, s43, 0x2000
v_mfma_f32_16x16x32_bf16 v[232:235], v[72:75], a[8:11], 0
s_add_u32 s50, s45, 0x9280
MA 204,64,156
MA 204,68,172
v_mfma_f32_16x16x32_bf16 v[236:239], v[72:75], a[12:15], 0
buffer_load_dwordx4 v3, s[16:19], s50 offen lds
s_waitcnt lgkmcnt(0)
MA 208,76,144
s_add_u32 m0, s43, 0x3000
TR 64,5,36864
MA 208,80,160
s_add_u32 s51, s45, 0x12280
TR 66,5,38912
v_mfma_f32_16x16x32_bf16 v[240:243], v[84:87], a[0:3], 0
TR 68,5,40960
MA 212,76,148
TR 70,5,43008
MA 212,80,164
TR 72,5,45056
v_mfma_f32_16x16x32_bf16 v[244:247], v[84:87], a[4:7], 0
TR 74,5,47104
MA 216,76,152
buffer_load_dwordx4 v3, s[16:19], s51 offen lds
MA 216,80,168
s_add_u32 m0, s43, 0x4000
v_mfma_f32_16x16x32_bf16 v[248:251], v[84:87], a[8:11], 0
s_add_u32 s50, s45, 0x1b280
MA 220,76,156
MA 220,80,172
v_mfma_f32_16x16x32_bf16 v[252:255], v[84:87], a[12:15], 0
buffer_load_dwordx4 v3, s[16:19], s50 offen lds
s_waitcnt lgkmcnt(0)
MA 224,64,16
s_add_u32 m0, s43, 0x5000
TR 76,6,36864
MA 224,68,32
s_add_u32 s51, s45, 0x24280
TR 78,6,38912
MA 224,72,48
TR 80,6,40960
MA 228,64,20
TR 82,6,43008
MA 228,68,36
TR 84,6,45056
s_add_u32 s99, s49, 0xc000
v_cvt_pk_bf16_f32 v144, v192, v193
MA 228,72,52
TR 86,6,47104
v_cvt_pk_bf16_f32 v145, v194, v195
MA 232,64,24
buffer_load_dwordx4 v3, s[16:19], s51 offen lds
MA 232,68,40
s_waitcnt vmcnt(9)
s_nop 0
v_cvt_pk_bf16_f32 v146, v208, v209
MA 232,72,56
v_cvt_pk_bf16_f32 v147, v210, v211
v_cvt_pk_bf16_f32 v148, v196, v197
MA 236,64,28
buffer_store_dwordx4 v[144:147], v14, s[20:23], s99 offen offset:0 sc1
MA 236,68,44
v_cvt_pk_bf16_f32 v149, v198, v199
v_cvt_pk_bf16_f32 v150, v212, v213
MA 236,72,60
v_cvt_pk_bf16_f32 v151, v214, v215
s_waitcnt lgkmcnt(0)
MA 240,76,16
s_waitcnt vmcnt(8)
s_barrier
s_add_u32 m0, s43, 0x6000
buffer_store_dword v49, v48, s[20:23], s54 offen offset:8 sc1
MA 240,80,32
s_add_u32 s50, s45, 0x2d280
TR 64,5,49152
v_cvt_pk_bf16_f32 v152, v200, v201
MA 240,84,48
TR 66,5,51200
v_cvt_pk_bf16_f32 v153, v202, v203
MA 244,76,20
TR 68,5,53248
v_cvt_pk_bf16_f32 v154, v216, v217
MA 244,80,36
TR 70,5,55296
v_cvt_pk_bf16_f32 v155, v218, v219
MA 244,84,52
TR 72,5,57344
v_cvt_pk_bf16_f32 v156, v204, v205
MA 248,76,24
TR 74,5,59392
v_cvt_pk_bf16_f32 v157, v206, v207
MA 248,80,40
buffer_load_dwordx4 v3, s[16:19], s50 offen lds
MA 248,84,56
s_add_u32 m0, s43, 0x7000
buffer_store_dwordx4 v[148:151], v14, s[20:23], s99 offen offset:1024 sc1
MA 252,76,28
s_add_u32 s51, s45, 0x36280
v_cvt_pk_bf16_f32 v158, v220, v221
v_cvt_pk_bf16_f32 v159, v222, v223
MA 252,80,44
MA 252,84,60
s_waitcnt lgkmcnt(0)
MA 224,64,64
TR 76,6,49152
MA 224,68,80
TR 78,6,51200
MA 224,72,96
TR 80,6,53248
MA 228,64,68
TR 82,6,55296
MA 228,68,84
TR 84,6,57344
MA 228,72,100
TR 86,6,59392
MA 232,64,72
buffer_load_dwordx4 v3, s[16:19], s51 offen lds
MA 232,68,88
s_add_u32 m0, s43, 0x8000
buffer_store_dwordx4 v[152:155], v14, s[20:23], s99 offen offset:2048 sc1
MA 232,72,104
s_add_u32 s50, s45, 0x3f280
MA 236,64,76
MA 236,68,92
MA 236,72,108
buffer_load_dwordx4 v3, s[16:19], s50 offen lds
s_waitcnt lgkmcnt(0)
MA 240,76,64
s_add_u32 m0, s43, 0x9000
TR 64,5,61440
MA 240,80,80
s_add_u32 s51, s45, 0x48280
TR 66,5,63488
MA 240,84,96
TR 68,7,0
MA 244,76,68
TR 70,7,2048
MA 244,80,84
TR 72,7,4096
MA 244,84,100
TR 74,7,6144
MA 248,76,72
buffer_load_dwordx4 v3, s[16:19], s51 offen lds
MA 248,80,88
s_add_u32 m0, s43, 0xa000
buffer_store_dwordx4 v[156:159], v14, s[20:23], s99 offen offset:3072 sc1
MA 248,84,104
s_add_u32 s50, s45, 0x51280
MA 252,76,76
MA 252,80,92
MA 252,84,108
buffer_load_dwordx4 v3, s[16:19], s50 offen lds
s_waitcnt lgkmcnt(0)
MA 224,64,112
s_add_u32 m0, s43, 0xb000
TR 76,6,61440
MA 224,68,128
s_add_u32 s51, s53, 0x280
TR 78,6,63488
MA 224,72,144
TR 80,8,0
MA 228,64,116
TR 82,8,2048
MA 228,68,132
TR 84,8,4096
MA 228,72,148
TR 86,8,6144
MA 232,64,120
buffer_load_dwordx4 v3, s[16:19], s51 offen lds
MA 232,68,136
MA 232,72,152
MA 236,64,124
MA 236,68,140
MA 236,72,156
s_waitcnt lgkmcnt(0)
MA 240,76,112
s_waitcnt vmcnt(11)
s_barrier
s_add_u32 m0, s43, 0xc000
MA 240,80,128
s_add_u32 s50, s45, 0x300
TR 64,5,0
MA 240,84,144
TR 66,5,2048
MA 244,76,116
TR 68,5,4096
MA 244,80,132
TR 70,5,6144
MA 244,84,148
TR 72,5,8192
MA 248,76,120
TR 74,5,10240
MA 248,80,136
buffer_load_dwordx4 v3, s[16:19], s50 offen lds
MA 248,84,152
s_add_u32 m0, s43, 0xd000
MA 252,76,124
s_add_u32 s51, s45, 0x9300
MA 252,80,140
MA 252,84,156
s_waitcnt lgkmcnt(0)
MA 224,64,160
TR 76,6,0
v_mfma_f32_16x16x32_bf16 v[16:19], v[68:71], a[0:3], 0
TR 78,6,2048
MA 16,72,16
TR 80,6,4096
MA 228,64,164
TR 82,6,6144
v_mfma_f32_16x16x32_bf16 v[20:23], v[68:71], a[4:7], 0
TR 84,6,8192
MA 20,72,20
TR 86,6,10240
MA 232,64,168
buffer_load_dwordx4 v3, s[16:19], s51 offen lds
v_mfma_f32_16x16x32_bf16 v[24:27], v[68:71], a[8:11], 0
s_add_u32 m0, s43, 0xe000
MA 24,72,24
s_add_u32 s50, s45, 0x12300
MA 236,64,172
v_mfma_f32_16x16x32_bf16 v[28:31], v[68:71], a[12:15], 0
MA 28,72,28
buffer_load_dwordx4 v3, s[16:19], s50 offen lds
s_waitcnt lgkmcnt(0)
MA 240,76,160
s_add_u32 m0, s43, 0xf000
TR 64,5,12288
v_mfma_f32_16x16x32_bf16 v[32:35], v[80:83], a[0:3], 0
s_add_u32 s51, s45, 0x1b300
TR 66,5,14336
MA 32,84,16
TR 68,5,16384
MA 244,76,164
TR 70,5,18432
v_mfma_f32_16x16x32_bf16 v[36:39], v[80:83], a[4:7], 0
TR 72,5,20480
MA 36,84,20
TR 74,5,22528
MA 248,76,168
buffer_load_dwordx4 v3, s[16:19], s51 offen lds
v_mfma_f32_16x16x32_bf16 v[40:43], v[80:83], a[8:11], 0
s_add_u32 m0, s43, 0x10000
MA 40,84,24
s_add_u32 s50, s45, 0x24300
MA 252,76,172
v_mfma_f32_16x16x32_bf16 v[44:47], v[80:83], a[12:15], 0
MA 44,84,28
buffer_load_dwordx4 v3, s[16:19], s50 offen lds
s_waitcnt lgkmcnt(0)
MA 16,64,32
s_add_u32 m0, s43, 0x11000
TR 76,6,12288
MA 16,68,48
s_add_u32 s51, s45, 0x2d300
TR 78,6,14336
MA 16,72,64
TR 80,6,16384
MA 20,64,36
TR 82,6,18432
MA 20,68,52
TR 84,6,20480
s_add_u32 s96, s49, 0x10000
v_cvt_pk_bf16_f32 v96, v224, v225
MA 20,72,68
TR 86,6,22528
v_cvt_pk_bf16_f32 v97, v226, v227
MA 24,64,40
buffer_load_dwordx4 v3, s[16:19], s51 offen lds
MA 24,68,56
s_waitcnt vmcnt(8)
s_nop 0
v_cvt_pk_bf16_f32 v98, v240, v241
MA 24,72,72
v_cvt_pk_bf16_f32 v99, v242, v243
v_cvt_pk_bf16_f32 v100, v228, v229
MA 28,64,44
buffer_store_dwordx4 v[96:99], v14, s[20:23], s96 offen offset:0 sc1
MA 28,68,60
v_cvt_pk_bf16_f32 v101, v230, v231
v_cvt_pk_bf16_f32 v102, v244, v245
MA 28,72,76
v_cvt_pk_bf16_f32 v103, v246, v247
s_waitcnt lgkmcnt(0)
MA 32,76,32
s_waitcnt vmcnt(7)
s_barrier
s_add_u32 m0, s43, 0x0
buffer_store_dword v49, v48, s[20:23], s54 offen offset:12 sc1
MA 32,80,48
s_add_u32 s50, s45, 0x36300
TR 64,5,24576
v_cvt_pk_bf16_f32 v104, v232, v233
MA 32,84,64
TR 66,5,26624
v_cvt_pk_bf16_f32 v105, v234, v235
MA 36,76,36
TR 68,5,28672
v_cvt_pk_bf16_f32 v106, v248, v249
MA 36,80,52
TR 70,5,30720
v_cvt_pk_bf16_f32 v107, v250, v251
MA 36,84,68
TR 72,5,32768
v_cvt_pk_bf16_f32 v108, v236, v237
MA 40,76,40
TR 74,5,34816
v_cvt_pk_bf16_f32 v109, v238, v239
MA 40,80,56
buffer_load_dwordx4 v3, s[16:19], s50 offen lds
MA 40,84,72
s_add_u32 m0, s43, 0x1000
buffer_store_dwordx4 v[100:103], v14, s[20:23], s96 offen offset:1024 sc1
MA 44,76,44
s_add_u32 s51, s45, 0x3f300
v_cvt_pk_bf16_f32 v110, v252, v253
v_cvt_pk_bf16_f32 v111, v254, v255
MA 44,80,60
MA 44,84,76
s_waitcnt lgkmcnt(0)
MA 16,64,80
TR 76,6,24576
MA 16,68,96
TR 78,6,26624
MA 16,72,112
TR 80,6,28672
MA 20,64,84
TR 82,6,30720
MA 20,68,100
TR 84,6,32768
MA 20,72,116
TR 86,6,34816
MA 24,64,88
buffer_load_dwordx4 v3, s[16:19], s51 offen lds
MA 24,68,104
s_add_u32 m0, s43, 0x2000
buffer_store_dwordx4 v[104:107], v14, s[20:23], s96 offen offset:2048 sc1
MA 24,72,120
s_add_u32 s50, s45, 0x48300
MA 28,64,92
MA 28,68,108
MA 28,72,124
buffer_load_dwordx4 v3, s[16:19], s50 offen lds
s_waitcnt lgkmcnt(0)
MA 32,76,80
s_add_u32 m0, s43, 0x3000
TR 64,5,36864
MA 32,80,96
s_add_u32 s51, s45, 0x51300
TR 66,5,38912
MA 32,84,112
TR 68,5,40960
MA 36,76,84
TR 70,5,43008
MA 36,80,100
TR 72,5,45056
MA 36,84,116
TR 74,5,47104
MA 40,76,88
buffer_load_dwordx4 v3, s[16:19], s51 offen lds
MA 40,80,104
s_add_u32 m0, s43, 0x4000
buffer_store_dwordx4 v[108:111], v14, s[20:23], s96 offen offset:3072 sc1
MA 40,84,120
s_add_u32 s50, s53, 0x300
MA 44,76,92
MA 44,80,108
MA 44,84,124
buffer_load_dwordx4 v3, s[16:19], s50 offen lds
s_waitcnt lgkmcnt(0)
MA 16,64,128
s_add_u32 m0, s43, 0x5000
TR 76,6,36864
MA 16,68,144
s_add_u32 s51, s45, 0x380
TR 78,6,38912
MA 16,72,160
TR 80,6,40960
MA 20,64,132
TR 82,6,43008
MA 20,68,148
TR 84,6,45056
MA 20,72,164
TR 86,6,47104
MA 24,64,136
buffer_load_dwordx4 v3, s[16:19], s51 offen lds
MA 24,68,152
MA 24,72,168
MA 28,64,140
MA 28,68,156
MA 28,72,172
s_waitcnt lgkmcnt(0)
MA 32,76,128
s_waitcnt vmcnt(11)
s_barrier
s_add_u32 m0, s43, 0x6000
MA 32,80,144
s_add_u32 s50, s45, 0x9380
TR 64,5,49152
MA 32,84,160
TR 66,5,51200
MA 36,76,132
TR 68,5,53248
MA 36,80,148
TR 70,5,55296
MA 36,84,164
TR 72,5,57344
MA 40,76,136
TR 74,5,59392
MA 40,80,152
buffer_load_dwordx4 v3, s[16:19], s50 offen lds
MA 40,84,168
s_add_u32 m0, s43, 0x7000
MA 44,76,140
s_add_u32 s51, s45, 0x12380
MA 44,80,156
MA 44,84,172
s_waitcnt lgkmcnt(0)
v_mfma_f32_16x16x32_bf16 v[192:195], v[64:67], a[0:3], 0
TR 76,6,49152
MA 192,68,16
TR 78,6,51200
MA 192,72,32
TR 80,6,53248
v_mfma_f32_16x16x32_bf16 v[196:199], v[64:67], a[4:7], 0
TR 82,6,55296
MA 196,68,20
TR 84,6,57344
s_add_u32 s97, s49, 0x14000
v_cvt_pk_bf16_f32 v112, v16, v17
MA 196,72,36
TR 86,6,59392
v_cvt_pk_bf16_f32 v113, v18, v19
v_mfma_f32_16x16x32_bf16 v[200:203], v[64:67], a[8:11], 0
buffer_load_dwordx4 v3, s[16:19], s51 offen lds
MA 200,68,24
s_add_u32 m0, s43, 0x8000
v_cvt_pk_bf16_f32 v114, v32, v33
v_cvt_pk_bf16_f32 v115, v34, v35
MA 200,72,40
s_add_u32 s50, s45, 0x1b380
buffer_store_dwordx4 v[112:115], v14, s[20:23], s97 offen offset:0 sc1
v_mfma_f32_16x16x32_bf16 v[204:207], v[64:67], a[12:15], 0
v_cvt_pk_bf16_f32 v116, v20, v21
v_cvt_pk_bf16_f32 v117, v22, v23
MA 204,68,28
v_cvt_pk_bf16_f32 v118, v36, v37
v_cvt_pk_bf16_f32 v119, v38, v39
MA 204,72,44
buffer_load_dwordx4 v3, s[16:19], s50 offen lds
s_waitcnt lgkmcnt(0)
v_mfma_f32_16x16x32_bf16 v[208:211], v[76:79], a[0:3], 0
s_add_u32 m0, s43, 0x9000
TR 64,5,61440
v_cvt_pk_bf16_f32 v120, v24, v25
MA 208,80,16
s_add_u32 s51, s45, 0x24380
TR 66,5,63488
v_cvt_pk_bf16_f32 v121, v26, v27
MA 208,84,32
TR 68,7,0
v_cvt_pk_bf16_f32 v122, v40, v41
v_mfma_f32_16x16x32_bf16 v[212:215], v[76:79], a[4:7], 0
TR 70,7,2048
v_cvt_pk_bf16_f32 v123, v42, v43
MA 212,80,20
TR 72,7,4096
v_cvt_pk_bf16_f32 v124, v28, v29
MA 212,84,36
TR 74,7,6144
v_cvt_pk_bf16_f32 v125, v30, v31
v_mfma_f32_16x16x32_bf16 v[216:219], v[76:79], a[8:11], 0
buffer_load_dwordx4 v3, s[16:19], s51 offen lds
MA 216,80,24
s_add_u32 m0, s43, 0xa000
buffer_store_dwordx4 v[116:119], v14, s[20:23], s97 offen offset:1024 sc1
MA 216,84,40
s_add_u32 s50, s45, 0x2d380
v_cvt_pk_bf16_f32 v126, v44, v45
v_cvt_pk_bf16_f32 v127, v46, v47
v_mfma_f32_16x16x32_bf16 v[220:223], v[76:79], a[12:15], 0
MA 220,80,28
MA 220,84,44
buffer_load_dwordx4 v3, s[16:19], s50 offen lds
s_waitcnt lgkmcnt(0)
MA 192,64,48
s_add_u32 m0, s43, 0xb000
TR 76,6,61440
MA 192,68,64
s_add_u32 s51, s45, 0x36380
TR 78,6,63488
MA 192,72,80
TR 80,8,0
MA 196,64,52
TR 82,8,2048
MA 196,68,68
TR 84,8,4096
MA 196,72,84
TR 86,8,6144
MA 200,64,56
buffer_load_dwordx4 v3, s[16:19], s51 offen lds
MA 200,68,72
buffer_store_dwordx4 v[120:123], v14, s[20:23], s97 offen offset:2048 sc1
s_waitcnt vmcnt(11)
s_nop 0
MA 200,72,88
MA 204,64,60
MA 204,68,76
MA 204,72,92
s_waitcnt lgkmcnt(0)
MA 208,76,48
s_waitcnt vmcnt(9)
s_barrier
s_add_u32 m0, s43, 0xc000
buffer_store_dword v49, v48, s[20:23], s54 offen offset:16 sc1
MA 208,80,64
s_add_u32 s50, s45, 0x3f380
TR 64,5,0
MA 208,84,80
TR 66,5,2048
MA 212,76,52
TR 68,5,4096
MA 212,80,68
TR 70,5,6144
MA 212,84,84
TR 72,5,8192
MA 216,76,56
TR 74,5,10240
MA 216,80,72
buffer_load_dwordx4 v3, s[16:19], s50 offen lds
MA 216,84,88
s_add_u32 m0, s43, 0xd000
buffer_store_dwordx4 v[124:127], v14, s[20:23], s97 offen offset:3072 sc1
MA 220,76,60
s_add_u32 s51, s45, 0x48380
MA 220,80,76
MA 220,84,92
s_waitcnt lgkmcnt(0)
MA 192,64,96
TR 76,6,0
MA 192,68,112
TR 78,6,2048
MA 192,72,128
TR 80,6,4096
MA 196,64,100
TR 82,6,6144
MA 196,68,116
TR 84,6,8192
MA 196,72,132
TR 86,6,10240
MA 200,64,104
buffer_load_dwordx4 v3, s[16:19], s51 offen lds
MA 200,68,120
s_add_u32 m0, s43, 0xe000
MA 200,72,136
s_add_u32 s50, s45, 0x51380
MA 204,64,108
MA 204,68,124
MA 204,72,140
buffer_load_dwordx4 v3, s[16:19], s50 offen lds
s_waitcnt lgkmcnt(0)
MA 208,76,96
s_add_u32 m0, s43, 0xf000
TR 64,5,12288
MA 208,80,112
s_add_u32 s51, s53, 0x380
TR 66,5,14336
MA 208,84,128
TR 68,5,16384
MA 212,76,100
TR 70,5,18432
MA 212,80,116
TR 72,5,20480
MA 212,84,132
TR 74,5,22528
MA 216,76,104
buffer_load_dwordx4 v3, s[16:19], s51 offen lds
MA 216,80,120
s_add_u32 m0, s43, 0x10000
MA 216,84,136
s_add_u32 s50, s45, 0x400
MA 220,76,108
MA 220,80,124
MA 220,84,140
buffer_load_dwordx4 v3, s[16:19], s50 offen lds
s_waitcnt lgkmcnt(0)
MA 192,64,144
s_add_u32 m0, s43, 0x11000
TR 76,6,12288
MA 192,68,160
s_add_u32 s51, s45, 0x9400
TR 78,6,14336
v_mfma_f32_16x16x32_bf16 v[224:227], v[72:75], a[0:3], 0
TR 80,6,16384
MA 196,64,148
TR 82,6,18432
MA 196,68,164
TR 84,6,20480
v_mfma_f32_16x16x32_bf16 v[228:231], v[72:75], a[4:7], 0
TR 86,6,22528
MA 200,64,152
buffer_load_dwordx4 v3, s[16:19], s51 offen lds
MA 200,68,168
v_mfma_f32_16x16x32_bf16 v[232:235], v[72:75], a[8:11], 0
MA 204,64,156
MA 204,68,172
v_mfma_f32_16x16x32_bf16 v[236:239], v[72:75], a[12:15], 0
s_waitcnt lgkmcnt(0)
MA 208,76,144
s_waitcnt vmcnt(9)
s_barrier
s_add_u32 m0, s43, 0x0
MA 208,80,160
s_add_u32 s50, s45, 0x12400
TR 64,5,24576
v_mfma_f32_16x16x32_bf16 v[240:243], v[84:87], a[0:3], 0
TR 66,5,26624
MA 212,76,148
TR 68,5,28672
MA 212,80,164
TR 70,5,30720
v_mfma_f32_16x16x32_bf16 v[244:247], v[84:87], a[4:7], 0
TR 72,5,32768
MA 216,76,152
TR 74,5,34816
MA 216,80,168
buffer_load_dwordx4 v3, s[16:19], s50 offen lds
v_mfma_f32_16x16x32_bf16 v[248:251], v[84:87], a[8:11], 0
s_add_u32 m0, s43, 0x1000
MA 220,76,156
s_add_u32 s51, s45, 0x1b400
MA 220,80,172
v_mfma_f32_16x16x32_bf16 v[252:255], v[84:87], a[12:15], 0
s_waitcnt lgkmcnt(0)
MA 224,64,16
TR 76,6,24576
MA 224,68,32
TR 78,6,26624
MA 224,72,48
TR 80,6,28672
MA 228,64,20
TR 82,6,30720
MA 228,68,36
TR 84,6,32768
s_add_u32 s98, s49, 0x18000
v_cvt_pk_bf16_f32 v128, v192, v193
MA 228,72,52
TR 86,6,34816
v_cvt_pk_bf16_f32 v129, v194, v195
MA 232,64,24
buffer_load_dwordx4 v3, s[16:19], s51 offen lds
MA 232,68,40
s_add_u32 m0, s43, 0x2000
v_cvt_pk_bf16_f32 v130, v208, v209
v_cvt_pk_bf16_f32 v131, v210, v211
MA 232,72,56
s_add_u32 s50, s45, 0x24400
buffer_store_dwordx4 v[128:131], v14, s[20:23], s98 offen offset:0 sc1
s_waitcnt vmcnt(8)
s_nop 0
MA 236,64,28
v_cvt_pk_bf16_f32 v132, v196, v197
v_cvt_pk_bf16_f32 v133, v198, v199
MA 236,68,44
v_cvt_pk_bf16_f32 v134, v212, v213
v_cvt_pk_bf16_f32 v135, v214, v215
MA 236,72,60
buffer_load_dwordx4 v3, s[16:19], s50 offen lds
s_waitcnt lgkmcnt(0)
MA 240,76,16
s_add_u32 m0, s43, 0x3000
TR 64,5,36864
v_cvt_pk_bf16_f32 v136, v200, v201
MA 240,80,32
s_add_u32 s51, s45, 0x2d400
TR 66,5,38912
v_cvt_pk_bf16_f32 v137, v202, v203
MA 240,84,48
TR 68,5,40960
v_cvt_pk_bf16_f32 v138, v216, v217
MA 244,76,20
TR 70,5,43008
v_cvt_pk_bf16_f32 v139, v218, v219
MA 244,80,36
TR 72,5,45056
v_cvt_pk_bf16_f32 v140, v204, v205
MA 244,84,52
TR 74,5,47104
v_cvt_pk_bf16_f32 v141, v206, v207
MA 248,76,24
buffer_load_dwordx4 v3, s[16:19], s51 offen lds
MA 248,80,40
s_add_u32 m0, s43, 0x4000
buffer_store_dwordx4 v[132:135], v14, s[20:23], s98 offen offset:1024 sc1
MA 248,84,56
s_add_u32 s50, s45, 0x36400
v_cvt_pk_bf16_f32 v142, v220, v221
v_cvt_pk_bf16_f32 v143, v222, v223
MA 252,76,28
MA 252,80,44
MA 252,84,60
buffer_load_dwordx4 v3, s[16:19], s50 offen lds
s_waitcnt lgkmcnt(0)
MA 224,64,64
s_add_u32 m0, s43, 0x5000
TR 76,6,36864
MA 224,68,80
s_add_u32 s51, s45, 0x3f400
TR 78,6,38912
MA 224,72,96
TR 80,6,40960
MA 228,64,68
TR 82,6,43008
MA 228,68,84
TR 84,6,45056
MA 228,72,100
TR 86,6,47104
MA 232,64,72
buffer_load_dwordx4 v3, s[16:19], s51 offen lds
MA 232,68,88
buffer_store_dwordx4 v[136:139], v14, s[20:23], s98 offen offset:2048 sc1
MA 232,72,104
MA 236,64,76
MA 236,68,92
MA 236,72,108
s_waitcnt lgkmcnt(0)
MA 240,76,64
s_waitcnt vmcnt(9)
s_barrier
s_add_u32 m0, s43, 0x6000
buffer_store_dword v49, v48, s[20:23], s54 offen offset:20 sc1
MA 240,80,80
s_add_u32 s50, s45, 0x48400
TR 64,5,49152
MA 240,84,96
TR 66,5,51200
MA 244,76,68
TR 68,5,53248
MA 244,80,84
TR 70,5,55296
MA 244,84,100
TR 72,5,57344
MA 248,76,72
TR 74,5,59392
MA 248,80,88
buffer_load_dwordx4 v3, s[16:19], s50 offen lds
MA 248,84,104
s_add_u32 m0, s43, 0x7000
buffer_store_dwordx4 v[140:143], v14, s[20:23], s98 offen offset:3072 sc1
MA 252,76,76
s_add_u32 s51, s45, 0x51400
MA 252,80,92
MA 252,84,108
s_waitcnt lgkmcnt(0)
MA 224,64,112
TR 76,6,49152
MA 224,68,128
TR 78,6,51200
MA 224,72,144
TR 80,6,53248
MA 228,64,116
TR 82,6,55296
MA 228,68,132
TR 84,6,57344
MA 228,72,148
TR 86,6,59392
MA 232,64,120
buffer_load_dwordx4 v3, s[16:19], s51 offen lds
MA 232,68,136
s_add_u32 m0, s43, 0x8000
MA 232,72,152
s_add_u32 s50, s53, 0x400
MA 236,64,124
MA 236,68,140
MA 236,72,156
buffer_load_dwordx4 v3, s[16:19], s50 offen lds
s_waitcnt lgkmcnt(0)
MA 240,76,112
TR 64,5,61440
MA 240,80,128
TR 66,5,63488
MA 240,84,144
TR 68,7,0
MA 244,76,116
TR 70,7,2048
MA 244,80,132
TR 72,7,4096
MA 244,84,148
TR 74,7,6144
MA 248,76,120
MA 248,80,136
MA 248,84,152
MA 252,76,124
MA 252,80,140
MA 252,84,156
s_waitcnt lgkmcnt(0)
MA 224,64,160
TR 76,6,61440
v_mfma_f32_16x16x32_bf16 v[16:19], v[68:71], a[0:3], 0
TR 78,6,63488
MA 16,72,16
TR 80,8,0
MA 228,64,164
TR 82,8,2048
v_mfma_f32_16x16x32_bf16 v[20:23], v[68:71], a[4:7], 0
TR 84,8,4096
MA 20,72,20
TR 86,8,6144
MA 232,64,168
v_mfma_f32_16x16x32_bf16 v[24:27], v[68:71], a[8:11], 0
MA 24,72,24
MA 236,64,172
v_mfma_f32_16x16x32_bf16 v[28:31], v[68:71], a[12:15], 0
MA 28,72,28
s_waitcnt lgkmcnt(0)
MA 240,76,160
s_waitcnt vmcnt(6)
s_barrier
v_mfma_f32_16x16x32_bf16 v[32:35], v[80:83], a[0:3], 0
TR 64,5,0
MA 32,84,16
TR 66,5,2048
MA 244,76,164
TR 68,5,4096
v_mfma_f32_16x16x32_bf16 v[36:39], v[80:83], a[4:7], 0
TR 70,5,6144
MA 36,84,20
TR 72,5,8192
MA 248,76,168
TR 74,5,10240
v_mfma_f32_16x16x32_bf16 v[40:43], v[80:83], a[8:11], 0
MA 40,84,24
MA 252,76,172
v_mfma_f32_16x16x32_bf16 v[44:47], v[80:83], a[12:15], 0
MA 44,84,28
s_waitcnt lgkmcnt(0)
MA 16,64,32
TR 76,6,0
MA 16,68,48
TR 78,6,2048
MA 16,72,64
TR 80,6,4096
MA 20,64,36
TR 82,6,6144
MA 20,68,52
TR 84,6,8192
s_add_u32 s99, s49, 0x1c000
v_cvt_pk_bf16_f32 v144, v224, v225
MA 20,72,68
TR 86,6,10240
v_cvt_pk_bf16_f32 v145, v226, v227
MA 24,64,40
v_cvt_pk_bf16_f32 v146, v240, v241
v_cvt_pk_bf16_f32 v147, v242, v243
MA 24,68,56
buffer_store_dwordx4 v[144:147], v14, s[20:23], s99 offen offset:0 sc1
MA 24,72,72
s_waitcnt vmcnt(3)
s_nop 0
v_cvt_pk_bf16_f32 v148, v228, v229
MA 28,64,44
v_cvt_pk_bf16_f32 v149, v230, v231
v_cvt_pk_bf16_f32 v150, v244, v245
MA 28,68,60
v_cvt_pk_bf16_f32 v151, v246, v247
v_cvt_pk_bf16_f32 v152, v232, v233
MA 28,72,76
v_cvt_pk_bf16_f32 v153, v234, v235
s_waitcnt lgkmcnt(0)
MA 32,76,32
TR 64,5,12288
v_cvt_pk_bf16_f32 v154, v248, v249
MA 32,80,48
TR 66,5,14336
v_cvt_pk_bf16_f32 v155, v250, v251
MA 32,84,64
TR 68,5,16384
v_cvt_pk_bf16_f32 v156, v236, v237
MA 36,76,36
TR 70,5,18432
v_cvt_pk_bf16_f32 v157, v238, v239
MA 36,80,52
TR 72,5,20480
v_cvt_pk_bf16_f32 v158, v252, v253
MA 36,84,68
TR 74,5,22528
v_cvt_pk_bf16_f32 v159, v254, v255
MA 40,76,40
buffer_store_dwordx4 v[148:151], v14, s[20:23], s99 offen offset:1024 sc1
MA 40,80,56
MA 40,84,72
MA 44,76,44
MA 44,80,60
MA 44,84,76
s_waitcnt lgkmcnt(0)
MA 16,64,80
TR 76,6,12288
MA 16,68,96
TR 78,6,14336
MA 16,72,112
TR 80,6,16384
MA 20,64,84
TR 82,6,18432
MA 20,68,100
TR 84,6,20480
MA 20,72,116
TR 86,6,22528
MA 24,64,88
buffer_store_dwordx4 v[152:155], v14, s[20:23], s99 offen offset:2048 sc1
MA 24,68,104
MA 24,72,120
MA 28,64,92
MA 28,68,108
MA 28,72,124
s_waitcnt lgkmcnt(0)
MA 32,76,80
s_waitcnt vmcnt(3)
s_barrier
buffer_store_dword v49, v48, s[20:23], s54 offen offset:24 sc1
MA 32,80,96
TR 64,5,24576
MA 32,84,112
TR 66,5,26624
MA 36,76,84
TR 68,5,28672
MA 36,80,100
TR 70,5,30720
MA 36,84,116
TR 72,5,32768
MA 40,76,88
TR 74,5,34816
MA 40,80,104
buffer_store_dwordx4 v[156:159], v14, s[20:23], s99 offen offset:3072 sc1
MA 40,84,120
MA 44,76,92
MA 44,80,108
MA 44,84,124
s_waitcnt lgkmcnt(0)
MA 16,64,128
TR 76,6,24576
MA 16,68,144
TR 78,6,26624
MA 16,72,160
TR 80,6,28672
MA 20,64,132
TR 82,6,30720
MA 20,68,148
TR 84,6,32768
MA 20,72,164
TR 86,6,34816
MA 24,64,136
MA 24,68,152
MA 24,72,168
MA 28,64,140
MA 28,68,156
MA 28,72,172
s_waitcnt lgkmcnt(0)
MA 32,76,128
MA 32,80,144
MA 32,84,160
MA 36,76,132
MA 36,80,148
MA 36,84,164
MA 40,76,136
MA 40,80,152
MA 40,84,168
MA 44,76,140
MA 44,80,156
MA 44,84,172
s_nop 7
s_add_u32 s96, s49, 0x20000
v_cvt_pk_bf16_f32 v96, v16, v17
v_cvt_pk_bf16_f32 v97, v18, v19
v_cvt_pk_bf16_f32 v98, v32, v33
v_cvt_pk_bf16_f32 v99, v34, v35
v_cvt_pk_bf16_f32 v100, v20, v21
v_cvt_pk_bf16_f32 v101, v22, v23
v_cvt_pk_bf16_f32 v102, v36, v37
v_cvt_pk_bf16_f32 v103, v38, v39
v_cvt_pk_bf16_f32 v104, v24, v25
v_cvt_pk_bf16_f32 v105, v26, v27
v_cvt_pk_bf16_f32 v106, v40, v41
v_cvt_pk_bf16_f32 v107, v42, v43
v_cvt_pk_bf16_f32 v108, v28, v29
v_cvt_pk_bf16_f32 v109, v30, v31
v_cvt_pk_bf16_f32 v110, v44, v45
v_cvt_pk_bf16_f32 v111, v46, v47
buffer_store_dwordx4 v[96:99], v14, s[20:23], s96 offen offset:0 sc1
buffer_store_dwordx4 v[100:103], v14, s[20:23], s96 offen offset:1024 sc1
buffer_store_dwordx4 v[104:107], v14, s[20:23], s96 offen offset:2048 sc1
buffer_store_dwordx4 v[108:111], v14, s[20:23], s96 offen offset:3072 sc1
s_mov_b32 s78, 0x180
s_mov_b32 s77, 0
s_branch L_tail
L_k1_B_end:
L_tail:
s_load_dwordx2 s[4:5], s[0:1], 0
s_load_dwordx2 s[6:7], s[0:1], 104
s_load_dwordx2 s[24:25], s[0:1], 64
v_lshrrev_b32 v18, v0, s78
v_cmp_gt_u32 vcc, 16, v0
v_and_b32 v18, 1, v18
v_mov_b32 v19, 1
v_cndmask_b32 v18, 0, v18, vcc
v_cmp_eq_u32 vcc, 1, v18
v_lshlrev_b32 v18, 2, v0
v_and_b32 v0, 63, v0
v_cndmask_b32 v18, -4, v18, vcc
v_lshlrev_b32 v1, 4, v0
v_bfe_u32 v2, v0, 2, 2
v_lshlrev_b32 v2, 4, v2
v_and_b32 v3, 3, v0
s_lshl_b32 s28, s41, 7
v_add3_u32 v2, v2, v3, s28
v_bfe_u32 v3, v0, 4, 2
v_lshlrev_b32 v3, 2, v3
v_mul_u32_u24 v4, 576, v2
v_add_u32 v4, v4, v3
v_lshlrev_b32 v5, 1, v4
v_lshlrev_b32 v6, 1, v3
v_lshlrev_b32 v7, 3, v2
v_lshlrev_b32 v4, 2, v4
v_and_b32 v8, 15, v0
v_lshlrev_b32 v8, 6, v8
v_lshrrev_b32 v9, 4, v0
v_cmp_eq_u32 s[62:63], 1, v9
v_cmp_eq_u32 s[64:65], 2, v9
s_lshl_b32 s30, s41, 10
s_add_u32 s30, s30, 0x254000
s_mul_i32 s31, s41, 2359296
s_add_u32 s31, s31, 0x300000
s_mov_b32 s34, 0x40000
s_mov_b32 s35, 0x3ef5fdf0
s_mov_b32 s79, 0
s_mov_b64 s[56:57], -1
s_mov_b64 s[58:59], -1
s_mov_b64 s[60:61], -1
s_lshl_b32 s28, s42, 1
s_add_u32 s28, s28, s40
s_add_u32 s28, s28, 112
s_cmp_lt_u32 s40, 2
s_cselect_b32 s29, s28, -1
s_cmp_lt_u32 s42, 9
s_cbranch_scc1 L_tail_S
s_cmp_lt_u32 s42, 14
s_cbranch_scc1 L_tail_A
s_mul_i32 s28, s42, 6
s_mul_i32 s56, s40, 3
s_add_u32 s56, s56, s28
s_sub_u32 s56, s56, 26
s_add_u32 s57, s56, 1
s_add_u32 s58, s56, 2
s_cmp_lt_u32 s40, 2
s_cbranch_scc0 L_tail_go
s_sub_u32 s56, s29, 10
s_mov_b32 s57, -1
s_mov_b32 s58, -1
s_branch L_tail_go
L_tail_A:
s_mov_b32 s79, 2
s_lshl_b32 s28, s42, 2
s_add_u32 s28, s28, s40
s_sub_u32 s56, s28, 36
s_add_u32 s57, s56, 20
s_add_u32 s58, s57, 20
s_add_u32 s28, s56, 60
s_cmp_lt_u32 s56, 4
s_cselect_b32 s59, s28, -1
s_branch L_tail_go
L_tail_S:
s_lshl_b32 s28, s42, 1
s_add_u32 s28, s28, s40
s_lshl_b32 s28, s28, 1
s_add_u32 s28, s28, 72
s_add_u32 s46, s28, 1
s_add_u32 s47, s29, 22
s_cmp_lt_u32 s29, 122
s_cselect_b32 s47, s47, -1
s_cmp_lt_u32 s40, 2
s_cselect_b32 s56, s29, s28
s_cselect_b32 s57, s47, s46
L_tail_go:
s_waitcnt lgkmcnt(0)
s_mov_b32 s8, s4
s_mov_b32 s9, s5
s_mov_b32 s10, 0x240000
s_mov_b32 s11, 0x20000
s_mov_b32 s12, s6
s_mov_b32 s13, s7
s_mov_b32 s14, 0x480000
s_mov_b32 s15, 0x20000
s_mov_b32 s16, s24
s_mov_b32 s17, s25
s_mov_b32 s18, 0x480
s_mov_b32 s19, 0x20000
L_tail_pass:
s_mov_b32 s44, 0x0
s_mov_b32 s48, 0xffff
s_mov_b32 s49, 0xc1ff
s_mov_b32 s33, 0
s_cmp_lg_u32 s56, -1
s_cselect_b32 s33, 1, 0
s_cmp_lg_u32 s57, -1
s_cselect_b32 s46, 2, 0
s_or_b32 s33, s33, s46
s_cmp_lg_u32 s58, -1
s_cselect_b32 s46, 4, 0
s_or_b32 s33, s33, s46
s_or_b32 s46, s33, s78
s_cmp_eq_u32 s46, 0
s_cbranch_scc1 L_tail_end
s_bfe_u32 s45, s56, 0x40004
s_bfe_u32 s46, s57, 0x40004
s_bfe_u32 s47, s58, 0x40004
s_bitcmp1_b32 s44, s45
s_cselect_b32 s50, s49, s48
s_bitcmp1_b32 s44, s46
s_cselect_b32 s51, s49, s48
s_bitcmp1_b32 s44, s47
s_cselect_b32 s52, s49, s48
v_mov_b32 v10, s45
v_mov_b32 v11, s46
v_cndmask_b32 v10, v10, v11, s[62:63]
v_mov_b32 v11, s47
v_cndmask_b32 v10, v10, v11, s[64:65]
v_lshl_add_u32 v9, v10, 2, v8
L_tail_loop:
buffer_load_dword v10, v9, s[20:23], s30 offen sc1
s_waitcnt vmcnt(0)
s_cmp_eq_u32 s78, 0
s_cbranch_scc1 L_tail_pubd
s_barrier
buffer_store_dword v19, v18, s[20:23], s54 offen sc1
s_mov_b32 s78, 0
s_cmp_eq_u32 s33, 0
s_cbranch_scc1 L_tail_end
L_tail_pubd:
v_cmp_eq_u32 vcc, 1, v10
s_mov_b32 s45, 0
s_and_b32 s46, vcc_lo, s50
s_cmp_eq_u32 s46, s50
s_cselect_b32 s45, 1, 0
s_lshr_b32 s46, vcc_lo, 16
s_and_b32 s46, s46, s51
s_cmp_eq_u32 s46, s51
s_cselect_b32 s46, 2, 0
s_or_b32 s45, s45, s46
s_and_b32 s46, vcc_hi, s52
s_cmp_eq_u32 s46, s52
s_cselect_b32 s46, 4, 0
s_or_b32 s45, s45, s46
s_sub_u32 s34, s34, 1
s_cselect_b32 s45, 7, s45
s_or_b32 s45, s45, s77
s_and_b32 s45, s45, s33
s_cmp_eq_u32 s45, s33
s_cbranch_scc1 L_tail_take
s_sleep 4
s_sub_u32 s79, s79, 1
s_cmp_gt_i32 s79, 0
s_cbranch_scc1 L_tail_loop
s_cmp_eq_u32 s45, 0
s_cbranch_scc1 L_tail_loop
L_tail_take:
s_andn2_b32 s33, s33, s45
s_bitcmp1_b32 s45, 0
s_cselect_b32 s46, 0, 0x40000000
s_lshl_b32 s47, s56, 10
s_add_u32 s47, s47, s31
s_add_u32 s47, s47, s46
buffer_load_dwordx4 v[32:35], v1, s[20:23], s47 offen sc1
s_add_u32 s47, s47, 147456
buffer_load_dwordx4 v[36:39], v1, s[20:23], s47 offen sc1
s_add_u32 s47, s47, 147456
buffer_load_dwordx4 v[40:43], v1, s[20:23], s47 offen sc1
s_add_u32 s47, s47, 147456
buffer_load_dwordx4 v[44:47], v1, s[20:23], s47 offen sc1
s_add_u32 s47, s47, 147456
buffer_load_dwordx4 v[48:51], v1, s[20:23], s47 offen sc1
s_add_u32 s47, s47, 147456
buffer_load_dwordx4 v[52:55], v1, s[20:23], s47 offen sc1
s_add_u32 s47, s47, 147456
buffer_load_dwordx4 v[56:59], v1, s[20:23], s47 offen sc1
s_add_u32 s47, s47, 147456
buffer_load_dwordx4 v[60:63], v1, s[20:23], s47 offen sc1
s_add_u32 s47, s47, 147456
buffer_load_dwordx4 v[64:67], v1, s[20:23], s47 offen sc1
s_add_u32 s47, s47, 147456
buffer_load_dwordx4 v[68:71], v1, s[20:23], s47 offen sc1
s_add_u32 s47, s47, 147456
buffer_load_dwordx4 v[72:75], v1, s[20:23], s47 offen sc1
s_add_u32 s47, s47, 147456
buffer_load_dwordx4 v[76:79], v1, s[20:23], s47 offen sc1
s_add_u32 s47, s47, 147456
buffer_load_dwordx4 v[80:83], v1, s[20:23], s47 offen sc1
s_add_u32 s47, s47, 147456
buffer_load_dwordx4 v[84:87], v1, s[20:23], s47 offen sc1
s_add_u32 s47, s47, 147456
buffer_load_dwordx4 v[88:91], v1, s[20:23], s47 offen sc1
s_add_u32 s47, s47, 147456
buffer_load_dwordx4 v[92:95], v1, s[20:23], s47 offen sc1
s_bfe_u32 s48, s56, 0x10002
s_lshl_b32 s48, s48, 6
s_and_b32 s47, s56, 3
s_lshl_b32 s47, s47, 2
s_add_u32 s48, s48, s47
s_bfe_u32 s49, s56, 0x50003
s_lshl_b32 s49, s49, 6
s_add_u32 s49, s49, s46
s_mul_i32 s47, s48, 1152
s_add_u32 s47, s47, s49
s_lshl_b32 s66, s47, 1
s_lshl_b32 s48, s48, 3
s_add_u32 s48, s48, 0x240000
s_add_u32 s48, s48, s46
buffer_load_dwordx2 v[96:97], v5, s[8:11], s47 offen
buffer_load_dwordx2 v[98:99], v5, s[8:11], s47 offen offset:32
buffer_load_dwordx2 v[100:101], v6, s[16:19], s49 offen
buffer_load_dwordx2 v[102:103], v6, s[16:19], s49 offen offset:32
buffer_load_dwordx2 v[104:105], v7, s[20:23], s48 offen sc1
s_bitcmp1_b32 s45, 1
s_cselect_b32 s46, 0, 0x40000000
s_lshl_b32 s47, s57, 10
s_add_u32 s47, s47, s31
s_add_u32 s47, s47, s46
buffer_load_dwordx4 v[106:109], v1, s[20:23], s47 offen sc1
s_add_u32 s47, s47, 147456
buffer_load_dwordx4 v[110:113], v1, s[20:23], s47 offen sc1
s_add_u32 s47, s47, 147456
buffer_load_dwordx4 v[114:117], v1, s[20:23], s47 offen sc1
s_add_u32 s47, s47, 147456
buffer_load_dwordx4 v[118:121], v1, s[20:23], s47 offen sc1
s_add_u32 s47, s47, 147456
buffer_load_dwordx4 v[122:125], v1, s[20:23], s47 offen sc1
s_add_u32 s47, s47, 147456
buffer_load_dwordx4 v[126:129], v1, s[20:23], s47 offen sc1
s_add_u32 s47, s47, 147456
buffer_load_dwordx4 v[130:133], v1, s[20:23], s47 offen sc1
s_add_u32 s47, s47, 147456
buffer_load_dwordx4 v[134:137], v1, s[20:23], s47 offen sc1
s_add_u32 s47, s47, 147456
buffer_load_dwordx4 v[138:141], v1, s[20:23], s47 offen sc1
s_add_u32 s47, s47, 147456
buffer_load_dwordx4 v[142:145], v1, s[20:23], s47 offen sc1
s_add_u32 s47, s47, 147456
buffer_load_dwordx4 v[146:149], v1, s[20:23], s47 offen sc1
s_add_u32 s47, s47, 147456
buffer_load_dwordx4 v[150:153], v1, s[20:23], s47 offen sc1
s_add_u32 s47, s47, 147456
buffer_load_dwordx4 v[154:157], v1, s[20:23], s47 offen sc1
s_add_u32 s47, s47, 147456
buffer_load_dwordx4 v[158:161], v1, s[20:23], s47 offen sc1
s_add_u32 s47, s47, 147456
buffer_load_dwordx4 v[162:165], v1, s[20:23], s47 offen sc1
s_add_u32 s47, s47, 147456
buffer_load_dwordx4 v[166:169], v1, s[20:23], s47 offen sc1
s_bfe_u32 s48, s57, 0x10002
s_lshl_b32 s48, s48, 6
s_and_b32 s47, s57, 3
s_lshl_b32 s47, s47, 2
s_add_u32 s48, s48, s47
s_bfe_u32 s49, s57, 0x50003
s_lshl_b32 s49, s49, 6
s_add_u32 s49, s49, s46
s_mul_i32 s47, s48, 1152
s_add_u32 s47, s47, s49
s_lshl_b32 s67, s47, 1
s_lshl_b32 s48, s48, 3
s_add_u32 s48, s48, 0x240000
s_add_u32 s48, s48, s46
buffer_load_dwordx2 v[170:171], v5, s[8:11], s47 offen
buffer_load_dwordx2 v[172:173], v5, s[8:11], s47 offen offset:32
buffer_load_dwordx2 v[174:175], v6, s[16:19], s49 offen
buffer_load_dwordx2 v[176:177], v6, s[16:19], s49 offen offset:32
buffer_load_dwordx2 v[178:179], v7, s[20:23], s48 offen sc1
s_bitcmp1_b32 s45, 2
s_cselect_b32 s46, 0, 0x40000000
s_lshl_b32 s47, s58, 10
s_add_u32 s47, s47, s31
s_add_u32 s47, s47, s46
buffer_load_dwordx4 v[180:183], v1, s[20:23], s47 offen sc1
s_add_u32 s47, s47, 147456
buffer_load_dwordx4 v[184:187], v1, s[20:23], s47 offen sc1
s_add_u32 s47, s47, 147456
buffer_load_dwordx4 v[188:191], v1, s[20:23], s47 offen sc1
s_add_u32 s47, s47, 147456
buffer_load_dwordx4 v[192:195], v1, s[20:23], s47 offen sc1
s_add_u32 s47, s47, 147456
buffer_load_dwordx4 v[196:199], v1, s[20:23], s47 offen sc1
s_add_u32 s47, s47, 147456
buffer_load_dwordx4 v[200:203], v1, s[20:23], s47 offen sc1
s_add_u32 s47, s47, 147456
buffer_load_dwordx4 v[204:207], v1, s[20:23], s47 offen sc1
s_add_u32 s47, s47, 147456
buffer_load_dwordx4 v[208:211], v1, s[20:23], s47 offen sc1
s_add_u32 s47, s47, 147456
buffer_load_dwordx4 v[212:215], v1, s[20:23], s47 offen sc1
s_add_u32 s47, s47, 147456
buffer_load_dwordx4 v[216:219], v1, s[20:23], s47 offen sc1
s_add_u32 s47, s47, 147456
buffer_load_dwordx4 v[220:223], v1, s[20:23], s47 offen sc1
s_add_u32 s47, s47, 147456
buffer_load_dwordx4 v[224:227], v1, s[20:23], s47 offen sc1
s_add_u32 s47, s47, 147456
buffer_load_dwordx4 v[228:231], v1, s[20:23], s47 offen sc1
s_add_u32 s47, s47, 147456
buffer_load_dwordx4 v[232:235], v1, s[20:23], s47 offen sc1
s_add_u32 s47, s47, 147456
buffer_load_dwordx4 v[236:239], v1, s[20:23], s47 offen sc1
s_add_u32 s47, s47, 147456
buffer_load_dwordx4 v[240:243], v1, s[20:23], s47 offen sc1
s_bfe_u32 s48, s58, 0x10002
s_lshl_b32 s48, s48, 6
s_and_b32 s47, s58, 3
s_lshl_b32 s47, s47, 2
s_add_u32 s48, s48, s47
s_bfe_u32 s49, s58, 0x50003
s_lshl_b32 s49, s49, 6
s_add_u32 s49, s49, s46
s_mul_i32 s47, s48, 1152
s_add_u32 s47, s47, s49
s_lshl_b32 s68, s47, 1
s_lshl_b32 s48, s48, 3
s_add_u32 s48, s48, 0x240000
s_add_u32 s48, s48, s46
buffer_load_dwordx2 v[244:245], v5, s[8:11], s47 offen
buffer_load_dwordx2 v[246:247], v5, s[8:11], s47 offen offset:32
buffer_load_dwordx2 v[248:249], v6, s[16:19], s49 offen
buffer_load_dwordx2 v[250:251], v6, s[16:19], s49 offen offset:32
buffer_load_dwordx2 v[252:253], v7, s[20:23], s48 offen sc1
s_bitcmp1_b32 s45, 0
s_cbranch_scc0 L_tail_skip0
s_waitcnt vmcnt(62)
v_lshlrev_b32 v20, 16, v32
v_and_b32 v21, 0xffff0000, v32
v_lshlrev_b32 v22, 16, v33
v_and_b32 v23, 0xffff0000, v33
v_lshlrev_b32 v24, 16, v34
v_and_b32 v25, 0xffff0000, v34
v_lshlrev_b32 v26, 16, v35
v_and_b32 v27, 0xffff0000, v35
s_waitcnt vmcnt(61)
v_lshlrev_b32 v28, 16, v36
v_and_b32 v29, 0xffff0000, v36
v_pk_add_f32 v[20:21], v[20:21], v[28:29]
v_lshlrev_b32 v30, 16, v37
v_and_b32 v31, 0xffff0000, v37
v_pk_add_f32 v[22:23], v[22:23], v[30:31]
v_lshlrev_b32 v28, 16, v38
v_and_b32 v29, 0xffff0000, v38
v_pk_add_f32 v[24:25], v[24:25], v[28:29]
v_lshlrev_b32 v30, 16, v39
v_and_b32 v31, 0xffff0000, v39
v_pk_add_f32 v[26:27], v[26:27], v[30:31]
s_waitcnt vmcnt(60)
v_lshlrev_b32 v28, 16, v40
v_and_b32 v29, 0xffff0000, v40
v_pk_add_f32 v[20:21], v[20:21], v[28:29]
v_lshlrev_b32 v30, 16, v41
v_and_b32 v31, 0xffff0000, v41
v_pk_add_f32 v[22:23], v[22:23], v[30:31]
v_lshlrev_b32 v28, 16, v42
v_and_b32 v29, 0xffff0000, v42
v_pk_add_f32 v[24:25], v[24:25], v[28:29]
v_lshlrev_b32 v30, 16, v43
v_and_b32 v31, 0xffff0000, v43
v_pk_add_f32 v[26:27], v[26:27], v[30:31]
s_waitcnt vmcnt(59)
v_lshlrev_b32 v28, 16, v44
v_and_b32 v29, 0xffff0000, v44
v_pk_add_f32 v[20:21], v[20:21], v[28:29]
v_lshlrev_b32 v30, 16, v45
v_and_b32 v31, 0xffff0000, v45
v_pk_add_f32 v[22:23], v[22:23], v[30:31]
v_lshlrev_b32 v28, 16, v46
v_and_b32 v29, 0xffff0000, v46
v_pk_add_f32 v[24:25], v[24:25], v[28:29]
v_lshlrev_b32 v30, 16, v47
v_and_b32 v31, 0xffff0000, v47
v_pk_add_f32 v[26:27], v[26:27], v[30:31]
s_waitcnt vmcnt(58)
v_lshlrev_b32 v28, 16, v48
v_and_b32 v29, 0xffff0000, v48
v_pk_add_f32 v[20:21], v[20:21], v[28:29]
v_lshlrev_b32 v30, 16, v49
v_and_b32 v31, 0xffff0000, v49
v_pk_add_f32 v[22:23], v[22:23], v[30:31]
v_lshlrev_b32 v28, 16, v50
v_and_b32 v29, 0xffff0000, v50
v_pk_add_f32 v[24:25], v[24:25], v[28:29]
v_lshlrev_b32 v30, 16, v51
v_and_b32 v31, 0xffff0000, v51
v_pk_add_f32 v[26:27], v[26:27], v[30:31]
s_waitcnt vmcnt(57)
v_lshlrev_b32 v28, 16, v52
v_and_b32 v29, 0xffff0000, v52
v_pk_add_f32 v[20:21], v[20:21], v[28:29]
v_lshlrev_b32 v30, 16, v53
v_and_b32 v31, 0xffff0000, v53
v_pk_add_f32 v[22:23], v[22:23], v[30:31]
v_lshlrev_b32 v28, 16, v54
v_and_b32 v29, 0xffff0000, v54
v_pk_add_f32 v[24:25], v[24:25], v[28:29]
v_lshlrev_b32 v30, 16, v55
v_and_b32 v31, 0xffff0000, v55
v_pk_add_f32 v[26:27], v[26:27], v[30:31]
s_waitcnt vmcnt(56)
v_lshlrev_b32 v28, 16, v56
v_and_b32 v29, 0xffff0000, v56
v_pk_add_f32 v[20:21], v[20:21], v[28:29]
v_lshlrev_b32 v30, 16, v57
v_and_b32 v31, 0xffff0000, v57
v_pk_add_f32 v[22:23], v[22:23], v[30:31]
v_lshlrev_b32 v28, 16, v58
v_and_b32 v29, 0xffff0000, v58
v_pk_add_f32 v[24:25], v[24:25], v[28:29]
v_lshlrev_b32 v30, 16, v59
v_and_b32 v31, 0xffff0000, v59
v_pk_add_f32 v[26:27], v[26:27], v[30:31]
s_waitcnt vmcnt(55)
v_lshlrev_b32 v28, 16, v60
v_and_b32 v29, 0xffff0000, v60
v_pk_add_f32 v[20:21], v[20:21], v[28:29]
v_lshlrev_b32 v30, 16, v61
v_and_b32 v31, 0xffff0000, v61
v_pk_add_f32 v[22:23], v[22:23], v[30:31]
v_lshlrev_b32 v28, 16, v62
v_and_b32 v29, 0xffff0000, v62
v_pk_add_f32 v[24:25], v[24:25], v[28:29]
v_lshlrev_b32 v30, 16, v63
v_and_b32 v31, 0xffff0000, v63
v_pk_add_f32 v[26:27], v[26:27], v[30:31]
s_waitcnt vmcnt(54)
v_lshlrev_b32 v28, 16, v64
v_and_b32 v29, 0xffff0000, v64
v_pk_add_f32 v[20:21], v[20:21], v[28:29]
v_lshlrev_b32 v30, 16, v65
v_and_b32 v31, 0xffff0000, v65
v_pk_add_f32 v[22:23], v[22:23], v[30:31]
v_lshlrev_b32 v28, 16, v66
v_and_b32 v29, 0xffff0000, v66
v_pk_add_f32 v[24:25], v[24:25], v[28:29]
v_lshlrev_b32 v30, 16, v67
v_and_b32 v31, 0xffff0000, v67
v_pk_add_f32 v[26:27], v[26:27], v[30:31]
s_waitcnt vmcnt(53)
v_lshlrev_b32 v28, 16, v68
v_and_b32 v29, 0xffff0000, v68
v_pk_add_f32 v[20:21], v[20:21], v[28:29]
v_lshlrev_b32 v30, 16, v69
v_and_b32 v31, 0xffff0000, v69
v_pk_add_f32 v[22:23], v[22:23], v[30:31]
v_lshlrev_b32 v28, 16, v70
v_and_b32 v29, 0xffff0000, v70
v_pk_add_f32 v[24:25], v[24:25], v[28:29]
v_lshlrev_b32 v30, 16, v71
v_and_b32 v31, 0xffff0000, v71
v_pk_add_f32 v[26:27], v[26:27], v[30:31]
s_waitcnt vmcnt(52)
v_lshlrev_b32 v28, 16, v72
v_and_b32 v29, 0xffff0000, v72
v_pk_add_f32 v[20:21], v[20:21], v[28:29]
v_lshlrev_b32 v30, 16, v73
v_and_b32 v31, 0xffff0000, v73
v_pk_add_f32 v[22:23], v[22:23], v[30:31]
v_lshlrev_b32 v28, 16, v74
v_and_b32 v29, 0xffff0000, v74
v_pk_add_f32 v[24:25], v[24:25], v[28:29]
v_lshlrev_b32 v30, 16, v75
v_and_b32 v31, 0xffff0000, v75
v_pk_add_f32 v[26:27], v[26:27], v[30:31]
s_waitcnt vmcnt(51)
v_lshlrev_b32 v28, 16, v76
v_and_b32 v29, 0xffff0000, v76
v_pk_add_f32 v[20:21], v[20:21], v[28:29]
v_lshlrev_b32 v30, 16, v77
v_and_b32 v31, 0xffff0000, v77
v_pk_add_f32 v[22:23], v[22:23], v[30:31]
v_lshlrev_b32 v28, 16, v78
v_and_b32 v29, 0xffff0000, v78
v_pk_add_f32 v[24:25], v[24:25], v[28:29]
v_lshlrev_b32 v30, 16, v79
v_and_b32 v31, 0xffff0000, v79
v_pk_add_f32 v[26:27], v[26:27], v[30:31]
s_waitcnt vmcnt(50)
v_lshlrev_b32 v28, 16, v80
v_and_b32 v29, 0xffff0000, v80
v_pk_add_f32 v[20:21], v[20:21], v[28:29]
v_lshlrev_b32 v30, 16, v81
v_and_b32 v31, 0xffff0000, v81
v_pk_add_f32 v[22:23], v[22:23], v[30:31]
v_lshlrev_b32 v28, 16, v82
v_and_b32 v29, 0xffff0000, v82
v_pk_add_f32 v[24:25], v[24:25], v[28:29]
v_lshlrev_b32 v30, 16, v83
v_and_b32 v31, 0xffff0000, v83
v_pk_add_f32 v[26:27], v[26:27], v[30:31]
s_waitcnt vmcnt(49)
v_lshlrev_b32 v28, 16, v84
v_and_b32 v29, 0xffff0000, v84
v_pk_add_f32 v[20:21], v[20:21], v[28:29]
v_lshlrev_b32 v30, 16, v85
v_and_b32 v31, 0xffff0000, v85
v_pk_add_f32 v[22:23], v[22:23], v[30:31]
v_lshlrev_b32 v28, 16, v86
v_and_b32 v29, 0xffff0000, v86
v_pk_add_f32 v[24:25], v[24:25], v[28:29]
v_lshlrev_b32 v30, 16, v87
v_and_b32 v31, 0xffff0000, v87
v_pk_add_f32 v[26:27], v[26:27], v[30:31]
s_waitcnt vmcnt(48)
v_lshlrev_b32 v28, 16, v88
v_and_b32 v29, 0xffff0000, v88
v_pk_add_f32 v[20:21], v[20:21], v[28:29]
v_lshlrev_b32 v30, 16, v89
v_and_b32 v31, 0xffff0000, v89
v_pk_add_f32 v[22:23], v[22:23], v[30:31]
v_lshlrev_b32 v28, 16, v90
v_and_b32 v29, 0xffff0000, v90
v_pk_add_f32 v[24:25], v[24:25], v[28:29]
v_lshlrev_b32 v30, 16, v91
v_and_b32 v31, 0xffff0000, v91
v_pk_add_f32 v[26:27], v[26:27], v[30:31]
s_waitcnt vmcnt(47)
v_lshlrev_b32 v28, 16, v92
v_and_b32 v29, 0xffff0000, v92
v_pk_add_f32 v[20:21], v[20:21], v[28:29]
v_lshlrev_b32 v30, 16, v93
v_and_b32 v31, 0xffff0000, v93
v_pk_add_f32 v[22:23], v[22:23], v[30:31]
v_lshlrev_b32 v28, 16, v94
v_and_b32 v29, 0xffff0000, v94
v_pk_add_f32 v[24:25], v[24:25], v[28:29]
v_lshlrev_b32 v30, 16, v95
v_and_b32 v31, 0xffff0000, v95
v_pk_add_f32 v[26:27], v[26:27], v[30:31]
s_waitcnt vmcnt(42)
v_lshlrev_b32 v12, 16, v96
v_and_b32 v13, 0xffff0000, v96
v_lshlrev_b32 v14, 16, v100
v_and_b32 v15, 0xffff0000, v100
v_sub_f32 v16, v12, v104
v_sub_f32 v17, v13, v104
v_cvt_pk_bf16_f32 v16, v16, v17
v_and_b32 v17, 0xffff0000, v16
v_lshlrev_b32 v16, 16, v16
v_mul_f32 v16, v16, v105
v_mul_f32 v17, v17, v105
v_cvt_pk_bf16_f32 v16, v16, v17
v_and_b32 v17, 0xffff0000, v16
v_lshlrev_b32 v16, 16, v16
v_mul_f32 v16, v16, v14
v_mul_f32 v17, v17, v15
v_cvt_pk_bf16_f32 v16, v16, v17
v_and_b32 v17, 0xffff0000, v16
v_lshlrev_b32 v16, 16, v16
v_add_f32 v16, v16, v12
v_add_f32 v17, v17, v13
v_fma_f32 v20, v20, s35, v16
v_fma_f32 v21, v21, s35, v17
v_lshlrev_b32 v12, 16, v97
v_and_b32 v13, 0xffff0000, v97
v_lshlrev_b32 v14, 16, v101
v_and_b32 v15, 0xffff0000, v101
v_sub_f32 v16, v12, v104
v_sub_f32 v17, v13, v104
v_cvt_pk_bf16_f32 v16, v16, v17
v_and_b32 v17, 0xffff0000, v16
v_lshlrev_b32 v16, 16, v16
v_mul_f32 v16, v16, v105
v_mul_f32 v17, v17, v105
v_cvt_pk_bf16_f32 v16, v16, v17
v_and_b32 v17, 0xffff0000, v16
v_lshlrev_b32 v16, 16, v16
v_mul_f32 v16, v16, v14
v_mul_f32 v17, v17, v15
v_cvt_pk_bf16_f32 v16, v16, v17
v_and_b32 v17, 0xffff0000, v16
v_lshlrev_b32 v16, 16, v16
v_add_f32 v16, v16, v12
v_add_f32 v17, v17, v13
v_fma_f32 v22, v22, s35, v16
v_fma_f32 v23, v23, s35, v17
v_lshlrev_b32 v12, 16, v98
v_and_b32 v13, 0xffff0000, v98
v_lshlrev_b32 v14, 16, v102
v_and_b32 v15, 0xffff0000, v102
v_sub_f32 v16, v12, v104
v_sub_f32 v17, v13, v104
v_cvt_pk_bf16_f32 v16, v16, v17
v_and_b32 v17, 0xffff0000, v16
v_lshlrev_b32 v16, 16, v16
v_mul_f32 v16, v16, v105
v_mul_f32 v17, v17, v105
v_cvt_pk_bf16_f32 v16, v16, v17
v_and_b32 v17, 0xffff0000, v16
v_lshlrev_b32 v16, 16, v16
v_mul_f32 v16, v16, v14
v_mul_f32 v17, v17, v15
v_cvt_pk_bf16_f32 v16, v16, v17
v_and_b32 v17, 0xffff0000, v16
v_lshlrev_b32 v16, 16, v16
v_add_f32 v16, v16, v12
v_add_f32 v17, v17, v13
v_fma_f32 v24, v24, s35, v16
v_fma_f32 v25, v25, s35, v17
v_lshlrev_b32 v12, 16, v99
v_and_b32 v13, 0xffff0000, v99
v_lshlrev_b32 v14, 16, v103
v_and_b32 v15, 0xffff0000, v103
v_sub_f32 v16, v12, v104
v_sub_f32 v17, v13, v104
v_cvt_pk_bf16_f32 v16, v16, v17
v_and_b32 v17, 0xffff0000, v16
v_lshlrev_b32 v16, 16, v16
v_mul_f32 v16, v16, v105
v_mul_f32 v17, v17, v105
v_cvt_pk_bf16_f32 v16, v16, v17
v_and_b32 v17, 0xffff0000, v16
v_lshlrev_b32 v16, 16, v16
v_mul_f32 v16, v16, v14
v_mul_f32 v17, v17, v15
v_cvt_pk_bf16_f32 v16, v16, v17
v_and_b32 v17, 0xffff0000, v16
v_lshlrev_b32 v16, 16, v16
v_add_f32 v16, v16, v12
v_add_f32 v17, v17, v13
v_fma_f32 v26, v26, s35, v16
v_fma_f32 v27, v27, s35, v17
buffer_store_dwordx4 v[20:23], v4, s[12:15], s66 offen
buffer_store_dwordx4 v[24:27], v4, s[12:15], s66 offen offset:64
L_tail_skip0:
s_bitcmp1_b32 s45, 1
s_cbranch_scc0 L_tail_skip1
s_waitcnt vmcnt(41)
v_lshlrev_b32 v20, 16, v106
v_and_b32 v21, 0xffff0000, v106
v_lshlrev_b32 v22, 16, v107
v_and_b32 v23, 0xffff0000, v107
v_lshlrev_b32 v24, 16, v108
v_and_b32 v25, 0xffff0000, v108
v_lshlrev_b32 v26, 16, v109
v_and_b32 v27, 0xffff0000, v109
s_waitcnt vmcnt(40)
v_lshlrev_b32 v28, 16, v110
v_and_b32 v29, 0xffff0000, v110
v_pk_add_f32 v[20:21], v[20:21], v[28:29]
v_lshlrev_b32 v30, 16, v111
v_and_b32 v31, 0xffff0000, v111
v_pk_add_f32 v[22:23], v[22:23], v[30:31]
v_lshlrev_b32 v28, 16, v112
v_and_b32 v29, 0xffff0000, v112
v_pk_add_f32 v[24:25], v[24:25], v[28:29]
v_lshlrev_b32 v30, 16, v113
v_and_b32 v31, 0xffff0000, v113
v_pk_add_f32 v[26:27], v[26:27], v[30:31]
s_waitcnt vmcnt(39)
v_lshlrev_b32 v28, 16, v114
v_and_b32 v29, 0xffff0000, v114
v_pk_add_f32 v[20:21], v[20:21], v[28:29]
v_lshlrev_b32 v30, 16, v115
v_and_b32 v31, 0xffff0000, v115
v_pk_add_f32 v[22:23], v[22:23], v[30:31]
v_lshlrev_b32 v28, 16, v116
v_and_b32 v29, 0xffff0000, v116
v_pk_add_f32 v[24:25], v[24:25], v[28:29]
v_lshlrev_b32 v30, 16, v117
v_and_b32 v31, 0xffff0000, v117
v_pk_add_f32 v[26:27], v[26:27], v[30:31]
s_waitcnt vmcnt(38)
v_lshlrev_b32 v28, 16, v118
v_and_b32 v29, 0xffff0000, v118
v_pk_add_f32 v[20:21], v[20:21], v[28:29]
v_lshlrev_b32 v30, 16, v119
v_and_b32 v31, 0xffff0000, v119
v_pk_add_f32 v[22:23], v[22:23], v[30:31]
v_lshlrev_b32 v28, 16, v120
v_and_b32 v29, 0xffff0000, v120
v_pk_add_f32 v[24:25], v[24:25], v[28:29]
v_lshlrev_b32 v30, 16, v121
v_and_b32 v31, 0xffff0000, v121
v_pk_add_f32 v[26:27], v[26:27], v[30:31]
s_waitcnt vmcnt(37)
v_lshlrev_b32 v28, 16, v122
v_and_b32 v29, 0xffff0000, v122
v_pk_add_f32 v[20:21], v[20:21], v[28:29]
v_lshlrev_b32 v30, 16, v123
v_and_b32 v31, 0xffff0000, v123
v_pk_add_f32 v[22:23], v[22:23], v[30:31]
v_lshlrev_b32 v28, 16, v124
v_and_b32 v29, 0xffff0000, v124
v_pk_add_f32 v[24:25], v[24:25], v[28:29]
v_lshlrev_b32 v30, 16, v125
v_and_b32 v31, 0xffff0000, v125
v_pk_add_f32 v[26:27], v[26:27], v[30:31]
s_waitcnt vmcnt(36)
v_lshlrev_b32 v28, 16, v126
v_and_b32 v29, 0xffff0000, v126
v_pk_add_f32 v[20:21], v[20:21], v[28:29]
v_lshlrev_b32 v30, 16, v127
v_and_b32 v31, 0xffff0000, v127
v_pk_add_f32 v[22:23], v[22:23], v[30:31]
v_lshlrev_b32 v28, 16, v128
v_and_b32 v29, 0xffff0000, v128
v_pk_add_f32 v[24:25], v[24:25], v[28:29]
v_lshlrev_b32 v30, 16, v129
v_and_b32 v31, 0xffff0000, v129
v_pk_add_f32 v[26:27], v[26:27], v[30:31]
s_waitcnt vmcnt(35)
v_lshlrev_b32 v28, 16, v130
v_and_b32 v29, 0xffff0000, v130
v_pk_add_f32 v[20:21], v[20:21], v[28:29]
v_lshlrev_b32 v30, 16, v131
v_and_b32 v31, 0xffff0000, v131
v_pk_add_f32 v[22:23], v[22:23], v[30:31]
v_lshlrev_b32 v28, 16, v132
v_and_b32 v29, 0xffff0000, v132
v_pk_add_f32 v[24:25], v[24:25], v[28:29]
v_lshlrev_b32 v30, 16, v133
v_and_b32 v31, 0xffff0000, v133
v_pk_add_f32 v[26:27], v[26:27], v[30:31]
s_waitcnt vmcnt(34)
v_lshlrev_b32 v28, 16, v134
v_and_b32 v29, 0xffff0000, v134
v_pk_add_f32 v[20:21], v[20:21], v[28:29]
v_lshlrev_b32 v30, 16, v135
v_and_b32 v31, 0xffff0000, v135
v_pk_add_f32 v[22:23], v[22:23], v[30:31]
v_lshlrev_b32 v28, 16, v136
v_and_b32 v29, 0xffff0000, v136
v_pk_add_f32 v[24:25], v[24:25], v[28:29]
v_lshlrev_b32 v30, 16, v137
v_and_b32 v31, 0xffff0000, v137
v_pk_add_f32 v[26:27], v[26:27], v[30:31]
s_waitcnt vmcnt(33)
v_lshlrev_b32 v28, 16, v138
v_and_b32 v29, 0xffff0000, v138
v_pk_add_f32 v[20:21], v[20:21], v[28:29]
v_lshlrev_b32 v30, 16, v139
v_and_b32 v31, 0xffff0000, v139
v_pk_add_f32 v[22:23], v[22:23], v[30:31]
v_lshlrev_b32 v28, 16, v140
v_and_b32 v29, 0xffff0000, v140
v_pk_add_f32 v[24:25], v[24:25], v[28:29]
v_lshlrev_b32 v30, 16, v141
v_and_b32 v31, 0xffff0000, v141
v_pk_add_f32 v[26:27], v[26:27], v[30:31]
s_waitcnt vmcnt(32)
v_lshlrev_b32 v28, 16, v142
v_and_b32 v29, 0xffff0000, v142
v_pk_add_f32 v[20:21], v[20:21], v[28:29]
v_lshlrev_b32 v30, 16, v143
v_and_b32 v31, 0xffff0000, v143
v_pk_add_f32 v[22:23], v[22:23], v[30:31]
v_lshlrev_b32 v28, 16, v144
v_and_b32 v29, 0xffff0000, v144
v_pk_add_f32 v[24:25], v[24:25], v[28:29]
v_lshlrev_b32 v30, 16, v145
v_and_b32 v31, 0xffff0000, v145
v_pk_add_f32 v[26:27], v[26:27], v[30:31]
s_waitcnt vmcnt(31)
v_lshlrev_b32 v28, 16, v146
v_and_b32 v29, 0xffff0000, v146
v_pk_add_f32 v[20:21], v[20:21], v[28:29]
v_lshlrev_b32 v30, 16, v147
v_and_b32 v31, 0xffff0000, v147
v_pk_add_f32 v[22:23], v[22:23], v[30:31]
v_lshlrev_b32 v28, 16, v148
v_and_b32 v29, 0xffff0000, v148
v_pk_add_f32 v[24:25], v[24:25], v[28:29]
v_lshlrev_b32 v30, 16, v149
v_and_b32 v31, 0xffff0000, v149
v_pk_add_f32 v[26:27], v[26:27], v[30:31]
s_waitcnt vmcnt(30)
v_lshlrev_b32 v28, 16, v150
v_and_b32 v29, 0xffff0000, v150
v_pk_add_f32 v[20:21], v[20:21], v[28:29]
v_lshlrev_b32 v30, 16, v151
v_and_b32 v31, 0xffff0000, v151
v_pk_add_f32 v[22:23], v[22:23], v[30:31]
v_lshlrev_b32 v28, 16, v152
v_and_b32 v29, 0xffff0000, v152
v_pk_add_f32 v[24:25], v[24:25], v[28:29]
v_lshlrev_b32 v30, 16, v153
v_and_b32 v31, 0xffff0000, v153
v_pk_add_f32 v[26:27], v[26:27], v[30:31]
s_waitcnt vmcnt(29)
v_lshlrev_b32 v28, 16, v154
v_and_b32 v29, 0xffff0000, v154
v_pk_add_f32 v[20:21], v[20:21], v[28:29]
v_lshlrev_b32 v30, 16, v155
v_and_b32 v31, 0xffff0000, v155
v_pk_add_f32 v[22:23], v[22:23], v[30:31]
v_lshlrev_b32 v28, 16, v156
v_and_b32 v29, 0xffff0000, v156
v_pk_add_f32 v[24:25], v[24:25], v[28:29]
v_lshlrev_b32 v30, 16, v157
v_and_b32 v31, 0xffff0000, v157
v_pk_add_f32 v[26:27], v[26:27], v[30:31]
s_waitcnt vmcnt(28)
v_lshlrev_b32 v28, 16, v158
v_and_b32 v29, 0xffff0000, v158
v_pk_add_f32 v[20:21], v[20:21], v[28:29]
v_lshlrev_b32 v30, 16, v159
v_and_b32 v31, 0xffff0000, v159
v_pk_add_f32 v[22:23], v[22:23], v[30:31]
v_lshlrev_b32 v28, 16, v160
v_and_b32 v29, 0xffff0000, v160
v_pk_add_f32 v[24:25], v[24:25], v[28:29]
v_lshlrev_b32 v30, 16, v161
v_and_b32 v31, 0xffff0000, v161
v_pk_add_f32 v[26:27], v[26:27], v[30:31]
s_waitcnt vmcnt(27)
v_lshlrev_b32 v28, 16, v162
v_and_b32 v29, 0xffff0000, v162
v_pk_add_f32 v[20:21], v[20:21], v[28:29]
v_lshlrev_b32 v30, 16, v163
v_and_b32 v31, 0xffff0000, v163
v_pk_add_f32 v[22:23], v[22:23], v[30:31]
v_lshlrev_b32 v28, 16, v164
v_and_b32 v29, 0xffff0000, v164
v_pk_add_f32 v[24:25], v[24:25], v[28:29]
v_lshlrev_b32 v30, 16, v165
v_and_b32 v31, 0xffff0000, v165
v_pk_add_f32 v[26:27], v[26:27], v[30:31]
s_waitcnt vmcnt(26)
v_lshlrev_b32 v28, 16, v166
v_and_b32 v29, 0xffff0000, v166
v_pk_add_f32 v[20:21], v[20:21], v[28:29]
v_lshlrev_b32 v30, 16, v167
v_and_b32 v31, 0xffff0000, v167
v_pk_add_f32 v[22:23], v[22:23], v[30:31]
v_lshlrev_b32 v28, 16, v168
v_and_b32 v29, 0xffff0000, v168
v_pk_add_f32 v[24:25], v[24:25], v[28:29]
v_lshlrev_b32 v30, 16, v169
v_and_b32 v31, 0xffff0000, v169
v_pk_add_f32 v[26:27], v[26:27], v[30:31]
s_waitcnt vmcnt(21)
v_lshlrev_b32 v12, 16, v170
v_and_b32 v13, 0xffff0000, v170
v_lshlrev_b32 v14, 16, v174
v_and_b32 v15, 0xffff0000, v174
v_sub_f32 v16, v12, v178
v_sub_f32 v17, v13, v178
v_cvt_pk_bf16_f32 v16, v16, v17
v_and_b32 v17, 0xffff0000, v16
v_lshlrev_b32 v16, 16, v16
v_mul_f32 v16, v16, v179
v_mul_f32 v17, v17, v179
v_cvt_pk_bf16_f32 v16, v16, v17
v_and_b32 v17, 0xffff0000, v16
v_lshlrev_b32 v16, 16, v16
v_mul_f32 v16, v16, v14
v_mul_f32 v17, v17, v15
v_cvt_pk_bf16_f32 v16, v16, v17
v_and_b32 v17, 0xffff0000, v16
v_lshlrev_b32 v16, 16, v16
v_add_f32 v16, v16, v12
v_add_f32 v17, v17, v13
v_fma_f32 v20, v20, s35, v16
v_fma_f32 v21, v21, s35, v17
v_lshlrev_b32 v12, 16, v171
v_and_b32 v13, 0xffff0000, v171
v_lshlrev_b32 v14, 16, v175
v_and_b32 v15, 0xffff0000, v175
v_sub_f32 v16, v12, v178
v_sub_f32 v17, v13, v178
v_cvt_pk_bf16_f32 v16, v16, v17
v_and_b32 v17, 0xffff0000, v16
v_lshlrev_b32 v16, 16, v16
v_mul_f32 v16, v16, v179
v_mul_f32 v17, v17, v179
v_cvt_pk_bf16_f32 v16, v16, v17
v_and_b32 v17, 0xffff0000, v16
v_lshlrev_b32 v16, 16, v16
v_mul_f32 v16, v16, v14
v_mul_f32 v17, v17, v15
v_cvt_pk_bf16_f32 v16, v16, v17
v_and_b32 v17, 0xffff0000, v16
v_lshlrev_b32 v16, 16, v16
v_add_f32 v16, v16, v12
v_add_f32 v17, v17, v13
v_fma_f32 v22, v22, s35, v16
v_fma_f32 v23, v23, s35, v17
v_lshlrev_b32 v12, 16, v172
v_and_b32 v13, 0xffff0000, v172
v_lshlrev_b32 v14, 16, v176
v_and_b32 v15, 0xffff0000, v176
v_sub_f32 v16, v12, v178
v_sub_f32 v17, v13, v178
v_cvt_pk_bf16_f32 v16, v16, v17
v_and_b32 v17, 0xffff0000, v16
v_lshlrev_b32 v16, 16, v16
v_mul_f32 v16, v16, v179
v_mul_f32 v17, v17, v179
v_cvt_pk_bf16_f32 v16, v16, v17
v_and_b32 v17, 0xffff0000, v16
v_lshlrev_b32 v16, 16, v16
v_mul_f32 v16, v16, v14
v_mul_f32 v17, v17, v15
v_cvt_pk_bf16_f32 v16, v16, v17
v_and_b32 v17, 0xffff0000, v16
v_lshlrev_b32 v16, 16, v16
v_add_f32 v16, v16, v12
v_add_f32 v17, v17, v13
v_fma_f32 v24, v24, s35, v16
v_fma_f32 v25, v25, s35, v17
v_lshlrev_b32 v12, 16, v173
v_and_b32 v13, 0xffff0000, v173
v_lshlrev_b32 v14, 16, v177
v_and_b32 v15, 0xffff0000, v177
v_sub_f32 v16, v12, v178
v_sub_f32 v17, v13, v178
v_cvt_pk_bf16_f32 v16, v16, v17
v_and_b32 v17, 0xffff0000, v16
v_lshlrev_b32 v16, 16, v16
v_mul_f32 v16, v16, v179
v_mul_f32 v17, v17, v179
v_cvt_pk_bf16_f32 v16, v16, v17
v_and_b32 v17, 0xffff0000, v16
v_lshlrev_b32 v16, 16, v16
v_mul_f32 v16, v16, v14
v_mul_f32 v17, v17, v15
v_cvt_pk_bf16_f32 v16, v16, v17
v_and_b32 v17, 0xffff0000, v16
v_lshlrev_b32 v16, 16, v16
v_add_f32 v16, v16, v12
v_add_f32 v17, v17, v13
v_fma_f32 v26, v26, s35, v16
v_fma_f32 v27, v27, s35, v17
buffer_store_dwordx4 v[20:23], v4, s[12:15], s67 offen
buffer_store_dwordx4 v[24:27], v4, s[12:15], s67 offen offset:64
L_tail_skip1:
s_bitcmp1_b32 s45, 2
s_cbranch_scc0 L_tail_skip2
s_waitcnt vmcnt(20)
v_lshlrev_b32 v20, 16, v180
v_and_b32 v21, 0xffff0000, v180
v_lshlrev_b32 v22, 16, v181
v_and_b32 v23, 0xffff0000, v181
v_lshlrev_b32 v24, 16, v182
v_and_b32 v25, 0xffff0000, v182
v_lshlrev_b32 v26, 16, v183
v_and_b32 v27, 0xffff0000, v183
s_waitcnt vmcnt(19)
v_lshlrev_b32 v28, 16, v184
v_and_b32 v29, 0xffff0000, v184
v_pk_add_f32 v[20:21], v[20:21], v[28:29]
v_lshlrev_b32 v30, 16, v185
v_and_b32 v31, 0xffff0000, v185
v_pk_add_f32 v[22:23], v[22:23], v[30:31]
v_lshlrev_b32 v28, 16, v186
v_and_b32 v29, 0xffff0000, v186
v_pk_add_f32 v[24:25], v[24:25], v[28:29]
v_lshlrev_b32 v30, 16, v187
v_and_b32 v31, 0xffff0000, v187
v_pk_add_f32 v[26:27], v[26:27], v[30:31]
s_waitcnt vmcnt(18)
v_lshlrev_b32 v28, 16, v188
v_and_b32 v29, 0xffff0000, v188
v_pk_add_f32 v[20:21], v[20:21], v[28:29]
v_lshlrev_b32 v30, 16, v189
v_and_b32 v31, 0xffff0000, v189
v_pk_add_f32 v[22:23], v[22:23], v[30:31]
v_lshlrev_b32 v28, 16, v190
v_and_b32 v29, 0xffff0000, v190
v_pk_add_f32 v[24:25], v[24:25], v[28:29]
v_lshlrev_b32 v30, 16, v191
v_and_b32 v31, 0xffff0000, v191
v_pk_add_f32 v[26:27], v[26:27], v[30:31]
s_waitcnt vmcnt(17)
v_lshlrev_b32 v28, 16, v192
v_and_b32 v29, 0xffff0000, v192
v_pk_add_f32 v[20:21], v[20:21], v[28:29]
v_lshlrev_b32 v30, 16, v193
v_and_b32 v31, 0xffff0000, v193
v_pk_add_f32 v[22:23], v[22:23], v[30:31]
v_lshlrev_b32 v28, 16, v194
v_and_b32 v29, 0xffff0000, v194
v_pk_add_f32 v[24:25], v[24:25], v[28:29]
v_lshlrev_b32 v30, 16, v195
v_and_b32 v31, 0xffff0000, v195
v_pk_add_f32 v[26:27], v[26:27], v[30:31]
s_waitcnt vmcnt(16)
v_lshlrev_b32 v28, 16, v196
v_and_b32 v29, 0xffff0000, v196
v_pk_add_f32 v[20:21], v[20:21], v[28:29]
v_lshlrev_b32 v30, 16, v197
v_and_b32 v31, 0xffff0000, v197
v_pk_add_f32 v[22:23], v[22:23], v[30:31]
v_lshlrev_b32 v28, 16, v198
v_and_b32 v29, 0xffff0000, v198
v_pk_add_f32 v[24:25], v[24:25], v[28:29]
v_lshlrev_b32 v30, 16, v199
v_and_b32 v31, 0xffff0000, v199
v_pk_add_f32 v[26:27], v[26:27], v[30:31]
s_waitcnt vmcnt(15)
v_lshlrev_b32 v28, 16, v200
v_and_b32 v29, 0xffff0000, v200
v_pk_add_f32 v[20:21], v[20:21], v[28:29]
v_lshlrev_b32 v30, 16, v201
v_and_b32 v31, 0xffff0000, v201
v_pk_add_f32 v[22:23], v[22:23], v[30:31]
v_lshlrev_b32 v28, 16, v202
v_and_b32 v29, 0xffff0000, v202
v_pk_add_f32 v[24:25], v[24:25], v[28:29]
v_lshlrev_b32 v30, 16, v203
v_and_b32 v31, 0xffff0000, v203
v_pk_add_f32 v[26:27], v[26:27], v[30:31]
s_waitcnt vmcnt(14)
v_lshlrev_b32 v28, 16, v204
v_and_b32 v29, 0xffff0000, v204
v_pk_add_f32 v[20:21], v[20:21], v[28:29]
v_lshlrev_b32 v30, 16, v205
v_and_b32 v31, 0xffff0000, v205
v_pk_add_f32 v[22:23], v[22:23], v[30:31]
v_lshlrev_b32 v28, 16, v206
v_and_b32 v29, 0xffff0000, v206
v_pk_add_f32 v[24:25], v[24:25], v[28:29]
v_lshlrev_b32 v30, 16, v207
v_and_b32 v31, 0xffff0000, v207
v_pk_add_f32 v[26:27], v[26:27], v[30:31]
s_waitcnt vmcnt(13)
v_lshlrev_b32 v28, 16, v208
v_and_b32 v29, 0xffff0000, v208
v_pk_add_f32 v[20:21], v[20:21], v[28:29]
v_lshlrev_b32 v30, 16, v209
v_and_b32 v31, 0xffff0000, v209
v_pk_add_f32 v[22:23], v[22:23], v[30:31]
v_lshlrev_b32 v28, 16, v210
v_and_b32 v29, 0xffff0000, v210
v_pk_add_f32 v[24:25], v[24:25], v[28:29]
v_lshlrev_b32 v30, 16, v211
v_and_b32 v31, 0xffff0000, v211
v_pk_add_f32 v[26:27], v[26:27], v[30:31]
s_waitcnt vmcnt(12)
v_lshlrev_b32 v28, 16, v212
v_and_b32 v29, 0xffff0000, v212
v_pk_add_f32 v[20:21], v[20:21], v[28:29]
v_lshlrev_b32 v30, 16, v213
v_and_b32 v31, 0xffff0000, v213
v_pk_add_f32 v[22:23], v[22:23], v[30:31]
v_lshlrev_b32 v28, 16, v214
v_and_b32 v29, 0xffff0000, v214
v_pk_add_f32 v[24:25], v[24:25], v[28:29]
v_lshlrev_b32 v30, 16, v215
v_and_b32 v31, 0xffff0000, v215
v_pk_add_f32 v[26:27], v[26:27], v[30:31]
s_waitcnt vmcnt(11)
v_lshlrev_b32 v28, 16, v216
v_and_b32 v29, 0xffff0000, v216
v_pk_add_f32 v[20:21], v[20:21], v[28:29]
v_lshlrev_b32 v30, 16, v217
v_and_b32 v31, 0xffff0000, v217
v_pk_add_f32 v[22:23], v[22:23], v[30:31]
v_lshlrev_b32 v28, 16, v218
v_and_b32 v29, 0xffff0000, v218
v_pk_add_f32 v[24:25], v[24:25], v[28:29]
v_lshlrev_b32 v30, 16, v219
v_and_b32 v31, 0xffff0000, v219
v_pk_add_f32 v[26:27], v[26:27], v[30:31]
s_waitcnt vmcnt(10)
v_lshlrev_b32 v28, 16, v220
v_and_b32 v29, 0xffff0000, v220
v_pk_add_f32 v[20:21], v[20:21], v[28:29]
v_lshlrev_b32 v30, 16, v221
v_and_b32 v31, 0xffff0000, v221
v_pk_add_f32 v[22:23], v[22:23], v[30:31]
v_lshlrev_b32 v28, 16, v222
v_and_b32 v29, 0xffff0000, v222
v_pk_add_f32 v[24:25], v[24:25], v[28:29]
v_lshlrev_b32 v30, 16, v223
v_and_b32 v31, 0xffff0000, v223
v_pk_add_f32 v[26:27], v[26:27], v[30:31]
s_waitcnt vmcnt(9)
v_lshlrev_b32 v28, 16, v224
v_and_b32 v29, 0xffff0000, v224
v_pk_add_f32 v[20:21], v[20:21], v[28:29]
v_lshlrev_b32 v30, 16, v225
v_and_b32 v31, 0xffff0000, v225
v_pk_add_f32 v[22:23], v[22:23], v[30:31]
v_lshlrev_b32 v28, 16, v226
v_and_b32 v29, 0xffff0000, v226
v_pk_add_f32 v[24:25], v[24:25], v[28:29]
v_lshlrev_b32 v30, 16, v227
v_and_b32 v31, 0xffff0000, v227
v_pk_add_f32 v[26:27], v[26:27], v[30:31]
s_waitcnt vmcnt(8)
v_lshlrev_b32 v28, 16, v228
v_and_b32 v29, 0xffff0000, v228
v_pk_add_f32 v[20:21], v[20:21], v[28:29]
v_lshlrev_b32 v30, 16, v229
v_and_b32 v31, 0xffff0000, v229
v_pk_add_f32 v[22:23], v[22:23], v[30:31]
v_lshlrev_b32 v28, 16, v230
v_and_b32 v29, 0xffff0000, v230
v_pk_add_f32 v[24:25], v[24:25], v[28:29]
v_lshlrev_b32 v30, 16, v231
v_and_b32 v31, 0xffff0000, v231
v_pk_add_f32 v[26:27], v[26:27], v[30:31]
s_waitcnt vmcnt(7)
v_lshlrev_b32 v28, 16, v232
v_and_b32 v29, 0xffff0000, v232
v_pk_add_f32 v[20:21], v[20:21], v[28:29]
v_lshlrev_b32 v30, 16, v233
v_and_b32 v31, 0xffff0000, v233
v_pk_add_f32 v[22:23], v[22:23], v[30:31]
v_lshlrev_b32 v28, 16, v234
v_and_b32 v29, 0xffff0000, v234
v_pk_add_f32 v[24:25], v[24:25], v[28:29]
v_lshlrev_b32 v30, 16, v235
v_and_b32 v31, 0xffff0000, v235
v_pk_add_f32 v[26:27], v[26:27], v[30:31]
s_waitcnt vmcnt(6)
v_lshlrev_b32 v28, 16, v236
v_and_b32 v29, 0xffff0000, v236
v_pk_add_f32 v[20:21], v[20:21], v[28:29]
v_lshlrev_b32 v30, 16, v237
v_and_b32 v31, 0xffff0000, v237
v_pk_add_f32 v[22:23], v[22:23], v[30:31]
v_lshlrev_b32 v28, 16, v238
v_and_b32 v29, 0xffff0000, v238
v_pk_add_f32 v[24:25], v[24:25], v[28:29]
v_lshlrev_b32 v30, 16, v239
v_and_b32 v31, 0xffff0000, v239
v_pk_add_f32 v[26:27], v[26:27], v[30:31]
s_waitcnt vmcnt(5)
v_lshlrev_b32 v28, 16, v240
v_and_b32 v29, 0xffff0000, v240
v_pk_add_f32 v[20:21], v[20:21], v[28:29]
v_lshlrev_b32 v30, 16, v241
v_and_b32 v31, 0xffff0000, v241
v_pk_add_f32 v[22:23], v[22:23], v[30:31]
v_lshlrev_b32 v28, 16, v242
v_and_b32 v29, 0xffff0000, v242
v_pk_add_f32 v[24:25], v[24:25], v[28:29]
v_lshlrev_b32 v30, 16, v243
v_and_b32 v31, 0xffff0000, v243
v_pk_add_f32 v[26:27], v[26:27], v[30:31]
s_waitcnt vmcnt(0)
v_lshlrev_b32 v12, 16, v244
v_and_b32 v13, 0xffff0000, v244
v_lshlrev_b32 v14, 16, v248
v_and_b32 v15, 0xffff0000, v248
v_sub_f32 v16, v12, v252
v_sub_f32 v17, v13, v252
v_cvt_pk_bf16_f32 v16, v16, v17
v_and_b32 v17, 0xffff0000, v16
v_lshlrev_b32 v16, 16, v16
v_mul_f32 v16, v16, v253
v_mul_f32 v17, v17, v253
v_cvt_pk_bf16_f32 v16, v16, v17
v_and_b32 v17, 0xffff0000, v16
v_lshlrev_b32 v16, 16, v16
v_mul_f32 v16, v16, v14
v_mul_f32 v17, v17, v15
v_cvt_pk_bf16_f32 v16, v16, v17
v_and_b32 v17, 0xffff0000, v16
v_lshlrev_b32 v16, 16, v16
v_add_f32 v16, v16, v12
v_add_f32 v17, v17, v13
v_fma_f32 v20, v20, s35, v16
v_fma_f32 v21, v21, s35, v17
v_lshlrev_b32 v12, 16, v245
v_and_b32 v13, 0xffff0000, v245
v_lshlrev_b32 v14, 16, v249
v_and_b32 v15, 0xffff0000, v249
v_sub_f32 v16, v12, v252
v_sub_f32 v17, v13, v252
v_cvt_pk_bf16_f32 v16, v16, v17
v_and_b32 v17, 0xffff0000, v16
v_lshlrev_b32 v16, 16, v16
v_mul_f32 v16, v16, v253
v_mul_f32 v17, v17, v253
v_cvt_pk_bf16_f32 v16, v16, v17
v_and_b32 v17, 0xffff0000, v16
v_lshlrev_b32 v16, 16, v16
v_mul_f32 v16, v16, v14
v_mul_f32 v17, v17, v15
v_cvt_pk_bf16_f32 v16, v16, v17
v_and_b32 v17, 0xffff0000, v16
v_lshlrev_b32 v16, 16, v16
v_add_f32 v16, v16, v12
v_add_f32 v17, v17, v13
v_fma_f32 v22, v22, s35, v16
v_fma_f32 v23, v23, s35, v17
v_lshlrev_b32 v12, 16, v246
v_and_b32 v13, 0xffff0000, v246
v_lshlrev_b32 v14, 16, v250
v_and_b32 v15, 0xffff0000, v250
v_sub_f32 v16, v12, v252
v_sub_f32 v17, v13, v252
v_cvt_pk_bf16_f32 v16, v16, v17
v_and_b32 v17, 0xffff0000, v16
v_lshlrev_b32 v16, 16, v16
v_mul_f32 v16, v16, v253
v_mul_f32 v17, v17, v253
v_cvt_pk_bf16_f32 v16, v16, v17
v_and_b32 v17, 0xffff0000, v16
v_lshlrev_b32 v16, 16, v16
v_mul_f32 v16, v16, v14
v_mul_f32 v17, v17, v15
v_cvt_pk_bf16_f32 v16, v16, v17
v_and_b32 v17, 0xffff0000, v16
v_lshlrev_b32 v16, 16, v16
v_add_f32 v16, v16, v12
v_add_f32 v17, v17, v13
v_fma_f32 v24, v24, s35, v16
v_fma_f32 v25, v25, s35, v17
v_lshlrev_b32 v12, 16, v247
v_and_b32 v13, 0xffff0000, v247
v_lshlrev_b32 v14, 16, v251
v_and_b32 v15, 0xffff0000, v251
v_sub_f32 v16, v12, v252
v_sub_f32 v17, v13, v252
v_cvt_pk_bf16_f32 v16, v16, v17
v_and_b32 v17, 0xffff0000, v16
v_lshlrev_b32 v16, 16, v16
v_mul_f32 v16, v16, v253
v_mul_f32 v17, v17, v253
v_cvt_pk_bf16_f32 v16, v16, v17
v_and_b32 v17, 0xffff0000, v16
v_lshlrev_b32 v16, 16, v16
v_mul_f32 v16, v16, v14
v_mul_f32 v17, v17, v15
v_cvt_pk_bf16_f32 v16, v16, v17
v_and_b32 v17, 0xffff0000, v16
v_lshlrev_b32 v16, 16, v16
v_add_f32 v16, v16, v12
v_add_f32 v17, v17, v13
v_fma_f32 v26, v26, s35, v16
v_fma_f32 v27, v27, s35, v17
buffer_store_dwordx4 v[20:23], v4, s[12:15], s68 offen
buffer_store_dwordx4 v[24:27], v4, s[12:15], s68 offen offset:64
L_tail_skip2:
s_cmp_lg_u32 s33, 0
s_cbranch_scc1 L_tail_loop
s_mov_b32 s56, s59
s_mov_b32 s57, s60
s_mov_b32 s58, s61
s_mov_b32 s59, -1
s_mov_b64 s[60:61], -1
s_branch L_tail_pass
L_tail_end:
s_endpgm
L_code_end:
.section .rodata,"a"
.p2align 6
.amdhsa_kernel parallel_sum__ssm_conv_s5__glu_gated_swiglu__prompt_kernel
  .amdhsa_next_free_vgpr 512
  .amdhsa_next_free_sgpr 102
  .amdhsa_accum_offset 256
  .amdhsa_group_segment_fixed_size 0
  .amdhsa_kernarg_size 128
  .amdhsa_user_sgpr_count 2
  .amdhsa_user_sgpr_kernarg_segment_ptr 1
  .amdhsa_system_sgpr_workgroup_id_x 1
  .amdhsa_float_denorm_mode_32 3
.end_amdhsa_kernel
```
